```python
import torch

def _softmax(x, axis=-1):
    return torch.softmax(x, dim=axis)
def _gelu(x):
    return torch.nn.functional.gelu(x, approximate="tanh")
def _silu(x):
    return torch.nn.functional.silu(x)
def _sigmoid(x):
    return torch.sigmoid(x)
def _layernorm(x, axis=-1, eps=1e-5):
    m = x.mean(dim=axis, keepdim=True)
    v = x.var(dim=axis, keepdim=True, unbiased=False)
    return (x - m) / torch.sqrt(v + eps)
def _scatter_add(tgt, idx, src, axis=0):
    return tgt.clone().index_add_(axis, idx, src)
def _segment_sum(src, seg, n):
    out = torch.zeros((n,) + src.shape[1:], dtype=src.dtype)
    return out.index_add_(0, seg, src)
def _pad(x, pw):
    flat = tuple(v for pair in reversed(pw) for v in pair)
    return torch.nn.functional.pad(x, flat)

kernel_name = 'sequential_preLN__mha_block__glu_gated_glu__prompt'

def setup_inputs():

    _w = (lambda a: (lambda t: t.to(torch.bfloat16) if t.is_floating_point() else t)(torch.as_tensor(a)))
    def _A_setup():
        B, S, D, H = 1, 2048, 1024, 32
        return {
            "x": _w((lambda *s: torch.randn(*s, dtype=torch.bfloat16) * 0.05)(B, S, D)),
            "wqkv": _w((lambda *s: torch.randn(*s, dtype=torch.bfloat16) * 0.05)(D, 3 * D)),
            "wo": _w((lambda *s: torch.randn(*s, dtype=torch.bfloat16) * 0.05)(D, D)),
        }
    _A_in = _A_setup()

    def _B_setup():
        B, S, D, F = 1, 2048, 1024, 3584
        return {
            "x": _w((lambda *s: torch.randn(*s, dtype=torch.bfloat16) * 0.05)(B, S, D)),
            "w_gate": _w((lambda *s: torch.randn(*s, dtype=torch.bfloat16) * 0.05)(D, F)),
            "w_up": _w((lambda *s: torch.randn(*s, dtype=torch.bfloat16) * 0.05)(D, F)),
            "w_down": _w((lambda *s: torch.randn(*s, dtype=torch.bfloat16) * 0.05)(F, D)),
        }
    _B_in = _B_setup()

    return {
        "A_x": _A_in["x"],
        "A_wqkv": _A_in["wqkv"],
        "A_wo": _A_in["wo"],
        "B_x": _B_in["x"],
        "B_w_gate": _B_in["w_gate"],
        "B_w_up": _B_in["w_up"],
        "B_w_down": _B_in["w_down"],
    }

def reference(A_x, A_wqkv, A_wo, B_x, B_w_gate, B_w_up, B_w_down):
    def _A_ref(x, wqkv, wo):
        B, S, D = x.shape
        H = 32
        Dh = D // H
        qkv = (lambda x, *d: x.permute(*d))((x @ wqkv).reshape(B, S, 3, H, Dh), 2, 0, 3, 1, 4)
        q, k, v = qkv[0], qkv[1], qkv[2]
        scores = torch.einsum("bhqd,bhkd->bhqk", q, k) * (Dh ** -0.5)
        p = _softmax(scores, axis=-1)
        o = torch.einsum("bhqk,bhkd->bhqd", p, v)
        return (lambda x, *d: x.permute(*d))(o, 0, 2, 1, 3).reshape(B, S, D) @ wo

    def _B_ref(x, w_gate, w_up, w_down):
        g = torch.einsum("bsd,df->bsf", x, w_gate)
        u = torch.einsum("bsd,df->bsf", x, w_up)
        h = _sigmoid(g) * u
        return torch.einsum("bsf,fd->bsd", h, w_down)

    x = A_x
    h = x + _A_ref(_layernorm(x, axis=-1), A_wqkv, A_wo)
    h2 = h + _B_ref(_layernorm(h, axis=-1), B_w_gate, B_w_up, B_w_down)
    return h2
```

```asm
; @launch kernel=qkv_kernel grid=(256,1,1) block=(512,1,1) lds=163840
; @launch kernel=attn_kernel grid=(256,1,1) block=(768,1,1) lds=163840
; @launch kernel=mlp_kernel grid=(256,1,1) block=(256,1,1) lds=163840
.amdgcn_target "amdgcn-amd-amdhsa--gfx950"
.text
.globl qkv_kernel
.p2align 8
.type qkv_kernel,@function
qkv_kernel:
qkv_kernel_beg:
    s_load_dwordx4 s[32:35], s[0:1], 0
    s_load_dwordx4 s[28:31], s[0:1], 64
    s_cmp_ge_u32 s2, 256
    s_cbranch_scc1 qkv_kernel_done
    v_lshrrev_b32 v104, 6, v0
    v_and_b32 v99, 63, v0
    v_readfirstlane_b32 s51, v104
    s_and_b32 s44, s2, 7
    s_lshr_b32 s45, s2, 3
    s_lshr_b32 s22, s44, 2
    s_lshl_b32 s22, s22, 3
    s_lshr_b32 s46, s45, 2
    s_add_u32 s22, s22, s46
    s_and_b32 s23, s44, 3
    s_lshl_b32 s23, s23, 2
    s_and_b32 s46, s45, 3
    s_add_u32 s23, s23, s46
    s_and_b32 s21, s51, 3
    s_lshl_b32 s24, s22, 2
    s_add_u32 s24, s24, s21
    s_mov_b32 s52, s23
    s_add_u32 s53, s23, 5
    s_and_b32 s53, s53, 15
    s_add_u32 s54, s23, 10
    s_and_b32 s54, s54, 15
    s_lshl_b32 s25, s21, 12
    s_add_u32 s25, s25, 98304
    s_cmp_ge_u32 s51, 4
    s_cbranch_scc1 qkv_kernel_compute
    v_lshrrev_b32 v104, 3, v99
    v_and_b32 v105, 7, v99
    v_lshrrev_b32 v106, 4, v99
    v_xor_b32 v106, v105, v106
    v_lshlrev_b32 v107, 11, v104
    v_lshl_add_u32 v6, v106, 4, v107
    v_xor_b32 v106, 64, v6
    v_add_u32 v7, 15360, v106
    v_add_u32 v8, 30720, v6
    v_add_u32 v9, 46080, v106
    v_bfe_u32 v106, v99, 4, 1
    v_lshlrev_b32 v106, 2, v106
    v_xor_b32 v106, v105, v106
    v_mul_u32_u24 v107, 6144, v104
    v_lshl_add_u32 v107, v106, 4, v107
    s_mul_i32 s46, s21, 98304
    v_add_u32 v107, s46, v107
    s_lshl_b32 s47, s52, 7
    v_add_u32 v0, s47, v107
    v_add_u32 v1, 48128, v0
    s_lshl_b32 s47, s53, 7
    s_add_u32 s47, s47, 2048
    v_add_u32 v2, s47, v107
    v_add_u32 v3, 48128, v2
    s_lshl_b32 s47, s54, 7
    s_add_u32 s47, s47, 4096
    v_add_u32 v4, s47, v107
    v_add_u32 v5, 48128, v4
    s_lshl_b32 s18, s21, 11
    s_lshl_b32 s48, s24, 16
    s_add_u32 s27, s22, s23
    s_and_b32 s27, s27, 15
    s_lshl_b32 s16, s27, 7
    s_mul_i32 s17, s27, 393216
    s_mul_i32 s3, s44, 0
    s_sub_u32 s27, s27, s3
    s_and_b32 s27, s27, 15
    s_setprio 3
    s_waitcnt lgkmcnt(0)
    s_mov_b32 s4, s32
    s_mov_b32 s5, s33
    s_add_u32 s4, s4, s48
    s_addc_u32 s5, s5, 0
    s_mov_b32 s6, 65536
    s_mov_b32 s7, 0x20000
    s_mov_b32 s12, s34
    s_mov_b32 s13, s35
    s_mov_b32 s14, 6291456
    s_mov_b32 s15, 0x20000
    s_add_u32 m0, s25, 0
    s_nop 0
    buffer_load_dwordx4 v6, s[4:7], s16 offen offset:0 lds
    buffer_load_dwordx4 v7, s[4:7], s16 offen offset:1024 lds
    buffer_load_dwordx4 v8, s[4:7], s16 offen offset:2048 lds
    buffer_load_dwordx4 v9, s[4:7], s16 offen offset:3072 lds
    s_add_u32 m0, s18, 16384
    s_nop 0
    buffer_load_dwordx4 v4, s[12:15], s17 offen offset:0 lds
    buffer_load_dwordx4 v5, s[12:15], s17 offen offset:1024 lds
    s_add_u32 m0, s18, 8192
    s_nop 0
    buffer_load_dwordx4 v2, s[12:15], s17 offen offset:0 lds
    buffer_load_dwordx4 v3, s[12:15], s17 offen offset:1024 lds
    s_add_u32 m0, s18, 0
    s_nop 0
    buffer_load_dwordx4 v0, s[12:15], s17 offen offset:0 lds
    buffer_load_dwordx4 v1, s[12:15], s17 offen offset:1024 lds
    s_mov_b32 s56, s28
    s_mov_b32 s57, s29
    s_mov_b32 s58, 256
    s_mov_b32 s59, 0x20000
    v_mov_b32 v117, 0
    s_or_b32 s49, s2, s21
    s_cmp_lg_u32 s49, 0
    s_cbranch_scc1 qkv_kernel_nononce
    s_memrealtime s[46:47]
    s_waitcnt lgkmcnt(0)
    s_or_b32 s46, s46, 1
    v_mov_b32 v112, s46
    v_mov_b32 v113, s47
    s_mov_b64 exec, 1
    buffer_store_dwordx2 v[112:113], v117, s[56:59], 0 offen sc1
    s_mov_b64 exec, -1
qkv_kernel_nononce:
    s_getpc_b64 s[92:93]
.Lpc1:
    s_add_u32 s92, s92, qkv_kernel_pc0-.Lpc1
    s_addc_u32 s93, s93, 0
    s_mov_b32 s94, qkv_kernel_end-qkv_kernel_pc0
    s_mov_b32 s95, 0x20000
    v_lshlrev_b32 v118, 7, v99
    s_lshl_b32 s50, s21, 13
    buffer_load_dword v119, v118, s[92:95], s50 offen
qkv_kernel_pc0:
    s_add_u32 m0, s25, 16384
    s_mov_b32 s26, 0
    s_cmp_eq_u32 s26, s27
    s_addc_u32 s26, s26, 0
    s_add_u32 s17, s26, s3
    s_and_b32 s17, s17, 15
    s_lshl_b32 s16, s17, 7
    s_mul_i32 s17, s17, 393216
    buffer_load_dwordx4 v6, s[4:7], s16 offen offset:0 lds
    buffer_load_dwordx4 v7, s[4:7], s16 offen offset:1024 lds
    buffer_load_dwordx4 v8, s[4:7], s16 offen offset:2048 lds
    buffer_load_dwordx4 v9, s[4:7], s16 offen offset:3072 lds
    s_add_u32 m0, s18, 40960
    s_nop 0
    buffer_load_dwordx4 v4, s[12:15], s17 offen offset:0 lds
    buffer_load_dwordx4 v5, s[12:15], s17 offen offset:1024 lds
    s_add_u32 m0, s18, 32768
    s_nop 0
    buffer_load_dwordx4 v2, s[12:15], s17 offen offset:0 lds
    buffer_load_dwordx4 v3, s[12:15], s17 offen offset:1024 lds
    s_add_u32 m0, s18, 24576
    s_nop 0
    buffer_load_dwordx4 v0, s[12:15], s17 offen offset:0 lds
    buffer_load_dwordx4 v1, s[12:15], s17 offen offset:1024 lds
    s_mov_b32 s47, s25
    s_mov_b32 s19, 0xffff0000
    s_and_b32 s20, s21, 1
    v_lshlrev_b32 v98, 4, v99
    v_bfe_u32 v104, v99, 2, 2
    v_lshrrev_b32 v105, 5, v99
    v_lshl_add_u32 v107, v105, 3, v104
    v_lshlrev_b32 v107, 7, v107
    v_and_b32 v106, 3, v99
    v_lshl_add_u32 v107, v106, 3, v107
    v_bfe_u32 v106, v99, 4, 1
    v_lshl_add_u32 v107, v106, 5, v107
    v_bfe_u32 v106, v99, 3, 1
    v_lshl_add_u32 v107, v106, 6, v107
    s_lshl_b32 s46, s20, 6
    v_xor_b32 v96, s46, v107
    v_add_u32 v97, 49152, v96
    v_and_b32 v104, 31, v99
    v_bfe_u32 v106, v99, 1, 3
    v_xor_b32 v106, v106, v105
    v_lshlrev_b32 v107, 7, v104
    v_lshl_add_u32 v107, v106, 4, v107
    v_add_u32 v100, s47, v107
    v_xor_b32 v101, 32, v100
    v_xor_b32 v102, 64, v100
    v_xor_b32 v103, 96, v100
    v_lshrrev_b32 v104, 4, v99
    v_xor_b32 v104, v104, v99
    v_and_b32 v104, 1, v104
    v_bfe_u32 v106, v99, 1, 3
    v_lshl_add_u32 v104, v104, 3, v106
    v_mov_b32 v106, 0x3f803f80
    v_mov_b32 v12, 0
    v_mov_b32 v13, 0
    v_mov_b32 v14, 0
    v_mov_b32 v15, 0
    v_cmp_eq_u32 vcc, 0, v104
    s_nop 1
    v_cndmask_b32 v32, 0, v106, vcc
    v_cndmask_b32 v33, 0, v106, vcc
    v_cndmask_b32 v34, 0, v106, vcc
    v_cndmask_b32 v35, 0, v106, vcc
    v_cmp_eq_u32 vcc, 1, v104
    s_nop 1
    v_cndmask_b32 v36, 0, v106, vcc
    v_cndmask_b32 v37, 0, v106, vcc
    v_cndmask_b32 v38, 0, v106, vcc
    v_cndmask_b32 v39, 0, v106, vcc
    v_cmp_eq_u32 vcc, 2, v104
    s_nop 1
    v_cndmask_b32 v40, 0, v106, vcc
    v_cndmask_b32 v41, 0, v106, vcc
    v_cndmask_b32 v42, 0, v106, vcc
    v_cndmask_b32 v43, 0, v106, vcc
    s_add_u32 s40, s30, 1048576
    s_addc_u32 s41, s31, 0
    s_mov_b32 s42, 262144
    s_mov_b32 s43, 0x20000
    s_add_u32 s36, s30, 1310720
    s_addc_u32 s37, s31, 0
    s_mov_b32 s38, 196608
    s_mov_b32 s39, 0x20000
    s_add_u32 s8, s30, 1572864
    s_addc_u32 s9, s31, 0
    s_mov_b32 s10, 131072
    s_mov_b32 s11, 0x20000
    s_waitcnt vmcnt(11)
    s_barrier
    s_add_u32 m0, s25, 32768
    s_add_u32 s26, s26, 1
    s_cmp_eq_u32 s26, s27
    s_addc_u32 s26, s26, 0
    s_add_u32 s17, s26, s3
    s_and_b32 s17, s17, 15
    s_lshl_b32 s16, s17, 7
    s_mul_i32 s17, s17, 393216
    buffer_load_dwordx4 v6, s[4:7], s16 offen offset:0 lds
    buffer_load_dwordx4 v7, s[4:7], s16 offen offset:1024 lds
    ds_read_b128 v[16:19], v100
    ds_read_b128 v[20:23], v101
    buffer_load_dwordx4 v8, s[4:7], s16 offen offset:2048 lds
    ds_read_b128 v[24:27], v102
    ds_read_b128 v[28:31], v103
    buffer_load_dwordx4 v9, s[4:7], s16 offen offset:3072 lds
    ds_read_b64_tr_b16 v[48:49], v96 offset:0
    ds_read_b64_tr_b16 v[50:51], v96 offset:512
    s_add_u32 m0, s18, 65536
    s_nop 0
    buffer_load_dwordx4 v4, s[12:15], s17 offen offset:0 lds
    ds_read_b64_tr_b16 v[52:53], v96 offset:2048
    ds_read_b64_tr_b16 v[54:55], v96 offset:2560
    buffer_load_dwordx4 v5, s[12:15], s17 offen offset:1024 lds
    ds_read_b64_tr_b16 v[56:57], v96 offset:4096
    ds_read_b64_tr_b16 v[58:59], v96 offset:4608
    s_add_u32 m0, s18, 57344
    s_nop 0
    buffer_load_dwordx4 v2, s[12:15], s17 offen offset:0 lds
    ds_read_b64_tr_b16 v[60:61], v96 offset:6144
    ds_read_b64_tr_b16 v[62:63], v96 offset:6656
    buffer_load_dwordx4 v3, s[12:15], s17 offen offset:1024 lds
    s_add_u32 m0, s18, 49152
    s_nop 0
    buffer_load_dwordx4 v0, s[12:15], s17 offen offset:0 lds
    buffer_load_dwordx4 v1, s[12:15], s17 offen offset:1024 lds
    s_waitcnt vmcnt(10)
    s_barrier
    s_add_u32 m0, s25, 49152
    s_add_u32 s26, s26, 1
    s_cmp_eq_u32 s26, s27
    s_addc_u32 s26, s26, 0
    s_add_u32 s17, s26, s3
    s_and_b32 s17, s17, 15
    s_lshl_b32 s16, s17, 7
    s_mul_i32 s17, s17, 393216
    buffer_load_dwordx4 v6, s[4:7], s16 offen offset:0 lds
    buffer_load_dwordx4 v7, s[4:7], s16 offen offset:1024 lds
    ds_read_b64_tr_b16 v[64:65], v96 offset:8192
    ds_read_b64_tr_b16 v[66:67], v96 offset:8704
    ds_read_b64_tr_b16 v[68:69], v96 offset:10240
    ds_read_b64_tr_b16 v[70:71], v96 offset:10752
    ds_read_b64_tr_b16 v[72:73], v96 offset:12288
    buffer_load_dwordx4 v8, s[4:7], s16 offen offset:2048 lds
    ds_read_b64_tr_b16 v[74:75], v96 offset:12800
    ds_read_b64_tr_b16 v[76:77], v96 offset:14336
    ds_read_b64_tr_b16 v[78:79], v96 offset:14848
    ds_read_b64_tr_b16 v[80:81], v96 offset:16384
    ds_read_b64_tr_b16 v[82:83], v96 offset:16896
    buffer_load_dwordx4 v9, s[4:7], s16 offen offset:3072 lds
    ds_read_b64_tr_b16 v[84:85], v96 offset:18432
    ds_read_b64_tr_b16 v[86:87], v96 offset:18944
    ds_read_b64_tr_b16 v[88:89], v96 offset:20480
    ds_read_b64_tr_b16 v[90:91], v96 offset:20992
    ds_read_b64_tr_b16 v[92:93], v96 offset:22528
    s_add_u32 m0, s18, 90112
    s_nop 0
    buffer_load_dwordx4 v4, s[12:15], s17 offen offset:0 lds
    ds_read_b64_tr_b16 v[94:95], v96 offset:23040
    buffer_load_dwordx2 v[112:113], v117, s[56:59], 0 offen sc1
    s_waitcnt lgkmcnt(15)
    v_lshlrev_b32 v104, 16, v16
    v_and_b32 v105, s19, v16
    buffer_load_dwordx4 v5, s[12:15], s17 offen offset:1024 lds
    v_add_f32 v12, v12, v104
    v_fmac_f32 v13, v104, v104
    v_add_f32 v14, v14, v105
    v_fmac_f32 v15, v105, v105
    v_lshlrev_b32 v104, 16, v17
    s_add_u32 m0, s18, 81920
    s_nop 0
    buffer_load_dwordx4 v2, s[12:15], s17 offen offset:0 lds
    v_and_b32 v105, s19, v17
    v_add_f32 v12, v12, v104
    v_fmac_f32 v13, v104, v104
    v_add_f32 v14, v14, v105
    v_fmac_f32 v15, v105, v105
    buffer_load_dwordx4 v3, s[12:15], s17 offen offset:1024 lds
    v_lshlrev_b32 v104, 16, v18
    v_and_b32 v105, s19, v18
    v_add_f32 v12, v12, v104
    v_fmac_f32 v13, v104, v104
    v_add_f32 v14, v14, v105
    s_add_u32 m0, s18, 73728
    s_nop 0
    buffer_load_dwordx4 v0, s[12:15], s17 offen offset:0 lds
    v_fmac_f32 v15, v105, v105
    v_lshlrev_b32 v104, 16, v19
    v_and_b32 v105, s19, v19
    v_add_f32 v12, v12, v104
    v_fmac_f32 v13, v104, v104
    buffer_load_dwordx4 v1, s[12:15], s17 offen offset:1024 lds
    v_add_f32 v14, v14, v105
    v_fmac_f32 v15, v105, v105
    s_waitcnt vmcnt(11) lgkmcnt(0)
    s_barrier
    s_add_u32 m0, s25, 0
    s_add_u32 s26, s26, 1
    s_cmp_eq_u32 s26, s27
    s_addc_u32 s26, s26, 0
    s_add_u32 s17, s26, s3
    s_and_b32 s17, s17, 15
    s_lshl_b32 s16, s17, 7
    s_mul_i32 s17, s17, 393216
    buffer_load_dwordx4 v6, s[4:7], s16 offen offset:0 lds
    buffer_load_dwordx4 v7, s[4:7], s16 offen offset:1024 lds
    v_lshlrev_b32 v104, 16, v20
    v_and_b32 v105, s19, v20
    v_add_f32 v12, v12, v104
    v_fmac_f32 v13, v104, v104
    v_add_f32 v14, v14, v105
    buffer_load_dwordx4 v8, s[4:7], s16 offen offset:2048 lds
    v_fmac_f32 v15, v105, v105
    v_lshlrev_b32 v104, 16, v21
    v_and_b32 v105, s19, v21
    v_add_f32 v12, v12, v104
    v_fmac_f32 v13, v104, v104
    v_add_f32 v14, v14, v105
    buffer_load_dwordx4 v9, s[4:7], s16 offen offset:3072 lds
    v_fmac_f32 v15, v105, v105
    v_lshlrev_b32 v104, 16, v22
    v_and_b32 v105, s19, v22
    v_add_f32 v12, v12, v104
    v_fmac_f32 v13, v104, v104
    v_add_f32 v14, v14, v105
    s_add_u32 m0, s18, 16384
    s_nop 0
    buffer_load_dwordx4 v4, s[12:15], s17 offen offset:0 lds
    v_fmac_f32 v15, v105, v105
    v_lshlrev_b32 v104, 16, v23
    v_and_b32 v105, s19, v23
    v_add_f32 v12, v12, v104
    v_fmac_f32 v13, v104, v104
    v_add_f32 v14, v14, v105
    buffer_load_dwordx4 v5, s[12:15], s17 offen offset:1024 lds
    v_fmac_f32 v15, v105, v105
    v_lshlrev_b32 v104, 16, v24
    v_and_b32 v105, s19, v24
    v_add_f32 v12, v12, v104
    v_fmac_f32 v13, v104, v104
    s_add_u32 m0, s18, 8192
    s_nop 0
    buffer_load_dwordx4 v2, s[12:15], s17 offen offset:0 lds
    v_add_f32 v14, v14, v105
    v_fmac_f32 v15, v105, v105
    v_lshlrev_b32 v104, 16, v25
    v_and_b32 v105, s19, v25
    v_add_f32 v12, v12, v104
    v_fmac_f32 v13, v104, v104
    buffer_load_dwordx4 v3, s[12:15], s17 offen offset:1024 lds
    v_add_f32 v14, v14, v105
    v_fmac_f32 v15, v105, v105
    v_lshlrev_b32 v104, 16, v26
    v_and_b32 v105, s19, v26
    v_add_f32 v12, v12, v104
    v_fmac_f32 v13, v104, v104
    s_add_u32 m0, s18, 0
    s_nop 0
    buffer_load_dwordx4 v0, s[12:15], s17 offen offset:0 lds
    v_add_f32 v14, v14, v105
    v_fmac_f32 v15, v105, v105
    v_lshlrev_b32 v104, 16, v27
    v_and_b32 v105, s19, v27
    v_add_f32 v12, v12, v104
    v_fmac_f32 v13, v104, v104
    buffer_load_dwordx4 v1, s[12:15], s17 offen offset:1024 lds
    v_add_f32 v14, v14, v105
    v_fmac_f32 v15, v105, v105
    s_waitcnt vmcnt(10)
    s_barrier
    s_add_u32 m0, s25, 16384
    s_add_u32 s26, s26, 1
    s_cmp_eq_u32 s26, s27
    s_addc_u32 s26, s26, 0
    s_add_u32 s17, s26, s3
    s_and_b32 s17, s17, 15
    s_lshl_b32 s16, s17, 7
    s_mul_i32 s17, s17, 393216
    buffer_load_dwordx4 v6, s[4:7], s16 offen offset:0 lds
    buffer_load_dwordx4 v7, s[4:7], s16 offen offset:1024 lds
    v_lshlrev_b32 v104, 16, v28
    v_and_b32 v105, s19, v28
    v_add_f32 v12, v12, v104
    v_fmac_f32 v13, v104, v104
    v_add_f32 v14, v14, v105
    v_fmac_f32 v15, v105, v105
    buffer_load_dwordx4 v8, s[4:7], s16 offen offset:2048 lds
    v_lshlrev_b32 v104, 16, v29
    v_and_b32 v105, s19, v29
    v_add_f32 v12, v12, v104
    v_fmac_f32 v13, v104, v104
    v_add_f32 v14, v14, v105
    v_fmac_f32 v15, v105, v105
    v_lshlrev_b32 v104, 16, v30
    buffer_load_dwordx4 v9, s[4:7], s16 offen offset:3072 lds
    v_and_b32 v105, s19, v30
    v_add_f32 v12, v12, v104
    v_fmac_f32 v13, v104, v104
    v_add_f32 v14, v14, v105
    v_fmac_f32 v15, v105, v105
    v_lshlrev_b32 v104, 16, v31
    v_and_b32 v105, s19, v31
    s_add_u32 m0, s18, 40960
    s_nop 0
    buffer_load_dwordx4 v4, s[12:15], s17 offen offset:0 lds
    v_add_f32 v12, v12, v104
    v_fmac_f32 v13, v104, v104
    v_add_f32 v14, v14, v105
    v_fmac_f32 v15, v105, v105
    v_mfma_f32_16x16x32_bf16 v[44:47], v[48:51], v[32:35], 0
    v_mfma_f32_16x16x32_bf16 v[44:47], v[52:55], v[32:35], v[44:47]
    v_mfma_f32_16x16x32_bf16 v[44:47], v[56:59], v[32:35], v[44:47]
    buffer_load_dwordx4 v5, s[12:15], s17 offen offset:1024 lds
    v_mfma_f32_16x16x32_bf16 v[44:47], v[60:63], v[32:35], v[44:47]
    v_mfma_f32_16x16x32_bf16 v[44:47], v[64:67], v[36:39], v[44:47]
    v_mfma_f32_16x16x32_bf16 v[44:47], v[68:71], v[36:39], v[44:47]
    v_mfma_f32_16x16x32_bf16 v[44:47], v[72:75], v[36:39], v[44:47]
    v_mfma_f32_16x16x32_bf16 v[44:47], v[76:79], v[36:39], v[44:47]
    v_mfma_f32_16x16x32_bf16 v[44:47], v[80:83], v[40:43], v[44:47]
    v_mfma_f32_16x16x32_bf16 v[44:47], v[84:87], v[40:43], v[44:47]
    s_add_u32 m0, s18, 32768
    s_nop 0
    buffer_load_dwordx4 v2, s[12:15], s17 offen offset:0 lds
    v_mfma_f32_16x16x32_bf16 v[44:47], v[88:91], v[40:43], v[44:47]
    v_mfma_f32_16x16x32_bf16 v[44:47], v[92:95], v[40:43], v[44:47]
    v_add_f32 v12, v12, v14
    v_add_f32 v13, v13, v15
    v_mov_b32 v104, v12
    v_mov_b32 v105, v13
    v_lshlrev_b32 v109, 3, v99
    buffer_load_dwordx4 v3, s[12:15], s17 offen offset:1024 lds
    v_and_b32 v108, 15, v99
    v_permlane32_swap_b32 v12, v104
    v_permlane32_swap_b32 v13, v105
    s_lshl_b32 s46, s24, 12
    s_lshl_b32 s47, s23, 8
    s_add_u32 s46, s46, s47
    v_add_f32 v104, v12, v104
    s_add_u32 m0, s18, 24576
    s_nop 0
    buffer_load_dwordx4 v0, s[12:15], s17 offen offset:0 lds
    v_add_f32 v105, v13, v105
    v_lshlrev_b32 v108, 6, v108
    v_and_b32 v110, 48, v99
    v_mov_b32_dpp v106, v104 quad_perm:[1,1,3,3] row_mask:0xf bank_mask:0xf
    v_mov_b32_dpp v107, v105 quad_perm:[1,1,3,3] row_mask:0xf bank_mask:0xf
    v_add_u32 v108, v108, v110
    s_mov_b32 exec_lo, 0x55555555
    s_mov_b32 exec_hi, 0
    buffer_store_dwordx4 v[104:107], v109, s[40:43], s46 offen sc1
    s_mov_b64 exec, -1
    buffer_load_dwordx4 v1, s[12:15], s17 offen offset:1024 lds
    s_mul_i32 s46, s22, 12288
    s_mul_i32 s47, s23, 768
    s_add_u32 s46, s46, s47
    s_mul_i32 s47, s20, 384
    s_add_u32 s46, s46, s47
    s_mov_b32 exec_lo, 0x003f003f
    s_mov_b32 exec_hi, 0x003f003f
    buffer_store_dwordx4 v[44:47], v108, s[36:39], s46 offen sc1
    s_mov_b64 exec, -1
    s_waitcnt vmcnt(12)
    s_barrier
    s_add_u32 m0, s25, 32768
    s_add_u32 s26, s26, 1
    s_cmp_eq_u32 s26, s27
    s_addc_u32 s26, s26, 0
    s_add_u32 s17, s26, s3
    s_and_b32 s17, s17, 15
    s_lshl_b32 s16, s17, 7
    s_mul_i32 s17, s17, 393216
    buffer_load_dwordx4 v6, s[4:7], s16 offen offset:0 lds
    buffer_load_dwordx4 v7, s[4:7], s16 offen offset:1024 lds
    v_cmp_eq_u32 vcc, 0, v112
    s_nop 1
    s_cmp_eq_u64 vcc, 0
    s_cbranch_scc0 qkv_kernel_polln_slow
qkv_kernel_polln_go:
    buffer_load_dwordx4 v8, s[4:7], s16 offen offset:2048 lds
    v_and_b32 v110, 15, v99
    s_lshl_b32 s48, s22, 4
    buffer_load_dwordx4 v9, s[4:7], s16 offen offset:3072 lds
    v_add_u32 v111, s48, v110
    v_lshlrev_b32 v110, 4, v110
    s_add_u32 m0, s18, 65536
    s_nop 0
    buffer_load_dwordx4 v4, s[12:15], s17 offen offset:0 lds
    v_add_u32 v110, s23, v110
    v_and_b32 v114, 16, v99
    buffer_load_dwordx4 v5, s[12:15], s17 offen offset:1024 lds
    v_cmp_eq_u32 vcc, 0, v114
    s_add_u32 s48, s48, s23
    s_add_u32 m0, s18, 57344
    s_nop 0
    buffer_load_dwordx4 v2, s[12:15], s17 offen offset:0 lds
    s_lshl_b32 s48, s48, 7
    v_cndmask_b32 v116, v110, v111, vcc
    buffer_load_dwordx4 v3, s[12:15], s17 offen offset:1024 lds
    v_lshlrev_b32 v116, 7, v116
    s_add_u32 m0, s18, 49152
    s_nop 0
    buffer_load_dwordx4 v0, s[12:15], s17 offen offset:0 lds
    buffer_load_dwordx4 v1, s[12:15], s17 offen offset:1024 lds
    s_waitcnt vmcnt(10)
    s_barrier
    s_add_u32 m0, s25, 49152
    s_cmp_lg_u32 s21, 0
    s_cbranch_scc1 qkv_kernel_nosig
    s_mov_b64 exec, 1
    buffer_store_dwordx2 v[112:113], v117, s[8:11], s48 offen sc1
    s_mov_b64 exec, -1
qkv_kernel_nosig:
    s_add_u32 s26, s26, 1
    s_cmp_eq_u32 s26, s27
    s_addc_u32 s26, s26, 0
    s_add_u32 s17, s26, s3
    s_and_b32 s17, s17, 15
    s_lshl_b32 s16, s17, 7
    s_mul_i32 s17, s17, 393216
    buffer_load_dwordx4 v6, s[4:7], s16 offen offset:0 lds
    buffer_load_dwordx4 v7, s[4:7], s16 offen offset:1024 lds
    buffer_load_dwordx4 v8, s[4:7], s16 offen offset:2048 lds
    buffer_load_dwordx4 v9, s[4:7], s16 offen offset:3072 lds
    s_add_u32 m0, s18, 90112
    s_nop 0
    buffer_load_dwordx4 v4, s[12:15], s17 offen offset:0 lds
    buffer_load_dwordx4 v5, s[12:15], s17 offen offset:1024 lds
    s_add_u32 m0, s18, 81920
    s_nop 0
    buffer_load_dwordx4 v2, s[12:15], s17 offen offset:0 lds
    buffer_load_dwordx4 v3, s[12:15], s17 offen offset:1024 lds
    s_add_u32 m0, s18, 73728
    s_nop 0
    buffer_load_dwordx4 v0, s[12:15], s17 offen offset:0 lds
    buffer_load_dwordx4 v1, s[12:15], s17 offen offset:1024 lds
    s_waitcnt vmcnt(10)
    s_barrier
    s_add_u32 m0, s25, 0
    s_add_u32 s26, s26, 1
    s_cmp_eq_u32 s26, s27
    s_addc_u32 s26, s26, 0
    s_add_u32 s17, s26, s3
    s_and_b32 s17, s17, 15
    s_lshl_b32 s16, s17, 7
    s_mul_i32 s17, s17, 393216
    buffer_load_dwordx4 v6, s[4:7], s16 offen offset:0 lds
    buffer_load_dwordx4 v7, s[4:7], s16 offen offset:1024 lds
    v_mov_b32 v48, 0
    buffer_load_dwordx4 v8, s[4:7], s16 offen offset:2048 lds
    v_mov_b32 v49, 0
    buffer_load_dwordx4 v9, s[4:7], s16 offen offset:3072 lds
    v_mov_b32 v50, 0
    s_add_u32 m0, s18, 16384
    s_nop 0
    buffer_load_dwordx4 v4, s[12:15], s17 offen offset:0 lds
    v_mov_b32 v51, 0
    buffer_load_dwordx4 v5, s[12:15], s17 offen offset:1024 lds
    v_lshlrev_b32 v110, 15, v99
    s_add_u32 m0, s18, 8192
    s_nop 0
    buffer_load_dwordx4 v2, s[12:15], s17 offen offset:0 lds
    s_lshl_b32 s49, s2, 7
    buffer_load_dwordx4 v3, s[12:15], s17 offen offset:1024 lds
    s_add_u32 s49, s49, 32768
    s_add_u32 m0, s18, 0
    s_nop 0
    buffer_load_dwordx4 v0, s[12:15], s17 offen offset:0 lds
    s_cmp_lg_u32 s21, 1
    s_cbranch_scc1 qkv_kernel_noreset
    s_mov_b64 exec, 7
    buffer_store_dwordx4 v[48:51], v110, s[8:11], s49 offen sc1
    s_mov_b64 exec, -1
qkv_kernel_noreset:
    buffer_load_dwordx4 v1, s[12:15], s17 offen offset:1024 lds
    s_waitcnt vmcnt(10)
    s_barrier
    s_add_u32 m0, s25, 16384
    s_add_u32 s26, s26, 1
    s_cmp_eq_u32 s26, s27
    s_addc_u32 s26, s26, 0
    s_add_u32 s17, s26, s3
    s_and_b32 s17, s17, 15
    s_lshl_b32 s16, s17, 7
    s_mul_i32 s17, s17, 393216
    buffer_load_dwordx4 v6, s[4:7], s16 offen offset:0 lds
    buffer_load_dwordx4 v7, s[4:7], s16 offen offset:1024 lds
    buffer_load_dwordx4 v8, s[4:7], s16 offen offset:2048 lds
    buffer_load_dwordx4 v9, s[4:7], s16 offen offset:3072 lds
    s_add_u32 m0, s18, 40960
    s_nop 0
    buffer_load_dwordx4 v4, s[12:15], s17 offen offset:0 lds
    buffer_load_dwordx4 v5, s[12:15], s17 offen offset:1024 lds
    s_add_u32 m0, s18, 32768
    s_nop 0
    buffer_load_dwordx4 v2, s[12:15], s17 offen offset:0 lds
    buffer_load_dwordx4 v3, s[12:15], s17 offen offset:1024 lds
    s_add_u32 m0, s18, 24576
    s_nop 0
    buffer_load_dwordx4 v0, s[12:15], s17 offen offset:0 lds
    buffer_load_dwordx4 v1, s[12:15], s17 offen offset:1024 lds
    s_waitcnt vmcnt(10)
    s_barrier
    s_add_u32 m0, s25, 32768
    s_add_u32 s26, s26, 1
    s_cmp_eq_u32 s26, s27
    s_addc_u32 s26, s26, 0
    s_add_u32 s17, s26, s3
    s_and_b32 s17, s17, 15
    s_lshl_b32 s16, s17, 7
    s_mul_i32 s17, s17, 393216
    buffer_load_dwordx4 v6, s[4:7], s16 offen offset:0 lds
    buffer_load_dwordx4 v7, s[4:7], s16 offen offset:1024 lds
    v_lshrrev_b32 v107, 4, v99
    v_mul_u32_u24 v104, 49152, v107
    v_and_b32 v106, 15, v99
    buffer_load_dwordx4 v8, s[4:7], s16 offen offset:2048 lds
    v_lshl_add_u32 v104, v106, 4, v104
    s_lshl_b32 s46, s24, 12
    s_min_u32 s49, s21, 2
    buffer_load_dwordx4 v9, s[4:7], s16 offen offset:3072 lds
    s_mul_i32 s47, s23, 768
    s_lshl_b32 s50, s49, 8
    s_add_u32 s47, s47, s50
    s_add_u32 m0, s18, 65536
    s_nop 0
    buffer_load_dwordx4 v4, s[12:15], s17 offen offset:0 lds
    v_and_b32 v107, 1, v107
    v_lshl_add_u32 v108, v106, 1, v107
    v_lshlrev_b32 v109, 4, v108
    buffer_load_dwordx4 v5, s[12:15], s17 offen offset:1024 lds
    v_lshlrev_b32 v108, 2, v108
    s_lshl_b32 s50, s21, 7
    v_add_u32 v108, s50, v108
    s_add_u32 m0, s18, 57344
    s_nop 0
    buffer_load_dwordx4 v2, s[12:15], s17 offen offset:0 lds
    s_lshl_b32 s50, s21, 9
    v_add_u32 v110, s50, v109
    s_lshl_b32 s50, s49, 10
    buffer_load_dwordx4 v3, s[12:15], s17 offen offset:1024 lds
    v_lshlrev_b32 v106, 6, v106
    v_add_u32 v106, s50, v106
    s_add_u32 m0, s18, 49152
    s_nop 0
    buffer_load_dwordx4 v0, s[12:15], s17 offen offset:0 lds
    buffer_load_dwordx4 v1, s[12:15], s17 offen offset:1024 lds
    s_waitcnt vmcnt(10)
    s_barrier
    s_add_u32 m0, s25, 49152
    buffer_load_dwordx2 v[114:115], v116, s[8:11], 0 offen sc1
    s_add_u32 s26, s26, 1
    s_cmp_eq_u32 s26, s27
    s_addc_u32 s26, s26, 0
    s_add_u32 s17, s26, s3
    s_and_b32 s17, s17, 15
    s_lshl_b32 s16, s17, 7
    s_mul_i32 s17, s17, 393216
    buffer_load_dwordx4 v6, s[4:7], s16 offen offset:0 lds
    buffer_load_dwordx4 v7, s[4:7], s16 offen offset:1024 lds
    buffer_load_dwordx4 v8, s[4:7], s16 offen offset:2048 lds
    buffer_load_dwordx4 v9, s[4:7], s16 offen offset:3072 lds
    s_add_u32 m0, s18, 90112
    s_nop 0
    buffer_load_dwordx4 v4, s[12:15], s17 offen offset:0 lds
    buffer_load_dwordx4 v5, s[12:15], s17 offen offset:1024 lds
    s_add_u32 m0, s18, 81920
    s_nop 0
    buffer_load_dwordx4 v2, s[12:15], s17 offen offset:0 lds
    buffer_load_dwordx4 v3, s[12:15], s17 offen offset:1024 lds
    s_add_u32 m0, s18, 73728
    s_nop 0
    buffer_load_dwordx4 v0, s[12:15], s17 offen offset:0 lds
    buffer_load_dwordx4 v1, s[12:15], s17 offen offset:1024 lds
    s_waitcnt vmcnt(10)
    v_cmp_eq_u64 vcc, v[112:113], v[114:115]
    s_nop 1
    s_cmp_eq_u64 vcc, -1
    s_cbranch_scc0 qkv_kernel_pollf_slow
qkv_kernel_pollf_go:
    s_barrier
    s_add_u32 m0, s25, 0
    s_add_u32 s26, s26, 1
    s_cmp_eq_u32 s26, s27
    s_addc_u32 s26, s26, 0
    s_add_u32 s17, s26, s3
    s_and_b32 s17, s17, 15
    s_lshl_b32 s16, s17, 7
    s_mul_i32 s17, s17, 393216
    buffer_load_dwordx4 v6, s[4:7], s16 offen offset:0 lds
    buffer_load_dwordx4 v7, s[4:7], s16 offen offset:1024 lds
    buffer_load_dwordx4 v[16:19], v98, s[40:43], s46 offen offset:0 sc1
    buffer_load_dwordx4 v8, s[4:7], s16 offen offset:2048 lds
    buffer_load_dwordx4 v[20:23], v98, s[40:43], s46 offen offset:1024 sc1
    buffer_load_dwordx4 v9, s[4:7], s16 offen offset:3072 lds
    buffer_load_dwordx4 v[24:27], v98, s[40:43], s46 offen offset:2048 sc1
    s_add_u32 m0, s18, 16384
    s_nop 0
    buffer_load_dwordx4 v4, s[12:15], s17 offen offset:0 lds
    buffer_load_dwordx4 v[28:31], v98, s[40:43], s46 offen offset:3072 sc1
    buffer_load_dwordx4 v5, s[12:15], s17 offen offset:1024 lds
    buffer_load_dwordx4 v[32:35], v104, s[36:39], s47 offen sc1
    s_add_u32 m0, s18, 8192
    s_nop 0
    buffer_load_dwordx4 v2, s[12:15], s17 offen offset:0 lds
    s_add_u32 s47, s47, 12288
    buffer_load_dwordx4 v[36:39], v104, s[36:39], s47 offen sc1
    buffer_load_dwordx4 v3, s[12:15], s17 offen offset:1024 lds
    s_add_u32 s47, s47, 12288
    buffer_load_dwordx4 v[40:43], v104, s[36:39], s47 offen sc1
    s_add_u32 m0, s18, 0
    s_nop 0
    buffer_load_dwordx4 v0, s[12:15], s17 offen offset:0 lds
    s_add_u32 s47, s47, 12288
    buffer_load_dwordx4 v[44:47], v104, s[36:39], s47 offen sc1
    buffer_load_dwordx4 v1, s[12:15], s17 offen offset:1024 lds
    s_waitcnt vmcnt(18)
    s_barrier
    s_add_u32 m0, s25, 16384
    s_add_u32 s26, s26, 1
    s_cmp_eq_u32 s26, s27
    s_addc_u32 s26, s26, 0
    s_add_u32 s17, s26, s3
    s_and_b32 s17, s17, 15
    s_lshl_b32 s16, s17, 7
    s_mul_i32 s17, s17, 393216
    buffer_load_dwordx4 v6, s[4:7], s16 offen offset:0 lds
    buffer_load_dwordx4 v7, s[4:7], s16 offen offset:1024 lds
    buffer_load_dwordx4 v8, s[4:7], s16 offen offset:2048 lds
    buffer_load_dwordx4 v9, s[4:7], s16 offen offset:3072 lds
    s_add_u32 m0, s18, 40960
    s_nop 0
    buffer_load_dwordx4 v4, s[12:15], s17 offen offset:0 lds
    buffer_load_dwordx4 v5, s[12:15], s17 offen offset:1024 lds
    s_add_u32 m0, s18, 32768
    s_nop 0
    buffer_load_dwordx4 v2, s[12:15], s17 offen offset:0 lds
    buffer_load_dwordx4 v3, s[12:15], s17 offen offset:1024 lds
    s_add_u32 m0, s18, 24576
    s_nop 0
    buffer_load_dwordx4 v0, s[12:15], s17 offen offset:0 lds
    buffer_load_dwordx4 v1, s[12:15], s17 offen offset:1024 lds
    s_waitcnt vmcnt(10)
    s_barrier
    s_add_u32 m0, s25, 32768
    s_add_u32 s26, s26, 1
    s_cmp_eq_u32 s26, s27
    s_addc_u32 s26, s26, 0
    s_add_u32 s17, s26, s3
    s_and_b32 s17, s17, 15
    s_lshl_b32 s16, s17, 7
    s_mul_i32 s17, s17, 393216
    buffer_load_dwordx4 v6, s[4:7], s16 offen offset:0 lds
    buffer_load_dwordx4 v7, s[4:7], s16 offen offset:1024 lds
    v_add_f32 v16, v16, v20
    v_add_f32 v17, v17, v21
    v_add_f32 v18, v18, v22
    v_add_f32 v19, v19, v23
    v_add_f32 v16, v16, v24
    v_add_f32 v17, v17, v25
    v_add_f32 v18, v18, v26
    buffer_load_dwordx4 v8, s[4:7], s16 offen offset:2048 lds
    v_add_f32 v19, v19, v27
    v_add_f32 v16, v16, v28
    v_add_f32 v17, v17, v29
    v_add_f32 v18, v18, v30
    v_add_f32 v19, v19, v31
    v_mov_b32 v20, v16
    v_mov_b32 v21, v17
    v_mov_b32 v22, v18
    buffer_load_dwordx4 v9, s[4:7], s16 offen offset:3072 lds
    v_mov_b32 v23, v19
    s_nop 0
    v_permlane16_swap_b32 v16, v20
    v_permlane16_swap_b32 v17, v21
    v_permlane16_swap_b32 v18, v22
    v_permlane16_swap_b32 v19, v23
    v_add_f32 v16, v16, v20
    v_add_f32 v17, v17, v21
    s_add_u32 m0, s18, 65536
    s_nop 0
    buffer_load_dwordx4 v4, s[12:15], s17 offen offset:0 lds
    v_add_f32 v18, v18, v22
    v_add_f32 v19, v19, v23
    v_mov_b32 v20, v16
    v_mov_b32 v21, v17
    v_mov_b32 v22, v18
    v_mov_b32 v23, v19
    s_nop 0
    v_permlane32_swap_b32 v16, v20
    buffer_load_dwordx4 v5, s[12:15], s17 offen offset:1024 lds
    v_permlane32_swap_b32 v17, v21
    v_permlane32_swap_b32 v18, v22
    v_permlane32_swap_b32 v19, v23
    v_add_f32 v16, v16, v20
    v_add_f32 v17, v17, v21
    v_add_f32 v18, v18, v22
    v_add_f32 v19, v19, v23
    v_cmp_eq_u32 vcc, 1, v107
    s_add_u32 m0, s18, 57344
    s_nop 0
    buffer_load_dwordx4 v2, s[12:15], s17 offen offset:0 lds
    s_nop 1
    v_cndmask_b32 v16, v16, v18, vcc
    v_cndmask_b32 v17, v17, v19, vcc
    v_mul_f32 v16, 0xba800000, v16
    v_mul_f32 v17, 0x3a800000, v17
    v_fma_f32 v17, -v16, v16, v17
    v_max_f32 v17, 0, v17
    v_cvt_pk_bf16_f32 v17, v17, v17
    buffer_load_dwordx4 v3, s[12:15], s17 offen offset:1024 lds
    v_and_b32 v17, s19, v17
    v_add_f32 v17, 0x3727c5ac, v17
    v_cvt_pk_bf16_f32 v17, v17, v17
    v_and_b32 v17, s19, v17
    v_sqrt_f32 v17, v17
    s_nop 0
    v_cvt_pk_bf16_f32 v24, v17, v17
    v_and_b32 v24, s19, v24
    s_add_u32 m0, s18, 49152
    s_nop 0
    buffer_load_dwordx4 v0, s[12:15], s17 offen offset:0 lds
    v_rcp_f32 v13, v24
    v_cvt_pk_bf16_f32 v20, v16, v16
    v_and_b32 v20, s19, v20
    v_sub_f32 v21, v16, v20
    v_cvt_pk_bf16_f32 v22, v21, v21
    v_and_b32 v22, s19, v22
    v_sub_f32 v23, v21, v22
    v_cvt_pk_bf16_f32 v12, v20, v22
    buffer_load_dwordx4 v1, s[12:15], s17 offen offset:1024 lds
    v_cvt_pk_bf16_f32 v14, v20, v23
    v_mul_f32 v15, 0x3e8293ee, v13
    s_waitcnt vmcnt(10)
    s_barrier
    s_add_u32 m0, s25, 49152
    s_add_u32 s26, s26, 1
    s_cmp_eq_u32 s26, s27
    s_addc_u32 s26, s26, 0
    s_add_u32 s17, s26, s3
    s_and_b32 s17, s17, 15
    s_lshl_b32 s16, s17, 7
    s_mul_i32 s17, s17, 393216
    buffer_load_dwordx4 v6, s[4:7], s16 offen offset:0 lds
    buffer_load_dwordx4 v7, s[4:7], s16 offen offset:1024 lds
    v_add_f32 v32, v32, v36
    v_add_f32 v33, v33, v37
    v_add_f32 v34, v34, v38
    v_add_f32 v35, v35, v39
    v_add_f32 v32, v32, v40
    v_add_f32 v33, v33, v41
    v_add_f32 v34, v34, v42
    v_add_f32 v35, v35, v43
    buffer_load_dwordx4 v8, s[4:7], s16 offen offset:2048 lds
    v_add_f32 v32, v32, v44
    v_add_f32 v33, v33, v45
    v_add_f32 v34, v34, v46
    v_add_f32 v35, v35, v47
    v_mov_b32 v36, v32
    v_mov_b32 v37, v33
    v_mov_b32 v38, v34
    v_mov_b32 v39, v35
    s_nop 0
    buffer_load_dwordx4 v9, s[4:7], s16 offen offset:3072 lds
    v_permlane16_swap_b32 v32, v36
    v_permlane16_swap_b32 v33, v37
    v_permlane16_swap_b32 v34, v38
    v_permlane16_swap_b32 v35, v39
    v_add_f32 v32, v32, v36
    v_add_f32 v33, v33, v37
    v_add_f32 v34, v34, v38
    v_add_f32 v35, v35, v39
    v_mov_b32 v36, v32
    s_add_u32 m0, s18, 90112
    s_nop 0
    buffer_load_dwordx4 v4, s[12:15], s17 offen offset:0 lds
    v_mov_b32 v37, v33
    v_mov_b32 v38, v34
    v_mov_b32 v39, v35
    s_nop 0
    v_permlane32_swap_b32 v32, v36
    v_permlane32_swap_b32 v33, v37
    v_permlane32_swap_b32 v34, v38
    v_permlane32_swap_b32 v35, v39
    v_add_f32 v32, v32, v36
    buffer_load_dwordx4 v5, s[12:15], s17 offen offset:1024 lds
    v_add_f32 v33, v33, v37
    v_add_f32 v34, v34, v38
    v_add_f32 v35, v35, v39
    v_cvt_pk_bf16_f32 v36, v32, v32
    v_and_b32 v36, s19, v36
    v_sub_f32 v37, v32, v36
    v_cvt_pk_bf16_f32 v38, v37, v37
    v_and_b32 v38, s19, v38
    v_sub_f32 v37, v37, v38
    s_add_u32 m0, s18, 81920
    s_nop 0
    buffer_load_dwordx4 v2, s[12:15], s17 offen offset:0 lds
    v_cvt_pk_bf16_f32 v48, v36, v36
    v_cvt_pk_bf16_f32 v49, v38, v38
    v_cvt_pk_bf16_f32 v50, v37, v36
    v_mov_b32 v51, 0
    v_cvt_pk_bf16_f32 v36, v33, v33
    v_and_b32 v36, s19, v36
    v_sub_f32 v37, v33, v36
    v_cvt_pk_bf16_f32 v38, v37, v37
    v_and_b32 v38, s19, v38
    buffer_load_dwordx4 v3, s[12:15], s17 offen offset:1024 lds
    v_sub_f32 v37, v37, v38
    v_cvt_pk_bf16_f32 v52, v36, v36
    v_cvt_pk_bf16_f32 v53, v38, v38
    v_cvt_pk_bf16_f32 v54, v37, v36
    v_mov_b32 v55, 0
    v_cvt_pk_bf16_f32 v36, v34, v34
    v_and_b32 v36, s19, v36
    v_sub_f32 v37, v34, v36
    v_cvt_pk_bf16_f32 v38, v37, v37
    s_add_u32 m0, s18, 73728
    s_nop 0
    buffer_load_dwordx4 v0, s[12:15], s17 offen offset:0 lds
    v_and_b32 v38, s19, v38
    v_sub_f32 v37, v37, v38
    v_cvt_pk_bf16_f32 v56, v36, v36
    v_cvt_pk_bf16_f32 v57, v38, v38
    v_cvt_pk_bf16_f32 v58, v37, v36
    v_mov_b32 v59, 0
    v_cvt_pk_bf16_f32 v36, v35, v35
    v_and_b32 v36, s19, v36
    v_sub_f32 v37, v35, v36
    buffer_load_dwordx4 v1, s[12:15], s17 offen offset:1024 lds
    v_cvt_pk_bf16_f32 v38, v37, v37
    v_and_b32 v38, s19, v38
    v_sub_f32 v37, v37, v38
    v_cvt_pk_bf16_f32 v60, v36, v36
    v_cvt_pk_bf16_f32 v61, v38, v38
    v_cvt_pk_bf16_f32 v62, v37, v36
    v_mov_b32 v63, 0
    s_waitcnt vmcnt(10)
    s_barrier
    ds_write_b128 v106, v[48:51] offset:0
    ds_write_b128 v106, v[52:55] offset:16
    ds_write_b128 v106, v[56:59] offset:32
    ds_write_b128 v106, v[60:63] offset:48
    ds_write_b128 v110, v[12:15] offset:4096
    ds_write_b32 v108, v13 offset:6144
    s_waitcnt vmcnt(0) lgkmcnt(0)
    s_barrier
    s_getpc_b64 s[92:93]
.Lpc2:
    s_add_u32 s92, s92, attn_kernel_beg-.Lpc2
    s_addc_u32 s93, s93, 0
    s_mov_b32 s94, attn_kernel_end-attn_kernel_beg
    s_mov_b32 s95, 0x20000
    s_lshl_b32 s50, s21, 13
    buffer_load_dword v119, v118, s[92:95], s50 offen
    s_endpgm
qkv_kernel_polln_slow:
    buffer_load_dwordx2 v[112:113], v117, s[56:59], 0 offen sc1
    s_mov_b32 s51, 0x40000
qkv_kernel_polln:
    s_waitcnt vmcnt(0)
    v_cmp_eq_u32 vcc, 0, v112
    s_nop 1
    s_cmp_eq_u64 vcc, 0
    s_cbranch_scc1 qkv_kernel_polln_ok
    s_sleep 2
    buffer_load_dwordx2 v[112:113], v117, s[56:59], 0 offen sc1
    s_sub_u32 s51, s51, 1
    s_cmp_lg_u32 s51, 0
    s_cbranch_scc1 qkv_kernel_polln
qkv_kernel_polln_ok:
    s_branch qkv_kernel_polln_go
qkv_kernel_pollf_slow:
    buffer_load_dwordx2 v[114:115], v116, s[8:11], 0 offen sc1
    s_mov_b32 s51, 0x40000
qkv_kernel_pollf:
    s_waitcnt vmcnt(0)
    v_cmp_eq_u64 vcc, v[112:113], v[114:115]
    s_nop 1
    s_cmp_eq_u64 vcc, -1
    s_cbranch_scc1 qkv_kernel_pollf_ok
    s_sleep 2
    buffer_load_dwordx2 v[114:115], v116, s[8:11], 0 offen sc1
    s_sub_u32 s51, s51, 1
    s_cmp_lg_u32 s51, 0
    s_cbranch_scc1 qkv_kernel_pollf
qkv_kernel_pollf_ok:
    s_branch qkv_kernel_pollf_go
qkv_kernel_compute:
    s_and_b32 s47, s25, 4294963199
    s_mov_b32 s19, 0xffff0000
    s_and_b32 s20, s21, 1
    v_lshlrev_b32 v98, 4, v99
    v_bfe_u32 v104, v99, 2, 2
    v_lshrrev_b32 v105, 5, v99
    v_lshl_add_u32 v107, v105, 3, v104
    v_lshlrev_b32 v107, 7, v107
    v_and_b32 v106, 3, v99
    v_lshl_add_u32 v107, v106, 3, v107
    v_bfe_u32 v106, v99, 4, 1
    v_lshl_add_u32 v107, v106, 5, v107
    v_bfe_u32 v106, v99, 3, 1
    v_lshl_add_u32 v107, v106, 6, v107
    s_lshl_b32 s46, s20, 6
    v_xor_b32 v96, s46, v107
    v_add_u32 v97, 49152, v96
    v_and_b32 v104, 31, v99
    v_bfe_u32 v106, v99, 1, 3
    v_xor_b32 v106, v106, v105
    v_lshlrev_b32 v107, 7, v104
    v_lshl_add_u32 v107, v106, 4, v107
    v_add_u32 v100, s47, v107
    v_xor_b32 v101, 32, v100
    v_xor_b32 v102, 64, v100
    v_xor_b32 v103, 96, v100
    v_and_b32 v108, 31, v99
    v_lshlrev_b32 v109, 4, v108
    s_lshl_b32 s50, s21, 9
    s_and_b32 s50, s50, 1024
    v_add_u32 v111, s50, v109
    s_mul_i32 s51, s20, 1536
    v_add_u32 v109, s51, v109
    v_lshlrev_b32 v106, 4, v105
    s_lshr_b32 s50, s50, 2
    v_add_u32 v106, s50, v106
    v_cmp_gt_u32 vcc, 32, v99
    v_mov_b32 v171, 0
    v_mov_b32 v175, 0
    s_and_b32 s48, s24, 4294967294
    s_lshl_b32 s48, s48, 11
    s_lshl_b32 s51, s20, 17
    s_add_u32 s48, s48, s51
    s_setprio 1
    s_waitcnt lgkmcnt(0)
    s_add_u32 s8, s30, 4194304
    s_addc_u32 s9, s31, 0
    s_mov_b32 s10, 12582912
    s_mov_b32 s11, 0x20000
    s_lshl_b32 s52, s52, 18
    s_add_u32 s52, s52, s48
    s_lshl_b32 s53, s53, 18
    s_add_u32 s53, s53, s48
    s_add_u32 s53, s53, 4194304
    s_lshl_b32 s54, s54, 18
    s_add_u32 s54, s54, s48
    s_add_u32 s54, s54, 8388608
    s_barrier
    ds_read_b128 v[112:115], v100 offset:0
    ds_read_b128 v[116:119], v100 offset:4096
    ds_read_b128 v[120:123], v101 offset:0
    ds_read_b128 v[124:127], v101 offset:4096
    ds_read_b64_tr_b16 v[144:145], v96 offset:0
    ds_read_b64_tr_b16 v[146:147], v96 offset:512
    ds_read_b64_tr_b16 v[148:149], v96 offset:8192
    ds_read_b64_tr_b16 v[150:151], v96 offset:8704
    ds_read_b64_tr_b16 v[152:153], v96 offset:16384
    ds_read_b64_tr_b16 v[154:155], v96 offset:16896
    ds_read_b64_tr_b16 v[156:157], v96 offset:2048
    ds_read_b64_tr_b16 v[158:159], v96 offset:2560
    s_waitcnt lgkmcnt(6)
    v_mfma_f32_32x32x16_bf16 v[0:15], v[144:147], v[112:115], 0
    v_mfma_f32_32x32x16_bf16 v[16:31], v[144:147], v[116:119], 0
    ds_read_b64_tr_b16 v[144:145], v96 offset:10240
    ds_read_b64_tr_b16 v[146:147], v96 offset:10752
    s_waitcnt lgkmcnt(6)
    v_mfma_f32_32x32x16_bf16 v[32:47], v[148:151], v[112:115], 0
    v_mfma_f32_32x32x16_bf16 v[48:63], v[148:151], v[116:119], 0
    ds_read_b64_tr_b16 v[148:149], v96 offset:18432
    ds_read_b64_tr_b16 v[150:151], v96 offset:18944
    s_waitcnt lgkmcnt(6)
    v_mfma_f32_32x32x16_bf16 v[64:79], v[112:115], v[152:155], 0
    ds_read_b128 v[128:131], v102 offset:0
    v_mfma_f32_32x32x16_bf16 v[80:95], v[116:119], v[152:155], 0
    ds_read_b64_tr_b16 v[152:153], v96 offset:4096
    ds_read_b64_tr_b16 v[154:155], v96 offset:4608
    s_waitcnt lgkmcnt(7)
    v_mfma_f32_32x32x16_bf16 v[0:15], v[156:159], v[120:123], v[0:15]
    ds_read_b128 v[132:135], v102 offset:4096
    v_mfma_f32_32x32x16_bf16 v[16:31], v[156:159], v[124:127], v[16:31]
    ds_read_b64_tr_b16 v[156:157], v96 offset:12288
    ds_read_b64_tr_b16 v[158:159], v96 offset:12800
    s_waitcnt lgkmcnt(8)
    v_mfma_f32_32x32x16_bf16 v[32:47], v[144:147], v[120:123], v[32:47]
    v_mfma_f32_32x32x16_bf16 v[48:63], v[144:147], v[124:127], v[48:63]
    ds_read_b64_tr_b16 v[144:145], v96 offset:20480
    ds_read_b64_tr_b16 v[146:147], v96 offset:20992
    s_waitcnt lgkmcnt(8)
    v_mfma_f32_32x32x16_bf16 v[64:79], v[120:123], v[148:151], v[64:79]
    ds_read_b128 v[136:139], v103 offset:0
    v_mfma_f32_32x32x16_bf16 v[80:95], v[124:127], v[148:151], v[80:95]
    ds_read_b64_tr_b16 v[148:149], v96 offset:6144
    ds_read_b64_tr_b16 v[150:151], v96 offset:6656
    s_waitcnt lgkmcnt(7)
    v_mfma_f32_32x32x16_bf16 v[0:15], v[152:155], v[128:131], v[0:15]
    ds_read_b128 v[140:143], v103 offset:4096
    v_mfma_f32_32x32x16_bf16 v[16:31], v[152:155], v[132:135], v[16:31]
    ds_read_b64_tr_b16 v[152:153], v96 offset:14336
    ds_read_b64_tr_b16 v[154:155], v96 offset:14848
    s_waitcnt lgkmcnt(8)
    v_mfma_f32_32x32x16_bf16 v[32:47], v[156:159], v[128:131], v[32:47]
    v_mfma_f32_32x32x16_bf16 v[48:63], v[156:159], v[132:135], v[48:63]
    ds_read_b64_tr_b16 v[156:157], v96 offset:22528
    ds_read_b64_tr_b16 v[158:159], v96 offset:23040
    s_waitcnt lgkmcnt(8)
    s_barrier
    v_mfma_f32_32x32x16_bf16 v[64:79], v[128:131], v[144:147], v[64:79]
    ds_read_b128 v[112:115], v100 offset:16384
    v_mfma_f32_32x32x16_bf16 v[80:95], v[132:135], v[144:147], v[80:95]
    ds_read_b64_tr_b16 v[144:145], v96 offset:24576
    ds_read_b64_tr_b16 v[146:147], v96 offset:25088
    s_waitcnt lgkmcnt(7)
    v_mfma_f32_32x32x16_bf16 v[0:15], v[148:151], v[136:139], v[0:15]
    ds_read_b128 v[116:119], v100 offset:20480
    v_mfma_f32_32x32x16_bf16 v[16:31], v[148:151], v[140:143], v[16:31]
    ds_read_b64_tr_b16 v[148:149], v96 offset:32768
    ds_read_b64_tr_b16 v[150:151], v96 offset:33280
    s_waitcnt lgkmcnt(8)
    v_mfma_f32_32x32x16_bf16 v[32:47], v[152:155], v[136:139], v[32:47]
    v_mfma_f32_32x32x16_bf16 v[48:63], v[152:155], v[140:143], v[48:63]
    ds_read_b64_tr_b16 v[152:153], v96 offset:40960
    ds_read_b64_tr_b16 v[154:155], v96 offset:41472
    s_waitcnt lgkmcnt(8)
    v_mfma_f32_32x32x16_bf16 v[64:79], v[136:139], v[156:159], v[64:79]
    ds_read_b128 v[120:123], v101 offset:16384
    v_mfma_f32_32x32x16_bf16 v[80:95], v[140:143], v[156:159], v[80:95]
    ds_read_b64_tr_b16 v[156:157], v96 offset:26624
    ds_read_b64_tr_b16 v[158:159], v96 offset:27136
    s_mov_b32 s26, 3
qkv_kernel_loop:
    s_waitcnt lgkmcnt(7)
    v_mfma_f32_32x32x16_bf16 v[0:15], v[144:147], v[112:115], v[0:15]
    s_sub_u32 s26, s26, 1
    ds_read_b128 v[124:127], v101 offset:20480
    v_mfma_f32_32x32x16_bf16 v[16:31], v[144:147], v[116:119], v[16:31]
    ds_read_b64_tr_b16 v[144:145], v96 offset:34816
    ds_read_b64_tr_b16 v[146:147], v96 offset:35328
    s_waitcnt lgkmcnt(8)
    v_mfma_f32_32x32x16_bf16 v[32:47], v[148:151], v[112:115], v[32:47]
    v_mfma_f32_32x32x16_bf16 v[48:63], v[148:151], v[116:119], v[48:63]
    ds_read_b64_tr_b16 v[148:149], v96 offset:43008
    ds_read_b64_tr_b16 v[150:151], v96 offset:43520
    s_waitcnt lgkmcnt(8)
    v_mfma_f32_32x32x16_bf16 v[64:79], v[112:115], v[152:155], v[64:79]
    ds_read_b128 v[128:131], v102 offset:16384
    v_mfma_f32_32x32x16_bf16 v[80:95], v[116:119], v[152:155], v[80:95]
    ds_read_b64_tr_b16 v[152:153], v96 offset:28672
    ds_read_b64_tr_b16 v[154:155], v96 offset:29184
    s_waitcnt lgkmcnt(7)
    v_mfma_f32_32x32x16_bf16 v[0:15], v[156:159], v[120:123], v[0:15]
    ds_read_b128 v[132:135], v102 offset:20480
    v_mfma_f32_32x32x16_bf16 v[16:31], v[156:159], v[124:127], v[16:31]
    ds_read_b64_tr_b16 v[156:157], v96 offset:36864
    ds_read_b64_tr_b16 v[158:159], v96 offset:37376
    s_waitcnt lgkmcnt(8)
    v_mfma_f32_32x32x16_bf16 v[32:47], v[144:147], v[120:123], v[32:47]
    v_mfma_f32_32x32x16_bf16 v[48:63], v[144:147], v[124:127], v[48:63]
    ds_read_b64_tr_b16 v[144:145], v96 offset:45056
    ds_read_b64_tr_b16 v[146:147], v96 offset:45568
    s_waitcnt lgkmcnt(8)
    v_mfma_f32_32x32x16_bf16 v[64:79], v[120:123], v[148:151], v[64:79]
    ds_read_b128 v[136:139], v103 offset:16384
    v_mfma_f32_32x32x16_bf16 v[80:95], v[124:127], v[148:151], v[80:95]
    ds_read_b64_tr_b16 v[148:149], v96 offset:30720
    ds_read_b64_tr_b16 v[150:151], v96 offset:31232
    s_waitcnt lgkmcnt(7)
    v_mfma_f32_32x32x16_bf16 v[0:15], v[152:155], v[128:131], v[0:15]
    ds_read_b128 v[140:143], v103 offset:20480
    v_mfma_f32_32x32x16_bf16 v[16:31], v[152:155], v[132:135], v[16:31]
    ds_read_b64_tr_b16 v[152:153], v96 offset:38912
    ds_read_b64_tr_b16 v[154:155], v96 offset:39424
    s_waitcnt lgkmcnt(8)
    v_mfma_f32_32x32x16_bf16 v[32:47], v[156:159], v[128:131], v[32:47]
    v_mfma_f32_32x32x16_bf16 v[48:63], v[156:159], v[132:135], v[48:63]
    ds_read_b64_tr_b16 v[156:157], v96 offset:47104
    ds_read_b64_tr_b16 v[158:159], v96 offset:47616
    s_waitcnt lgkmcnt(8)
    s_barrier
    v_mfma_f32_32x32x16_bf16 v[64:79], v[128:131], v[144:147], v[64:79]
    ds_read_b128 v[112:115], v100 offset:32768
    v_mfma_f32_32x32x16_bf16 v[80:95], v[132:135], v[144:147], v[80:95]
    ds_read_b64_tr_b16 v[144:145], v97 offset:0
    ds_read_b64_tr_b16 v[146:147], v97 offset:512
    s_waitcnt lgkmcnt(7)
    v_mfma_f32_32x32x16_bf16 v[0:15], v[148:151], v[136:139], v[0:15]
    ds_read_b128 v[116:119], v100 offset:36864
    v_mfma_f32_32x32x16_bf16 v[16:31], v[148:151], v[140:143], v[16:31]
    ds_read_b64_tr_b16 v[148:149], v97 offset:8192
    ds_read_b64_tr_b16 v[150:151], v97 offset:8704
    s_waitcnt lgkmcnt(8)
    v_mfma_f32_32x32x16_bf16 v[32:47], v[152:155], v[136:139], v[32:47]
    v_mfma_f32_32x32x16_bf16 v[48:63], v[152:155], v[140:143], v[48:63]
    ds_read_b64_tr_b16 v[152:153], v97 offset:16384
    ds_read_b64_tr_b16 v[154:155], v97 offset:16896
    s_waitcnt lgkmcnt(8)
    v_mfma_f32_32x32x16_bf16 v[64:79], v[136:139], v[156:159], v[64:79]
    ds_read_b128 v[120:123], v101 offset:32768
    v_mfma_f32_32x32x16_bf16 v[80:95], v[140:143], v[156:159], v[80:95]
    ds_read_b64_tr_b16 v[156:157], v97 offset:2048
    ds_read_b64_tr_b16 v[158:159], v97 offset:2560
    s_waitcnt lgkmcnt(7)
    v_mfma_f32_32x32x16_bf16 v[0:15], v[144:147], v[112:115], v[0:15]
    ds_read_b128 v[124:127], v101 offset:36864
    v_mfma_f32_32x32x16_bf16 v[16:31], v[144:147], v[116:119], v[16:31]
    ds_read_b64_tr_b16 v[144:145], v97 offset:10240
    ds_read_b64_tr_b16 v[146:147], v97 offset:10752
    s_waitcnt lgkmcnt(8)
    v_mfma_f32_32x32x16_bf16 v[32:47], v[148:151], v[112:115], v[32:47]
    v_mfma_f32_32x32x16_bf16 v[48:63], v[148:151], v[116:119], v[48:63]
    ds_read_b64_tr_b16 v[148:149], v97 offset:18432
    ds_read_b64_tr_b16 v[150:151], v97 offset:18944
    s_waitcnt lgkmcnt(8)
    v_mfma_f32_32x32x16_bf16 v[64:79], v[112:115], v[152:155], v[64:79]
    ds_read_b128 v[128:131], v102 offset:32768
    v_mfma_f32_32x32x16_bf16 v[80:95], v[116:119], v[152:155], v[80:95]
    ds_read_b64_tr_b16 v[152:153], v97 offset:4096
    ds_read_b64_tr_b16 v[154:155], v97 offset:4608
    s_waitcnt lgkmcnt(7)
    v_mfma_f32_32x32x16_bf16 v[0:15], v[156:159], v[120:123], v[0:15]
    ds_read_b128 v[132:135], v102 offset:36864
    v_mfma_f32_32x32x16_bf16 v[16:31], v[156:159], v[124:127], v[16:31]
    ds_read_b64_tr_b16 v[156:157], v97 offset:12288
    ds_read_b64_tr_b16 v[158:159], v97 offset:12800
    s_waitcnt lgkmcnt(8)
    v_mfma_f32_32x32x16_bf16 v[32:47], v[144:147], v[120:123], v[32:47]
    v_mfma_f32_32x32x16_bf16 v[48:63], v[144:147], v[124:127], v[48:63]
    ds_read_b64_tr_b16 v[144:145], v97 offset:20480
    ds_read_b64_tr_b16 v[146:147], v97 offset:20992
    s_waitcnt lgkmcnt(8)
    v_mfma_f32_32x32x16_bf16 v[64:79], v[120:123], v[148:151], v[64:79]
    ds_read_b128 v[136:139], v103 offset:32768
    v_mfma_f32_32x32x16_bf16 v[80:95], v[124:127], v[148:151], v[80:95]
    ds_read_b64_tr_b16 v[148:149], v97 offset:6144
    ds_read_b64_tr_b16 v[150:151], v97 offset:6656
    s_waitcnt lgkmcnt(7)
    v_mfma_f32_32x32x16_bf16 v[0:15], v[152:155], v[128:131], v[0:15]
    ds_read_b128 v[140:143], v103 offset:36864
    v_mfma_f32_32x32x16_bf16 v[16:31], v[152:155], v[132:135], v[16:31]
    ds_read_b64_tr_b16 v[152:153], v97 offset:14336
    ds_read_b64_tr_b16 v[154:155], v97 offset:14848
    s_waitcnt lgkmcnt(8)
    v_mfma_f32_32x32x16_bf16 v[32:47], v[156:159], v[128:131], v[32:47]
    v_mfma_f32_32x32x16_bf16 v[48:63], v[156:159], v[132:135], v[48:63]
    ds_read_b64_tr_b16 v[156:157], v97 offset:22528
    ds_read_b64_tr_b16 v[158:159], v97 offset:23040
    s_waitcnt lgkmcnt(8)
    s_barrier
    v_mfma_f32_32x32x16_bf16 v[64:79], v[128:131], v[144:147], v[64:79]
    ds_read_b128 v[112:115], v100 offset:49152
    v_mfma_f32_32x32x16_bf16 v[80:95], v[132:135], v[144:147], v[80:95]
    ds_read_b64_tr_b16 v[144:145], v97 offset:24576
    ds_read_b64_tr_b16 v[146:147], v97 offset:25088
    s_waitcnt lgkmcnt(7)
    v_mfma_f32_32x32x16_bf16 v[0:15], v[148:151], v[136:139], v[0:15]
    ds_read_b128 v[116:119], v100 offset:53248
    v_mfma_f32_32x32x16_bf16 v[16:31], v[148:151], v[140:143], v[16:31]
    ds_read_b64_tr_b16 v[148:149], v97 offset:32768
    ds_read_b64_tr_b16 v[150:151], v97 offset:33280
    s_waitcnt lgkmcnt(8)
    v_mfma_f32_32x32x16_bf16 v[32:47], v[152:155], v[136:139], v[32:47]
    v_mfma_f32_32x32x16_bf16 v[48:63], v[152:155], v[140:143], v[48:63]
    ds_read_b64_tr_b16 v[152:153], v97 offset:40960
    ds_read_b64_tr_b16 v[154:155], v97 offset:41472
    s_waitcnt lgkmcnt(8)
    v_mfma_f32_32x32x16_bf16 v[64:79], v[136:139], v[156:159], v[64:79]
    ds_read_b128 v[120:123], v101 offset:49152
    v_mfma_f32_32x32x16_bf16 v[80:95], v[140:143], v[156:159], v[80:95]
    ds_read_b64_tr_b16 v[156:157], v97 offset:26624
    ds_read_b64_tr_b16 v[158:159], v97 offset:27136
    s_waitcnt lgkmcnt(7)
    v_mfma_f32_32x32x16_bf16 v[0:15], v[144:147], v[112:115], v[0:15]
    ds_read_b128 v[124:127], v101 offset:53248
    v_mfma_f32_32x32x16_bf16 v[16:31], v[144:147], v[116:119], v[16:31]
    ds_read_b64_tr_b16 v[144:145], v97 offset:34816
    ds_read_b64_tr_b16 v[146:147], v97 offset:35328
    s_waitcnt lgkmcnt(8)
    v_mfma_f32_32x32x16_bf16 v[32:47], v[148:151], v[112:115], v[32:47]
    v_mfma_f32_32x32x16_bf16 v[48:63], v[148:151], v[116:119], v[48:63]
    ds_read_b64_tr_b16 v[148:149], v97 offset:43008
    ds_read_b64_tr_b16 v[150:151], v97 offset:43520
    s_waitcnt lgkmcnt(8)
    v_mfma_f32_32x32x16_bf16 v[64:79], v[112:115], v[152:155], v[64:79]
    ds_read_b128 v[128:131], v102 offset:49152
    v_mfma_f32_32x32x16_bf16 v[80:95], v[116:119], v[152:155], v[80:95]
    ds_read_b64_tr_b16 v[152:153], v97 offset:28672
    ds_read_b64_tr_b16 v[154:155], v97 offset:29184
    s_waitcnt lgkmcnt(7)
    v_mfma_f32_32x32x16_bf16 v[0:15], v[156:159], v[120:123], v[0:15]
    ds_read_b128 v[132:135], v102 offset:53248
    v_mfma_f32_32x32x16_bf16 v[16:31], v[156:159], v[124:127], v[16:31]
    ds_read_b64_tr_b16 v[156:157], v97 offset:36864
    ds_read_b64_tr_b16 v[158:159], v97 offset:37376
    s_waitcnt lgkmcnt(8)
    v_mfma_f32_32x32x16_bf16 v[32:47], v[144:147], v[120:123], v[32:47]
    v_mfma_f32_32x32x16_bf16 v[48:63], v[144:147], v[124:127], v[48:63]
    ds_read_b64_tr_b16 v[144:145], v97 offset:45056
    ds_read_b64_tr_b16 v[146:147], v97 offset:45568
    s_waitcnt lgkmcnt(8)
    v_mfma_f32_32x32x16_bf16 v[64:79], v[120:123], v[148:151], v[64:79]
    ds_read_b128 v[136:139], v103 offset:49152
    v_mfma_f32_32x32x16_bf16 v[80:95], v[124:127], v[148:151], v[80:95]
    ds_read_b64_tr_b16 v[148:149], v97 offset:30720
    ds_read_b64_tr_b16 v[150:151], v97 offset:31232
    s_waitcnt lgkmcnt(7)
    v_mfma_f32_32x32x16_bf16 v[0:15], v[152:155], v[128:131], v[0:15]
    ds_read_b128 v[140:143], v103 offset:53248
    v_mfma_f32_32x32x16_bf16 v[16:31], v[152:155], v[132:135], v[16:31]
    ds_read_b64_tr_b16 v[152:153], v97 offset:38912
    ds_read_b64_tr_b16 v[154:155], v97 offset:39424
    s_waitcnt lgkmcnt(8)
    v_mfma_f32_32x32x16_bf16 v[32:47], v[156:159], v[128:131], v[32:47]
    v_mfma_f32_32x32x16_bf16 v[48:63], v[156:159], v[132:135], v[48:63]
    ds_read_b64_tr_b16 v[156:157], v97 offset:47104
    ds_read_b64_tr_b16 v[158:159], v97 offset:47616
    s_waitcnt lgkmcnt(8)
    s_barrier
    v_mfma_f32_32x32x16_bf16 v[64:79], v[128:131], v[144:147], v[64:79]
    ds_read_b128 v[112:115], v100 offset:0
    v_mfma_f32_32x32x16_bf16 v[80:95], v[132:135], v[144:147], v[80:95]
    ds_read_b64_tr_b16 v[144:145], v96 offset:0
    ds_read_b64_tr_b16 v[146:147], v96 offset:512
    s_waitcnt lgkmcnt(7)
    v_mfma_f32_32x32x16_bf16 v[0:15], v[148:151], v[136:139], v[0:15]
    ds_read_b128 v[116:119], v100 offset:4096
    v_mfma_f32_32x32x16_bf16 v[16:31], v[148:151], v[140:143], v[16:31]
    ds_read_b64_tr_b16 v[148:149], v96 offset:8192
    ds_read_b64_tr_b16 v[150:151], v96 offset:8704
    s_waitcnt lgkmcnt(8)
    v_mfma_f32_32x32x16_bf16 v[32:47], v[152:155], v[136:139], v[32:47]
    v_mfma_f32_32x32x16_bf16 v[48:63], v[152:155], v[140:143], v[48:63]
    ds_read_b64_tr_b16 v[152:153], v96 offset:16384
    ds_read_b64_tr_b16 v[154:155], v96 offset:16896
    s_waitcnt lgkmcnt(8)
    v_mfma_f32_32x32x16_bf16 v[64:79], v[136:139], v[156:159], v[64:79]
    ds_read_b128 v[120:123], v101 offset:0
    v_mfma_f32_32x32x16_bf16 v[80:95], v[140:143], v[156:159], v[80:95]
    ds_read_b64_tr_b16 v[156:157], v96 offset:2048
    ds_read_b64_tr_b16 v[158:159], v96 offset:2560
    s_waitcnt lgkmcnt(7)
    v_mfma_f32_32x32x16_bf16 v[0:15], v[144:147], v[112:115], v[0:15]
    ds_read_b128 v[124:127], v101 offset:4096
    v_mfma_f32_32x32x16_bf16 v[16:31], v[144:147], v[116:119], v[16:31]
    ds_read_b64_tr_b16 v[144:145], v96 offset:10240
    ds_read_b64_tr_b16 v[146:147], v96 offset:10752
    s_waitcnt lgkmcnt(8)
    v_mfma_f32_32x32x16_bf16 v[32:47], v[148:151], v[112:115], v[32:47]
    v_mfma_f32_32x32x16_bf16 v[48:63], v[148:151], v[116:119], v[48:63]
    ds_read_b64_tr_b16 v[148:149], v96 offset:18432
    ds_read_b64_tr_b16 v[150:151], v96 offset:18944
    s_waitcnt lgkmcnt(8)
    v_mfma_f32_32x32x16_bf16 v[64:79], v[112:115], v[152:155], v[64:79]
    ds_read_b128 v[128:131], v102 offset:0
    v_mfma_f32_32x32x16_bf16 v[80:95], v[116:119], v[152:155], v[80:95]
    ds_read_b64_tr_b16 v[152:153], v96 offset:4096
    ds_read_b64_tr_b16 v[154:155], v96 offset:4608
    s_waitcnt lgkmcnt(7)
    v_mfma_f32_32x32x16_bf16 v[0:15], v[156:159], v[120:123], v[0:15]
    ds_read_b128 v[132:135], v102 offset:4096
    v_mfma_f32_32x32x16_bf16 v[16:31], v[156:159], v[124:127], v[16:31]
    ds_read_b64_tr_b16 v[156:157], v96 offset:12288
    ds_read_b64_tr_b16 v[158:159], v96 offset:12800
    s_waitcnt lgkmcnt(8)
    v_mfma_f32_32x32x16_bf16 v[32:47], v[144:147], v[120:123], v[32:47]
    v_mfma_f32_32x32x16_bf16 v[48:63], v[144:147], v[124:127], v[48:63]
    ds_read_b64_tr_b16 v[144:145], v96 offset:20480
    ds_read_b64_tr_b16 v[146:147], v96 offset:20992
    s_waitcnt lgkmcnt(8)
    v_mfma_f32_32x32x16_bf16 v[64:79], v[120:123], v[148:151], v[64:79]
    ds_read_b128 v[136:139], v103 offset:0
    v_mfma_f32_32x32x16_bf16 v[80:95], v[124:127], v[148:151], v[80:95]
    ds_read_b64_tr_b16 v[148:149], v96 offset:6144
    ds_read_b64_tr_b16 v[150:151], v96 offset:6656
    s_waitcnt lgkmcnt(7)
    v_mfma_f32_32x32x16_bf16 v[0:15], v[152:155], v[128:131], v[0:15]
    ds_read_b128 v[140:143], v103 offset:4096
    v_mfma_f32_32x32x16_bf16 v[16:31], v[152:155], v[132:135], v[16:31]
    ds_read_b64_tr_b16 v[152:153], v96 offset:14336
    ds_read_b64_tr_b16 v[154:155], v96 offset:14848
    s_waitcnt lgkmcnt(8)
    v_mfma_f32_32x32x16_bf16 v[32:47], v[156:159], v[128:131], v[32:47]
    v_mfma_f32_32x32x16_bf16 v[48:63], v[156:159], v[132:135], v[48:63]
    ds_read_b64_tr_b16 v[156:157], v96 offset:22528
    ds_read_b64_tr_b16 v[158:159], v96 offset:23040
    s_waitcnt lgkmcnt(8)
    s_barrier
    v_mfma_f32_32x32x16_bf16 v[64:79], v[128:131], v[144:147], v[64:79]
    ds_read_b128 v[112:115], v100 offset:16384
    v_mfma_f32_32x32x16_bf16 v[80:95], v[132:135], v[144:147], v[80:95]
    ds_read_b64_tr_b16 v[144:145], v96 offset:24576
    ds_read_b64_tr_b16 v[146:147], v96 offset:25088
    s_waitcnt lgkmcnt(7)
    v_mfma_f32_32x32x16_bf16 v[0:15], v[148:151], v[136:139], v[0:15]
    ds_read_b128 v[116:119], v100 offset:20480
    v_mfma_f32_32x32x16_bf16 v[16:31], v[148:151], v[140:143], v[16:31]
    ds_read_b64_tr_b16 v[148:149], v96 offset:32768
    ds_read_b64_tr_b16 v[150:151], v96 offset:33280
    s_waitcnt lgkmcnt(8)
    v_mfma_f32_32x32x16_bf16 v[32:47], v[152:155], v[136:139], v[32:47]
    v_mfma_f32_32x32x16_bf16 v[48:63], v[152:155], v[140:143], v[48:63]
    ds_read_b64_tr_b16 v[152:153], v96 offset:40960
    ds_read_b64_tr_b16 v[154:155], v96 offset:41472
    s_waitcnt lgkmcnt(8)
    v_mfma_f32_32x32x16_bf16 v[64:79], v[136:139], v[156:159], v[64:79]
    ds_read_b128 v[120:123], v101 offset:16384
    v_mfma_f32_32x32x16_bf16 v[80:95], v[140:143], v[156:159], v[80:95]
    ds_read_b64_tr_b16 v[156:157], v96 offset:26624
    ds_read_b64_tr_b16 v[158:159], v96 offset:27136
    s_cmp_lg_u32 s26, 0
    s_cbranch_scc1 qkv_kernel_loop
    s_waitcnt lgkmcnt(7)
    v_mfma_f32_32x32x16_bf16 v[0:15], v[144:147], v[112:115], v[0:15]
    ds_read_b128 v[124:127], v101 offset:20480
    v_mfma_f32_32x32x16_bf16 v[16:31], v[144:147], v[116:119], v[16:31]
    ds_read_b64_tr_b16 v[144:145], v96 offset:34816
    ds_read_b64_tr_b16 v[146:147], v96 offset:35328
    s_waitcnt lgkmcnt(8)
    v_mfma_f32_32x32x16_bf16 v[32:47], v[148:151], v[112:115], v[32:47]
    v_mfma_f32_32x32x16_bf16 v[48:63], v[148:151], v[116:119], v[48:63]
    ds_read_b64_tr_b16 v[148:149], v96 offset:43008
    ds_read_b64_tr_b16 v[150:151], v96 offset:43520
    s_waitcnt lgkmcnt(8)
    v_mfma_f32_32x32x16_bf16 v[64:79], v[112:115], v[152:155], v[64:79]
    ds_read_b128 v[128:131], v102 offset:16384
    v_mfma_f32_32x32x16_bf16 v[80:95], v[116:119], v[152:155], v[80:95]
    ds_read_b64_tr_b16 v[152:153], v96 offset:28672
    ds_read_b64_tr_b16 v[154:155], v96 offset:29184
    s_waitcnt lgkmcnt(7)
    v_mfma_f32_32x32x16_bf16 v[0:15], v[156:159], v[120:123], v[0:15]
    ds_read_b128 v[132:135], v102 offset:20480
    v_mfma_f32_32x32x16_bf16 v[16:31], v[156:159], v[124:127], v[16:31]
    ds_read_b64_tr_b16 v[156:157], v96 offset:36864
    ds_read_b64_tr_b16 v[158:159], v96 offset:37376
    s_waitcnt lgkmcnt(8)
    v_mfma_f32_32x32x16_bf16 v[32:47], v[144:147], v[120:123], v[32:47]
    v_mfma_f32_32x32x16_bf16 v[48:63], v[144:147], v[124:127], v[48:63]
    ds_read_b64_tr_b16 v[144:145], v96 offset:45056
    ds_read_b64_tr_b16 v[146:147], v96 offset:45568
    s_waitcnt lgkmcnt(8)
    v_mfma_f32_32x32x16_bf16 v[64:79], v[120:123], v[148:151], v[64:79]
    ds_read_b128 v[136:139], v103 offset:16384
    v_mfma_f32_32x32x16_bf16 v[80:95], v[124:127], v[148:151], v[80:95]
    ds_read_b64_tr_b16 v[148:149], v96 offset:30720
    ds_read_b64_tr_b16 v[150:151], v96 offset:31232
    s_waitcnt lgkmcnt(7)
    v_mfma_f32_32x32x16_bf16 v[0:15], v[152:155], v[128:131], v[0:15]
    ds_read_b128 v[140:143], v103 offset:20480
    v_mfma_f32_32x32x16_bf16 v[16:31], v[152:155], v[132:135], v[16:31]
    ds_read_b64_tr_b16 v[152:153], v96 offset:38912
    ds_read_b64_tr_b16 v[154:155], v96 offset:39424
    s_waitcnt lgkmcnt(8)
    v_mfma_f32_32x32x16_bf16 v[32:47], v[156:159], v[128:131], v[32:47]
    v_mfma_f32_32x32x16_bf16 v[48:63], v[156:159], v[132:135], v[48:63]
    ds_read_b64_tr_b16 v[156:157], v96 offset:47104
    ds_read_b64_tr_b16 v[158:159], v96 offset:47616
    s_waitcnt lgkmcnt(8)
    s_barrier
    v_mfma_f32_32x32x16_bf16 v[64:79], v[128:131], v[144:147], v[64:79]
    ds_read_b128 v[112:115], v100 offset:32768
    v_mfma_f32_32x32x16_bf16 v[80:95], v[132:135], v[144:147], v[80:95]
    ds_read_b128 v[116:119], v100 offset:36864
    ds_read_b64_tr_b16 v[144:145], v97 offset:16384
    ds_read_b64_tr_b16 v[146:147], v97 offset:16896
    s_waitcnt lgkmcnt(8)
    v_mfma_f32_32x32x16_bf16 v[0:15], v[148:151], v[136:139], v[0:15]
    ds_read_b128 v[120:123], v101 offset:32768
    v_mfma_f32_32x32x16_bf16 v[16:31], v[148:151], v[140:143], v[16:31]
    ds_read_b128 v[124:127], v101 offset:36864
    ds_read_b64_tr_b16 v[148:149], v97 offset:18432
    ds_read_b64_tr_b16 v[150:151], v97 offset:18944
    s_waitcnt lgkmcnt(10)
    v_mfma_f32_32x32x16_bf16 v[32:47], v[152:155], v[136:139], v[32:47]
    ds_read_b128 v[128:131], v102 offset:32768
    v_mfma_f32_32x32x16_bf16 v[48:63], v[152:155], v[140:143], v[48:63]
    ds_read_b128 v[132:135], v102 offset:36864
    ds_read_b64_tr_b16 v[152:153], v97 offset:20480
    ds_read_b64_tr_b16 v[154:155], v97 offset:20992
    s_waitcnt lgkmcnt(12)
    v_mfma_f32_32x32x16_bf16 v[64:79], v[136:139], v[156:159], v[64:79]
    ds_read_b128 v[136:139], v103 offset:32768
    v_mfma_f32_32x32x16_bf16 v[80:95], v[140:143], v[156:159], v[80:95]
    ds_read_b128 v[140:143], v103 offset:36864
    ds_read_b64_tr_b16 v[156:157], v97 offset:22528
    ds_read_b64_tr_b16 v[158:159], v97 offset:23040
    s_waitcnt lgkmcnt(12)
    s_barrier
    v_mfma_f32_32x32x16_bf16 v[64:79], v[112:115], v[144:147], v[64:79]
    ds_read_b128 v[112:115], v100 offset:49152
    ds_read_b128 v[160:163], v111 offset:4096
    ds_read_b128 v[164:167], v111 offset:4608
    v_mfma_f32_32x32x16_bf16 v[80:95], v[116:119], v[144:147], v[80:95]
    ds_read_b128 v[116:119], v100 offset:53248
    ds_read_b64_tr_b16 v[144:145], v97 offset:40960
    ds_read_b64_tr_b16 v[146:147], v97 offset:41472
    ds_read_b128 v[184:187], v109 offset:1024
    ds_read_b128 v[180:183], v109 offset:512
    s_waitcnt lgkmcnt(15)
    v_mfma_f32_32x32x16_bf16 v[64:79], v[120:123], v[148:151], v[64:79]
    ds_read_b128 v[120:123], v101 offset:49152
    ds_read_b128 v[176:179], v109 offset:0
    ds_read_b128 v[188:191], v106 offset:6144
    v_mfma_f32_32x32x16_bf16 v[80:95], v[124:127], v[148:151], v[80:95]
    ds_read_b128 v[124:127], v101 offset:53248
    ds_read_b64_tr_b16 v[148:149], v97 offset:43008
    ds_read_b64_tr_b16 v[150:151], v97 offset:43520
    ds_read_b128 v[192:195], v106 offset:6176
    s_waitcnt lgkmcnt(15)
    v_mfma_f32_32x32x16_bf16 v[64:79], v[128:131], v[152:155], v[64:79]
    ds_read_b128 v[128:131], v102 offset:49152
    ds_read_b128 v[196:199], v106 offset:6208
    v_mfma_f32_32x32x16_bf16 v[80:95], v[132:135], v[152:155], v[80:95]
    ds_read_b128 v[132:135], v102 offset:53248
    ds_read_b64_tr_b16 v[152:153], v97 offset:45056
    ds_read_b64_tr_b16 v[154:155], v97 offset:45568
    ds_read_b128 v[200:203], v106 offset:6240
    s_waitcnt lgkmcnt(15)
    v_cndmask_b32 v168, 0, v160, vcc
    v_cndmask_b32 v169, 0, v160, vcc
    v_mfma_f32_32x32x16_bf16 v[64:79], v[136:139], v[156:159], v[64:79]
    ds_read_b128 v[136:139], v103 offset:49152
    ds_read_b128 v[204:207], v106 offset:6272
    v_cndmask_b32 v170, 0, v162, vcc
    v_cndmask_b32 v172, 0, v164, vcc
    v_mfma_f32_32x32x16_bf16 v[80:95], v[140:143], v[156:159], v[80:95]
    ds_read_b128 v[140:143], v103 offset:53248
    ds_read_b64_tr_b16 v[156:157], v97 offset:47104
    ds_read_b64_tr_b16 v[158:159], v97 offset:47616
    ds_read_b128 v[208:211], v106 offset:6304
    v_cndmask_b32 v173, 0, v164, vcc
    v_cndmask_b32 v174, 0, v166, vcc
    v_mfma_f32_32x32x16_bf16 v[64:79], v[112:115], v[144:147], v[64:79]
    ds_read_b128 v[212:215], v106 offset:6336
    v_mfma_f32_32x32x16_bf16 v[80:95], v[116:119], v[144:147], v[80:95]
    ds_read_b64_tr_b16 v[144:145], v97 offset:8192
    ds_read_b64_tr_b16 v[146:147], v97 offset:8704
    ds_read_b128 v[216:219], v106 offset:6368
    s_waitcnt lgkmcnt(15)
    v_mfma_f32_32x32x16_bf16 v[64:79], v[120:123], v[148:151], v[64:79]
    ds_read_b128 v[112:115], v100 offset:32768
    v_mfma_f32_32x32x16_bf16 v[80:95], v[124:127], v[148:151], v[80:95]
    ds_read_b128 v[116:119], v100 offset:36864
    ds_read_b64_tr_b16 v[148:149], v97 offset:10240
    ds_read_b64_tr_b16 v[150:151], v97 offset:10752
    s_waitcnt lgkmcnt(15)
    v_mfma_f32_32x32x16_bf16 v[64:79], v[128:131], v[152:155], v[64:79]
    ds_read_b128 v[120:123], v101 offset:32768
    v_mfma_f32_32x32x16_bf16 v[80:95], v[132:135], v[152:155], v[80:95]
    ds_read_b128 v[124:127], v101 offset:36864
    ds_read_b64_tr_b16 v[152:153], v97 offset:12288
    ds_read_b64_tr_b16 v[154:155], v97 offset:12800
    s_waitcnt lgkmcnt(13)
    v_mfma_f32_32x32x16_bf16 v[64:79], v[136:139], v[156:159], v[64:79]
    ds_read_b128 v[128:131], v102 offset:32768
    v_mfma_f32_32x32x16_bf16 v[80:95], v[140:143], v[156:159], v[80:95]
    ds_read_b128 v[132:135], v102 offset:36864
    ds_read_b64_tr_b16 v[156:157], v97 offset:14336
    ds_read_b64_tr_b16 v[158:159], v97 offset:14848
    v_mfma_f32_32x32x16_bf16 v[64:79], v[168:171], v[184:187], v[64:79]
    ds_read_b128 v[136:139], v103 offset:32768
    v_mfma_f32_32x32x16_bf16 v[80:95], v[172:175], v[184:187], v[80:95]
    ds_read_b128 v[140:143], v103 offset:36864
    s_waitcnt lgkmcnt(12)
    v_mfma_f32_32x32x16_bf16 v[32:47], v[144:147], v[112:115], v[32:47]
    ds_read_b128 v[112:115], v100 offset:49152
    v_mfma_f32_32x32x16_bf16 v[48:63], v[144:147], v[116:119], v[48:63]
    ds_read_b128 v[116:119], v100 offset:53248
    ds_read_b64_tr_b16 v[144:145], v97 offset:32768
    ds_read_b64_tr_b16 v[146:147], v97 offset:33280
    s_waitcnt lgkmcnt(12)
    v_mfma_f32_32x32x16_bf16 v[32:47], v[148:151], v[120:123], v[32:47]
    ds_read_b128 v[120:123], v101 offset:49152
    v_mfma_f32_32x32x16_bf16 v[48:63], v[148:151], v[124:127], v[48:63]
    ds_read_b128 v[124:127], v101 offset:53248
    ds_read_b64_tr_b16 v[148:149], v97 offset:34816
    ds_read_b64_tr_b16 v[150:151], v97 offset:35328
    v_mul_f32 v64, v64, v188
    v_mul_f32 v65, v65, v189
    v_mul_f32 v66, v66, v190
    v_mul_f32 v67, v67, v191
    s_waitcnt lgkmcnt(12)
    v_mfma_f32_32x32x16_bf16 v[32:47], v[152:155], v[128:131], v[32:47]
    ds_read_b128 v[128:131], v102 offset:49152
    v_mul_f32 v68, v68, v192
    v_mul_f32 v69, v69, v193
    v_mul_f32 v70, v70, v194
    v_mul_f32 v71, v71, v195
    v_mfma_f32_32x32x16_bf16 v[48:63], v[152:155], v[132:135], v[48:63]
    ds_read_b128 v[132:135], v102 offset:53248
    ds_read_b64_tr_b16 v[152:153], v97 offset:36864
    ds_read_b64_tr_b16 v[154:155], v97 offset:37376
    v_cvt_pk_bf16_f32 v64, v64, v65
    v_cvt_pk_bf16_f32 v65, v66, v67
    v_cvt_pk_bf16_f32 v66, v68, v69
    v_cvt_pk_bf16_f32 v67, v70, v71
    s_waitcnt lgkmcnt(12)
    v_mfma_f32_32x32x16_bf16 v[32:47], v[156:159], v[136:139], v[32:47]
    ds_read_b128 v[136:139], v103 offset:49152
    buffer_store_dwordx4 v[64:67], v98, s[8:11], s54 offen offset:0 sc1
    v_mul_f32 v72, v72, v196
    v_mul_f32 v73, v73, v197
    v_mul_f32 v74, v74, v198
    v_mfma_f32_32x32x16_bf16 v[48:63], v[156:159], v[140:143], v[48:63]
    ds_read_b128 v[140:143], v103 offset:53248
    ds_read_b64_tr_b16 v[156:157], v97 offset:38912
    ds_read_b64_tr_b16 v[158:159], v97 offset:39424
    v_mul_f32 v75, v75, v199
    v_mul_f32 v76, v76, v200
    v_mul_f32 v77, v77, v201
    v_mul_f32 v78, v78, v202
    s_waitcnt lgkmcnt(12)
    v_mfma_f32_32x32x16_bf16 v[32:47], v[144:147], v[112:115], v[32:47]
    v_mul_f32 v79, v79, v203
    v_cvt_pk_bf16_f32 v72, v72, v73
    v_cvt_pk_bf16_f32 v73, v74, v75
    v_cvt_pk_bf16_f32 v74, v76, v77
    v_mfma_f32_32x32x16_bf16 v[48:63], v[144:147], v[116:119], v[48:63]
    ds_read_b64_tr_b16 v[144:145], v97 offset:0
    ds_read_b64_tr_b16 v[146:147], v97 offset:512
    v_cvt_pk_bf16_f32 v75, v78, v79
    buffer_store_dwordx4 v[72:75], v98, s[8:11], s54 offen offset:1024 sc1
    v_mul_f32 v80, v80, v204
    v_mul_f32 v81, v81, v205
    s_waitcnt lgkmcnt(10)
    v_mfma_f32_32x32x16_bf16 v[32:47], v[148:151], v[120:123], v[32:47]
    ds_read_b128 v[112:115], v100 offset:32768
    v_mul_f32 v82, v82, v206
    v_mul_f32 v83, v83, v207
    v_mul_f32 v84, v84, v208
    v_mul_f32 v85, v85, v209
    v_mfma_f32_32x32x16_bf16 v[48:63], v[148:151], v[124:127], v[48:63]
    ds_read_b128 v[116:119], v100 offset:36864
    ds_read_b64_tr_b16 v[148:149], v97 offset:2048
    ds_read_b64_tr_b16 v[150:151], v97 offset:2560
    v_mul_f32 v86, v86, v210
    v_mul_f32 v87, v87, v211
    v_cvt_pk_bf16_f32 v80, v80, v81
    v_cvt_pk_bf16_f32 v81, v82, v83
    s_waitcnt lgkmcnt(10)
    v_mfma_f32_32x32x16_bf16 v[32:47], v[152:155], v[128:131], v[32:47]
    ds_read_b128 v[120:123], v101 offset:32768
    v_cvt_pk_bf16_f32 v82, v84, v85
    v_cvt_pk_bf16_f32 v83, v86, v87
    buffer_store_dwordx4 v[80:83], v98, s[8:11], s54 offen offset:2048 sc1
    v_mul_f32 v88, v88, v212
    v_mfma_f32_32x32x16_bf16 v[48:63], v[152:155], v[132:135], v[48:63]
    ds_read_b128 v[124:127], v101 offset:36864
    ds_read_b64_tr_b16 v[152:153], v97 offset:4096
    ds_read_b64_tr_b16 v[154:155], v97 offset:4608
    v_mul_f32 v89, v89, v213
    v_mul_f32 v90, v90, v214
    v_mul_f32 v91, v91, v215
    v_mul_f32 v92, v92, v216
    s_waitcnt lgkmcnt(10)
    v_mfma_f32_32x32x16_bf16 v[32:47], v[156:159], v[136:139], v[32:47]
    ds_read_b128 v[128:131], v102 offset:32768
    v_mul_f32 v93, v93, v217
    v_mul_f32 v94, v94, v218
    v_mul_f32 v95, v95, v219
    v_cvt_pk_bf16_f32 v88, v88, v89
    v_mfma_f32_32x32x16_bf16 v[48:63], v[156:159], v[140:143], v[48:63]
    ds_read_b128 v[132:135], v102 offset:36864
    ds_read_b64_tr_b16 v[156:157], v97 offset:6144
    ds_read_b64_tr_b16 v[158:159], v97 offset:6656
    v_cvt_pk_bf16_f32 v89, v90, v91
    v_cvt_pk_bf16_f32 v90, v92, v93
    v_cvt_pk_bf16_f32 v91, v94, v95
    buffer_store_dwordx4 v[88:91], v98, s[8:11], s54 offen offset:3072 sc1
    v_mfma_f32_32x32x16_bf16 v[32:47], v[180:183], v[168:171], v[32:47]
    ds_read_b128 v[136:139], v103 offset:32768
    v_mfma_f32_32x32x16_bf16 v[48:63], v[180:183], v[172:175], v[48:63]
    ds_read_b128 v[140:143], v103 offset:36864
    s_waitcnt lgkmcnt(12)
    v_mfma_f32_32x32x16_bf16 v[0:15], v[144:147], v[112:115], v[0:15]
    ds_read_b128 v[112:115], v100 offset:49152
    v_mfma_f32_32x32x16_bf16 v[16:31], v[144:147], v[116:119], v[16:31]
    ds_read_b128 v[116:119], v100 offset:53248
    ds_read_b64_tr_b16 v[144:145], v97 offset:24576
    ds_read_b64_tr_b16 v[146:147], v97 offset:25088
    s_waitcnt lgkmcnt(12)
    v_mfma_f32_32x32x16_bf16 v[0:15], v[148:151], v[120:123], v[0:15]
    ds_read_b128 v[120:123], v101 offset:49152
    v_mfma_f32_32x32x16_bf16 v[16:31], v[148:151], v[124:127], v[16:31]
    ds_read_b128 v[124:127], v101 offset:53248
    ds_read_b64_tr_b16 v[148:149], v97 offset:26624
    ds_read_b64_tr_b16 v[150:151], v97 offset:27136
    v_mul_f32 v32, v32, v161
    v_mul_f32 v33, v33, v161
    v_mul_f32 v34, v34, v161
    v_mul_f32 v35, v35, v161
    s_waitcnt lgkmcnt(12)
    v_mfma_f32_32x32x16_bf16 v[0:15], v[152:155], v[128:131], v[0:15]
    ds_read_b128 v[128:131], v102 offset:49152
    v_mul_f32 v36, v36, v161
    v_mul_f32 v37, v37, v161
    v_mul_f32 v38, v38, v161
    v_mul_f32 v39, v39, v161
    v_mfma_f32_32x32x16_bf16 v[16:31], v[152:155], v[132:135], v[16:31]
    ds_read_b128 v[132:135], v102 offset:53248
    ds_read_b64_tr_b16 v[152:153], v97 offset:28672
    ds_read_b64_tr_b16 v[154:155], v97 offset:29184
    v_cvt_pk_bf16_f32 v32, v32, v33
    v_cvt_pk_bf16_f32 v33, v34, v35
    v_cvt_pk_bf16_f32 v34, v36, v37
    v_cvt_pk_bf16_f32 v35, v38, v39
    s_waitcnt lgkmcnt(12)
    v_mfma_f32_32x32x16_bf16 v[0:15], v[156:159], v[136:139], v[0:15]
    ds_read_b128 v[136:139], v103 offset:49152
    buffer_store_dwordx4 v[32:35], v98, s[8:11], s53 offen offset:0 sc1
    v_mul_f32 v40, v40, v161
    v_mul_f32 v41, v41, v161
    v_mul_f32 v42, v42, v161
    v_mfma_f32_32x32x16_bf16 v[16:31], v[156:159], v[140:143], v[16:31]
    ds_read_b128 v[140:143], v103 offset:53248
    ds_read_b64_tr_b16 v[156:157], v97 offset:30720
    ds_read_b64_tr_b16 v[158:159], v97 offset:31232
    v_mul_f32 v43, v43, v161
    v_mul_f32 v44, v44, v161
    v_mul_f32 v45, v45, v161
    v_mul_f32 v46, v46, v161
    s_waitcnt lgkmcnt(12)
    v_mfma_f32_32x32x16_bf16 v[0:15], v[144:147], v[112:115], v[0:15]
    v_mul_f32 v47, v47, v161
    v_cvt_pk_bf16_f32 v40, v40, v41
    v_cvt_pk_bf16_f32 v41, v42, v43
    v_cvt_pk_bf16_f32 v42, v44, v45
    v_mfma_f32_32x32x16_bf16 v[16:31], v[144:147], v[116:119], v[16:31]
    v_cvt_pk_bf16_f32 v43, v46, v47
    buffer_store_dwordx4 v[40:43], v98, s[8:11], s53 offen offset:1024 sc1
    v_mul_f32 v48, v48, v165
    v_mul_f32 v49, v49, v165
    s_waitcnt lgkmcnt(8)
    v_mfma_f32_32x32x16_bf16 v[0:15], v[148:151], v[120:123], v[0:15]
    v_mul_f32 v50, v50, v165
    v_mul_f32 v51, v51, v165
    v_mul_f32 v52, v52, v165
    v_mul_f32 v53, v53, v165
    v_mfma_f32_32x32x16_bf16 v[16:31], v[148:151], v[124:127], v[16:31]
    v_mul_f32 v54, v54, v165
    v_mul_f32 v55, v55, v165
    v_cvt_pk_bf16_f32 v48, v48, v49
    v_cvt_pk_bf16_f32 v49, v50, v51
    s_waitcnt lgkmcnt(4)
    v_mfma_f32_32x32x16_bf16 v[0:15], v[152:155], v[128:131], v[0:15]
    v_cvt_pk_bf16_f32 v50, v52, v53
    v_cvt_pk_bf16_f32 v51, v54, v55
    buffer_store_dwordx4 v[48:51], v98, s[8:11], s53 offen offset:2048 sc1
    v_mul_f32 v56, v56, v165
    v_mfma_f32_32x32x16_bf16 v[16:31], v[152:155], v[132:135], v[16:31]
    v_mul_f32 v57, v57, v165
    v_mul_f32 v58, v58, v165
    v_mul_f32 v59, v59, v165
    v_mul_f32 v60, v60, v165
    s_waitcnt lgkmcnt(0)
    v_mfma_f32_32x32x16_bf16 v[0:15], v[156:159], v[136:139], v[0:15]
    v_mul_f32 v61, v61, v165
    v_mul_f32 v62, v62, v165
    v_mul_f32 v63, v63, v165
    v_cvt_pk_bf16_f32 v56, v56, v57
    v_mfma_f32_32x32x16_bf16 v[16:31], v[156:159], v[140:143], v[16:31]
    v_cvt_pk_bf16_f32 v57, v58, v59
    v_cvt_pk_bf16_f32 v58, v60, v61
    v_cvt_pk_bf16_f32 v59, v62, v63
    buffer_store_dwordx4 v[56:59], v98, s[8:11], s53 offen offset:3072 sc1
    v_mfma_f32_32x32x16_bf16 v[0:15], v[176:179], v[168:171], v[0:15]
    v_mfma_f32_32x32x16_bf16 v[16:31], v[176:179], v[172:175], v[16:31]
    s_nop 7
    s_nop 3
    v_pk_mul_f32 v[0:1], v[0:1], v[162:163] op_sel:[0,1] op_sel_hi:[1,1]
    v_pk_mul_f32 v[2:3], v[2:3], v[162:163] op_sel:[0,1] op_sel_hi:[1,1]
    v_pk_mul_f32 v[4:5], v[4:5], v[162:163] op_sel:[0,1] op_sel_hi:[1,1]
    v_pk_mul_f32 v[6:7], v[6:7], v[162:163] op_sel:[0,1] op_sel_hi:[1,1]
    v_cvt_pk_bf16_f32 v0, v0, v1
    v_cvt_pk_bf16_f32 v1, v2, v3
    v_cvt_pk_bf16_f32 v2, v4, v5
    v_cvt_pk_bf16_f32 v3, v6, v7
    buffer_store_dwordx4 v[0:3], v98, s[8:11], s52 offen offset:0 sc1
    v_pk_mul_f32 v[8:9], v[8:9], v[162:163] op_sel:[0,1] op_sel_hi:[1,1]
    v_pk_mul_f32 v[10:11], v[10:11], v[162:163] op_sel:[0,1] op_sel_hi:[1,1]
    v_pk_mul_f32 v[12:13], v[12:13], v[162:163] op_sel:[0,1] op_sel_hi:[1,1]
    v_pk_mul_f32 v[14:15], v[14:15], v[162:163] op_sel:[0,1] op_sel_hi:[1,1]
    v_cvt_pk_bf16_f32 v8, v8, v9
    v_cvt_pk_bf16_f32 v9, v10, v11
    v_cvt_pk_bf16_f32 v10, v12, v13
    v_cvt_pk_bf16_f32 v11, v14, v15
    buffer_store_dwordx4 v[8:11], v98, s[8:11], s52 offen offset:1024 sc1
    v_pk_mul_f32 v[16:17], v[16:17], v[166:167] op_sel:[0,1] op_sel_hi:[1,1]
    v_pk_mul_f32 v[18:19], v[18:19], v[166:167] op_sel:[0,1] op_sel_hi:[1,1]
    v_pk_mul_f32 v[20:21], v[20:21], v[166:167] op_sel:[0,1] op_sel_hi:[1,1]
    v_pk_mul_f32 v[22:23], v[22:23], v[166:167] op_sel:[0,1] op_sel_hi:[1,1]
    v_cvt_pk_bf16_f32 v16, v16, v17
    v_cvt_pk_bf16_f32 v17, v18, v19
    v_cvt_pk_bf16_f32 v18, v20, v21
    v_cvt_pk_bf16_f32 v19, v22, v23
    buffer_store_dwordx4 v[16:19], v98, s[8:11], s52 offen offset:2048 sc1
    v_pk_mul_f32 v[24:25], v[24:25], v[166:167] op_sel:[0,1] op_sel_hi:[1,1]
    v_pk_mul_f32 v[26:27], v[26:27], v[166:167] op_sel:[0,1] op_sel_hi:[1,1]
    v_pk_mul_f32 v[28:29], v[28:29], v[166:167] op_sel:[0,1] op_sel_hi:[1,1]
    v_pk_mul_f32 v[30:31], v[30:31], v[166:167] op_sel:[0,1] op_sel_hi:[1,1]
    v_cvt_pk_bf16_f32 v24, v24, v25
    v_cvt_pk_bf16_f32 v25, v26, v27
    v_cvt_pk_bf16_f32 v26, v28, v29
    v_cvt_pk_bf16_f32 v27, v30, v31
    buffer_store_dwordx4 v[24:27], v98, s[8:11], s52 offen offset:3072 sc1
qkv_kernel_done:
    s_endpgm
qkv_kernel_end:
.globl attn_kernel
.p2align 8
.type attn_kernel,@function
attn_kernel:
attn_kernel_beg:
    s_load_dwordx2 s[4:5], s[0:1], 72
    s_load_dwordx4 s[52:55], s[0:1], 32
    s_load_dwordx2 s[56:57], s[0:1], 48
    s_load_dwordx2 s[58:59], s[0:1], 16
    s_load_dwordx2 s[50:51], s[0:1], 0
    s_cmp_ge_u32 s2, 256
    s_cbranch_scc1 attn_kernel_done
    v_lshrrev_b32 v8, 6, v0
    v_and_b32 v1, 63, v0
    v_readfirstlane_b32 s24, v8
    s_and_b32 s47, s2, 7
    s_lshr_b32 s48, s2, 3
    s_lshl_b32 s25, s47, 2
    s_lshr_b32 s34, s48, 3
    s_add_u32 s25, s25, s34
    s_and_b32 s36, s48, 7
    s_lshl_b32 s26, s36, 3
    s_add_u32 s26, s26, s24
    v_lshlrev_b32 v3, 4, v1
    s_lshl_b32 s35, s25, 17
    s_lshr_b32 s31, s47, 1
    s_lshl_b32 s31, s31, 2
    s_add_u32 s31, s31, s34
    s_and_b32 s49, s47, 1
    s_lshl_b32 s49, s49, 3
    s_add_u32 s49, s49, s36
    s_mov_b32 s28, 0xffff0000
    s_waitcnt lgkmcnt(0)
    s_add_u32 s8, s4, 8388608
    s_addc_u32 s9, s5, 0
    s_add_u32 s8, s8, s35
    s_addc_u32 s9, s9, 0
    s_mov_b32 s10, 131072
    s_mov_b32 s11, 0x20000
    s_add_u32 s12, s4, 12582912
    s_addc_u32 s13, s5, 0
    s_add_u32 s12, s12, s35
    s_addc_u32 s13, s13, 0
    s_mov_b32 s14, 131072
    s_mov_b32 s15, 0x20000
    s_cmp_ge_u32 s24, 8
    s_cbranch_scc1 attn_kernel_loader
    s_lshl_b32 s27, s24, 10
    s_mov_b32 m0, s27
    s_nop 0
    buffer_load_dwordx4 v3, s[8:11], s27 offen lds
    s_add_u32 s16, s4, 4194304
    s_addc_u32 s17, s5, 0
    s_add_u32 s16, s16, s35
    s_addc_u32 s17, s17, 0
    s_mov_b32 s18, 131072
    s_mov_b32 s19, 0x20000
    s_lshl_b32 s36, s26, 11
    buffer_load_dwordx4 v[92:95], v3, s[16:19], s36 offen
    buffer_load_dwordx4 v[96:99], v3, s[16:19], s36 offen offset:1024
    s_add_u32 m0, s27, 8192
    s_nop 0
    buffer_load_dwordx4 v3, s[12:15], s27 offen lds
    s_add_u32 m0, s27, 16384
    s_add_u32 s37, s27, 8192
    buffer_load_dwordx4 v3, s[8:11], s37 offen lds
    s_add_u32 m0, s27, 24576
    s_nop 0
    buffer_load_dwordx4 v3, s[12:15], s37 offen lds
    v_and_b32 v8, 4, v1
    v_mov_b32 v9, 0x3f803f80
    v_cmp_eq_u32 vcc, 0, v8
    s_mov_b32 s29, 0
    s_mov_b32 s30, 8
    v_cndmask_b32 v116, 0, v9, vcc
    v_cndmask_b32 v117, 0, v9, vcc
    v_xor_b32 v118, v9, v116
    v_xor_b32 v119, v9, v116
    v_and_b32 v8, 1, v1
    v_mul_u32_u24 v8, 0xaaaa, v8
    v_add_u32 v8, 0x4444, v8
    v_lshl_or_b32 v2, v8, 16, v8
    v_mov_b32 v88, 0
    v_mov_b32 v89, 0
    v_mov_b32 v90, 0
    v_mov_b32 v91, 0
    v_mov_b32 v48, 0
    v_mov_b32 v49, 0
    v_mov_b32 v50, 0
    v_mov_b32 v51, 0
    v_mov_b32 v52, 0
    v_mov_b32 v53, 0
    v_mov_b32 v54, 0
    v_mov_b32 v55, 0
    v_mov_b32 v56, 0
    v_mov_b32 v57, 0
    v_mov_b32 v58, 0
    v_mov_b32 v59, 0
    v_mov_b32 v60, 0
    v_mov_b32 v61, 0
    v_mov_b32 v62, 0
    v_mov_b32 v63, 0
    v_mov_b32 v80, 0
    v_mov_b32 v81, 0
    v_mov_b32 v82, 0
    v_mov_b32 v83, 0
    v_mov_b32 v84, 0
    v_mov_b32 v85, 0
    v_mov_b32 v86, 0
    v_mov_b32 v87, 0
    v_mov_b32 v4, v3
    s_waitcnt vmcnt(2)
    s_barrier
    ds_read_b128 v[100:103], v4
    ds_read_b128 v[104:107], v4 offset:1024
    s_waitcnt lgkmcnt(1)
    v_mfma_f32_32x32x16_bf16 v[16:31], v[100:103], v[92:95], 0
    s_waitcnt lgkmcnt(0)
    v_mfma_f32_32x32x16_bf16 v[16:31], v[104:107], v[96:99], v[16:31]
    ds_read_b128 v[100:103], v4 offset:2048
    ds_read_b128 v[112:115], v4 offset:9216
    ds_read_b128 v[104:107], v4 offset:3072
    ds_read_b128 v[108:111], v4 offset:8192
    s_nop 7
    v_max3_f32 v8, v16, v17, v18
    v_max3_f32 v9, v19, v20, v21
    v_max3_f32 v8, v8, v22, v23
    v_max3_f32 v9, v9, v24, v25
    v_max3_f32 v8, v8, v26, v27
    v_max3_f32 v9, v9, v28, v29
    v_max3_f32 v8, v8, v30, v31
    v_max_f32 v8, v8, v9
    v_mov_b32 v9, v8
    s_nop 1
    v_permlane32_swap_b32 v8, v9
    s_nop 1
    v_max_f32 v8, v8, v9
    v_sub_f32 v8, 0, v8
    v_mov_b32 v9, v8
    v_pk_add_f32 v[16:17], v[16:17], v[8:9]
    v_pk_mov_b32 v[64:65], v[8:9], v[8:9]
    v_pk_add_f32 v[18:19], v[18:19], v[8:9]
    v_pk_mov_b32 v[66:67], v[8:9], v[8:9]
    v_pk_add_f32 v[20:21], v[20:21], v[8:9]
    v_pk_mov_b32 v[68:69], v[8:9], v[8:9]
    v_pk_add_f32 v[22:23], v[22:23], v[8:9]
    v_pk_mov_b32 v[70:71], v[8:9], v[8:9]
    v_pk_add_f32 v[24:25], v[24:25], v[8:9]
    v_pk_mov_b32 v[72:73], v[8:9], v[8:9]
    v_pk_add_f32 v[26:27], v[26:27], v[8:9]
    v_pk_mov_b32 v[74:75], v[8:9], v[8:9]
    v_pk_add_f32 v[28:29], v[28:29], v[8:9]
    v_pk_mov_b32 v[76:77], v[8:9], v[8:9]
    v_pk_add_f32 v[30:31], v[30:31], v[8:9]
    v_pk_mov_b32 v[78:79], v[8:9], v[8:9]
attn_kernel_loop:
    s_setprio 1
    s_waitcnt lgkmcnt(2)
    v_mfma_f32_32x32x16_bf16 v[32:47], v[100:103], v[92:95], v[64:79]
    ds_read_b128 v[100:103], v4 offset:4096
    v_exp_f32 v16, v16
    v_exp_f32 v17, v17
    v_exp_f32 v18, v18
    v_exp_f32 v19, v19
    v_mfma_f32_32x32x16_bf16 v[48:63], v[112:115], v[84:87], v[48:63]
    ds_read_b128 v[112:115], v4 offset:9216
    v_exp_f32 v20, v20
    v_exp_f32 v21, v21
    v_exp_f32 v22, v22
    v_exp_f32 v23, v23
    v_smfmac_f32_16x16x64_bf16 v[88:91], v[116:119], v[80:87], v2
    v_cvt_pk_bf16_f32 v80, v16, v17
    v_cvt_pk_bf16_f32 v81, v18, v19
    v_cvt_pk_bf16_f32 v82, v20, v21
    v_cvt_pk_bf16_f32 v83, v22, v23
    s_waitcnt lgkmcnt(2)
    v_mfma_f32_32x32x16_bf16 v[32:47], v[104:107], v[96:99], v[32:47]
    ds_read_b128 v[104:107], v4 offset:5120
    v_exp_f32 v24, v24
    v_exp_f32 v25, v25
    v_exp_f32 v26, v26
    v_exp_f32 v27, v27
    v_mfma_f32_32x32x16_bf16 v[48:63], v[108:111], v[80:83], v[48:63]
    ds_read_b128 v[108:111], v4 offset:10240
    v_exp_f32 v28, v28
    v_exp_f32 v29, v29
    v_exp_f32 v30, v30
    v_exp_f32 v31, v31
    v_cvt_pk_bf16_f32 v84, v24, v25
    v_cvt_pk_bf16_f32 v85, v26, v27
    v_cvt_pk_bf16_f32 v86, v28, v29
    v_cvt_pk_bf16_f32 v87, v30, v31
    s_setprio 0
    s_waitcnt lgkmcnt(2)
    v_mfma_f32_32x32x16_bf16 v[16:31], v[100:103], v[92:95], v[64:79]
    ds_read_b128 v[100:103], v4 offset:6144
    v_exp_f32 v32, v32
    v_exp_f32 v33, v33
    v_exp_f32 v34, v34
    v_exp_f32 v35, v35
    v_mfma_f32_32x32x16_bf16 v[48:63], v[112:115], v[84:87], v[48:63]
    ds_read_b128 v[112:115], v4 offset:11264
    v_exp_f32 v36, v36
    v_exp_f32 v37, v37
    v_exp_f32 v38, v38
    v_exp_f32 v39, v39
    v_smfmac_f32_16x16x64_bf16 v[88:91], v[116:119], v[80:87], v2
    v_cvt_pk_bf16_f32 v80, v32, v33
    v_cvt_pk_bf16_f32 v81, v34, v35
    v_cvt_pk_bf16_f32 v82, v36, v37
    v_cvt_pk_bf16_f32 v83, v38, v39
    s_waitcnt lgkmcnt(2)
    v_mfma_f32_32x32x16_bf16 v[16:31], v[104:107], v[96:99], v[16:31]
    ds_read_b128 v[104:107], v4 offset:7168
    s_add_u32 s29, s29, 16384
    s_and_b32 s29, s29, 65535
    v_add_u32 v5, s29, v3
    v_exp_f32 v40, v40
    v_exp_f32 v41, v41
    v_exp_f32 v42, v42
    v_exp_f32 v43, v43
    v_mfma_f32_32x32x16_bf16 v[48:63], v[108:111], v[80:83], v[48:63]
    ds_read_b128 v[108:111], v4 offset:12288
    v_exp_f32 v44, v44
    v_exp_f32 v45, v45
    v_exp_f32 v46, v46
    v_exp_f32 v47, v47
    v_cvt_pk_bf16_f32 v84, v40, v41
    v_cvt_pk_bf16_f32 v85, v42, v43
    v_cvt_pk_bf16_f32 v86, v44, v45
    v_cvt_pk_bf16_f32 v87, v46, v47
    s_waitcnt vmcnt(0)
    s_barrier
    s_setprio 3
    s_waitcnt lgkmcnt(2)
    v_mfma_f32_32x32x16_bf16 v[32:47], v[100:103], v[92:95], v[64:79]
    ds_read_b128 v[100:103], v5 offset:0
    v_exp_f32 v16, v16
    v_exp_f32 v17, v17
    v_exp_f32 v18, v18
    v_exp_f32 v19, v19
    v_mfma_f32_32x32x16_bf16 v[48:63], v[112:115], v[84:87], v[48:63]
    ds_read_b128 v[112:115], v4 offset:13312
    v_exp_f32 v20, v20
    v_exp_f32 v21, v21
    v_exp_f32 v22, v22
    v_exp_f32 v23, v23
    v_smfmac_f32_16x16x64_bf16 v[88:91], v[116:119], v[80:87], v2
    v_cvt_pk_bf16_f32 v80, v16, v17
    v_cvt_pk_bf16_f32 v81, v18, v19
    v_cvt_pk_bf16_f32 v82, v20, v21
    v_cvt_pk_bf16_f32 v83, v22, v23
    s_waitcnt lgkmcnt(2)
    v_mfma_f32_32x32x16_bf16 v[32:47], v[104:107], v[96:99], v[32:47]
    ds_read_b128 v[104:107], v5 offset:1024
    v_exp_f32 v24, v24
    v_exp_f32 v25, v25
    v_exp_f32 v26, v26
    v_exp_f32 v27, v27
    v_mfma_f32_32x32x16_bf16 v[48:63], v[108:111], v[80:83], v[48:63]
    ds_read_b128 v[108:111], v4 offset:14336
    v_exp_f32 v28, v28
    v_exp_f32 v29, v29
    v_exp_f32 v30, v30
    v_exp_f32 v31, v31
    v_cvt_pk_bf16_f32 v84, v24, v25
    v_cvt_pk_bf16_f32 v85, v26, v27
    v_cvt_pk_bf16_f32 v86, v28, v29
    v_cvt_pk_bf16_f32 v87, v30, v31
    s_setprio 2
    s_waitcnt lgkmcnt(2)
    v_mfma_f32_32x32x16_bf16 v[16:31], v[100:103], v[92:95], v[64:79]
    ds_read_b128 v[100:103], v5 offset:2048
    v_exp_f32 v32, v32
    v_exp_f32 v33, v33
    v_exp_f32 v34, v34
    v_exp_f32 v35, v35
    v_mfma_f32_32x32x16_bf16 v[48:63], v[112:115], v[84:87], v[48:63]
    ds_read_b128 v[112:115], v4 offset:15360
    v_exp_f32 v36, v36
    v_exp_f32 v37, v37
    v_exp_f32 v38, v38
    v_exp_f32 v39, v39
    v_smfmac_f32_16x16x64_bf16 v[88:91], v[116:119], v[80:87], v2
    v_cvt_pk_bf16_f32 v80, v32, v33
    v_cvt_pk_bf16_f32 v81, v34, v35
    v_cvt_pk_bf16_f32 v82, v36, v37
    v_cvt_pk_bf16_f32 v83, v38, v39
    s_waitcnt lgkmcnt(2)
    v_mfma_f32_32x32x16_bf16 v[16:31], v[104:107], v[96:99], v[16:31]
    ds_read_b128 v[104:107], v5 offset:3072
    v_exp_f32 v40, v40
    v_exp_f32 v41, v41
    v_exp_f32 v42, v42
    v_exp_f32 v43, v43
    v_mfma_f32_32x32x16_bf16 v[48:63], v[108:111], v[80:83], v[48:63]
    ds_read_b128 v[108:111], v5 offset:8192
    v_exp_f32 v44, v44
    v_exp_f32 v45, v45
    v_exp_f32 v46, v46
    v_exp_f32 v47, v47
    v_cvt_pk_bf16_f32 v84, v40, v41
    v_cvt_pk_bf16_f32 v85, v42, v43
    v_cvt_pk_bf16_f32 v86, v44, v45
    v_cvt_pk_bf16_f32 v87, v46, v47
    s_setprio 1
    s_waitcnt lgkmcnt(2)
    v_mfma_f32_32x32x16_bf16 v[32:47], v[100:103], v[92:95], v[64:79]
    ds_read_b128 v[100:103], v5 offset:4096
    v_exp_f32 v16, v16
    v_exp_f32 v17, v17
    v_exp_f32 v18, v18
    v_exp_f32 v19, v19
    v_mfma_f32_32x32x16_bf16 v[48:63], v[112:115], v[84:87], v[48:63]
    ds_read_b128 v[112:115], v5 offset:9216
    v_exp_f32 v20, v20
    v_exp_f32 v21, v21
    v_exp_f32 v22, v22
    v_exp_f32 v23, v23
    v_smfmac_f32_16x16x64_bf16 v[88:91], v[116:119], v[80:87], v2
    v_cvt_pk_bf16_f32 v80, v16, v17
    v_cvt_pk_bf16_f32 v81, v18, v19
    v_cvt_pk_bf16_f32 v82, v20, v21
    v_cvt_pk_bf16_f32 v83, v22, v23
    s_waitcnt lgkmcnt(2)
    v_mfma_f32_32x32x16_bf16 v[32:47], v[104:107], v[96:99], v[32:47]
    ds_read_b128 v[104:107], v5 offset:5120
    v_exp_f32 v24, v24
    v_exp_f32 v25, v25
    v_exp_f32 v26, v26
    v_exp_f32 v27, v27
    v_mfma_f32_32x32x16_bf16 v[48:63], v[108:111], v[80:83], v[48:63]
    ds_read_b128 v[108:111], v5 offset:10240
    v_exp_f32 v28, v28
    v_exp_f32 v29, v29
    v_exp_f32 v30, v30
    v_exp_f32 v31, v31
    v_cvt_pk_bf16_f32 v84, v24, v25
    v_cvt_pk_bf16_f32 v85, v26, v27
    v_cvt_pk_bf16_f32 v86, v28, v29
    v_cvt_pk_bf16_f32 v87, v30, v31
    s_setprio 0
    s_waitcnt lgkmcnt(2)
    v_mfma_f32_32x32x16_bf16 v[16:31], v[100:103], v[92:95], v[64:79]
    ds_read_b128 v[100:103], v5 offset:6144
    v_exp_f32 v32, v32
    v_exp_f32 v33, v33
    v_exp_f32 v34, v34
    v_exp_f32 v35, v35
    v_mfma_f32_32x32x16_bf16 v[48:63], v[112:115], v[84:87], v[48:63]
    ds_read_b128 v[112:115], v5 offset:11264
    v_exp_f32 v36, v36
    v_exp_f32 v37, v37
    v_exp_f32 v38, v38
    v_exp_f32 v39, v39
    v_smfmac_f32_16x16x64_bf16 v[88:91], v[116:119], v[80:87], v2
    v_cvt_pk_bf16_f32 v80, v32, v33
    v_cvt_pk_bf16_f32 v81, v34, v35
    v_cvt_pk_bf16_f32 v82, v36, v37
    v_cvt_pk_bf16_f32 v83, v38, v39
    s_waitcnt lgkmcnt(2)
    v_mfma_f32_32x32x16_bf16 v[16:31], v[104:107], v[96:99], v[16:31]
    ds_read_b128 v[104:107], v5 offset:7168
    s_add_u32 s29, s29, 16384
    s_and_b32 s29, s29, 65535
    v_add_u32 v4, s29, v3
    v_exp_f32 v40, v40
    v_exp_f32 v41, v41
    v_exp_f32 v42, v42
    v_exp_f32 v43, v43
    v_mfma_f32_32x32x16_bf16 v[48:63], v[108:111], v[80:83], v[48:63]
    ds_read_b128 v[108:111], v5 offset:12288
    v_exp_f32 v44, v44
    v_exp_f32 v45, v45
    v_exp_f32 v46, v46
    v_exp_f32 v47, v47
    v_cvt_pk_bf16_f32 v84, v40, v41
    v_cvt_pk_bf16_f32 v85, v42, v43
    v_cvt_pk_bf16_f32 v86, v44, v45
    v_cvt_pk_bf16_f32 v87, v46, v47
    s_barrier
    s_setprio 3
    s_waitcnt lgkmcnt(2)
    v_mfma_f32_32x32x16_bf16 v[32:47], v[100:103], v[92:95], v[64:79]
    ds_read_b128 v[100:103], v4 offset:0
    v_exp_f32 v16, v16
    v_exp_f32 v17, v17
    v_exp_f32 v18, v18
    v_exp_f32 v19, v19
    v_mfma_f32_32x32x16_bf16 v[48:63], v[112:115], v[84:87], v[48:63]
    ds_read_b128 v[112:115], v5 offset:13312
    v_exp_f32 v20, v20
    v_exp_f32 v21, v21
    v_exp_f32 v22, v22
    v_exp_f32 v23, v23
    v_smfmac_f32_16x16x64_bf16 v[88:91], v[116:119], v[80:87], v2
    v_cvt_pk_bf16_f32 v80, v16, v17
    v_cvt_pk_bf16_f32 v81, v18, v19
    v_cvt_pk_bf16_f32 v82, v20, v21
    v_cvt_pk_bf16_f32 v83, v22, v23
    s_waitcnt lgkmcnt(2)
    v_mfma_f32_32x32x16_bf16 v[32:47], v[104:107], v[96:99], v[32:47]
    ds_read_b128 v[104:107], v4 offset:1024
    v_exp_f32 v24, v24
    v_exp_f32 v25, v25
    v_exp_f32 v26, v26
    v_exp_f32 v27, v27
    v_mfma_f32_32x32x16_bf16 v[48:63], v[108:111], v[80:83], v[48:63]
    ds_read_b128 v[108:111], v5 offset:14336
    v_exp_f32 v28, v28
    v_exp_f32 v29, v29
    v_exp_f32 v30, v30
    v_exp_f32 v31, v31
    v_cvt_pk_bf16_f32 v84, v24, v25
    v_cvt_pk_bf16_f32 v85, v26, v27
    v_cvt_pk_bf16_f32 v86, v28, v29
    v_cvt_pk_bf16_f32 v87, v30, v31
    s_setprio 2
    s_waitcnt lgkmcnt(2)
    v_mfma_f32_32x32x16_bf16 v[16:31], v[100:103], v[92:95], v[64:79]
    ds_read_b128 v[100:103], v4 offset:2048
    v_exp_f32 v32, v32
    v_exp_f32 v33, v33
    v_exp_f32 v34, v34
    v_exp_f32 v35, v35
    v_mfma_f32_32x32x16_bf16 v[48:63], v[112:115], v[84:87], v[48:63]
    ds_read_b128 v[112:115], v5 offset:15360
    v_exp_f32 v36, v36
    v_exp_f32 v37, v37
    v_exp_f32 v38, v38
    v_exp_f32 v39, v39
    v_smfmac_f32_16x16x64_bf16 v[88:91], v[116:119], v[80:87], v2
    v_cvt_pk_bf16_f32 v80, v32, v33
    v_cvt_pk_bf16_f32 v81, v34, v35
    v_cvt_pk_bf16_f32 v82, v36, v37
    v_cvt_pk_bf16_f32 v83, v38, v39
    s_waitcnt lgkmcnt(2)
    v_mfma_f32_32x32x16_bf16 v[16:31], v[104:107], v[96:99], v[16:31]
    ds_read_b128 v[104:107], v4 offset:3072
    v_exp_f32 v40, v40
    v_exp_f32 v41, v41
    v_exp_f32 v42, v42
    v_exp_f32 v43, v43
    v_mfma_f32_32x32x16_bf16 v[48:63], v[108:111], v[80:83], v[48:63]
    ds_read_b128 v[108:111], v4 offset:8192
    v_exp_f32 v44, v44
    v_exp_f32 v45, v45
    v_exp_f32 v46, v46
    v_exp_f32 v47, v47
    s_sub_u32 s30, s30, 1
    s_cmp_lg_u32 s30, 0
    v_cvt_pk_bf16_f32 v84, v40, v41
    v_cvt_pk_bf16_f32 v85, v42, v43
    v_cvt_pk_bf16_f32 v86, v44, v45
    v_cvt_pk_bf16_f32 v87, v46, v47
    s_cbranch_scc1 attn_kernel_loop
    s_waitcnt lgkmcnt(0)
    s_nop 0
    v_smfmac_f32_16x16x64_bf16 v[88:91], v[116:119], v[80:87], v2
    v_mfma_f32_32x32x16_bf16 v[48:63], v[112:115], v[84:87], v[48:63]
    s_lshl_b32 s32, s26, 11
    s_nop 3
attn_kernel_finish:
    s_nop 7
    v_add_f32 v88, v88, v89
    v_rcp_f32 v8, v88
    v_mov_b32 v9, 0x5f800000
    s_nop 3
    v_pk_mul_f32 v[32:33], v[48:49], v[8:9] op_sel_hi:[1,0]
    v_pk_mul_f32 v[34:35], v[50:51], v[8:9] op_sel_hi:[1,0]
    v_pk_mul_f32 v[36:37], v[52:53], v[8:9] op_sel_hi:[1,0]
    v_pk_mul_f32 v[38:39], v[54:55], v[8:9] op_sel_hi:[1,0]
    v_pk_mul_f32 v[40:41], v[56:57], v[8:9] op_sel_hi:[1,0]
    v_pk_mul_f32 v[42:43], v[58:59], v[8:9] op_sel_hi:[1,0]
    v_pk_mul_f32 v[44:45], v[60:61], v[8:9] op_sel_hi:[1,0]
    v_pk_mul_f32 v[46:47], v[62:63], v[8:9] op_sel_hi:[1,0]
    v_mov_b32 v10, v88
    v_mov_b32 v11, 0
    v_pk_fma_f32 v[10:11], v[32:33], 0, v[10:11] op_sel_hi:[1,0,1]
    v_pk_fma_f32 v[10:11], v[34:35], 0, v[10:11] op_sel_hi:[1,0,1]
    v_pk_fma_f32 v[10:11], v[36:37], 0, v[10:11] op_sel_hi:[1,0,1]
    v_pk_fma_f32 v[10:11], v[38:39], 0, v[10:11] op_sel_hi:[1,0,1]
    v_pk_fma_f32 v[10:11], v[40:41], 0, v[10:11] op_sel_hi:[1,0,1]
    v_pk_fma_f32 v[10:11], v[42:43], 0, v[10:11] op_sel_hi:[1,0,1]
    v_pk_fma_f32 v[10:11], v[44:45], 0, v[10:11] op_sel_hi:[1,0,1]
    v_pk_fma_f32 v[10:11], v[46:47], 0, v[10:11] op_sel_hi:[1,0,1]
    v_add_f32 v10, v10, v11
    v_cvt_pk_bf16_f32 v80, v32, v33
    v_cvt_pk_bf16_f32 v81, v34, v35
    v_cvt_pk_bf16_f32 v82, v36, v37
    v_cvt_pk_bf16_f32 v83, v38, v39
    v_cvt_pk_bf16_f32 v84, v40, v41
    v_cvt_pk_bf16_f32 v85, v42, v43
    v_cvt_pk_bf16_f32 v86, v44, v45
    v_cvt_pk_bf16_f32 v87, v46, v47
    v_cmp_nlt_f32 vcc, v10, v9
    s_cmp_lg_u32 s30, 0
    s_cbranch_scc1 attn_kernel_store
    s_cbranch_vccnz attn_kernel_slow
attn_kernel_store:
    buffer_store_dwordx4 v[80:83], v3, s[16:19], s32 offen sc1
    buffer_store_dwordx4 v[84:87], v3, s[16:19], s32 offen offset:1024 sc1
    s_lshr_b32 s44, s24, 2
    s_and_b32 s45, s24, 3
    s_lshl_b32 s34, s31, 2
    s_add_u32 s45, s45, s34
    v_bfe_u32 v8, v1, 2, 2
    v_lshrrev_b32 v9, 5, v1
    v_lshl_add_u32 v11, v9, 2, v8
    v_lshlrev_b32 v11, 7, v11
    v_and_b32 v10, 3, v1
    v_lshl_add_u32 v11, v10, 3, v11
    v_bfe_u32 v10, v1, 4, 1
    v_lshl_add_u32 v11, v10, 5, v11
    v_bfe_u32 v10, v1, 3, 1
    v_lshl_add_u32 v11, v10, 6, v11
    s_lshl_b32 s34, s44, 6
    v_xor_b32 v11, s34, v11
    s_lshl_b32 s34, s44, 16
    s_add_u32 s34, s34, 65536
    s_cmp_eq_u32 s44, 0
    s_cselect_b32 s35, 98304, 0
    v_add_u32 v4, s34, v11
    v_xor_b32 v5, 64, v4
    v_add_u32 v6, s35, v11
    v_xor_b32 v7, 64, v6
    s_lshl_b32 s36, s45, 16
    s_lshl_b32 s27, s47, 2
    s_add_u32 s27, s27, s44
    s_add_u32 s27, s27, 4
    s_lshl_b32 s27, s27, 17
    s_and_b32 s27, s27, 4194303
    s_lshl_b32 s37, s45, 11
    v_and_b32 v8, 31, v1
    v_lshlrev_b32 v8, 11, v8
    v_lshl_add_u32 v8, v9, 4, v8
    s_lshl_b32 s38, s49, 7
    s_add_u32 s38, s38, s36
    s_lshl_b32 s39, s44, 6
    s_add_u32 s38, s38, s39
    s_add_u32 s8, s4, 4194304
    s_addc_u32 s9, s5, 0
    s_add_u32 s8, s8, s37
    s_addc_u32 s9, s9, 0
    s_mov_b32 s10, 4065280
    s_mov_b32 s11, 0x20000
    s_mov_b32 s12, s50
    s_mov_b32 s13, s51
    s_mov_b32 s14, 4194304
    s_mov_b32 s15, 0x20000
    s_waitcnt vmcnt(0)
    s_barrier
    buffer_load_dwordx4 v[144:147], v8, s[12:15], s38 offen offset:0
    buffer_load_dwordx4 v[148:151], v8, s[12:15], s38 offen offset:32
    s_barrier
    buffer_load_dwordx4 v[48:51], v3, s[8:11], s27 offen offset:0 sc1
    buffer_load_dwordx4 v[52:55], v3, s[8:11], s27 offen offset:1024 sc1
    s_add_u32 s27, s27, 262144
    s_and_b32 s27, s27, 4194303
    buffer_load_dwordx4 v[56:59], v3, s[8:11], s27 offen offset:0 sc1
    buffer_load_dwordx4 v[60:63], v3, s[8:11], s27 offen offset:1024 sc1
    s_add_u32 s27, s27, 262144
    s_and_b32 s27, s27, 4194303
    buffer_load_dwordx4 v[64:67], v3, s[8:11], s27 offen offset:0 sc1
    buffer_load_dwordx4 v[68:71], v3, s[8:11], s27 offen offset:1024 sc1
    s_add_u32 s27, s27, 262144
    s_and_b32 s27, s27, 4194303
    buffer_load_dwordx4 v[72:75], v3, s[8:11], s27 offen offset:0 sc1
    buffer_load_dwordx4 v[76:79], v3, s[8:11], s27 offen offset:1024 sc1
    ds_read_b64_tr_b16 v[112:113], v4 offset:0
    ds_read_b64_tr_b16 v[114:115], v4 offset:1024
    ds_read_b64_tr_b16 v[116:117], v5 offset:0
    ds_read_b64_tr_b16 v[118:119], v5 offset:1024
    ds_read_b64_tr_b16 v[120:121], v4 offset:2048
    ds_read_b64_tr_b16 v[122:123], v4 offset:3072
    ds_read_b64_tr_b16 v[124:125], v5 offset:2048
    ds_read_b64_tr_b16 v[126:127], v5 offset:3072
    ds_read_b64_tr_b16 v[128:129], v4 offset:4096
    ds_read_b64_tr_b16 v[130:131], v4 offset:5120
    ds_read_b64_tr_b16 v[132:133], v5 offset:4096
    ds_read_b64_tr_b16 v[134:135], v5 offset:5120
    ds_read_b64_tr_b16 v[136:137], v4 offset:6144
    ds_read_b64_tr_b16 v[138:139], v4 offset:7168
    ds_read_b64_tr_b16 v[140:141], v5 offset:6144
    ds_read_b64_tr_b16 v[142:143], v5 offset:7168
    s_add_u32 s27, s27, 262144
    s_and_b32 s27, s27, 4194303
    buffer_load_dwordx4 v[80:83], v3, s[8:11], s27 offen offset:0 sc1
    buffer_load_dwordx4 v[84:87], v3, s[8:11], s27 offen offset:1024 sc1
    s_add_u32 s27, s27, 262144
    s_and_b32 s27, s27, 4194303
    buffer_load_dwordx4 v[88:91], v3, s[8:11], s27 offen offset:0 sc1
    buffer_load_dwordx4 v[92:95], v3, s[8:11], s27 offen offset:1024 sc1
    s_add_u32 s27, s27, 262144
    s_and_b32 s27, s27, 4194303
    buffer_load_dwordx4 v[96:99], v3, s[8:11], s27 offen offset:0 sc1
    buffer_load_dwordx4 v[100:103], v3, s[8:11], s27 offen offset:1024 sc1
    s_add_u32 s27, s27, 262144
    s_and_b32 s27, s27, 4194303
    buffer_load_dwordx4 v[104:107], v3, s[8:11], s27 offen offset:0 sc1
    buffer_load_dwordx4 v[108:111], v3, s[8:11], s27 offen offset:1024 sc1
    s_waitcnt vmcnt(15) lgkmcnt(12)
    v_mfma_f32_32x32x16_bf16 v[16:31], v[112:115], v[48:51], 0
    ds_read_b64_tr_b16 v[112:113], v4 offset:8192
    ds_read_b64_tr_b16 v[114:115], v4 offset:9216
    v_mfma_f32_32x32x16_bf16 v[32:47], v[116:119], v[48:51], 0
    ds_read_b64_tr_b16 v[116:117], v5 offset:8192
    ds_read_b64_tr_b16 v[118:119], v5 offset:9216
    s_add_u32 s27, s27, 262144
    s_and_b32 s27, s27, 4194303
    buffer_load_dwordx4 v[48:51], v3, s[8:11], s27 offen offset:0 sc1
    s_waitcnt vmcnt(15) lgkmcnt(12)
    v_mfma_f32_32x32x16_bf16 v[16:31], v[120:123], v[52:55], v[16:31]
    ds_read_b64_tr_b16 v[120:121], v4 offset:10240
    ds_read_b64_tr_b16 v[122:123], v4 offset:11264
    v_mfma_f32_32x32x16_bf16 v[32:47], v[124:127], v[52:55], v[32:47]
    ds_read_b64_tr_b16 v[124:125], v5 offset:10240
    ds_read_b64_tr_b16 v[126:127], v5 offset:11264
    buffer_load_dwordx4 v[52:55], v3, s[8:11], s27 offen offset:1024 sc1
    s_waitcnt vmcnt(15) lgkmcnt(12)
    v_mfma_f32_32x32x16_bf16 v[16:31], v[128:131], v[56:59], v[16:31]
    ds_read_b64_tr_b16 v[128:129], v4 offset:12288
    ds_read_b64_tr_b16 v[130:131], v4 offset:13312
    v_mfma_f32_32x32x16_bf16 v[32:47], v[132:135], v[56:59], v[32:47]
    ds_read_b64_tr_b16 v[132:133], v5 offset:12288
    ds_read_b64_tr_b16 v[134:135], v5 offset:13312
    s_add_u32 s27, s27, 262144
    s_and_b32 s27, s27, 4194303
    buffer_load_dwordx4 v[56:59], v3, s[8:11], s27 offen offset:0 sc1
    s_waitcnt vmcnt(15) lgkmcnt(12)
    v_mfma_f32_32x32x16_bf16 v[16:31], v[136:139], v[60:63], v[16:31]
    ds_read_b64_tr_b16 v[136:137], v4 offset:14336
    ds_read_b64_tr_b16 v[138:139], v4 offset:15360
    v_mfma_f32_32x32x16_bf16 v[32:47], v[140:143], v[60:63], v[32:47]
    ds_read_b64_tr_b16 v[140:141], v5 offset:14336
    ds_read_b64_tr_b16 v[142:143], v5 offset:15360
    buffer_load_dwordx4 v[60:63], v3, s[8:11], s27 offen offset:1024 sc1
    s_waitcnt vmcnt(15) lgkmcnt(12)
    v_mfma_f32_32x32x16_bf16 v[16:31], v[112:115], v[64:67], v[16:31]
    ds_read_b64_tr_b16 v[112:113], v4 offset:16384
    ds_read_b64_tr_b16 v[114:115], v4 offset:17408
    v_mfma_f32_32x32x16_bf16 v[32:47], v[116:119], v[64:67], v[32:47]
    ds_read_b64_tr_b16 v[116:117], v5 offset:16384
    ds_read_b64_tr_b16 v[118:119], v5 offset:17408
    s_add_u32 s27, s27, 262144
    s_and_b32 s27, s27, 4194303
    buffer_load_dwordx4 v[64:67], v3, s[8:11], s27 offen offset:0 sc1
    s_waitcnt vmcnt(15) lgkmcnt(12)
    v_mfma_f32_32x32x16_bf16 v[16:31], v[120:123], v[68:71], v[16:31]
    ds_read_b64_tr_b16 v[120:121], v4 offset:18432
    ds_read_b64_tr_b16 v[122:123], v4 offset:19456
    v_mfma_f32_32x32x16_bf16 v[32:47], v[124:127], v[68:71], v[32:47]
    ds_read_b64_tr_b16 v[124:125], v5 offset:18432
    ds_read_b64_tr_b16 v[126:127], v5 offset:19456
    buffer_load_dwordx4 v[68:71], v3, s[8:11], s27 offen offset:1024 sc1
    s_waitcnt vmcnt(15) lgkmcnt(12)
    v_mfma_f32_32x32x16_bf16 v[16:31], v[128:131], v[72:75], v[16:31]
    ds_read_b64_tr_b16 v[128:129], v4 offset:20480
    ds_read_b64_tr_b16 v[130:131], v4 offset:21504
    v_mfma_f32_32x32x16_bf16 v[32:47], v[132:135], v[72:75], v[32:47]
    ds_read_b64_tr_b16 v[132:133], v5 offset:20480
    ds_read_b64_tr_b16 v[134:135], v5 offset:21504
    s_add_u32 s27, s27, 262144
    s_and_b32 s27, s27, 4194303
    buffer_load_dwordx4 v[72:75], v3, s[8:11], s27 offen offset:0 sc1
    s_waitcnt vmcnt(15) lgkmcnt(12)
    v_mfma_f32_32x32x16_bf16 v[16:31], v[136:139], v[76:79], v[16:31]
    ds_read_b64_tr_b16 v[136:137], v4 offset:22528
    ds_read_b64_tr_b16 v[138:139], v4 offset:23552
    v_mfma_f32_32x32x16_bf16 v[32:47], v[140:143], v[76:79], v[32:47]
    ds_read_b64_tr_b16 v[140:141], v5 offset:22528
    ds_read_b64_tr_b16 v[142:143], v5 offset:23552
    buffer_load_dwordx4 v[76:79], v3, s[8:11], s27 offen offset:1024 sc1
    s_waitcnt vmcnt(15) lgkmcnt(12)
    v_mfma_f32_32x32x16_bf16 v[16:31], v[112:115], v[80:83], v[16:31]
    ds_read_b64_tr_b16 v[112:113], v4 offset:24576
    ds_read_b64_tr_b16 v[114:115], v4 offset:25600
    v_mfma_f32_32x32x16_bf16 v[32:47], v[116:119], v[80:83], v[32:47]
    ds_read_b64_tr_b16 v[116:117], v5 offset:24576
    ds_read_b64_tr_b16 v[118:119], v5 offset:25600
    s_add_u32 s27, s27, 262144
    s_and_b32 s27, s27, 4194303
    buffer_load_dwordx4 v[80:83], v3, s[8:11], s27 offen offset:0 sc1
    s_waitcnt vmcnt(15) lgkmcnt(12)
    v_mfma_f32_32x32x16_bf16 v[16:31], v[120:123], v[84:87], v[16:31]
    ds_read_b64_tr_b16 v[120:121], v4 offset:26624
    ds_read_b64_tr_b16 v[122:123], v4 offset:27648
    v_mfma_f32_32x32x16_bf16 v[32:47], v[124:127], v[84:87], v[32:47]
    ds_read_b64_tr_b16 v[124:125], v5 offset:26624
    ds_read_b64_tr_b16 v[126:127], v5 offset:27648
    buffer_load_dwordx4 v[84:87], v3, s[8:11], s27 offen offset:1024 sc1
    s_waitcnt vmcnt(15) lgkmcnt(12)
    v_mfma_f32_32x32x16_bf16 v[16:31], v[128:131], v[88:91], v[16:31]
    ds_read_b64_tr_b16 v[128:129], v4 offset:28672
    ds_read_b64_tr_b16 v[130:131], v4 offset:29696
    v_mfma_f32_32x32x16_bf16 v[32:47], v[132:135], v[88:91], v[32:47]
    ds_read_b64_tr_b16 v[132:133], v5 offset:28672
    ds_read_b64_tr_b16 v[134:135], v5 offset:29696
    s_add_u32 s27, s27, 262144
    s_and_b32 s27, s27, 4194303
    buffer_load_dwordx4 v[88:91], v3, s[8:11], s27 offen offset:0 sc1
    s_waitcnt vmcnt(15) lgkmcnt(12)
    v_mfma_f32_32x32x16_bf16 v[16:31], v[136:139], v[92:95], v[16:31]
    ds_read_b64_tr_b16 v[136:137], v4 offset:30720
    ds_read_b64_tr_b16 v[138:139], v4 offset:31744
    v_mfma_f32_32x32x16_bf16 v[32:47], v[140:143], v[92:95], v[32:47]
    ds_read_b64_tr_b16 v[140:141], v5 offset:30720
    ds_read_b64_tr_b16 v[142:143], v5 offset:31744
    buffer_load_dwordx4 v[92:95], v3, s[8:11], s27 offen offset:1024 sc1
    s_waitcnt vmcnt(15) lgkmcnt(12)
    v_mfma_f32_32x32x16_bf16 v[16:31], v[112:115], v[96:99], v[16:31]
    ds_read_b64_tr_b16 v[112:113], v6 offset:0
    ds_read_b64_tr_b16 v[114:115], v6 offset:1024
    v_mfma_f32_32x32x16_bf16 v[32:47], v[116:119], v[96:99], v[32:47]
    ds_read_b64_tr_b16 v[116:117], v7 offset:0
    ds_read_b64_tr_b16 v[118:119], v7 offset:1024
    s_waitcnt vmcnt(14) lgkmcnt(12)
    v_mfma_f32_32x32x16_bf16 v[16:31], v[120:123], v[100:103], v[16:31]
    ds_read_b64_tr_b16 v[120:121], v6 offset:2048
    ds_read_b64_tr_b16 v[122:123], v6 offset:3072
    v_mfma_f32_32x32x16_bf16 v[32:47], v[124:127], v[100:103], v[32:47]
    ds_read_b64_tr_b16 v[124:125], v7 offset:2048
    ds_read_b64_tr_b16 v[126:127], v7 offset:3072
    s_waitcnt vmcnt(13) lgkmcnt(12)
    v_mfma_f32_32x32x16_bf16 v[16:31], v[128:131], v[104:107], v[16:31]
    ds_read_b64_tr_b16 v[128:129], v6 offset:4096
    ds_read_b64_tr_b16 v[130:131], v6 offset:5120
    v_mfma_f32_32x32x16_bf16 v[32:47], v[132:135], v[104:107], v[32:47]
    ds_read_b64_tr_b16 v[132:133], v7 offset:4096
    ds_read_b64_tr_b16 v[134:135], v7 offset:5120
    s_waitcnt vmcnt(12) lgkmcnt(12)
    v_mfma_f32_32x32x16_bf16 v[16:31], v[136:139], v[108:111], v[16:31]
    ds_read_b64_tr_b16 v[136:137], v6 offset:6144
    ds_read_b64_tr_b16 v[138:139], v6 offset:7168
    v_mfma_f32_32x32x16_bf16 v[32:47], v[140:143], v[108:111], v[32:47]
    ds_read_b64_tr_b16 v[140:141], v7 offset:6144
    ds_read_b64_tr_b16 v[142:143], v7 offset:7168
    s_waitcnt vmcnt(11) lgkmcnt(12)
    v_mfma_f32_32x32x16_bf16 v[16:31], v[112:115], v[48:51], v[16:31]
    ds_read_b64_tr_b16 v[112:113], v6 offset:8192
    ds_read_b64_tr_b16 v[114:115], v6 offset:9216
    v_mfma_f32_32x32x16_bf16 v[32:47], v[116:119], v[48:51], v[32:47]
    ds_read_b64_tr_b16 v[116:117], v7 offset:8192
    ds_read_b64_tr_b16 v[118:119], v7 offset:9216
    s_barrier
    s_add_u32 s27, s27, 262144
    s_and_b32 s27, s27, 4194303
    buffer_load_dwordx4 v[96:99], v3, s[8:11], s27 offen offset:0 sc1
    buffer_load_dwordx4 v[100:103], v3, s[8:11], s27 offen offset:1024 sc1
    s_add_u32 s27, s27, 262144
    s_and_b32 s27, s27, 4194303
    buffer_load_dwordx4 v[104:107], v3, s[8:11], s27 offen offset:0 sc1
    buffer_load_dwordx4 v[108:111], v3, s[8:11], s27 offen offset:1024 sc1
    s_waitcnt vmcnt(14) lgkmcnt(12)
    v_mfma_f32_32x32x16_bf16 v[16:31], v[120:123], v[52:55], v[16:31]
    ds_read_b64_tr_b16 v[120:121], v6 offset:10240
    ds_read_b64_tr_b16 v[122:123], v6 offset:11264
    v_mfma_f32_32x32x16_bf16 v[32:47], v[124:127], v[52:55], v[32:47]
    ds_read_b64_tr_b16 v[124:125], v7 offset:10240
    ds_read_b64_tr_b16 v[126:127], v7 offset:11264
    s_waitcnt vmcnt(13) lgkmcnt(12)
    v_mfma_f32_32x32x16_bf16 v[16:31], v[128:131], v[56:59], v[16:31]
    ds_read_b64_tr_b16 v[128:129], v6 offset:12288
    ds_read_b64_tr_b16 v[130:131], v6 offset:13312
    v_mfma_f32_32x32x16_bf16 v[32:47], v[132:135], v[56:59], v[32:47]
    ds_read_b64_tr_b16 v[132:133], v7 offset:12288
    ds_read_b64_tr_b16 v[134:135], v7 offset:13312
    s_waitcnt vmcnt(12) lgkmcnt(12)
    v_mfma_f32_32x32x16_bf16 v[16:31], v[136:139], v[60:63], v[16:31]
    ds_read_b64_tr_b16 v[136:137], v6 offset:14336
    ds_read_b64_tr_b16 v[138:139], v6 offset:15360
    v_mfma_f32_32x32x16_bf16 v[32:47], v[140:143], v[60:63], v[32:47]
    ds_read_b64_tr_b16 v[140:141], v7 offset:14336
    ds_read_b64_tr_b16 v[142:143], v7 offset:15360
    s_waitcnt vmcnt(11) lgkmcnt(12)
    v_mfma_f32_32x32x16_bf16 v[16:31], v[112:115], v[64:67], v[16:31]
    ds_read_b64_tr_b16 v[112:113], v6 offset:16384
    ds_read_b64_tr_b16 v[114:115], v6 offset:17408
    v_mfma_f32_32x32x16_bf16 v[32:47], v[116:119], v[64:67], v[32:47]
    ds_read_b64_tr_b16 v[116:117], v7 offset:16384
    ds_read_b64_tr_b16 v[118:119], v7 offset:17408
    s_waitcnt vmcnt(10) lgkmcnt(12)
    v_mfma_f32_32x32x16_bf16 v[16:31], v[120:123], v[68:71], v[16:31]
    ds_read_b64_tr_b16 v[120:121], v6 offset:18432
    ds_read_b64_tr_b16 v[122:123], v6 offset:19456
    v_mfma_f32_32x32x16_bf16 v[32:47], v[124:127], v[68:71], v[32:47]
    ds_read_b64_tr_b16 v[124:125], v7 offset:18432
    ds_read_b64_tr_b16 v[126:127], v7 offset:19456
    s_waitcnt vmcnt(9) lgkmcnt(12)
    v_mfma_f32_32x32x16_bf16 v[16:31], v[128:131], v[72:75], v[16:31]
    ds_read_b64_tr_b16 v[128:129], v6 offset:20480
    ds_read_b64_tr_b16 v[130:131], v6 offset:21504
    v_mfma_f32_32x32x16_bf16 v[32:47], v[132:135], v[72:75], v[32:47]
    ds_read_b64_tr_b16 v[132:133], v7 offset:20480
    ds_read_b64_tr_b16 v[134:135], v7 offset:21504
    s_waitcnt vmcnt(8) lgkmcnt(12)
    v_mfma_f32_32x32x16_bf16 v[16:31], v[136:139], v[76:79], v[16:31]
    ds_read_b64_tr_b16 v[136:137], v6 offset:22528
    ds_read_b64_tr_b16 v[138:139], v6 offset:23552
    v_mfma_f32_32x32x16_bf16 v[32:47], v[140:143], v[76:79], v[32:47]
    ds_read_b64_tr_b16 v[140:141], v7 offset:22528
    ds_read_b64_tr_b16 v[142:143], v7 offset:23552
    s_waitcnt vmcnt(7) lgkmcnt(12)
    v_mfma_f32_32x32x16_bf16 v[16:31], v[112:115], v[80:83], v[16:31]
    ds_read_b64_tr_b16 v[112:113], v6 offset:24576
    ds_read_b64_tr_b16 v[114:115], v6 offset:25600
    v_mfma_f32_32x32x16_bf16 v[32:47], v[116:119], v[80:83], v[32:47]
    ds_read_b64_tr_b16 v[116:117], v7 offset:24576
    ds_read_b64_tr_b16 v[118:119], v7 offset:25600
    s_waitcnt vmcnt(6) lgkmcnt(12)
    v_mfma_f32_32x32x16_bf16 v[16:31], v[120:123], v[84:87], v[16:31]
    ds_read_b64_tr_b16 v[120:121], v6 offset:26624
    ds_read_b64_tr_b16 v[122:123], v6 offset:27648
    v_mfma_f32_32x32x16_bf16 v[32:47], v[124:127], v[84:87], v[32:47]
    ds_read_b64_tr_b16 v[124:125], v7 offset:26624
    ds_read_b64_tr_b16 v[126:127], v7 offset:27648
    s_waitcnt vmcnt(5) lgkmcnt(12)
    v_mfma_f32_32x32x16_bf16 v[16:31], v[128:131], v[88:91], v[16:31]
    ds_read_b64_tr_b16 v[128:129], v6 offset:28672
    ds_read_b64_tr_b16 v[130:131], v6 offset:29696
    v_mfma_f32_32x32x16_bf16 v[32:47], v[132:135], v[88:91], v[32:47]
    ds_read_b64_tr_b16 v[132:133], v7 offset:28672
    ds_read_b64_tr_b16 v[134:135], v7 offset:29696
    s_waitcnt vmcnt(4) lgkmcnt(12)
    v_mfma_f32_32x32x16_bf16 v[16:31], v[136:139], v[92:95], v[16:31]
    ds_read_b64_tr_b16 v[136:137], v6 offset:30720
    ds_read_b64_tr_b16 v[138:139], v6 offset:31744
    v_mfma_f32_32x32x16_bf16 v[32:47], v[140:143], v[92:95], v[32:47]
    ds_read_b64_tr_b16 v[140:141], v7 offset:30720
    ds_read_b64_tr_b16 v[142:143], v7 offset:31744
    s_waitcnt vmcnt(3) lgkmcnt(12)
    v_mfma_f32_32x32x16_bf16 v[16:31], v[112:115], v[96:99], v[16:31]
    v_mfma_f32_32x32x16_bf16 v[32:47], v[116:119], v[96:99], v[32:47]
    s_waitcnt vmcnt(2) lgkmcnt(8)
    v_mfma_f32_32x32x16_bf16 v[16:31], v[120:123], v[100:103], v[16:31]
    v_mfma_f32_32x32x16_bf16 v[32:47], v[124:127], v[100:103], v[32:47]
    s_waitcnt vmcnt(1) lgkmcnt(4)
    v_mfma_f32_32x32x16_bf16 v[16:31], v[128:131], v[104:107], v[16:31]
    v_mfma_f32_32x32x16_bf16 v[32:47], v[132:135], v[104:107], v[32:47]
    s_waitcnt vmcnt(0) lgkmcnt(0)
    v_mfma_f32_32x32x16_bf16 v[16:31], v[136:139], v[108:111], v[16:31]
    v_mfma_f32_32x32x16_bf16 v[32:47], v[140:143], v[108:111], v[32:47]
    s_lshl_b32 s32, s24, 12
    s_add_u32 s32, s32, 32768
    v_add_u32 v13, s32, v3
    v_xor_b32 v14, 16384, v13
    v_permlane32_swap_b32 v144, v146
    v_permlane32_swap_b32 v145, v147
    v_permlane32_swap_b32 v148, v150
    v_permlane32_swap_b32 v149, v151
    s_add_u32 s12, s4, 20971520
    s_addc_u32 s13, s5, 0
    s_mov_b32 s14, 4194304
    s_mov_b32 s15, 0x20000
    ds_write_b128 v13, v[32:35] offset:0
    ds_write_b128 v13, v[36:39] offset:1024
    ds_write_b128 v13, v[40:43] offset:2048
    ds_write_b128 v13, v[44:47] offset:3072
    v_lshlrev_b32 v48, 16, v144
    v_and_b32 v49, s28, v144
    v_pk_add_f32 v[16:17], v[16:17], v[48:49]
    v_lshlrev_b32 v48, 16, v145
    v_and_b32 v49, s28, v145
    v_pk_add_f32 v[18:19], v[18:19], v[48:49]
    v_lshlrev_b32 v48, 16, v146
    v_and_b32 v49, s28, v146
    v_pk_add_f32 v[20:21], v[20:21], v[48:49]
    v_lshlrev_b32 v48, 16, v147
    v_and_b32 v49, s28, v147
    v_pk_add_f32 v[22:23], v[22:23], v[48:49]
    v_lshlrev_b32 v48, 16, v148
    v_and_b32 v49, s28, v148
    v_pk_add_f32 v[24:25], v[24:25], v[48:49]
    v_lshlrev_b32 v48, 16, v149
    v_and_b32 v49, s28, v149
    v_pk_add_f32 v[26:27], v[26:27], v[48:49]
    v_lshlrev_b32 v48, 16, v150
    v_and_b32 v49, s28, v150
    v_pk_add_f32 v[28:29], v[28:29], v[48:49]
    v_lshlrev_b32 v48, 16, v151
    v_and_b32 v49, s28, v151
    v_pk_add_f32 v[30:31], v[30:31], v[48:49]
    s_waitcnt lgkmcnt(0)
    s_barrier
    ds_read_b128 v[64:67], v14 offset:0
    ds_read_b128 v[68:71], v14 offset:1024
    ds_read_b128 v[72:75], v14 offset:2048
    ds_read_b128 v[76:79], v14 offset:3072
    s_lshl_b32 s37, s49, 12
    s_add_u32 s37, s37, s36
    s_lshl_b32 s38, s44, 11
    s_add_u32 s37, s37, s38
    v_mov_b32 v52, 0
    v_mov_b32 v53, 0
    v_mov_b32 v54, 0
    v_mov_b32 v55, 0
    s_waitcnt lgkmcnt(2)
    v_pk_add_f32 v[16:17], v[16:17], v[64:65]
    v_cvt_pk_bf16_f32 v56, v16, v17
    v_pk_add_f32 v[18:19], v[18:19], v[66:67]
    v_cvt_pk_bf16_f32 v57, v18, v19
    v_pk_add_f32 v[20:21], v[20:21], v[68:69]
    v_cvt_pk_bf16_f32 v58, v20, v21
    v_pk_add_f32 v[22:23], v[22:23], v[70:71]
    v_cvt_pk_bf16_f32 v59, v22, v23
    buffer_store_dwordx4 v[56:59], v3, s[12:15], s37 offen offset:0 sc1
    s_waitcnt lgkmcnt(0)
    v_pk_add_f32 v[24:25], v[24:25], v[72:73]
    v_cvt_pk_bf16_f32 v60, v24, v25
    v_pk_add_f32 v[26:27], v[26:27], v[74:75]
    v_cvt_pk_bf16_f32 v61, v26, v27
    v_pk_add_f32 v[28:29], v[28:29], v[76:77]
    v_cvt_pk_bf16_f32 v62, v28, v29
    v_pk_add_f32 v[30:31], v[30:31], v[78:79]
    v_cvt_pk_bf16_f32 v63, v30, v31
    buffer_store_dwordx4 v[60:63], v3, s[12:15], s37 offen offset:1024 sc1
    v_lshlrev_b32 v48, 16, v56
    v_and_b32 v49, s28, v56
    v_pk_add_f32 v[52:53], v[52:53], v[48:49]
    v_pk_fma_f32 v[54:55], v[48:49], v[48:49], v[54:55]
    v_lshlrev_b32 v48, 16, v57
    v_and_b32 v49, s28, v57
    v_pk_add_f32 v[52:53], v[52:53], v[48:49]
    v_pk_fma_f32 v[54:55], v[48:49], v[48:49], v[54:55]
    v_lshlrev_b32 v48, 16, v58
    v_and_b32 v49, s28, v58
    v_pk_add_f32 v[52:53], v[52:53], v[48:49]
    v_pk_fma_f32 v[54:55], v[48:49], v[48:49], v[54:55]
    v_lshlrev_b32 v48, 16, v59
    v_and_b32 v49, s28, v59
    v_pk_add_f32 v[52:53], v[52:53], v[48:49]
    v_pk_fma_f32 v[54:55], v[48:49], v[48:49], v[54:55]
    v_lshlrev_b32 v48, 16, v60
    v_and_b32 v49, s28, v60
    v_pk_add_f32 v[52:53], v[52:53], v[48:49]
    v_pk_fma_f32 v[54:55], v[48:49], v[48:49], v[54:55]
    v_lshlrev_b32 v48, 16, v61
    v_and_b32 v49, s28, v61
    v_pk_add_f32 v[52:53], v[52:53], v[48:49]
    v_pk_fma_f32 v[54:55], v[48:49], v[48:49], v[54:55]
    v_lshlrev_b32 v48, 16, v62
    v_and_b32 v49, s28, v62
    v_pk_add_f32 v[52:53], v[52:53], v[48:49]
    v_pk_fma_f32 v[54:55], v[48:49], v[48:49], v[54:55]
    v_lshlrev_b32 v48, 16, v63
    v_and_b32 v49, s28, v63
    v_pk_add_f32 v[52:53], v[52:53], v[48:49]
    v_pk_fma_f32 v[54:55], v[48:49], v[48:49], v[54:55]
    v_add_f32 v52, v52, v53
    v_add_f32 v53, v54, v55
    s_lshl_b32 s32, s24, 9
    v_lshlrev_b32 v13, 3, v1
    v_add_u32 v14, s32, v13
    ds_write_b64 v14, v[52:53]
    s_waitcnt lgkmcnt(0)
    s_barrier
    s_cmp_ge_u32 s24, 4
    s_cbranch_scc1 attn_kernel_fin
    v_and_b32 v13, 15, v1
    v_lshlrev_b32 v13, 4, v13
    v_add_u32 v14, s32, v13
    ds_read_b128 v[64:67], v14 offset:0
    ds_read_b128 v[68:71], v14 offset:256
    ds_read_b128 v[72:75], v14 offset:2048
    ds_read_b128 v[76:79], v14 offset:2304
    s_add_u32 s8, s4, 786432
    s_addc_u32 s9, s5, 0
    s_mov_b32 s10, 262144
    s_mov_b32 s11, 0x20000
    s_lshl_b32 s35, s45, 12
    s_lshl_b32 s36, s49, 8
    s_add_u32 s35, s35, s36
    s_waitcnt lgkmcnt(0)
    v_pk_add_f32 v[64:65], v[64:65], v[68:69]
    v_pk_add_f32 v[66:67], v[66:67], v[70:71]
    v_pk_add_f32 v[64:65], v[64:65], v[72:73]
    v_pk_add_f32 v[66:67], v[66:67], v[74:75]
    v_pk_add_f32 v[64:65], v[64:65], v[76:77]
    v_pk_add_f32 v[66:67], v[66:67], v[78:79]
    s_mov_b64 exec, 0xffff
    buffer_store_dwordx4 v[64:67], v13, s[8:11], s35 offen sc1
    s_mov_b64 exec, -1
attn_kernel_fin:
attn_kernel_done:
    s_endpgm
attn_kernel_slow:
    v_mov_b32 v48, 0
    v_mov_b32 v49, 0
    v_mov_b32 v50, 0
    v_mov_b32 v51, 0
    v_mov_b32 v52, 0
    v_mov_b32 v53, 0
    v_mov_b32 v54, 0
    v_mov_b32 v55, 0
    v_mov_b32 v56, 0
    v_mov_b32 v57, 0
    v_mov_b32 v58, 0
    v_mov_b32 v59, 0
    v_mov_b32 v60, 0
    v_mov_b32 v61, 0
    v_mov_b32 v62, 0
    v_mov_b32 v63, 0
    v_mov_b32 v88, 0
    v_mov_b32 v89, 0
    v_mov_b32 v90, 0
    v_mov_b32 v91, 0
    v_mov_b32 v12, 0xff7fffff
    s_mov_b32 s27, 0
attn_kernel_slow1:
    buffer_load_dwordx4 v[100:103], v3, s[8:11], s27 offen
    buffer_load_dwordx4 v[104:107], v3, s[8:11], s27 offen offset:1024
    buffer_load_dwordx4 v[108:111], v3, s[12:15], s27 offen
    buffer_load_dwordx4 v[112:115], v3, s[12:15], s27 offen offset:1024
    s_waitcnt vmcnt(0)
    v_mfma_f32_32x32x16_bf16 v[16:31], v[100:103], v[92:95], 0
    v_mfma_f32_32x32x16_bf16 v[16:31], v[104:107], v[96:99], v[16:31]
    s_nop 7
    s_nop 7
    v_max3_f32 v8, v16, v17, v12
    v_max3_f32 v8, v8, v18, v19
    v_max3_f32 v8, v8, v20, v21
    v_max3_f32 v8, v8, v22, v23
    v_max3_f32 v8, v8, v24, v25
    v_max3_f32 v8, v8, v26, v27
    v_max3_f32 v8, v8, v28, v29
    v_max3_f32 v8, v8, v30, v31
    v_mov_b32 v9, v8
    s_nop 1
    v_permlane32_swap_b32 v8, v9
    s_nop 1
    v_max_f32 v8, v8, v9
    v_sub_f32 v9, v12, v8
    v_exp_f32 v9, v9
    v_mov_b32 v12, v8
    v_mul_f32 v48, v48, v9
    v_mul_f32 v49, v49, v9
    v_mul_f32 v50, v50, v9
    v_mul_f32 v51, v51, v9
    v_mul_f32 v52, v52, v9
    v_mul_f32 v53, v53, v9
    v_mul_f32 v54, v54, v9
    v_mul_f32 v55, v55, v9
    v_mul_f32 v56, v56, v9
    v_mul_f32 v57, v57, v9
    v_mul_f32 v58, v58, v9
    v_mul_f32 v59, v59, v9
    v_mul_f32 v60, v60, v9
    v_mul_f32 v61, v61, v9
    v_mul_f32 v62, v62, v9
    v_mul_f32 v63, v63, v9
    v_mul_f32 v88, v88, v9
    v_mul_f32 v89, v89, v9
    v_mul_f32 v90, v90, v9
    v_mul_f32 v91, v91, v9
    v_sub_f32 v16, v16, v8
    v_sub_f32 v17, v17, v8
    v_sub_f32 v18, v18, v8
    v_sub_f32 v19, v19, v8
    v_sub_f32 v20, v20, v8
    v_sub_f32 v21, v21, v8
    v_sub_f32 v22, v22, v8
    v_sub_f32 v23, v23, v8
    v_sub_f32 v24, v24, v8
    v_sub_f32 v25, v25, v8
    v_sub_f32 v26, v26, v8
    v_sub_f32 v27, v27, v8
    v_sub_f32 v28, v28, v8
    v_sub_f32 v29, v29, v8
    v_sub_f32 v30, v30, v8
    v_sub_f32 v31, v31, v8
    v_exp_f32 v16, v16
    v_exp_f32 v17, v17
    v_exp_f32 v18, v18
    v_exp_f32 v19, v19
    v_exp_f32 v20, v20
    v_exp_f32 v21, v21
    v_exp_f32 v22, v22
    v_exp_f32 v23, v23
    v_exp_f32 v24, v24
    v_exp_f32 v25, v25
    v_exp_f32 v26, v26
    v_exp_f32 v27, v27
    v_exp_f32 v28, v28
    v_exp_f32 v29, v29
    v_exp_f32 v30, v30
    v_exp_f32 v31, v31
    s_nop 0
    v_cvt_pk_bf16_f32 v80, v16, v17
    v_cvt_pk_bf16_f32 v81, v18, v19
    v_cvt_pk_bf16_f32 v82, v20, v21
    v_cvt_pk_bf16_f32 v83, v22, v23
    v_cvt_pk_bf16_f32 v84, v24, v25
    v_cvt_pk_bf16_f32 v85, v26, v27
    v_cvt_pk_bf16_f32 v86, v28, v29
    v_cvt_pk_bf16_f32 v87, v30, v31
    s_nop 1
    v_mfma_f32_32x32x16_bf16 v[48:63], v[108:111], v[80:83], v[48:63]
    v_mfma_f32_32x32x16_bf16 v[48:63], v[112:115], v[84:87], v[48:63]
    v_smfmac_f32_16x16x64_bf16 v[88:91], v[116:119], v[80:87], v2
    s_add_u32 s27, s27, 2048
    s_cmp_lt_u32 s27, 131072
    s_nop 7
    s_cbranch_scc1 attn_kernel_slow1
    s_mov_b32 s30, 1
    s_branch attn_kernel_finish
attn_kernel_loader:
    s_setprio 3
    s_barrier
    s_cmp_eq_u32 s24, 8
    s_cbranch_scc1 attn_kernel_role0
    v_lshrrev_b32 v8, 3, v1
    v_and_b32 v9, 7, v1
    v_mul_u32_u24 v4, 7168, v8
    v_lshl_add_u32 v4, v9, 4, v4
    v_bfe_u32 v10, v1, 4, 1
    v_lshlrev_b32 v10, 2, v10
    v_xor_b32 v10, v9, v10
    v_lshlrev_b32 v5, 11, v8
    v_lshl_add_u32 v5, v10, 4, v5
    v_lshlrev_b32 v6, 5, v9
    v_and_b32 v10, 16, v1
    v_add_u32 v6, v6, v10
    v_and_b32 v10, 15, v1
    v_lshrrev_b32 v11, 1, v10
    v_and_b32 v10, 1, v10
    v_lshlrev_b32 v10, 4, v10
    v_mov_b32 v12, 0x3f80
    v_lshlrev_b32 v10, v10, v12
    v_cmp_eq_u32 vcc, 0, v11
    s_nop 1
    v_cndmask_b32 v84, 0, v10, vcc
    v_cmp_eq_u32 vcc, 1, v11
    s_nop 1
    v_cndmask_b32 v85, 0, v10, vcc
    v_cmp_eq_u32 vcc, 2, v11
    s_nop 1
    v_cndmask_b32 v86, 0, v10, vcc
    v_cmp_eq_u32 vcc, 3, v11
    s_nop 1
    v_cndmask_b32 v87, 0, v10, vcc
    s_mov_b32 s60, s58
    s_mov_b32 s61, s59
    s_mov_b32 s62, 2097152
    s_mov_b32 s63, 0x20000
    s_mov_b32 s20, s4
    s_mov_b32 s21, s5
    s_mov_b32 s22, 458752
    s_mov_b32 s23, 0x20000
    s_lshl_b32 s41, s49, 7
    s_add_u32 s32, s47, 1
    s_lshl_b32 s32, s32, 18
    s_add_u32 s41, s41, s32
    s_lshr_b32 s39, s47, 2
    s_lshl_b32 s39, s39, 5
    s_add_u32 s39, s39, s48
    s_mul_i32 s39, s39, 7
    s_cmp_eq_u32 s24, 10
    s_cbranch_scc1 attn_kernel_role2
    s_cmp_eq_u32 s24, 11
    s_cbranch_scc1 attn_kernel_role3
    v_add_u32 v16, 0, v5
    v_add_u32 v17, 15360, v5
    v_add_u32 v18, 30720, v5
    v_add_u32 v19, 46080, v5
    s_barrier
    s_mov_b32 m0, 65536
    s_add_u32 s44, s41, 0
    s_and_b32 s44, s44, 2097151
    buffer_load_dwordx4 v16, s[60:63], s44 offen offset:0 lds
    buffer_load_dwordx4 v17, s[60:63], s44 offen offset:1024 lds
    buffer_load_dwordx4 v18, s[60:63], s44 offen offset:2048 lds
    buffer_load_dwordx4 v19, s[60:63], s44 offen offset:3072 lds
    s_mov_b32 m0, 69632
    s_add_u32 s44, s41, 131072
    s_and_b32 s44, s44, 2097151
    buffer_load_dwordx4 v16, s[60:63], s44 offen offset:0 lds
    buffer_load_dwordx4 v17, s[60:63], s44 offen offset:1024 lds
    buffer_load_dwordx4 v18, s[60:63], s44 offen offset:2048 lds
    buffer_load_dwordx4 v19, s[60:63], s44 offen offset:3072 lds
    s_barrier
    s_mov_b32 m0, 73728
    s_add_u32 s44, s41, 262144
    s_and_b32 s44, s44, 2097151
    buffer_load_dwordx4 v16, s[60:63], s44 offen offset:0 lds
    buffer_load_dwordx4 v17, s[60:63], s44 offen offset:1024 lds
    buffer_load_dwordx4 v18, s[60:63], s44 offen offset:2048 lds
    buffer_load_dwordx4 v19, s[60:63], s44 offen offset:3072 lds
    s_mov_b32 m0, 77824
    s_add_u32 s44, s41, 393216
    s_and_b32 s44, s44, 2097151
    buffer_load_dwordx4 v16, s[60:63], s44 offen offset:0 lds
    buffer_load_dwordx4 v17, s[60:63], s44 offen offset:1024 lds
    buffer_load_dwordx4 v18, s[60:63], s44 offen offset:2048 lds
    buffer_load_dwordx4 v19, s[60:63], s44 offen offset:3072 lds
    s_barrier
    s_mov_b32 m0, 81920
    s_add_u32 s44, s41, 524288
    s_and_b32 s44, s44, 2097151
    buffer_load_dwordx4 v16, s[60:63], s44 offen offset:0 lds
    buffer_load_dwordx4 v17, s[60:63], s44 offen offset:1024 lds
    buffer_load_dwordx4 v18, s[60:63], s44 offen offset:2048 lds
    buffer_load_dwordx4 v19, s[60:63], s44 offen offset:3072 lds
    s_mov_b32 m0, 86016
    s_add_u32 s44, s41, 655360
    s_and_b32 s44, s44, 2097151
    buffer_load_dwordx4 v16, s[60:63], s44 offen offset:0 lds
    buffer_load_dwordx4 v17, s[60:63], s44 offen offset:1024 lds
    buffer_load_dwordx4 v18, s[60:63], s44 offen offset:2048 lds
    buffer_load_dwordx4 v19, s[60:63], s44 offen offset:3072 lds
    s_barrier
    s_mov_b32 m0, 90112
    s_add_u32 s44, s41, 786432
    s_and_b32 s44, s44, 2097151
    buffer_load_dwordx4 v16, s[60:63], s44 offen offset:0 lds
    buffer_load_dwordx4 v17, s[60:63], s44 offen offset:1024 lds
    buffer_load_dwordx4 v18, s[60:63], s44 offen offset:2048 lds
    buffer_load_dwordx4 v19, s[60:63], s44 offen offset:3072 lds
    s_mov_b32 m0, 94208
    s_add_u32 s44, s41, 917504
    s_and_b32 s44, s44, 2097151
    buffer_load_dwordx4 v16, s[60:63], s44 offen offset:0 lds
    buffer_load_dwordx4 v17, s[60:63], s44 offen offset:1024 lds
    buffer_load_dwordx4 v18, s[60:63], s44 offen offset:2048 lds
    buffer_load_dwordx4 v19, s[60:63], s44 offen offset:3072 lds
    s_barrier
    s_mov_b32 m0, 98304
    s_add_u32 s44, s41, 1048576
    s_and_b32 s44, s44, 2097151
    buffer_load_dwordx4 v16, s[60:63], s44 offen offset:0 lds
    buffer_load_dwordx4 v17, s[60:63], s44 offen offset:1024 lds
    buffer_load_dwordx4 v18, s[60:63], s44 offen offset:2048 lds
    buffer_load_dwordx4 v19, s[60:63], s44 offen offset:3072 lds
    s_mov_b32 m0, 102400
    s_add_u32 s44, s41, 1179648
    s_and_b32 s44, s44, 2097151
    buffer_load_dwordx4 v16, s[60:63], s44 offen offset:0 lds
    buffer_load_dwordx4 v17, s[60:63], s44 offen offset:1024 lds
    buffer_load_dwordx4 v18, s[60:63], s44 offen offset:2048 lds
    buffer_load_dwordx4 v19, s[60:63], s44 offen offset:3072 lds
    s_barrier
    s_mov_b32 m0, 106496
    s_add_u32 s44, s41, 1310720
    s_and_b32 s44, s44, 2097151
    buffer_load_dwordx4 v16, s[60:63], s44 offen offset:0 lds
    buffer_load_dwordx4 v17, s[60:63], s44 offen offset:1024 lds
    buffer_load_dwordx4 v18, s[60:63], s44 offen offset:2048 lds
    buffer_load_dwordx4 v19, s[60:63], s44 offen offset:3072 lds
    s_mov_b32 m0, 110592
    s_add_u32 s44, s41, 1441792
    s_and_b32 s44, s44, 2097151
    buffer_load_dwordx4 v16, s[60:63], s44 offen offset:0 lds
    buffer_load_dwordx4 v17, s[60:63], s44 offen offset:1024 lds
    buffer_load_dwordx4 v18, s[60:63], s44 offen offset:2048 lds
    buffer_load_dwordx4 v19, s[60:63], s44 offen offset:3072 lds
    s_barrier
    s_mov_b32 m0, 114688
    s_add_u32 s44, s41, 1572864
    s_and_b32 s44, s44, 2097151
    buffer_load_dwordx4 v16, s[60:63], s44 offen offset:0 lds
    buffer_load_dwordx4 v17, s[60:63], s44 offen offset:1024 lds
    buffer_load_dwordx4 v18, s[60:63], s44 offen offset:2048 lds
    buffer_load_dwordx4 v19, s[60:63], s44 offen offset:3072 lds
    s_mov_b32 m0, 118784
    s_add_u32 s44, s41, 1703936
    s_and_b32 s44, s44, 2097151
    buffer_load_dwordx4 v16, s[60:63], s44 offen offset:0 lds
    buffer_load_dwordx4 v17, s[60:63], s44 offen offset:1024 lds
    buffer_load_dwordx4 v18, s[60:63], s44 offen offset:2048 lds
    buffer_load_dwordx4 v19, s[60:63], s44 offen offset:3072 lds
    s_barrier
    s_mov_b32 m0, 122880
    s_add_u32 s44, s41, 1835008
    s_and_b32 s44, s44, 2097151
    buffer_load_dwordx4 v16, s[60:63], s44 offen offset:0 lds
    buffer_load_dwordx4 v17, s[60:63], s44 offen offset:1024 lds
    buffer_load_dwordx4 v18, s[60:63], s44 offen offset:2048 lds
    buffer_load_dwordx4 v19, s[60:63], s44 offen offset:3072 lds
    s_mov_b32 m0, 126976
    s_add_u32 s44, s41, 1966080
    s_and_b32 s44, s44, 2097151
    buffer_load_dwordx4 v16, s[60:63], s44 offen offset:0 lds
    buffer_load_dwordx4 v17, s[60:63], s44 offen offset:1024 lds
    buffer_load_dwordx4 v18, s[60:63], s44 offen offset:2048 lds
    buffer_load_dwordx4 v19, s[60:63], s44 offen offset:3072 lds
    s_barrier
    s_mov_b32 m0, 131072
    s_add_u32 s44, s41, 65536
    s_and_b32 s44, s44, 2097151
    buffer_load_dwordx4 v16, s[60:63], s44 offen offset:0 lds
    buffer_load_dwordx4 v17, s[60:63], s44 offen offset:1024 lds
    buffer_load_dwordx4 v18, s[60:63], s44 offen offset:2048 lds
    buffer_load_dwordx4 v19, s[60:63], s44 offen offset:3072 lds
    s_mov_b32 m0, 135168
    s_add_u32 s44, s41, 196608
    s_and_b32 s44, s44, 2097151
    buffer_load_dwordx4 v16, s[60:63], s44 offen offset:0 lds
    buffer_load_dwordx4 v17, s[60:63], s44 offen offset:1024 lds
    buffer_load_dwordx4 v18, s[60:63], s44 offen offset:2048 lds
    buffer_load_dwordx4 v19, s[60:63], s44 offen offset:3072 lds
    s_barrier
    s_mov_b32 m0, 139264
    s_add_u32 s44, s41, 327680
    s_and_b32 s44, s44, 2097151
    buffer_load_dwordx4 v16, s[60:63], s44 offen offset:0 lds
    buffer_load_dwordx4 v17, s[60:63], s44 offen offset:1024 lds
    buffer_load_dwordx4 v18, s[60:63], s44 offen offset:2048 lds
    buffer_load_dwordx4 v19, s[60:63], s44 offen offset:3072 lds
    s_mov_b32 m0, 143360
    s_add_u32 s44, s41, 458752
    s_and_b32 s44, s44, 2097151
    buffer_load_dwordx4 v16, s[60:63], s44 offen offset:0 lds
    buffer_load_dwordx4 v17, s[60:63], s44 offen offset:1024 lds
    buffer_load_dwordx4 v18, s[60:63], s44 offen offset:2048 lds
    buffer_load_dwordx4 v19, s[60:63], s44 offen offset:3072 lds
    s_barrier
    s_mov_b32 m0, 147456
    s_add_u32 s44, s41, 589824
    s_and_b32 s44, s44, 2097151
    buffer_load_dwordx4 v16, s[60:63], s44 offen offset:0 lds
    buffer_load_dwordx4 v17, s[60:63], s44 offen offset:1024 lds
    buffer_load_dwordx4 v18, s[60:63], s44 offen offset:2048 lds
    buffer_load_dwordx4 v19, s[60:63], s44 offen offset:3072 lds
    s_mov_b32 m0, 151552
    s_add_u32 s44, s41, 720896
    s_and_b32 s44, s44, 2097151
    buffer_load_dwordx4 v16, s[60:63], s44 offen offset:0 lds
    buffer_load_dwordx4 v17, s[60:63], s44 offen offset:1024 lds
    buffer_load_dwordx4 v18, s[60:63], s44 offen offset:2048 lds
    buffer_load_dwordx4 v19, s[60:63], s44 offen offset:3072 lds
    s_barrier
    s_mov_b32 m0, 155648
    s_add_u32 s44, s41, 851968
    s_and_b32 s44, s44, 2097151
    buffer_load_dwordx4 v16, s[60:63], s44 offen offset:0 lds
    buffer_load_dwordx4 v17, s[60:63], s44 offen offset:1024 lds
    buffer_load_dwordx4 v18, s[60:63], s44 offen offset:2048 lds
    buffer_load_dwordx4 v19, s[60:63], s44 offen offset:3072 lds
    s_mov_b32 m0, 159744
    s_add_u32 s44, s41, 983040
    s_and_b32 s44, s44, 2097151
    buffer_load_dwordx4 v16, s[60:63], s44 offen offset:0 lds
    buffer_load_dwordx4 v17, s[60:63], s44 offen offset:1024 lds
    buffer_load_dwordx4 v18, s[60:63], s44 offen offset:2048 lds
    buffer_load_dwordx4 v19, s[60:63], s44 offen offset:3072 lds
    s_barrier
    s_barrier
    s_mov_b32 m0, 0
    s_add_u32 s44, s41, 1114112
    s_and_b32 s44, s44, 2097151
    buffer_load_dwordx4 v16, s[60:63], s44 offen offset:0 lds
    buffer_load_dwordx4 v17, s[60:63], s44 offen offset:1024 lds
    buffer_load_dwordx4 v18, s[60:63], s44 offen offset:2048 lds
    buffer_load_dwordx4 v19, s[60:63], s44 offen offset:3072 lds
    s_mov_b32 m0, 4096
    s_add_u32 s44, s41, 1245184
    s_and_b32 s44, s44, 2097151
    buffer_load_dwordx4 v16, s[60:63], s44 offen offset:0 lds
    buffer_load_dwordx4 v17, s[60:63], s44 offen offset:1024 lds
    buffer_load_dwordx4 v18, s[60:63], s44 offen offset:2048 lds
    buffer_load_dwordx4 v19, s[60:63], s44 offen offset:3072 lds
    s_mov_b32 m0, 8192
    s_add_u32 s44, s41, 1376256
    s_and_b32 s44, s44, 2097151
    buffer_load_dwordx4 v16, s[60:63], s44 offen offset:0 lds
    buffer_load_dwordx4 v17, s[60:63], s44 offen offset:1024 lds
    buffer_load_dwordx4 v18, s[60:63], s44 offen offset:2048 lds
    buffer_load_dwordx4 v19, s[60:63], s44 offen offset:3072 lds
    s_mov_b32 m0, 12288
    s_add_u32 s44, s41, 1507328
    s_and_b32 s44, s44, 2097151
    buffer_load_dwordx4 v16, s[60:63], s44 offen offset:0 lds
    buffer_load_dwordx4 v17, s[60:63], s44 offen offset:1024 lds
    buffer_load_dwordx4 v18, s[60:63], s44 offen offset:2048 lds
    buffer_load_dwordx4 v19, s[60:63], s44 offen offset:3072 lds
    s_barrier
    s_mov_b32 m0, 16384
    s_add_u32 s44, s41, 1638400
    s_and_b32 s44, s44, 2097151
    buffer_load_dwordx4 v16, s[60:63], s44 offen offset:0 lds
    buffer_load_dwordx4 v17, s[60:63], s44 offen offset:1024 lds
    buffer_load_dwordx4 v18, s[60:63], s44 offen offset:2048 lds
    buffer_load_dwordx4 v19, s[60:63], s44 offen offset:3072 lds
    s_mov_b32 m0, 20480
    s_add_u32 s44, s41, 1769472
    s_and_b32 s44, s44, 2097151
    buffer_load_dwordx4 v16, s[60:63], s44 offen offset:0 lds
    buffer_load_dwordx4 v17, s[60:63], s44 offen offset:1024 lds
    buffer_load_dwordx4 v18, s[60:63], s44 offen offset:2048 lds
    buffer_load_dwordx4 v19, s[60:63], s44 offen offset:3072 lds
    s_mov_b32 m0, 24576
    s_add_u32 s44, s41, 1900544
    s_and_b32 s44, s44, 2097151
    buffer_load_dwordx4 v16, s[60:63], s44 offen offset:0 lds
    buffer_load_dwordx4 v17, s[60:63], s44 offen offset:1024 lds
    buffer_load_dwordx4 v18, s[60:63], s44 offen offset:2048 lds
    buffer_load_dwordx4 v19, s[60:63], s44 offen offset:3072 lds
    s_mov_b32 m0, 28672
    s_add_u32 s44, s41, 2031616
    s_and_b32 s44, s44, 2097151
    buffer_load_dwordx4 v16, s[60:63], s44 offen offset:0 lds
    buffer_load_dwordx4 v17, s[60:63], s44 offen offset:1024 lds
    buffer_load_dwordx4 v18, s[60:63], s44 offen offset:2048 lds
    buffer_load_dwordx4 v19, s[60:63], s44 offen offset:3072 lds
    s_barrier
    s_waitcnt vmcnt(0)
    s_barrier
    s_endpgm
attn_kernel_role2:
    s_barrier
    s_add_u32 s32, s39, 0
    s_lshr_b32 s33, s32, 4
    s_and_b32 s32, s32, 15
    s_cmp_ge_u32 s33, 14
    s_cselect_b32 s34, 14, 0
    s_cselect_b32 s35, 3584, 0
    s_cselect_b32 s64, s54, s52
    s_cselect_b32 s65, s55, s53
    s_mov_b32 s66, 7340032
    s_mov_b32 s67, 0x20000
    s_sub_u32 s33, s33, s34
    s_lshl_b32 s33, s33, 6
    s_and_b32 s34, s47, 3
    s_mul_i32 s34, s34, 896
    s_add_u32 s33, s33, s34
    s_mul_i32 s45, s32, 458752
    s_lshl_b32 s34, s33, 1
    s_add_u32 s45, s45, s34
    s_mul_i32 s68, s32, 28672
    s_add_u32 s33, s33, s35
    s_lshl_b32 s33, s33, 2
    s_add_u32 s68, s68, s33
    buffer_load_dwordx4 v[16:19], v4, s[64:67], s45 offen
    s_add_u32 s45, s45, 57344
    buffer_load_dwordx4 v[20:23], v4, s[64:67], s45 offen
    s_add_u32 s45, s45, 57344
    buffer_load_dwordx4 v[24:27], v4, s[64:67], s45 offen
    s_add_u32 s45, s45, 57344
    buffer_load_dwordx4 v[28:31], v4, s[64:67], s45 offen
    s_add_u32 s45, s45, 57344
    buffer_load_dwordx4 v[32:35], v4, s[64:67], s45 offen
    s_add_u32 s45, s45, 57344
    buffer_load_dwordx4 v[36:39], v4, s[64:67], s45 offen
    s_add_u32 s45, s45, 57344
    buffer_load_dwordx4 v[40:43], v4, s[64:67], s45 offen
    s_add_u32 s45, s45, 57344
    buffer_load_dwordx4 v[44:47], v4, s[64:67], s45 offen
    s_barrier
    s_add_u32 s32, s39, 1
    s_lshr_b32 s33, s32, 4
    s_and_b32 s32, s32, 15
    s_cmp_ge_u32 s33, 14
    s_cselect_b32 s34, 14, 0
    s_cselect_b32 s35, 3584, 0
    s_cselect_b32 s64, s54, s52
    s_cselect_b32 s65, s55, s53
    s_mov_b32 s66, 7340032
    s_mov_b32 s67, 0x20000
    s_sub_u32 s33, s33, s34
    s_lshl_b32 s33, s33, 6
    s_and_b32 s34, s47, 3
    s_mul_i32 s34, s34, 896
    s_add_u32 s33, s33, s34
    s_mul_i32 s45, s32, 458752
    s_lshl_b32 s34, s33, 1
    s_add_u32 s45, s45, s34
    s_mul_i32 s69, s32, 28672
    s_add_u32 s33, s33, s35
    s_lshl_b32 s33, s33, 2
    s_add_u32 s69, s69, s33
    buffer_load_dwordx4 v[48:51], v4, s[64:67], s45 offen
    s_add_u32 s45, s45, 57344
    buffer_load_dwordx4 v[52:55], v4, s[64:67], s45 offen
    s_add_u32 s45, s45, 57344
    buffer_load_dwordx4 v[56:59], v4, s[64:67], s45 offen
    s_add_u32 s45, s45, 57344
    buffer_load_dwordx4 v[60:63], v4, s[64:67], s45 offen
    s_add_u32 s45, s45, 57344
    buffer_load_dwordx4 v[64:67], v4, s[64:67], s45 offen
    s_add_u32 s45, s45, 57344
    buffer_load_dwordx4 v[68:71], v4, s[64:67], s45 offen
    s_add_u32 s45, s45, 57344
    buffer_load_dwordx4 v[72:75], v4, s[64:67], s45 offen
    s_add_u32 s45, s45, 57344
    buffer_load_dwordx4 v[76:79], v4, s[64:67], s45 offen
    s_barrier
    s_waitcnt vmcnt(8)
    v_mfma_f32_16x16x32_bf16 v[80:83], v[84:87], v[16:19], 0
    v_mfma_f32_16x16x32_bf16 v[80:83], v[84:87], v[20:23], v[80:83]
    v_mfma_f32_16x16x32_bf16 v[80:83], v[84:87], v[24:27], v[80:83]
    v_mfma_f32_16x16x32_bf16 v[80:83], v[84:87], v[28:31], v[80:83]
    v_mfma_f32_16x16x32_bf16 v[80:83], v[84:87], v[32:35], v[80:83]
    v_mfma_f32_16x16x32_bf16 v[80:83], v[84:87], v[36:39], v[80:83]
    v_mfma_f32_16x16x32_bf16 v[80:83], v[84:87], v[40:43], v[80:83]
    v_mfma_f32_16x16x32_bf16 v[80:83], v[84:87], v[44:47], v[80:83]
    s_nop 7
    v_add_f32_dpp v12, v80, v80 row_ror:8 row_mask:0xf bank_mask:0xf
    v_add_f32_dpp v13, v81, v81 row_ror:8 row_mask:0xf bank_mask:0xf
    v_add_f32_dpp v14, v82, v82 row_ror:8 row_mask:0xf bank_mask:0xf
    v_add_f32_dpp v15, v83, v83 row_ror:8 row_mask:0xf bank_mask:0xf
    s_mov_b32 exec_lo, 0x00ff00ff
    s_mov_b32 exec_hi, 0
    buffer_store_dwordx4 v[12:15], v6, s[20:23], s68 offen sc1
    s_mov_b64 exec, -1
    s_add_u32 s32, s39, 2
    s_lshr_b32 s33, s32, 4
    s_and_b32 s32, s32, 15
    s_cmp_ge_u32 s33, 14
    s_cselect_b32 s34, 14, 0
    s_cselect_b32 s35, 3584, 0
    s_cselect_b32 s64, s54, s52
    s_cselect_b32 s65, s55, s53
    s_mov_b32 s66, 7340032
    s_mov_b32 s67, 0x20000
    s_sub_u32 s33, s33, s34
    s_lshl_b32 s33, s33, 6
    s_and_b32 s34, s47, 3
    s_mul_i32 s34, s34, 896
    s_add_u32 s33, s33, s34
    s_mul_i32 s45, s32, 458752
    s_lshl_b32 s34, s33, 1
    s_add_u32 s45, s45, s34
    s_mul_i32 s68, s32, 28672
    s_add_u32 s33, s33, s35
    s_lshl_b32 s33, s33, 2
    s_add_u32 s68, s68, s33
    buffer_load_dwordx4 v[16:19], v4, s[64:67], s45 offen
    s_add_u32 s45, s45, 57344
    buffer_load_dwordx4 v[20:23], v4, s[64:67], s45 offen
    s_add_u32 s45, s45, 57344
    buffer_load_dwordx4 v[24:27], v4, s[64:67], s45 offen
    s_add_u32 s45, s45, 57344
    buffer_load_dwordx4 v[28:31], v4, s[64:67], s45 offen
    s_add_u32 s45, s45, 57344
    buffer_load_dwordx4 v[32:35], v4, s[64:67], s45 offen
    s_add_u32 s45, s45, 57344
    buffer_load_dwordx4 v[36:39], v4, s[64:67], s45 offen
    s_add_u32 s45, s45, 57344
    buffer_load_dwordx4 v[40:43], v4, s[64:67], s45 offen
    s_add_u32 s45, s45, 57344
    buffer_load_dwordx4 v[44:47], v4, s[64:67], s45 offen
    s_barrier
    s_waitcnt vmcnt(9)
    v_mfma_f32_16x16x32_bf16 v[80:83], v[84:87], v[48:51], 0
    v_mfma_f32_16x16x32_bf16 v[80:83], v[84:87], v[52:55], v[80:83]
    v_mfma_f32_16x16x32_bf16 v[80:83], v[84:87], v[56:59], v[80:83]
    v_mfma_f32_16x16x32_bf16 v[80:83], v[84:87], v[60:63], v[80:83]
    v_mfma_f32_16x16x32_bf16 v[80:83], v[84:87], v[64:67], v[80:83]
    v_mfma_f32_16x16x32_bf16 v[80:83], v[84:87], v[68:71], v[80:83]
    v_mfma_f32_16x16x32_bf16 v[80:83], v[84:87], v[72:75], v[80:83]
    v_mfma_f32_16x16x32_bf16 v[80:83], v[84:87], v[76:79], v[80:83]
    s_nop 7
    v_add_f32_dpp v12, v80, v80 row_ror:8 row_mask:0xf bank_mask:0xf
    v_add_f32_dpp v13, v81, v81 row_ror:8 row_mask:0xf bank_mask:0xf
    v_add_f32_dpp v14, v82, v82 row_ror:8 row_mask:0xf bank_mask:0xf
    v_add_f32_dpp v15, v83, v83 row_ror:8 row_mask:0xf bank_mask:0xf
    s_mov_b32 exec_lo, 0x00ff00ff
    s_mov_b32 exec_hi, 0
    buffer_store_dwordx4 v[12:15], v6, s[20:23], s69 offen sc1
    s_mov_b64 exec, -1
    s_add_u32 s32, s39, 3
    s_lshr_b32 s33, s32, 4
    s_and_b32 s32, s32, 15
    s_cmp_ge_u32 s33, 14
    s_cselect_b32 s34, 14, 0
    s_cselect_b32 s35, 3584, 0
    s_cselect_b32 s64, s54, s52
    s_cselect_b32 s65, s55, s53
    s_mov_b32 s66, 7340032
    s_mov_b32 s67, 0x20000
    s_sub_u32 s33, s33, s34
    s_lshl_b32 s33, s33, 6
    s_and_b32 s34, s47, 3
    s_mul_i32 s34, s34, 896
    s_add_u32 s33, s33, s34
    s_mul_i32 s45, s32, 458752
    s_lshl_b32 s34, s33, 1
    s_add_u32 s45, s45, s34
    s_mul_i32 s69, s32, 28672
    s_add_u32 s33, s33, s35
    s_lshl_b32 s33, s33, 2
    s_add_u32 s69, s69, s33
    buffer_load_dwordx4 v[48:51], v4, s[64:67], s45 offen
    s_add_u32 s45, s45, 57344
    buffer_load_dwordx4 v[52:55], v4, s[64:67], s45 offen
    s_add_u32 s45, s45, 57344
    buffer_load_dwordx4 v[56:59], v4, s[64:67], s45 offen
    s_add_u32 s45, s45, 57344
    buffer_load_dwordx4 v[60:63], v4, s[64:67], s45 offen
    s_add_u32 s45, s45, 57344
    buffer_load_dwordx4 v[64:67], v4, s[64:67], s45 offen
    s_add_u32 s45, s45, 57344
    buffer_load_dwordx4 v[68:71], v4, s[64:67], s45 offen
    s_add_u32 s45, s45, 57344
    buffer_load_dwordx4 v[72:75], v4, s[64:67], s45 offen
    s_add_u32 s45, s45, 57344
    buffer_load_dwordx4 v[76:79], v4, s[64:67], s45 offen
    s_barrier
    s_waitcnt vmcnt(9)
    v_mfma_f32_16x16x32_bf16 v[80:83], v[84:87], v[16:19], 0
    v_mfma_f32_16x16x32_bf16 v[80:83], v[84:87], v[20:23], v[80:83]
    v_mfma_f32_16x16x32_bf16 v[80:83], v[84:87], v[24:27], v[80:83]
    v_mfma_f32_16x16x32_bf16 v[80:83], v[84:87], v[28:31], v[80:83]
    v_mfma_f32_16x16x32_bf16 v[80:83], v[84:87], v[32:35], v[80:83]
    v_mfma_f32_16x16x32_bf16 v[80:83], v[84:87], v[36:39], v[80:83]
    v_mfma_f32_16x16x32_bf16 v[80:83], v[84:87], v[40:43], v[80:83]
    v_mfma_f32_16x16x32_bf16 v[80:83], v[84:87], v[44:47], v[80:83]
    s_nop 7
    v_add_f32_dpp v12, v80, v80 row_ror:8 row_mask:0xf bank_mask:0xf
    v_add_f32_dpp v13, v81, v81 row_ror:8 row_mask:0xf bank_mask:0xf
    v_add_f32_dpp v14, v82, v82 row_ror:8 row_mask:0xf bank_mask:0xf
    v_add_f32_dpp v15, v83, v83 row_ror:8 row_mask:0xf bank_mask:0xf
    s_mov_b32 exec_lo, 0x00ff00ff
    s_mov_b32 exec_hi, 0
    buffer_store_dwordx4 v[12:15], v6, s[20:23], s68 offen sc1
    s_mov_b64 exec, -1
    s_add_u32 s32, s39, 4
    s_lshr_b32 s33, s32, 4
    s_and_b32 s32, s32, 15
    s_cmp_ge_u32 s33, 14
    s_cselect_b32 s34, 14, 0
    s_cselect_b32 s35, 3584, 0
    s_cselect_b32 s64, s54, s52
    s_cselect_b32 s65, s55, s53
    s_mov_b32 s66, 7340032
    s_mov_b32 s67, 0x20000
    s_sub_u32 s33, s33, s34
    s_lshl_b32 s33, s33, 6
    s_and_b32 s34, s47, 3
    s_mul_i32 s34, s34, 896
    s_add_u32 s33, s33, s34
    s_mul_i32 s45, s32, 458752
    s_lshl_b32 s34, s33, 1
    s_add_u32 s45, s45, s34
    s_mul_i32 s68, s32, 28672
    s_add_u32 s33, s33, s35
    s_lshl_b32 s33, s33, 2
    s_add_u32 s68, s68, s33
    buffer_load_dwordx4 v[16:19], v4, s[64:67], s45 offen
    s_add_u32 s45, s45, 57344
    buffer_load_dwordx4 v[20:23], v4, s[64:67], s45 offen
    s_add_u32 s45, s45, 57344
    buffer_load_dwordx4 v[24:27], v4, s[64:67], s45 offen
    s_add_u32 s45, s45, 57344
    buffer_load_dwordx4 v[28:31], v4, s[64:67], s45 offen
    s_add_u32 s45, s45, 57344
    buffer_load_dwordx4 v[32:35], v4, s[64:67], s45 offen
    s_add_u32 s45, s45, 57344
    buffer_load_dwordx4 v[36:39], v4, s[64:67], s45 offen
    s_add_u32 s45, s45, 57344
    buffer_load_dwordx4 v[40:43], v4, s[64:67], s45 offen
    s_add_u32 s45, s45, 57344
    buffer_load_dwordx4 v[44:47], v4, s[64:67], s45 offen
    s_barrier
    s_waitcnt vmcnt(9)
    v_mfma_f32_16x16x32_bf16 v[80:83], v[84:87], v[48:51], 0
    v_mfma_f32_16x16x32_bf16 v[80:83], v[84:87], v[52:55], v[80:83]
    v_mfma_f32_16x16x32_bf16 v[80:83], v[84:87], v[56:59], v[80:83]
    v_mfma_f32_16x16x32_bf16 v[80:83], v[84:87], v[60:63], v[80:83]
    v_mfma_f32_16x16x32_bf16 v[80:83], v[84:87], v[64:67], v[80:83]
    v_mfma_f32_16x16x32_bf16 v[80:83], v[84:87], v[68:71], v[80:83]
    v_mfma_f32_16x16x32_bf16 v[80:83], v[84:87], v[72:75], v[80:83]
    v_mfma_f32_16x16x32_bf16 v[80:83], v[84:87], v[76:79], v[80:83]
    s_nop 7
    v_add_f32_dpp v12, v80, v80 row_ror:8 row_mask:0xf bank_mask:0xf
    v_add_f32_dpp v13, v81, v81 row_ror:8 row_mask:0xf bank_mask:0xf
    v_add_f32_dpp v14, v82, v82 row_ror:8 row_mask:0xf bank_mask:0xf
    v_add_f32_dpp v15, v83, v83 row_ror:8 row_mask:0xf bank_mask:0xf
    s_mov_b32 exec_lo, 0x00ff00ff
    s_mov_b32 exec_hi, 0
    buffer_store_dwordx4 v[12:15], v6, s[20:23], s69 offen sc1
    s_mov_b64 exec, -1
    s_add_u32 s32, s39, 5
    s_lshr_b32 s33, s32, 4
    s_and_b32 s32, s32, 15
    s_cmp_ge_u32 s33, 14
    s_cselect_b32 s34, 14, 0
    s_cselect_b32 s35, 3584, 0
    s_cselect_b32 s64, s54, s52
    s_cselect_b32 s65, s55, s53
    s_mov_b32 s66, 7340032
    s_mov_b32 s67, 0x20000
    s_sub_u32 s33, s33, s34
    s_lshl_b32 s33, s33, 6
    s_and_b32 s34, s47, 3
    s_mul_i32 s34, s34, 896
    s_add_u32 s33, s33, s34
    s_mul_i32 s45, s32, 458752
    s_lshl_b32 s34, s33, 1
    s_add_u32 s45, s45, s34
    s_mul_i32 s69, s32, 28672
    s_add_u32 s33, s33, s35
    s_lshl_b32 s33, s33, 2
    s_add_u32 s69, s69, s33
    buffer_load_dwordx4 v[48:51], v4, s[64:67], s45 offen
    s_add_u32 s45, s45, 57344
    buffer_load_dwordx4 v[52:55], v4, s[64:67], s45 offen
    s_add_u32 s45, s45, 57344
    buffer_load_dwordx4 v[56:59], v4, s[64:67], s45 offen
    s_add_u32 s45, s45, 57344
    buffer_load_dwordx4 v[60:63], v4, s[64:67], s45 offen
    s_add_u32 s45, s45, 57344
    buffer_load_dwordx4 v[64:67], v4, s[64:67], s45 offen
    s_add_u32 s45, s45, 57344
    buffer_load_dwordx4 v[68:71], v4, s[64:67], s45 offen
    s_add_u32 s45, s45, 57344
    buffer_load_dwordx4 v[72:75], v4, s[64:67], s45 offen
    s_add_u32 s45, s45, 57344
    buffer_load_dwordx4 v[76:79], v4, s[64:67], s45 offen
    s_barrier
    s_waitcnt vmcnt(9)
    v_mfma_f32_16x16x32_bf16 v[80:83], v[84:87], v[16:19], 0
    v_mfma_f32_16x16x32_bf16 v[80:83], v[84:87], v[20:23], v[80:83]
    v_mfma_f32_16x16x32_bf16 v[80:83], v[84:87], v[24:27], v[80:83]
    v_mfma_f32_16x16x32_bf16 v[80:83], v[84:87], v[28:31], v[80:83]
    v_mfma_f32_16x16x32_bf16 v[80:83], v[84:87], v[32:35], v[80:83]
    v_mfma_f32_16x16x32_bf16 v[80:83], v[84:87], v[36:39], v[80:83]
    v_mfma_f32_16x16x32_bf16 v[80:83], v[84:87], v[40:43], v[80:83]
    v_mfma_f32_16x16x32_bf16 v[80:83], v[84:87], v[44:47], v[80:83]
    s_nop 7
    v_add_f32_dpp v12, v80, v80 row_ror:8 row_mask:0xf bank_mask:0xf
    v_add_f32_dpp v13, v81, v81 row_ror:8 row_mask:0xf bank_mask:0xf
    v_add_f32_dpp v14, v82, v82 row_ror:8 row_mask:0xf bank_mask:0xf
    v_add_f32_dpp v15, v83, v83 row_ror:8 row_mask:0xf bank_mask:0xf
    s_mov_b32 exec_lo, 0x00ff00ff
    s_mov_b32 exec_hi, 0
    buffer_store_dwordx4 v[12:15], v6, s[20:23], s68 offen sc1
    s_mov_b64 exec, -1
    s_add_u32 s32, s39, 6
    s_lshr_b32 s33, s32, 4
    s_and_b32 s32, s32, 15
    s_cmp_ge_u32 s33, 14
    s_cselect_b32 s34, 14, 0
    s_cselect_b32 s35, 3584, 0
    s_cselect_b32 s64, s54, s52
    s_cselect_b32 s65, s55, s53
    s_mov_b32 s66, 7340032
    s_mov_b32 s67, 0x20000
    s_sub_u32 s33, s33, s34
    s_lshl_b32 s33, s33, 6
    s_and_b32 s34, s47, 3
    s_mul_i32 s34, s34, 896
    s_add_u32 s33, s33, s34
    s_mul_i32 s45, s32, 458752
    s_lshl_b32 s34, s33, 1
    s_add_u32 s45, s45, s34
    s_mul_i32 s68, s32, 28672
    s_add_u32 s33, s33, s35
    s_lshl_b32 s33, s33, 2
    s_add_u32 s68, s68, s33
    buffer_load_dwordx4 v[16:19], v4, s[64:67], s45 offen
    s_add_u32 s45, s45, 57344
    buffer_load_dwordx4 v[20:23], v4, s[64:67], s45 offen
    s_add_u32 s45, s45, 57344
    buffer_load_dwordx4 v[24:27], v4, s[64:67], s45 offen
    s_add_u32 s45, s45, 57344
    buffer_load_dwordx4 v[28:31], v4, s[64:67], s45 offen
    s_add_u32 s45, s45, 57344
    buffer_load_dwordx4 v[32:35], v4, s[64:67], s45 offen
    s_add_u32 s45, s45, 57344
    buffer_load_dwordx4 v[36:39], v4, s[64:67], s45 offen
    s_add_u32 s45, s45, 57344
    buffer_load_dwordx4 v[40:43], v4, s[64:67], s45 offen
    s_add_u32 s45, s45, 57344
    buffer_load_dwordx4 v[44:47], v4, s[64:67], s45 offen
    s_barrier
    s_waitcnt vmcnt(9)
    v_mfma_f32_16x16x32_bf16 v[80:83], v[84:87], v[48:51], 0
    v_mfma_f32_16x16x32_bf16 v[80:83], v[84:87], v[52:55], v[80:83]
    v_mfma_f32_16x16x32_bf16 v[80:83], v[84:87], v[56:59], v[80:83]
    v_mfma_f32_16x16x32_bf16 v[80:83], v[84:87], v[60:63], v[80:83]
    v_mfma_f32_16x16x32_bf16 v[80:83], v[84:87], v[64:67], v[80:83]
    v_mfma_f32_16x16x32_bf16 v[80:83], v[84:87], v[68:71], v[80:83]
    v_mfma_f32_16x16x32_bf16 v[80:83], v[84:87], v[72:75], v[80:83]
    v_mfma_f32_16x16x32_bf16 v[80:83], v[84:87], v[76:79], v[80:83]
    s_nop 7
    v_add_f32_dpp v12, v80, v80 row_ror:8 row_mask:0xf bank_mask:0xf
    v_add_f32_dpp v13, v81, v81 row_ror:8 row_mask:0xf bank_mask:0xf
    v_add_f32_dpp v14, v82, v82 row_ror:8 row_mask:0xf bank_mask:0xf
    v_add_f32_dpp v15, v83, v83 row_ror:8 row_mask:0xf bank_mask:0xf
    s_mov_b32 exec_lo, 0x00ff00ff
    s_mov_b32 exec_hi, 0
    buffer_store_dwordx4 v[12:15], v6, s[20:23], s69 offen sc1
    s_mov_b64 exec, -1
    s_barrier
    s_waitcnt vmcnt(1)
    v_mfma_f32_16x16x32_bf16 v[80:83], v[84:87], v[16:19], 0
    v_mfma_f32_16x16x32_bf16 v[80:83], v[84:87], v[20:23], v[80:83]
    v_mfma_f32_16x16x32_bf16 v[80:83], v[84:87], v[24:27], v[80:83]
    v_mfma_f32_16x16x32_bf16 v[80:83], v[84:87], v[28:31], v[80:83]
    v_mfma_f32_16x16x32_bf16 v[80:83], v[84:87], v[32:35], v[80:83]
    v_mfma_f32_16x16x32_bf16 v[80:83], v[84:87], v[36:39], v[80:83]
    v_mfma_f32_16x16x32_bf16 v[80:83], v[84:87], v[40:43], v[80:83]
    v_mfma_f32_16x16x32_bf16 v[80:83], v[84:87], v[44:47], v[80:83]
    s_nop 7
    v_add_f32_dpp v12, v80, v80 row_ror:8 row_mask:0xf bank_mask:0xf
    v_add_f32_dpp v13, v81, v81 row_ror:8 row_mask:0xf bank_mask:0xf
    v_add_f32_dpp v14, v82, v82 row_ror:8 row_mask:0xf bank_mask:0xf
    v_add_f32_dpp v15, v83, v83 row_ror:8 row_mask:0xf bank_mask:0xf
    s_mov_b32 exec_lo, 0x00ff00ff
    s_mov_b32 exec_hi, 0
    buffer_store_dwordx4 v[12:15], v6, s[20:23], s68 offen sc1
    s_mov_b64 exec, -1
    s_barrier
    s_barrier
    s_add_u32 s72, s4, 1605632
    s_addc_u32 s73, s5, 0
    s_mov_b32 s74, 98304
    s_mov_b32 s75, 0x20000
    v_mov_b32 v9, 1
    v_mov_b32 v10, 0
    s_lshl_b32 s44, s2, 7
    s_add_u32 s44, s44, 65536
    s_waitcnt vmcnt(0)
    s_mov_b64 exec, 1
    buffer_store_dword v9, v10, s[72:75], s44 offen sc1
    s_mov_b64 exec, -1
    s_barrier
    s_barrier
    v_and_b32 v11, 31, v1
    v_lshlrev_b32 v11, 10, v11
    v_lshrrev_b32 v12, 5, v1
    v_lshl_add_u32 v11, v12, 9, v11
    s_bfe_u32 s45, s2, 131077
    s_lshl_b32 s45, s45, 7
    s_add_u32 s45, s45, 65536
    buffer_load_dword v88, v11, s[72:75], s45 offen sc1
    s_barrier
    s_mov_b32 s38, 0x40000
attn_kernel_spincs:
    s_waitcnt vmcnt(0)
    v_cmp_eq_u32 vcc, 1, v88
    s_nop 1
    s_cmp_eq_u64 vcc, -1
    s_cbranch_scc1 attn_kernel_spincs_ok
    s_sleep 2
    buffer_load_dword v88, v11, s[72:75], s45 offen sc1
    s_sub_u32 s38, s38, 1
    s_cmp_lg_u32 s38, 0
    s_cbranch_scc1 attn_kernel_spincs
attn_kernel_spincs_ok:
    v_lshrrev_b32 v12, 5, v1
    v_mul_u32_u24 v12, 229376, v12
    v_and_b32 v13, 31, v1
    v_lshl_add_u32 v12, v13, 2, v12
    s_mul_i32 s45, s2, 112
    buffer_load_dword v88, v12, s[20:23], s45 offen sc1
    s_add_u32 s45, s45, 28672
    buffer_load_dword v89, v12, s[20:23], s45 offen sc1
    s_add_u32 s45, s45, 28672
    buffer_load_dword v90, v12, s[20:23], s45 offen sc1
    s_add_u32 s45, s45, 28672
    buffer_load_dword v91, v12, s[20:23], s45 offen sc1
    s_add_u32 s45, s45, 28672
    buffer_load_dword v92, v12, s[20:23], s45 offen sc1
    s_add_u32 s45, s45, 28672
    buffer_load_dword v93, v12, s[20:23], s45 offen sc1
    s_add_u32 s45, s45, 28672
    buffer_load_dword v94, v12, s[20:23], s45 offen sc1
    s_add_u32 s45, s45, 28672
    buffer_load_dword v95, v12, s[20:23], s45 offen sc1
    s_barrier
    s_and_b32 s34, s2, 3
    s_mul_i32 s34, s34, 28
    v_add_u32 v13, s34, v13
    v_lshrrev_b32 v14, 4, v13
    v_lshlrev_b32 v14, 9, v14
    v_and_b32 v13, 15, v13
    v_lshl_add_u32 v13, v13, 4, v14
    s_bfe_u32 s34, s2, 327682
    s_mul_i32 s34, s34, 3584
    s_lshr_b32 s35, s2, 7
    s_lshl_b32 s35, s35, 8
    s_add_u32 s34, s34, s35
    s_add_u32 s16, s4, 524288
    s_addc_u32 s17, s5, 0
    s_mov_b32 s18, 114688
    s_mov_b32 s19, 0x20000
    s_waitcnt vmcnt(0)
    v_add_f32 v88, v88, v89
    v_add_f32 v88, v88, v90
    v_add_f32 v88, v88, v91
    v_add_f32 v88, v88, v92
    v_add_f32 v88, v88, v93
    v_add_f32 v88, v88, v94
    v_add_f32 v88, v88, v95
    v_mov_b32 v89, v88
    s_nop 1
    v_permlane32_swap_b32 v88, v89
    s_nop 1
    v_add_f32 v88, v88, v89
    v_cvt_pk_bf16_f32 v89, v88, v88
    v_and_b32 v89, s28, v89
    v_sub_f32 v90, v88, v89
    v_cvt_pk_bf16_f32 v91, v90, v90
    v_and_b32 v91, s28, v91
    v_sub_f32 v90, v90, v91
    v_cvt_pk_bf16_f32 v92, v89, v89
    v_cvt_pk_bf16_f32 v93, v91, v91
    v_cvt_pk_bf16_f32 v94, v90, v89
    v_mov_b32 v95, 0
    s_mov_b64 exec, 0x0fffffff
    buffer_store_dwordx4 v[92:95], v13, s[16:19], s34 offen sc1
    s_mov_b64 exec, -1
    s_endpgm
attn_kernel_role3:
    s_barrier
    s_add_u32 s76, s4, 33554432
    s_addc_u32 s77, s5, 0
    s_mov_b32 s78, 8388608
    s_mov_b32 s79, 0x20000
    v_mov_b32 v96, -1
    v_mov_b32 v97, -1
    v_mov_b32 v98, -1
    v_mov_b32 v99, -1
    s_mul_i32 s71, s2, 32768
    buffer_store_dwordx4 v[96:99], v3, s[76:79], s71 offen offset:0 sc1
    buffer_store_dwordx4 v[96:99], v3, s[76:79], s71 offen offset:1024 sc1
    buffer_store_dwordx4 v[96:99], v3, s[76:79], s71 offen offset:2048 sc1
    buffer_store_dwordx4 v[96:99], v3, s[76:79], s71 offen offset:3072 sc1
    s_barrier
    s_add_u32 s71, s71, 4096
    buffer_store_dwordx4 v[96:99], v3, s[76:79], s71 offen offset:0 sc1
    buffer_store_dwordx4 v[96:99], v3, s[76:79], s71 offen offset:1024 sc1
    buffer_store_dwordx4 v[96:99], v3, s[76:79], s71 offen offset:2048 sc1
    buffer_store_dwordx4 v[96:99], v3, s[76:79], s71 offen offset:3072 sc1
    s_barrier
    s_add_u32 s71, s71, 4096
    buffer_store_dwordx4 v[96:99], v3, s[76:79], s71 offen offset:0 sc1
    buffer_store_dwordx4 v[96:99], v3, s[76:79], s71 offen offset:1024 sc1
    buffer_store_dwordx4 v[96:99], v3, s[76:79], s71 offen offset:2048 sc1
    buffer_store_dwordx4 v[96:99], v3, s[76:79], s71 offen offset:3072 sc1
    s_barrier
    s_add_u32 s71, s71, 4096
    buffer_store_dwordx4 v[96:99], v3, s[76:79], s71 offen offset:0 sc1
    buffer_store_dwordx4 v[96:99], v3, s[76:79], s71 offen offset:1024 sc1
    buffer_store_dwordx4 v[96:99], v3, s[76:79], s71 offen offset:2048 sc1
    buffer_store_dwordx4 v[96:99], v3, s[76:79], s71 offen offset:3072 sc1
    s_barrier
    s_add_u32 s71, s71, 4096
    buffer_store_dwordx4 v[96:99], v3, s[76:79], s71 offen offset:0 sc1
    buffer_store_dwordx4 v[96:99], v3, s[76:79], s71 offen offset:1024 sc1
    buffer_store_dwordx4 v[96:99], v3, s[76:79], s71 offen offset:2048 sc1
    buffer_store_dwordx4 v[96:99], v3, s[76:79], s71 offen offset:3072 sc1
    s_barrier
    s_add_u32 s71, s71, 4096
    buffer_store_dwordx4 v[96:99], v3, s[76:79], s71 offen offset:0 sc1
    buffer_store_dwordx4 v[96:99], v3, s[76:79], s71 offen offset:1024 sc1
    buffer_store_dwordx4 v[96:99], v3, s[76:79], s71 offen offset:2048 sc1
    buffer_store_dwordx4 v[96:99], v3, s[76:79], s71 offen offset:3072 sc1
    s_barrier
    s_add_u32 s71, s71, 4096
    buffer_store_dwordx4 v[96:99], v3, s[76:79], s71 offen offset:0 sc1
    buffer_store_dwordx4 v[96:99], v3, s[76:79], s71 offen offset:1024 sc1
    buffer_store_dwordx4 v[96:99], v3, s[76:79], s71 offen offset:2048 sc1
    buffer_store_dwordx4 v[96:99], v3, s[76:79], s71 offen offset:3072 sc1
    s_add_u32 s71, s71, 4096
    buffer_store_dwordx4 v[96:99], v3, s[76:79], s71 offen offset:0 sc1
    buffer_store_dwordx4 v[96:99], v3, s[76:79], s71 offen offset:1024 sc1
    buffer_store_dwordx4 v[96:99], v3, s[76:79], s71 offen offset:2048 sc1
    buffer_store_dwordx4 v[96:99], v3, s[76:79], s71 offen offset:3072 sc1
    s_barrier
    s_mov_b32 s64, s56
    s_mov_b32 s65, s57
    s_mov_b32 s66, 7340032
    s_mov_b32 s67, 0x20000
    s_lshr_b32 s32, s2, 4
    s_mul_i32 s45, s32, 458752
    s_and_b32 s33, s2, 15
    s_lshl_b32 s34, s33, 7
    s_add_u32 s45, s45, s34
    s_mul_i32 s46, s33, 458752
    s_lshr_b32 s34, s32, 3
    s_mul_i32 s34, s34, 229376
    s_add_u32 s46, s46, s34
    s_and_b32 s32, s32, 7
    s_mul_i32 s70, s32, 16384
    s_add_u32 s70, s70, s46
    s_mul_i32 s32, s32, 12288
    s_add_u32 s46, s46, s32
    s_add_u32 s16, s4, 25165824
    s_addc_u32 s17, s5, 0
    s_mov_b32 s18, 7340032
    s_mov_b32 s19, 0x20000
    buffer_load_dwordx4 v[48:51], v5, s[64:67], s45 offen
    s_add_u32 s45, s45, 16384
    buffer_load_dwordx4 v[52:55], v5, s[64:67], s45 offen
    s_add_u32 s45, s45, 16384
    buffer_load_dwordx4 v[56:59], v5, s[64:67], s45 offen
    s_add_u32 s45, s45, 16384
    buffer_load_dwordx4 v[60:63], v5, s[64:67], s45 offen
    s_add_u32 s45, s45, 16384
    buffer_load_dwordx4 v[64:67], v5, s[64:67], s45 offen
    s_add_u32 s45, s45, 16384
    buffer_load_dwordx4 v[68:71], v5, s[64:67], s45 offen
    s_add_u32 s45, s45, 16384
    buffer_load_dwordx4 v[72:75], v5, s[64:67], s45 offen
    s_barrier
    s_add_u32 s45, s45, 16384
    buffer_load_dwordx4 v[16:19], v5, s[64:67], s45 offen
    s_add_u32 s45, s45, 16384
    buffer_load_dwordx4 v[20:23], v5, s[64:67], s45 offen
    s_add_u32 s45, s45, 16384
    buffer_load_dwordx4 v[24:27], v5, s[64:67], s45 offen
    s_add_u32 s45, s45, 16384
    buffer_load_dwordx4 v[28:31], v5, s[64:67], s45 offen
    s_add_u32 s45, s45, 16384
    buffer_load_dwordx4 v[32:35], v5, s[64:67], s45 offen
    s_add_u32 s45, s45, 16384
    buffer_load_dwordx4 v[36:39], v5, s[64:67], s45 offen
    s_add_u32 s45, s45, 16384
    buffer_load_dwordx4 v[40:43], v5, s[64:67], s45 offen
    s_barrier
    s_waitcnt vmcnt(7)
    s_add_u32 s37, s46, 0
    buffer_store_dwordx4 v[48:51], v3, s[16:19], s37 offen sc1
    s_add_u32 s37, s46, 1024
    buffer_store_dwordx4 v[52:55], v3, s[16:19], s37 offen sc1
    s_add_u32 s37, s46, 2048
    buffer_store_dwordx4 v[56:59], v3, s[16:19], s37 offen sc1
    s_add_u32 s37, s46, 3072
    buffer_store_dwordx4 v[60:63], v3, s[16:19], s37 offen sc1
    s_add_u32 s37, s46, 4096
    buffer_store_dwordx4 v[64:67], v3, s[16:19], s37 offen sc1
    s_add_u32 s37, s46, 5120
    buffer_store_dwordx4 v[68:71], v3, s[16:19], s37 offen sc1
    s_add_u32 s37, s70, 98304
    buffer_store_dwordx4 v[72:75], v3, s[16:19], s37 offen sc1
    s_add_u32 s45, s45, 16384
    buffer_load_dwordx4 v[48:51], v5, s[64:67], s45 offen
    s_add_u32 s45, s45, 16384
    buffer_load_dwordx4 v[52:55], v5, s[64:67], s45 offen
    s_add_u32 s45, s45, 16384
    buffer_load_dwordx4 v[56:59], v5, s[64:67], s45 offen
    s_add_u32 s45, s45, 16384
    buffer_load_dwordx4 v[60:63], v5, s[64:67], s45 offen
    s_add_u32 s45, s45, 16384
    buffer_load_dwordx4 v[64:67], v5, s[64:67], s45 offen
    s_add_u32 s45, s45, 16384
    buffer_load_dwordx4 v[68:71], v5, s[64:67], s45 offen
    s_add_u32 s45, s45, 16384
    buffer_load_dwordx4 v[72:75], v5, s[64:67], s45 offen
    s_barrier
    s_waitcnt vmcnt(14)
    s_add_u32 s37, s70, 99328
    buffer_store_dwordx4 v[16:19], v3, s[16:19], s37 offen sc1
    s_add_u32 s37, s70, 100352
    buffer_store_dwordx4 v[20:23], v3, s[16:19], s37 offen sc1
    s_add_u32 s37, s70, 101376
    buffer_store_dwordx4 v[24:27], v3, s[16:19], s37 offen sc1
    s_add_u32 s37, s70, 102400
    buffer_store_dwordx4 v[28:31], v3, s[16:19], s37 offen sc1
    s_add_u32 s37, s70, 103424
    buffer_store_dwordx4 v[32:35], v3, s[16:19], s37 offen sc1
    s_add_u32 s37, s70, 104448
    buffer_store_dwordx4 v[36:39], v3, s[16:19], s37 offen sc1
    s_add_u32 s37, s70, 105472
    buffer_store_dwordx4 v[40:43], v3, s[16:19], s37 offen sc1
    s_add_u32 s45, s45, 16384
    buffer_load_dwordx4 v[16:19], v5, s[64:67], s45 offen
    s_add_u32 s45, s45, 16384
    buffer_load_dwordx4 v[20:23], v5, s[64:67], s45 offen
    s_add_u32 s45, s45, 16384
    buffer_load_dwordx4 v[24:27], v5, s[64:67], s45 offen
    s_add_u32 s45, s45, 16384
    buffer_load_dwordx4 v[28:31], v5, s[64:67], s45 offen
    s_add_u32 s45, s45, 16384
    buffer_load_dwordx4 v[32:35], v5, s[64:67], s45 offen
    s_add_u32 s45, s45, 16384
    buffer_load_dwordx4 v[36:39], v5, s[64:67], s45 offen
    s_add_u32 s45, s45, 16384
    buffer_load_dwordx4 v[40:43], v5, s[64:67], s45 offen
    s_barrier
    s_waitcnt vmcnt(14)
    s_add_u32 s37, s46, 6144
    buffer_store_dwordx4 v[48:51], v3, s[16:19], s37 offen sc1
    s_add_u32 s37, s46, 7168
    buffer_store_dwordx4 v[52:55], v3, s[16:19], s37 offen sc1
    s_add_u32 s37, s46, 8192
    buffer_store_dwordx4 v[56:59], v3, s[16:19], s37 offen sc1
    s_add_u32 s37, s46, 9216
    buffer_store_dwordx4 v[60:63], v3, s[16:19], s37 offen sc1
    s_add_u32 s37, s46, 10240
    buffer_store_dwordx4 v[64:67], v3, s[16:19], s37 offen sc1
    s_add_u32 s37, s46, 11264
    buffer_store_dwordx4 v[68:71], v3, s[16:19], s37 offen sc1
    s_add_u32 s37, s70, 106496
    buffer_store_dwordx4 v[72:75], v3, s[16:19], s37 offen sc1
    s_barrier
    s_waitcnt vmcnt(7)
    s_add_u32 s37, s70, 107520
    buffer_store_dwordx4 v[16:19], v3, s[16:19], s37 offen sc1
    s_add_u32 s37, s70, 108544
    buffer_store_dwordx4 v[20:23], v3, s[16:19], s37 offen sc1
    s_add_u32 s37, s70, 109568
    buffer_store_dwordx4 v[24:27], v3, s[16:19], s37 offen sc1
    s_add_u32 s37, s70, 110592
    buffer_store_dwordx4 v[28:31], v3, s[16:19], s37 offen sc1
    s_add_u32 s37, s70, 111616
    buffer_store_dwordx4 v[32:35], v3, s[16:19], s37 offen sc1
    s_add_u32 s37, s70, 112640
    buffer_store_dwordx4 v[36:39], v3, s[16:19], s37 offen sc1
    s_add_u32 s37, s70, 113664
    buffer_store_dwordx4 v[40:43], v3, s[16:19], s37 offen sc1
    s_barrier
    s_getpc_b64 s[92:93]
.Lpc3:
    s_add_u32 s92, s92, mlp_kernel_beg-.Lpc3
    s_addc_u32 s93, s93, 0
    s_mov_b32 s94, mlp_kernel_end-mlp_kernel_beg
    s_mov_b32 s95, 0x20000
    v_lshlrev_b32 v8, 7, v1
    s_mov_b32 s44, 0
    buffer_load_dword v15, v8, s[92:95], s44 offen
    s_mov_b32 s44, 8192
    buffer_load_dword v15, v8, s[92:95], s44 offen
    s_mov_b32 s44, 16384
    buffer_load_dword v15, v8, s[92:95], s44 offen
    s_mov_b32 s44, 24576
    buffer_load_dword v15, v8, s[92:95], s44 offen
    s_mov_b32 s44, 32768
    buffer_load_dword v15, v8, s[92:95], s44 offen
    s_mov_b32 s44, 40960
    buffer_load_dword v15, v8, s[92:95], s44 offen
    s_endpgm
attn_kernel_role0:
    s_mov_b32 m0, 32768
    s_mov_b32 s27, 16384
    buffer_load_dwordx4 v3, s[8:11], s27 offen offset:0 lds
    buffer_load_dwordx4 v3, s[8:11], s27 offen offset:1024 lds
    buffer_load_dwordx4 v3, s[8:11], s27 offen offset:2048 lds
    buffer_load_dwordx4 v3, s[8:11], s27 offen offset:3072 lds
    s_mov_b32 m0, 36864
    s_mov_b32 s27, 20480
    buffer_load_dwordx4 v3, s[8:11], s27 offen offset:0 lds
    buffer_load_dwordx4 v3, s[8:11], s27 offen offset:1024 lds
    buffer_load_dwordx4 v3, s[8:11], s27 offen offset:2048 lds
    buffer_load_dwordx4 v3, s[8:11], s27 offen offset:3072 lds
    s_mov_b32 m0, 40960
    s_mov_b32 s27, 16384
    buffer_load_dwordx4 v3, s[12:15], s27 offen offset:0 lds
    buffer_load_dwordx4 v3, s[12:15], s27 offen offset:1024 lds
    buffer_load_dwordx4 v3, s[12:15], s27 offen offset:2048 lds
    buffer_load_dwordx4 v3, s[12:15], s27 offen offset:3072 lds
    s_mov_b32 m0, 45056
    s_mov_b32 s27, 20480
    buffer_load_dwordx4 v3, s[12:15], s27 offen offset:0 lds
    buffer_load_dwordx4 v3, s[12:15], s27 offen offset:1024 lds
    buffer_load_dwordx4 v3, s[12:15], s27 offen offset:2048 lds
    buffer_load_dwordx4 v3, s[12:15], s27 offen offset:3072 lds
    s_barrier
    s_mov_b32 m0, 49152
    s_mov_b32 s27, 24576
    buffer_load_dwordx4 v3, s[8:11], s27 offen offset:0 lds
    buffer_load_dwordx4 v3, s[8:11], s27 offen offset:1024 lds
    buffer_load_dwordx4 v3, s[8:11], s27 offen offset:2048 lds
    buffer_load_dwordx4 v3, s[8:11], s27 offen offset:3072 lds
    s_mov_b32 m0, 53248
    s_mov_b32 s27, 28672
    buffer_load_dwordx4 v3, s[8:11], s27 offen offset:0 lds
    buffer_load_dwordx4 v3, s[8:11], s27 offen offset:1024 lds
    buffer_load_dwordx4 v3, s[8:11], s27 offen offset:2048 lds
    buffer_load_dwordx4 v3, s[8:11], s27 offen offset:3072 lds
    s_mov_b32 m0, 57344
    s_mov_b32 s27, 24576
    buffer_load_dwordx4 v3, s[12:15], s27 offen offset:0 lds
    buffer_load_dwordx4 v3, s[12:15], s27 offen offset:1024 lds
    buffer_load_dwordx4 v3, s[12:15], s27 offen offset:2048 lds
    buffer_load_dwordx4 v3, s[12:15], s27 offen offset:3072 lds
    s_mov_b32 m0, 61440
    s_mov_b32 s27, 28672
    buffer_load_dwordx4 v3, s[12:15], s27 offen offset:0 lds
    buffer_load_dwordx4 v3, s[12:15], s27 offen offset:1024 lds
    buffer_load_dwordx4 v3, s[12:15], s27 offen offset:2048 lds
    buffer_load_dwordx4 v3, s[12:15], s27 offen offset:3072 lds
    s_waitcnt vmcnt(16)
    s_barrier
    s_mov_b32 m0, 0
    s_mov_b32 s27, 32768
    buffer_load_dwordx4 v3, s[8:11], s27 offen offset:0 lds
    buffer_load_dwordx4 v3, s[8:11], s27 offen offset:1024 lds
    buffer_load_dwordx4 v3, s[8:11], s27 offen offset:2048 lds
    buffer_load_dwordx4 v3, s[8:11], s27 offen offset:3072 lds
    s_mov_b32 m0, 4096
    s_mov_b32 s27, 36864
    buffer_load_dwordx4 v3, s[8:11], s27 offen offset:0 lds
    buffer_load_dwordx4 v3, s[8:11], s27 offen offset:1024 lds
    buffer_load_dwordx4 v3, s[8:11], s27 offen offset:2048 lds
    buffer_load_dwordx4 v3, s[8:11], s27 offen offset:3072 lds
    s_mov_b32 m0, 8192
    s_mov_b32 s27, 32768
    buffer_load_dwordx4 v3, s[12:15], s27 offen offset:0 lds
    buffer_load_dwordx4 v3, s[12:15], s27 offen offset:1024 lds
    buffer_load_dwordx4 v3, s[12:15], s27 offen offset:2048 lds
    buffer_load_dwordx4 v3, s[12:15], s27 offen offset:3072 lds
    s_mov_b32 m0, 12288
    s_mov_b32 s27, 36864
    buffer_load_dwordx4 v3, s[12:15], s27 offen offset:0 lds
    buffer_load_dwordx4 v3, s[12:15], s27 offen offset:1024 lds
    buffer_load_dwordx4 v3, s[12:15], s27 offen offset:2048 lds
    buffer_load_dwordx4 v3, s[12:15], s27 offen offset:3072 lds
    s_waitcnt vmcnt(16)
    s_barrier
    s_mov_b32 m0, 16384
    s_mov_b32 s27, 40960
    buffer_load_dwordx4 v3, s[8:11], s27 offen offset:0 lds
    buffer_load_dwordx4 v3, s[8:11], s27 offen offset:1024 lds
    buffer_load_dwordx4 v3, s[8:11], s27 offen offset:2048 lds
    buffer_load_dwordx4 v3, s[8:11], s27 offen offset:3072 lds
    s_mov_b32 m0, 20480
    s_mov_b32 s27, 45056
    buffer_load_dwordx4 v3, s[8:11], s27 offen offset:0 lds
    buffer_load_dwordx4 v3, s[8:11], s27 offen offset:1024 lds
    buffer_load_dwordx4 v3, s[8:11], s27 offen offset:2048 lds
    buffer_load_dwordx4 v3, s[8:11], s27 offen offset:3072 lds
    s_mov_b32 m0, 24576
    s_mov_b32 s27, 40960
    buffer_load_dwordx4 v3, s[12:15], s27 offen offset:0 lds
    buffer_load_dwordx4 v3, s[12:15], s27 offen offset:1024 lds
    buffer_load_dwordx4 v3, s[12:15], s27 offen offset:2048 lds
    buffer_load_dwordx4 v3, s[12:15], s27 offen offset:3072 lds
    s_mov_b32 m0, 28672
    s_mov_b32 s27, 45056
    buffer_load_dwordx4 v3, s[12:15], s27 offen offset:0 lds
    buffer_load_dwordx4 v3, s[12:15], s27 offen offset:1024 lds
    buffer_load_dwordx4 v3, s[12:15], s27 offen offset:2048 lds
    buffer_load_dwordx4 v3, s[12:15], s27 offen offset:3072 lds
    s_waitcnt vmcnt(16)
    s_barrier
    s_mov_b32 m0, 32768
    s_mov_b32 s27, 49152
    buffer_load_dwordx4 v3, s[8:11], s27 offen offset:0 lds
    buffer_load_dwordx4 v3, s[8:11], s27 offen offset:1024 lds
    buffer_load_dwordx4 v3, s[8:11], s27 offen offset:2048 lds
    buffer_load_dwordx4 v3, s[8:11], s27 offen offset:3072 lds
    s_mov_b32 m0, 36864
    s_mov_b32 s27, 53248
    buffer_load_dwordx4 v3, s[8:11], s27 offen offset:0 lds
    buffer_load_dwordx4 v3, s[8:11], s27 offen offset:1024 lds
    buffer_load_dwordx4 v3, s[8:11], s27 offen offset:2048 lds
    buffer_load_dwordx4 v3, s[8:11], s27 offen offset:3072 lds
    s_mov_b32 m0, 40960
    s_mov_b32 s27, 49152
    buffer_load_dwordx4 v3, s[12:15], s27 offen offset:0 lds
    buffer_load_dwordx4 v3, s[12:15], s27 offen offset:1024 lds
    buffer_load_dwordx4 v3, s[12:15], s27 offen offset:2048 lds
    buffer_load_dwordx4 v3, s[12:15], s27 offen offset:3072 lds
    s_mov_b32 m0, 45056
    s_mov_b32 s27, 53248
    buffer_load_dwordx4 v3, s[12:15], s27 offen offset:0 lds
    buffer_load_dwordx4 v3, s[12:15], s27 offen offset:1024 lds
    buffer_load_dwordx4 v3, s[12:15], s27 offen offset:2048 lds
    buffer_load_dwordx4 v3, s[12:15], s27 offen offset:3072 lds
    s_waitcnt vmcnt(16)
    s_barrier
    s_mov_b32 m0, 49152
    s_mov_b32 s27, 57344
    buffer_load_dwordx4 v3, s[8:11], s27 offen offset:0 lds
    buffer_load_dwordx4 v3, s[8:11], s27 offen offset:1024 lds
    buffer_load_dwordx4 v3, s[8:11], s27 offen offset:2048 lds
    buffer_load_dwordx4 v3, s[8:11], s27 offen offset:3072 lds
    s_mov_b32 m0, 53248
    s_mov_b32 s27, 61440
    buffer_load_dwordx4 v3, s[8:11], s27 offen offset:0 lds
    buffer_load_dwordx4 v3, s[8:11], s27 offen offset:1024 lds
    buffer_load_dwordx4 v3, s[8:11], s27 offen offset:2048 lds
    buffer_load_dwordx4 v3, s[8:11], s27 offen offset:3072 lds
    s_mov_b32 m0, 57344
    s_mov_b32 s27, 57344
    buffer_load_dwordx4 v3, s[12:15], s27 offen offset:0 lds
    buffer_load_dwordx4 v3, s[12:15], s27 offen offset:1024 lds
    buffer_load_dwordx4 v3, s[12:15], s27 offen offset:2048 lds
    buffer_load_dwordx4 v3, s[12:15], s27 offen offset:3072 lds
    s_mov_b32 m0, 61440
    s_mov_b32 s27, 61440
    buffer_load_dwordx4 v3, s[12:15], s27 offen offset:0 lds
    buffer_load_dwordx4 v3, s[12:15], s27 offen offset:1024 lds
    buffer_load_dwordx4 v3, s[12:15], s27 offen offset:2048 lds
    buffer_load_dwordx4 v3, s[12:15], s27 offen offset:3072 lds
    s_waitcnt vmcnt(16)
    s_barrier
    s_mov_b32 m0, 0
    s_mov_b32 s27, 65536
    buffer_load_dwordx4 v3, s[8:11], s27 offen offset:0 lds
    buffer_load_dwordx4 v3, s[8:11], s27 offen offset:1024 lds
    buffer_load_dwordx4 v3, s[8:11], s27 offen offset:2048 lds
    buffer_load_dwordx4 v3, s[8:11], s27 offen offset:3072 lds
    s_mov_b32 m0, 4096
    s_mov_b32 s27, 69632
    buffer_load_dwordx4 v3, s[8:11], s27 offen offset:0 lds
    buffer_load_dwordx4 v3, s[8:11], s27 offen offset:1024 lds
    buffer_load_dwordx4 v3, s[8:11], s27 offen offset:2048 lds
    buffer_load_dwordx4 v3, s[8:11], s27 offen offset:3072 lds
    s_mov_b32 m0, 8192
    s_mov_b32 s27, 65536
    buffer_load_dwordx4 v3, s[12:15], s27 offen offset:0 lds
    buffer_load_dwordx4 v3, s[12:15], s27 offen offset:1024 lds
    buffer_load_dwordx4 v3, s[12:15], s27 offen offset:2048 lds
    buffer_load_dwordx4 v3, s[12:15], s27 offen offset:3072 lds
    s_mov_b32 m0, 12288
    s_mov_b32 s27, 69632
    buffer_load_dwordx4 v3, s[12:15], s27 offen offset:0 lds
    buffer_load_dwordx4 v3, s[12:15], s27 offen offset:1024 lds
    buffer_load_dwordx4 v3, s[12:15], s27 offen offset:2048 lds
    buffer_load_dwordx4 v3, s[12:15], s27 offen offset:3072 lds
    s_waitcnt vmcnt(16)
    s_barrier
    s_mov_b32 m0, 16384
    s_mov_b32 s27, 73728
    buffer_load_dwordx4 v3, s[8:11], s27 offen offset:0 lds
    buffer_load_dwordx4 v3, s[8:11], s27 offen offset:1024 lds
    buffer_load_dwordx4 v3, s[8:11], s27 offen offset:2048 lds
    buffer_load_dwordx4 v3, s[8:11], s27 offen offset:3072 lds
    s_mov_b32 m0, 20480
    s_mov_b32 s27, 77824
    buffer_load_dwordx4 v3, s[8:11], s27 offen offset:0 lds
    buffer_load_dwordx4 v3, s[8:11], s27 offen offset:1024 lds
    buffer_load_dwordx4 v3, s[8:11], s27 offen offset:2048 lds
    buffer_load_dwordx4 v3, s[8:11], s27 offen offset:3072 lds
    s_mov_b32 m0, 24576
    s_mov_b32 s27, 73728
    buffer_load_dwordx4 v3, s[12:15], s27 offen offset:0 lds
    buffer_load_dwordx4 v3, s[12:15], s27 offen offset:1024 lds
    buffer_load_dwordx4 v3, s[12:15], s27 offen offset:2048 lds
    buffer_load_dwordx4 v3, s[12:15], s27 offen offset:3072 lds
    s_mov_b32 m0, 28672
    s_mov_b32 s27, 77824
    buffer_load_dwordx4 v3, s[12:15], s27 offen offset:0 lds
    buffer_load_dwordx4 v3, s[12:15], s27 offen offset:1024 lds
    buffer_load_dwordx4 v3, s[12:15], s27 offen offset:2048 lds
    buffer_load_dwordx4 v3, s[12:15], s27 offen offset:3072 lds
    s_waitcnt vmcnt(16)
    s_barrier
    s_mov_b32 m0, 32768
    s_mov_b32 s27, 81920
    buffer_load_dwordx4 v3, s[8:11], s27 offen offset:0 lds
    buffer_load_dwordx4 v3, s[8:11], s27 offen offset:1024 lds
    buffer_load_dwordx4 v3, s[8:11], s27 offen offset:2048 lds
    buffer_load_dwordx4 v3, s[8:11], s27 offen offset:3072 lds
    s_mov_b32 m0, 36864
    s_mov_b32 s27, 86016
    buffer_load_dwordx4 v3, s[8:11], s27 offen offset:0 lds
    buffer_load_dwordx4 v3, s[8:11], s27 offen offset:1024 lds
    buffer_load_dwordx4 v3, s[8:11], s27 offen offset:2048 lds
    buffer_load_dwordx4 v3, s[8:11], s27 offen offset:3072 lds
    s_mov_b32 m0, 40960
    s_mov_b32 s27, 81920
    buffer_load_dwordx4 v3, s[12:15], s27 offen offset:0 lds
    buffer_load_dwordx4 v3, s[12:15], s27 offen offset:1024 lds
    buffer_load_dwordx4 v3, s[12:15], s27 offen offset:2048 lds
    buffer_load_dwordx4 v3, s[12:15], s27 offen offset:3072 lds
    s_mov_b32 m0, 45056
    s_mov_b32 s27, 86016
    buffer_load_dwordx4 v3, s[12:15], s27 offen offset:0 lds
    buffer_load_dwordx4 v3, s[12:15], s27 offen offset:1024 lds
    buffer_load_dwordx4 v3, s[12:15], s27 offen offset:2048 lds
    buffer_load_dwordx4 v3, s[12:15], s27 offen offset:3072 lds
    s_waitcnt vmcnt(16)
    s_barrier
    s_mov_b32 m0, 49152
    s_mov_b32 s27, 90112
    buffer_load_dwordx4 v3, s[8:11], s27 offen offset:0 lds
    buffer_load_dwordx4 v3, s[8:11], s27 offen offset:1024 lds
    buffer_load_dwordx4 v3, s[8:11], s27 offen offset:2048 lds
    buffer_load_dwordx4 v3, s[8:11], s27 offen offset:3072 lds
    s_mov_b32 m0, 53248
    s_mov_b32 s27, 94208
    buffer_load_dwordx4 v3, s[8:11], s27 offen offset:0 lds
    buffer_load_dwordx4 v3, s[8:11], s27 offen offset:1024 lds
    buffer_load_dwordx4 v3, s[8:11], s27 offen offset:2048 lds
    buffer_load_dwordx4 v3, s[8:11], s27 offen offset:3072 lds
    s_mov_b32 m0, 57344
    s_mov_b32 s27, 90112
    buffer_load_dwordx4 v3, s[12:15], s27 offen offset:0 lds
    buffer_load_dwordx4 v3, s[12:15], s27 offen offset:1024 lds
    buffer_load_dwordx4 v3, s[12:15], s27 offen offset:2048 lds
    buffer_load_dwordx4 v3, s[12:15], s27 offen offset:3072 lds
    s_mov_b32 m0, 61440
    s_mov_b32 s27, 94208
    buffer_load_dwordx4 v3, s[12:15], s27 offen offset:0 lds
    buffer_load_dwordx4 v3, s[12:15], s27 offen offset:1024 lds
    buffer_load_dwordx4 v3, s[12:15], s27 offen offset:2048 lds
    buffer_load_dwordx4 v3, s[12:15], s27 offen offset:3072 lds
    s_waitcnt vmcnt(16)
    s_barrier
    s_mov_b32 m0, 0
    s_mov_b32 s27, 98304
    buffer_load_dwordx4 v3, s[8:11], s27 offen offset:0 lds
    buffer_load_dwordx4 v3, s[8:11], s27 offen offset:1024 lds
    buffer_load_dwordx4 v3, s[8:11], s27 offen offset:2048 lds
    buffer_load_dwordx4 v3, s[8:11], s27 offen offset:3072 lds
    s_mov_b32 m0, 4096
    s_mov_b32 s27, 102400
    buffer_load_dwordx4 v3, s[8:11], s27 offen offset:0 lds
    buffer_load_dwordx4 v3, s[8:11], s27 offen offset:1024 lds
    buffer_load_dwordx4 v3, s[8:11], s27 offen offset:2048 lds
    buffer_load_dwordx4 v3, s[8:11], s27 offen offset:3072 lds
    s_mov_b32 m0, 8192
    s_mov_b32 s27, 98304
    buffer_load_dwordx4 v3, s[12:15], s27 offen offset:0 lds
    buffer_load_dwordx4 v3, s[12:15], s27 offen offset:1024 lds
    buffer_load_dwordx4 v3, s[12:15], s27 offen offset:2048 lds
    buffer_load_dwordx4 v3, s[12:15], s27 offen offset:3072 lds
    s_mov_b32 m0, 12288
    s_mov_b32 s27, 102400
    buffer_load_dwordx4 v3, s[12:15], s27 offen offset:0 lds
    buffer_load_dwordx4 v3, s[12:15], s27 offen offset:1024 lds
    buffer_load_dwordx4 v3, s[12:15], s27 offen offset:2048 lds
    buffer_load_dwordx4 v3, s[12:15], s27 offen offset:3072 lds
    s_waitcnt vmcnt(16)
    s_barrier
    s_mov_b32 m0, 16384
    s_mov_b32 s27, 106496
    buffer_load_dwordx4 v3, s[8:11], s27 offen offset:0 lds
    buffer_load_dwordx4 v3, s[8:11], s27 offen offset:1024 lds
    buffer_load_dwordx4 v3, s[8:11], s27 offen offset:2048 lds
    buffer_load_dwordx4 v3, s[8:11], s27 offen offset:3072 lds
    s_mov_b32 m0, 20480
    s_mov_b32 s27, 110592
    buffer_load_dwordx4 v3, s[8:11], s27 offen offset:0 lds
    buffer_load_dwordx4 v3, s[8:11], s27 offen offset:1024 lds
    buffer_load_dwordx4 v3, s[8:11], s27 offen offset:2048 lds
    buffer_load_dwordx4 v3, s[8:11], s27 offen offset:3072 lds
    s_mov_b32 m0, 24576
    s_mov_b32 s27, 106496
    buffer_load_dwordx4 v3, s[12:15], s27 offen offset:0 lds
    buffer_load_dwordx4 v3, s[12:15], s27 offen offset:1024 lds
    buffer_load_dwordx4 v3, s[12:15], s27 offen offset:2048 lds
    buffer_load_dwordx4 v3, s[12:15], s27 offen offset:3072 lds
    s_mov_b32 m0, 28672
    s_mov_b32 s27, 110592
    buffer_load_dwordx4 v3, s[12:15], s27 offen offset:0 lds
    buffer_load_dwordx4 v3, s[12:15], s27 offen offset:1024 lds
    buffer_load_dwordx4 v3, s[12:15], s27 offen offset:2048 lds
    buffer_load_dwordx4 v3, s[12:15], s27 offen offset:3072 lds
    s_waitcnt vmcnt(16)
    s_barrier
    s_mov_b32 m0, 32768
    s_mov_b32 s27, 114688
    buffer_load_dwordx4 v3, s[8:11], s27 offen offset:0 lds
    buffer_load_dwordx4 v3, s[8:11], s27 offen offset:1024 lds
    buffer_load_dwordx4 v3, s[8:11], s27 offen offset:2048 lds
    buffer_load_dwordx4 v3, s[8:11], s27 offen offset:3072 lds
    s_mov_b32 m0, 36864
    s_mov_b32 s27, 118784
    buffer_load_dwordx4 v3, s[8:11], s27 offen offset:0 lds
    buffer_load_dwordx4 v3, s[8:11], s27 offen offset:1024 lds
    buffer_load_dwordx4 v3, s[8:11], s27 offen offset:2048 lds
    buffer_load_dwordx4 v3, s[8:11], s27 offen offset:3072 lds
    s_mov_b32 m0, 40960
    s_mov_b32 s27, 114688
    buffer_load_dwordx4 v3, s[12:15], s27 offen offset:0 lds
    buffer_load_dwordx4 v3, s[12:15], s27 offen offset:1024 lds
    buffer_load_dwordx4 v3, s[12:15], s27 offen offset:2048 lds
    buffer_load_dwordx4 v3, s[12:15], s27 offen offset:3072 lds
    s_mov_b32 m0, 45056
    s_mov_b32 s27, 118784
    buffer_load_dwordx4 v3, s[12:15], s27 offen offset:0 lds
    buffer_load_dwordx4 v3, s[12:15], s27 offen offset:1024 lds
    buffer_load_dwordx4 v3, s[12:15], s27 offen offset:2048 lds
    buffer_load_dwordx4 v3, s[12:15], s27 offen offset:3072 lds
    s_waitcnt vmcnt(16)
    s_barrier
    s_mov_b32 m0, 49152
    s_mov_b32 s27, 122880
    buffer_load_dwordx4 v3, s[8:11], s27 offen offset:0 lds
    buffer_load_dwordx4 v3, s[8:11], s27 offen offset:1024 lds
    buffer_load_dwordx4 v3, s[8:11], s27 offen offset:2048 lds
    buffer_load_dwordx4 v3, s[8:11], s27 offen offset:3072 lds
    s_mov_b32 m0, 53248
    s_mov_b32 s27, 126976
    buffer_load_dwordx4 v3, s[8:11], s27 offen offset:0 lds
    buffer_load_dwordx4 v3, s[8:11], s27 offen offset:1024 lds
    buffer_load_dwordx4 v3, s[8:11], s27 offen offset:2048 lds
    buffer_load_dwordx4 v3, s[8:11], s27 offen offset:3072 lds
    s_mov_b32 m0, 57344
    s_mov_b32 s27, 122880
    buffer_load_dwordx4 v3, s[12:15], s27 offen offset:0 lds
    buffer_load_dwordx4 v3, s[12:15], s27 offen offset:1024 lds
    buffer_load_dwordx4 v3, s[12:15], s27 offen offset:2048 lds
    buffer_load_dwordx4 v3, s[12:15], s27 offen offset:3072 lds
    s_mov_b32 m0, 61440
    s_mov_b32 s27, 126976
    buffer_load_dwordx4 v3, s[12:15], s27 offen offset:0 lds
    buffer_load_dwordx4 v3, s[12:15], s27 offen offset:1024 lds
    buffer_load_dwordx4 v3, s[12:15], s27 offen offset:2048 lds
    buffer_load_dwordx4 v3, s[12:15], s27 offen offset:3072 lds
    s_waitcnt vmcnt(16)
    s_barrier
    s_waitcnt vmcnt(0)
    s_barrier
    s_barrier
    s_add_u32 s72, s4, 1605632
    s_addc_u32 s73, s5, 0
    s_mov_b32 s74, 98304
    s_mov_b32 s75, 0x20000
    v_mov_b32 v9, 1
    v_mov_b32 v10, 0
    v_bfe_u32 v11, v1, 2, 3
    v_lshlrev_b32 v8, 7, v11
    v_and_b32 v12, 3, v1
    v_lshl_add_u32 v8, v12, 2, v8
    v_cmp_eq_u32 s[68:69], s47, v11
    s_lshr_b32 s45, s31, 1
    s_lshl_b32 s45, s45, 10
    s_and_b32 s44, s48, 7
    s_lshl_b32 s44, s44, 3
    s_add_u32 s44, s44, s47
    s_lshl_b32 s44, s44, 7
    s_lshr_b32 s32, s48, 3
    s_lshl_b32 s32, s32, 2
    s_add_u32 s44, s44, s32
attn_kernel_early:
    s_barrier
    buffer_load_dword v24, v8, s[72:75], s45 offen sc1
    s_mov_b64 exec, 1
    buffer_store_dword v9, v10, s[72:75], s44 offen sc1
    s_mov_b64 exec, -1
    s_waitcnt vmcnt(1)
    v_cmp_eq_u32 vcc, 1, v24
    s_nop 1
    s_or_b64 vcc, vcc, s[68:69]
    s_cmp_eq_u64 vcc, -1
    s_cbranch_scc1 attn_kernel_spin_ok
    buffer_load_dword v24, v8, s[72:75], s45 offen sc1
    s_mov_b32 s38, 0x40000
attn_kernel_spin:
    s_waitcnt vmcnt(0)
    v_cmp_eq_u32 vcc, 1, v24
    s_nop 1
    s_or_b64 vcc, vcc, s[68:69]
    s_cmp_eq_u64 vcc, -1
    s_cbranch_scc1 attn_kernel_spin_ok
    s_sleep 2
    buffer_load_dword v24, v8, s[72:75], s45 offen sc1
    s_sub_u32 s38, s38, 1
    s_cmp_lg_u32 s38, 0
    s_cbranch_scc1 attn_kernel_spin
attn_kernel_spin_ok:
    s_barrier
    buffer_load_dword v24, v8, s[72:75], s45 offen sc1
    s_mov_b32 s38, 0x40000
attn_kernel_spin2:
    s_waitcnt vmcnt(0)
    v_cmp_eq_u32 vcc, 1, v24
    s_nop 1
    s_cmp_eq_u64 vcc, -1
    s_cbranch_scc1 attn_kernel_spin2_ok
    s_sleep 2
    buffer_load_dword v24, v8, s[72:75], s45 offen sc1
    s_sub_u32 s38, s38, 1
    s_cmp_lg_u32 s38, 0
    s_cbranch_scc1 attn_kernel_spin2
attn_kernel_spin2_ok:
    s_barrier
    s_endpgm
attn_kernel_end:
.globl mlp_kernel
.p2align 8
.type mlp_kernel,@function
mlp_kernel:
mlp_kernel_beg:
    s_load_dwordx2 s[26:27], s[0:1], 32
    s_load_dwordx2 s[28:29], s[0:1], 40
    s_load_dwordx2 s[30:31], s[0:1], 72
    s_load_dwordx2 s[32:33], s[0:1], 56
    s_cmp_ge_u32 s2, 256
    s_cbranch_scc1 mlp_kernel_done
    v_lshrrev_b32 v244, 6, v0
    v_and_b32 v235, 63, v0
    v_readfirstlane_b32 s21, v244
    s_and_b32 s44, s2, 7
    s_lshr_b32 s45, s2, 3
    s_lshr_b32 s22, s44, 2
    s_lshl_b32 s22, s22, 2
    s_lshr_b32 s46, s45, 3
    s_add_u32 s22, s22, s46
    s_and_b32 s23, s44, 3
    s_lshl_b32 s23, s23, 3
    s_and_b32 s47, s45, 7
    s_add_u32 s23, s23, s47
    s_lshl_b32 s24, s22, 2
    s_add_u32 s24, s24, s21
    s_lshl_b32 s24, s24, 1
    v_lshlrev_b32 v226, 4, v235
    s_and_b32 s48, s21, 1
    s_lshl_b32 s49, s48, 6
    v_add_u32 v244, s49, v235
    s_mul_i32 s49, s23, 224
    v_lshlrev_b32 v246, 4, v244
    v_add_u32 v246, s49, v246
    v_mul_u32_u24 v244, 4682, v244
    v_add_u32 v245, 0, v244
    v_lshrrev_b32 v245, 16, v245
    v_mul_u32_u24 v245, 6944, v245
    v_add_u32 v228, v245, v246
    v_add_u32 v245, 599296, v244
    v_lshrrev_b32 v245, 16, v245
    v_mul_u32_u24 v245, 6944, v245
    v_add_u32 v246, 2048, v246
    v_add_u32 v229, v245, v246
    v_add_u32 v245, 1198592, v244
    v_lshrrev_b32 v245, 16, v245
    v_mul_u32_u24 v245, 6944, v245
    v_add_u32 v246, 2048, v246
    v_add_u32 v230, v245, v246
    v_add_u32 v245, 1797888, v244
    v_lshrrev_b32 v245, 16, v245
    v_mul_u32_u24 v245, 6944, v245
    v_add_u32 v246, 2048, v246
    v_add_u32 v231, v245, v246
    v_add_u32 v245, 2397184, v244
    v_lshrrev_b32 v245, 16, v245
    v_mul_u32_u24 v245, 6944, v245
    v_add_u32 v246, 2048, v246
    v_add_u32 v232, v245, v246
    v_add_u32 v245, 2996480, v244
    v_lshrrev_b32 v245, 16, v245
    v_mul_u32_u24 v245, 6944, v245
    v_add_u32 v246, 2048, v246
    v_add_u32 v233, v245, v246
    v_add_u32 v245, 3595776, v244
    v_lshrrev_b32 v245, 16, v245
    v_mul_u32_u24 v245, 6944, v245
    v_add_u32 v246, 2048, v246
    v_add_u32 v234, v245, v246
    s_lshr_b32 s49, s21, 1
    s_mul_i32 s18, s49, 14336
    s_lshl_b32 s48, s48, 10
    s_add_u32 s18, s18, s48
    v_lshrrev_b32 v244, 4, v235
    v_lshlrev_b32 v244, 9, v244
    v_and_b32 v245, 15, v235
    v_lshl_add_u32 v227, v245, 4, v244
    s_lshl_b32 s50, s24, 16
    s_add_u32 s51, s50, 65536
    s_mov_b32 s16, 0
    s_mov_b32 s17, 0
    s_waitcnt lgkmcnt(0)
    s_cmp_lg_u32 s49, 0
    s_cselect_b32 s12, s28, s26
    s_cselect_b32 s13, s29, s27
    s_mov_b32 s14, 7340032
    s_mov_b32 s15, 0x20000
    s_add_u32 m0, s18, 0
    s_nop 0
    buffer_load_dwordx4 v228, s[12:15], s17 offen lds
    s_add_u32 s4, s30, 20971520
    s_addc_u32 s5, s31, 0
    s_add_u32 s4, s4, s50
    s_addc_u32 s5, s5, 0
    s_mov_b32 s6, 65536
    s_mov_b32 s7, 0x20000
    s_add_u32 s8, s30, 20971520
    s_addc_u32 s9, s31, 0
    s_add_u32 s8, s8, s51
    s_addc_u32 s9, s9, 0
    s_mov_b32 s10, 65536
    s_mov_b32 s11, 0x20000
    s_add_u32 m0, s18, 2048
    buffer_load_dwordx4 a[0:3], v227, s[4:7], s16 offen offset:0
    buffer_load_dwordx4 v229, s[12:15], s17 offen lds
    buffer_load_dwordx4 a[4:7], v227, s[4:7], s16 offen offset:256
    s_add_u32 m0, s18, 4096
    s_nop 0
    buffer_load_dwordx4 v230, s[12:15], s17 offen lds
    buffer_load_dwordx4 a[8:11], v227, s[8:11], s16 offen offset:0
    s_add_u32 m0, s18, 6144
    s_nop 0
    buffer_load_dwordx4 v231, s[12:15], s17 offen lds
    buffer_load_dwordx4 a[12:15], v227, s[8:11], s16 offen offset:256
    s_add_u32 m0, s18, 8192
    s_nop 0
    buffer_load_dwordx4 v232, s[12:15], s17 offen lds
    s_add_u32 m0, s18, 10240
    s_nop 0
    buffer_load_dwordx4 v233, s[12:15], s17 offen lds
    s_add_u32 m0, s18, 12288
    s_nop 0
    buffer_load_dwordx4 v234, s[12:15], s17 offen lds
    s_mov_b32 s19, 0xffff0000
    v_bfe_u32 v244, v235, 2, 3
    v_lshrrev_b32 v245, 5, v235
    v_lshl_add_u32 v244, v245, 4, v244
    v_mul_u32_u24 v244, 224, v244
    v_and_b32 v245, 3, v235
    v_lshl_add_u32 v224, v245, 3, v244
    v_add_u32 v225, 57344, v224
    s_lshr_b32 s52, s44, 2
    s_lshl_b32 s52, s52, 3
    s_lshr_b32 s46, s45, 2
    s_add_u32 s52, s52, s46
    s_bfe_u32 s55, s44, 65537
    s_and_b32 s53, s44, 1
    s_lshl_b32 s53, s53, 2
    s_and_b32 s47, s45, 3
    s_add_u32 s53, s53, s47
    s_lshl_b32 s53, s53, 1
    s_add_u32 s53, s53, s55
    s_mul_i32 s48, s55, 229376
    s_lshl_b32 s47, s21, 11
    s_add_u32 s48, s48, s47
    s_mul_i32 s3, s53, 458752
    s_add_u32 s3, s3, s48
    s_xor_b32 s54, s53, 1
    s_mul_i32 s54, s54, 458752
    s_add_u32 s54, s54, s48
    s_mul_i32 s34, s24, 224
    s_lshr_b32 s49, s23, 4
    s_mul_i32 s49, s49, 112
    s_add_u32 s34, s34, s49
    s_and_b32 s49, s23, 15
    s_mul_i32 s25, s49, 1024
    s_add_u32 s25, s25, 49152
    s_mul_i32 s49, s49, 3
    s_add_u32 s34, s34, s49
    s_lshl_b32 s34, s34, 10
    s_add_u32 s35, s34, 229376
    s_add_u32 s56, s30, 25165824
    s_addc_u32 s57, s31, 0
    s_mov_b32 s58, 7340032
    s_mov_b32 s59, 0x20000
    v_accvgpr_write_b32 a152, 0
    v_accvgpr_write_b32 a153, 0
    v_accvgpr_write_b32 a154, 0
    v_accvgpr_write_b32 a155, 0
    v_accvgpr_write_b32 a156, 0
    v_accvgpr_write_b32 a157, 0
    v_accvgpr_write_b32 a158, 0
    v_accvgpr_write_b32 a159, 0
    v_accvgpr_write_b32 a160, 0
    v_accvgpr_write_b32 a161, 0
    v_accvgpr_write_b32 a162, 0
    v_accvgpr_write_b32 a163, 0
    v_accvgpr_write_b32 a164, 0
    v_accvgpr_write_b32 a165, 0
    v_accvgpr_write_b32 a166, 0
    v_accvgpr_write_b32 a167, 0
    v_accvgpr_write_b32 a168, 0
    v_accvgpr_write_b32 a169, 0
    v_accvgpr_write_b32 a170, 0
    v_accvgpr_write_b32 a171, 0
    v_accvgpr_write_b32 a172, 0
    v_accvgpr_write_b32 a173, 0
    v_accvgpr_write_b32 a174, 0
    v_accvgpr_write_b32 a175, 0
    v_accvgpr_write_b32 a176, 0
    v_accvgpr_write_b32 a177, 0
    v_accvgpr_write_b32 a178, 0
    v_accvgpr_write_b32 a179, 0
    v_accvgpr_write_b32 a180, 0
    v_accvgpr_write_b32 a181, 0
    v_accvgpr_write_b32 a182, 0
    v_accvgpr_write_b32 a183, 0
    s_waitcnt vmcnt(4)
    s_barrier
    ds_read_b64_tr_b16 a[64:65], v224 offset:0
    ds_read_b64_tr_b16 a[66:67], v224 offset:1792
    ds_read_b64_tr_b16 a[68:69], v224 offset:14336
    ds_read_b64_tr_b16 a[70:71], v224 offset:16128
    ds_read_b64_tr_b16 a[72:73], v224 offset:32
    ds_read_b64_tr_b16 a[74:75], v224 offset:1824
    ds_read_b64_tr_b16 a[76:77], v224 offset:14368
    ds_read_b64_tr_b16 a[78:79], v224 offset:16160
    ds_read_b64_tr_b16 a[80:81], v224 offset:64
    ds_read_b64_tr_b16 a[82:83], v224 offset:1856
    ds_read_b64_tr_b16 a[84:85], v224 offset:14400
    ds_read_b64_tr_b16 a[86:87], v224 offset:16192
    ds_read_b64_tr_b16 a[88:89], v224 offset:96
    ds_read_b64_tr_b16 a[90:91], v224 offset:1888
    s_waitcnt lgkmcnt(12)
    v_mfma_f32_16x16x32_bf16 v[0:3], a[64:67], a[0:3], 0
    v_mfma_f32_16x16x32_bf16 v[4:7], a[64:67], a[4:7], 0
    v_mfma_f32_16x16x32_bf16 v[8:11], a[64:67], a[8:11], 0
    buffer_load_dwordx4 a[16:19], v227, s[4:7], s16 offen offset:2048
    s_waitcnt vmcnt(4)
    v_mfma_f32_16x16x32_bf16 v[12:15], a[64:67], a[12:15], 0
    s_waitcnt lgkmcnt(10)
    v_mfma_f32_16x16x32_bf16 v[28:31], a[68:71], a[12:15], 0
    ds_read_b64_tr_b16 a[64:65], v224 offset:14432
    v_mfma_f32_16x16x32_bf16 v[24:27], a[68:71], a[8:11], 0
    ds_read_b64_tr_b16 a[66:67], v224 offset:16224
    v_mfma_f32_16x16x32_bf16 v[20:23], a[68:71], a[4:7], 0
    buffer_load_dwordx4 a[20:23], v227, s[4:7], s16 offen offset:2304
    v_mfma_f32_16x16x32_bf16 v[16:19], a[68:71], a[0:3], 0
    s_waitcnt lgkmcnt(10)
    v_mfma_f32_16x16x32_bf16 v[32:35], a[72:75], a[0:3], 0
    ds_read_b64_tr_b16 a[68:69], v224 offset:128
    v_mfma_f32_16x16x32_bf16 v[36:39], a[72:75], a[4:7], 0
    ds_read_b64_tr_b16 a[70:71], v224 offset:1920
    v_mfma_f32_16x16x32_bf16 v[40:43], a[72:75], a[8:11], 0
    buffer_load_dwordx4 a[24:27], v227, s[8:11], s16 offen offset:2048
    v_mfma_f32_16x16x32_bf16 v[44:47], a[72:75], a[12:15], 0
    s_waitcnt lgkmcnt(10)
    v_mfma_f32_16x16x32_bf16 v[60:63], a[76:79], a[12:15], 0
    ds_read_b64_tr_b16 a[72:73], v224 offset:14464
    v_mfma_f32_16x16x32_bf16 v[56:59], a[76:79], a[8:11], 0
    ds_read_b64_tr_b16 a[74:75], v224 offset:16256
    v_mfma_f32_16x16x32_bf16 v[52:55], a[76:79], a[4:7], 0
    buffer_load_dwordx4 a[28:31], v227, s[8:11], s16 offen offset:2304
    v_mfma_f32_16x16x32_bf16 v[48:51], a[76:79], a[0:3], 0
    s_waitcnt lgkmcnt(10)
    v_mfma_f32_16x16x32_bf16 v[64:67], a[80:83], a[0:3], 0
    ds_read_b64_tr_b16 a[76:77], v224 offset:160
    v_mfma_f32_16x16x32_bf16 v[68:71], a[80:83], a[4:7], 0
    ds_read_b64_tr_b16 a[78:79], v224 offset:1952
    s_add_u32 m0, s18, 28672
    s_add_u32 s17, s17, 458752
    v_mfma_f32_16x16x32_bf16 v[72:75], a[80:83], a[8:11], 0
    buffer_load_dwordx4 v228, s[12:15], s17 offen lds
    v_mfma_f32_16x16x32_bf16 v[76:79], a[80:83], a[12:15], 0
    s_waitcnt lgkmcnt(10)
    v_mfma_f32_16x16x32_bf16 v[92:95], a[84:87], a[12:15], 0
    ds_read_b64_tr_b16 a[80:81], v224 offset:14496
    v_mfma_f32_16x16x32_bf16 v[88:91], a[84:87], a[8:11], 0
    ds_read_b64_tr_b16 a[82:83], v224 offset:16288
    s_add_u32 m0, s18, 30720
    v_mfma_f32_16x16x32_bf16 v[84:87], a[84:87], a[4:7], 0
    buffer_load_dwordx4 v229, s[12:15], s17 offen lds
    v_mfma_f32_16x16x32_bf16 v[80:83], a[84:87], a[0:3], 0
    s_waitcnt lgkmcnt(10)
    v_mfma_f32_16x16x32_bf16 v[96:99], a[88:91], a[0:3], 0
    ds_read_b64_tr_b16 a[84:85], v224 offset:192
    v_mfma_f32_16x16x32_bf16 v[100:103], a[88:91], a[4:7], 0
    ds_read_b64_tr_b16 a[86:87], v224 offset:1984
    s_add_u32 m0, s18, 32768
    v_mfma_f32_16x16x32_bf16 v[104:107], a[88:91], a[8:11], 0
    buffer_load_dwordx4 v230, s[12:15], s17 offen lds
    v_mfma_f32_16x16x32_bf16 v[108:111], a[88:91], a[12:15], 0
    s_waitcnt lgkmcnt(10)
    v_mfma_f32_16x16x32_bf16 v[124:127], a[64:67], a[12:15], 0
    ds_read_b64_tr_b16 a[88:89], v224 offset:14528
    v_mfma_f32_16x16x32_bf16 v[120:123], a[64:67], a[8:11], 0
    ds_read_b64_tr_b16 a[90:91], v224 offset:16320
    s_add_u32 m0, s18, 34816
    v_mfma_f32_16x16x32_bf16 v[116:119], a[64:67], a[4:7], 0
    buffer_load_dwordx4 v231, s[12:15], s17 offen lds
    v_mfma_f32_16x16x32_bf16 v[112:115], a[64:67], a[0:3], 0
    s_waitcnt vmcnt(8) lgkmcnt(10)
    s_barrier
    v_mfma_f32_16x16x32_bf16 v[128:131], a[68:71], a[0:3], 0
    ds_read_b64_tr_b16 a[64:65], v224 offset:7168
    v_mfma_f32_16x16x32_bf16 v[132:135], a[68:71], a[4:7], 0
    ds_read_b64_tr_b16 a[66:67], v224 offset:8960
    s_add_u32 m0, s18, 36864
    v_mfma_f32_16x16x32_bf16 v[136:139], a[68:71], a[8:11], 0
    buffer_load_dwordx4 v232, s[12:15], s17 offen lds
    v_mfma_f32_16x16x32_bf16 v[140:143], a[68:71], a[12:15], 0
    s_waitcnt lgkmcnt(10)
    v_mfma_f32_16x16x32_bf16 v[156:159], a[72:75], a[12:15], 0
    ds_read_b64_tr_b16 a[68:69], v224 offset:21504
    v_mfma_f32_16x16x32_bf16 v[152:155], a[72:75], a[8:11], 0
    ds_read_b64_tr_b16 a[70:71], v224 offset:23296
    v_mfma_f32_16x16x32_bf16 v[148:151], a[72:75], a[4:7], 0
    s_add_u32 s16, s16, 4096
    buffer_load_dwordx4 a[32:35], v227, s[4:7], s16 offen offset:0
    v_mfma_f32_16x16x32_bf16 v[144:147], a[72:75], a[0:3], 0
    s_waitcnt lgkmcnt(10)
    v_mfma_f32_16x16x32_bf16 v[160:163], a[76:79], a[0:3], 0
    ds_read_b64_tr_b16 a[72:73], v224 offset:7200
    v_mfma_f32_16x16x32_bf16 v[164:167], a[76:79], a[4:7], 0
    ds_read_b64_tr_b16 a[74:75], v224 offset:8992
    s_add_u32 m0, s18, 38912
    v_mfma_f32_16x16x32_bf16 v[168:171], a[76:79], a[8:11], 0
    buffer_load_dwordx4 v233, s[12:15], s17 offen lds
    v_mfma_f32_16x16x32_bf16 v[172:175], a[76:79], a[12:15], 0
    s_waitcnt lgkmcnt(10)
    v_mfma_f32_16x16x32_bf16 v[188:191], a[80:83], a[12:15], 0
    ds_read_b64_tr_b16 a[76:77], v224 offset:21536
    v_mfma_f32_16x16x32_bf16 v[184:187], a[80:83], a[8:11], 0
    ds_read_b64_tr_b16 a[78:79], v224 offset:23328
    v_mfma_f32_16x16x32_bf16 v[180:183], a[80:83], a[4:7], 0
    buffer_load_dwordx4 a[36:39], v227, s[4:7], s16 offen offset:256
    v_mfma_f32_16x16x32_bf16 v[176:179], a[80:83], a[0:3], 0
    s_waitcnt lgkmcnt(10)
    v_mfma_f32_16x16x32_bf16 v[192:195], a[84:87], a[0:3], 0
    ds_read_b64_tr_b16 a[80:81], v224 offset:7232
    v_mfma_f32_16x16x32_bf16 v[196:199], a[84:87], a[4:7], 0
    ds_read_b64_tr_b16 a[82:83], v224 offset:9024
    v_mfma_f32_16x16x32_bf16 v[200:203], a[84:87], a[8:11], 0
    buffer_load_dwordx4 a[40:43], v227, s[8:11], s16 offen offset:0
    v_mfma_f32_16x16x32_bf16 v[204:207], a[84:87], a[12:15], 0
    s_waitcnt lgkmcnt(10)
    v_mfma_f32_16x16x32_bf16 v[220:223], a[88:91], a[12:15], 0
    ds_read_b64_tr_b16 a[84:85], v224 offset:21568
    v_mfma_f32_16x16x32_bf16 v[216:219], a[88:91], a[8:11], 0
    ds_read_b64_tr_b16 a[86:87], v224 offset:23360
    s_add_u32 m0, s18, 40960
    v_mfma_f32_16x16x32_bf16 v[212:215], a[88:91], a[4:7], 0
    buffer_load_dwordx4 v234, s[12:15], s17 offen lds
    v_mfma_f32_16x16x32_bf16 v[208:211], a[88:91], a[0:3], 0
    s_waitcnt vmcnt(13) lgkmcnt(10)
    v_mfma_f32_16x16x32_bf16 v[0:3], a[64:67], a[16:19], v[0:3]
    ds_read_b64_tr_b16 a[88:89], v224 offset:7264
    s_waitcnt vmcnt(12)
    v_mfma_f32_16x16x32_bf16 v[4:7], a[64:67], a[20:23], v[4:7]
    ds_read_b64_tr_b16 a[90:91], v224 offset:9056
    s_waitcnt vmcnt(11)
    v_mfma_f32_16x16x32_bf16 v[8:11], a[64:67], a[24:27], v[8:11]
    buffer_load_dwordx4 a[44:47], v227, s[8:11], s16 offen offset:256
    s_waitcnt vmcnt(11)
    v_mfma_f32_16x16x32_bf16 v[12:15], a[64:67], a[28:31], v[12:15]
    s_waitcnt lgkmcnt(10)
    v_mfma_f32_16x16x32_bf16 v[28:31], a[68:71], a[28:31], v[28:31]
    ds_read_b64_tr_b16 a[64:65], v224 offset:21600
    v_mfma_f32_16x16x32_bf16 v[24:27], a[68:71], a[24:27], v[24:27]
    ds_read_b64_tr_b16 a[66:67], v224 offset:23392
    s_add_u32 m0, s18, 57344
    s_add_u32 s17, s17, 458752
    v_mfma_f32_16x16x32_bf16 v[20:23], a[68:71], a[20:23], v[20:23]
    buffer_load_dwordx4 v228, s[12:15], s17 offen lds
    v_mfma_f32_16x16x32_bf16 v[16:19], a[68:71], a[16:19], v[16:19]
    s_waitcnt lgkmcnt(10)
    v_mfma_f32_16x16x32_bf16 v[32:35], a[72:75], a[16:19], v[32:35]
    ds_read_b64_tr_b16 a[68:69], v224 offset:7296
    v_mfma_f32_16x16x32_bf16 v[36:39], a[72:75], a[20:23], v[36:39]
    ds_read_b64_tr_b16 a[70:71], v224 offset:9088
    s_add_u32 m0, s18, 59392
    v_mfma_f32_16x16x32_bf16 v[40:43], a[72:75], a[24:27], v[40:43]
    buffer_load_dwordx4 v229, s[12:15], s17 offen lds
    v_mfma_f32_16x16x32_bf16 v[44:47], a[72:75], a[28:31], v[44:47]
    s_waitcnt lgkmcnt(10)
    v_mfma_f32_16x16x32_bf16 v[60:63], a[76:79], a[28:31], v[60:63]
    ds_read_b64_tr_b16 a[72:73], v224 offset:21632
    v_mfma_f32_16x16x32_bf16 v[56:59], a[76:79], a[24:27], v[56:59]
    ds_read_b64_tr_b16 a[74:75], v224 offset:23424
    v_mfma_f32_16x16x32_bf16 v[52:55], a[76:79], a[20:23], v[52:55]
    buffer_load_dwordx4 a[48:51], v227, s[4:7], s16 offen offset:2048
    v_mfma_f32_16x16x32_bf16 v[48:51], a[76:79], a[16:19], v[48:51]
    s_waitcnt lgkmcnt(10)
    v_mfma_f32_16x16x32_bf16 v[64:67], a[80:83], a[16:19], v[64:67]
    ds_read_b64_tr_b16 a[76:77], v224 offset:7328
    v_mfma_f32_16x16x32_bf16 v[68:71], a[80:83], a[20:23], v[68:71]
    ds_read_b64_tr_b16 a[78:79], v224 offset:9120
    v_mfma_f32_16x16x32_bf16 v[72:75], a[80:83], a[24:27], v[72:75]
    buffer_load_dwordx4 a[52:55], v227, s[4:7], s16 offen offset:2304
    v_mfma_f32_16x16x32_bf16 v[76:79], a[80:83], a[28:31], v[76:79]
    s_waitcnt lgkmcnt(10)
    v_mfma_f32_16x16x32_bf16 v[92:95], a[84:87], a[28:31], v[92:95]
    ds_read_b64_tr_b16 a[80:81], v224 offset:21664
    v_mfma_f32_16x16x32_bf16 v[88:91], a[84:87], a[24:27], v[88:91]
    ds_read_b64_tr_b16 a[82:83], v224 offset:23456
    s_add_u32 m0, s18, 61440
    v_mfma_f32_16x16x32_bf16 v[84:87], a[84:87], a[20:23], v[84:87]
    buffer_load_dwordx4 v230, s[12:15], s17 offen lds
    v_mfma_f32_16x16x32_bf16 v[80:83], a[84:87], a[16:19], v[80:83]
    s_waitcnt lgkmcnt(10)
    v_mfma_f32_16x16x32_bf16 v[96:99], a[88:91], a[16:19], v[96:99]
    ds_read_b64_tr_b16 a[84:85], v224 offset:7360
    v_mfma_f32_16x16x32_bf16 v[100:103], a[88:91], a[20:23], v[100:103]
    ds_read_b64_tr_b16 a[86:87], v224 offset:9152
    v_mfma_f32_16x16x32_bf16 v[104:107], a[88:91], a[24:27], v[104:107]
    buffer_load_dwordx4 a[56:59], v227, s[8:11], s16 offen offset:2048
    v_mfma_f32_16x16x32_bf16 v[108:111], a[88:91], a[28:31], v[108:111]
    s_waitcnt lgkmcnt(10)
    v_mfma_f32_16x16x32_bf16 v[124:127], a[64:67], a[28:31], v[124:127]
    ds_read_b64_tr_b16 a[88:89], v224 offset:21696
    v_mfma_f32_16x16x32_bf16 v[120:123], a[64:67], a[24:27], v[120:123]
    ds_read_b64_tr_b16 a[90:91], v224 offset:23488
    v_mfma_f32_16x16x32_bf16 v[116:119], a[64:67], a[20:23], v[116:119]
    buffer_load_dwordx4 a[60:63], v227, s[8:11], s16 offen offset:2304
    v_mfma_f32_16x16x32_bf16 v[112:115], a[64:67], a[16:19], v[112:115]
    s_waitcnt vmcnt(8) lgkmcnt(10)
    s_barrier
    v_mfma_f32_16x16x32_bf16 v[128:131], a[68:71], a[16:19], v[128:131]
    ds_read_b64_tr_b16 a[64:65], v224 offset:28672
    v_mfma_f32_16x16x32_bf16 v[132:135], a[68:71], a[20:23], v[132:135]
    ds_read_b64_tr_b16 a[66:67], v224 offset:30464
    s_add_u32 m0, s18, 63488
    v_mfma_f32_16x16x32_bf16 v[136:139], a[68:71], a[24:27], v[136:139]
    buffer_load_dwordx4 v231, s[12:15], s17 offen lds
    v_mfma_f32_16x16x32_bf16 v[140:143], a[68:71], a[28:31], v[140:143]
    s_waitcnt lgkmcnt(10)
    v_mfma_f32_16x16x32_bf16 v[156:159], a[72:75], a[28:31], v[156:159]
    ds_read_b64_tr_b16 a[68:69], v224 offset:43008
    v_mfma_f32_16x16x32_bf16 v[152:155], a[72:75], a[24:27], v[152:155]
    ds_read_b64_tr_b16 a[70:71], v224 offset:44800
    s_add_u32 m0, s18, 65536
    v_mfma_f32_16x16x32_bf16 v[148:151], a[72:75], a[20:23], v[148:151]
    buffer_load_dwordx4 v232, s[12:15], s17 offen lds
    s_add_u32 s16, s16, 4096
    buffer_load_dwordx4 a[0:3], v227, s[4:7], s16 offen offset:0
    v_mfma_f32_16x16x32_bf16 v[144:147], a[72:75], a[16:19], v[144:147]
    s_waitcnt lgkmcnt(10)
    v_mfma_f32_16x16x32_bf16 v[160:163], a[76:79], a[16:19], v[160:163]
    ds_read_b64_tr_b16 a[72:73], v224 offset:28704
    v_mfma_f32_16x16x32_bf16 v[164:167], a[76:79], a[20:23], v[164:167]
    ds_read_b64_tr_b16 a[74:75], v224 offset:30496
    s_add_u32 m0, s18, 67584
    v_mfma_f32_16x16x32_bf16 v[168:171], a[76:79], a[24:27], v[168:171]
    buffer_load_dwordx4 v233, s[12:15], s17 offen lds
    v_mfma_f32_16x16x32_bf16 v[172:175], a[76:79], a[28:31], v[172:175]
    s_waitcnt lgkmcnt(10)
    v_mfma_f32_16x16x32_bf16 v[188:191], a[80:83], a[28:31], v[188:191]
    ds_read_b64_tr_b16 a[76:77], v224 offset:43040
    v_mfma_f32_16x16x32_bf16 v[184:187], a[80:83], a[24:27], v[184:187]
    ds_read_b64_tr_b16 a[78:79], v224 offset:44832
    v_mfma_f32_16x16x32_bf16 v[180:183], a[80:83], a[20:23], v[180:183]
    buffer_load_dwordx4 a[4:7], v227, s[4:7], s16 offen offset:256
    v_mfma_f32_16x16x32_bf16 v[176:179], a[80:83], a[16:19], v[176:179]
    s_waitcnt lgkmcnt(10)
    v_mfma_f32_16x16x32_bf16 v[192:195], a[84:87], a[16:19], v[192:195]
    ds_read_b64_tr_b16 a[80:81], v224 offset:28736
    v_mfma_f32_16x16x32_bf16 v[196:199], a[84:87], a[20:23], v[196:199]
    ds_read_b64_tr_b16 a[82:83], v224 offset:30528
    v_mfma_f32_16x16x32_bf16 v[200:203], a[84:87], a[24:27], v[200:203]
    v_mfma_f32_16x16x32_bf16 v[204:207], a[84:87], a[28:31], v[204:207]
    s_waitcnt lgkmcnt(10)
    v_mfma_f32_16x16x32_bf16 v[220:223], a[88:91], a[28:31], v[220:223]
    ds_read_b64_tr_b16 a[84:85], v224 offset:43072
    v_mfma_f32_16x16x32_bf16 v[216:219], a[88:91], a[24:27], v[216:219]
    ds_read_b64_tr_b16 a[86:87], v224 offset:44864
    v_mfma_f32_16x16x32_bf16 v[212:215], a[88:91], a[20:23], v[212:215]
    buffer_load_dwordx4 a[8:11], v227, s[8:11], s16 offen offset:0
    v_mfma_f32_16x16x32_bf16 v[208:211], a[88:91], a[16:19], v[208:211]
    s_waitcnt lgkmcnt(10)
    v_mfma_f32_16x16x32_bf16 v[0:3], a[64:67], a[32:35], v[0:3]
    ds_read_b64_tr_b16 a[88:89], v224 offset:28768
    v_mfma_f32_16x16x32_bf16 v[4:7], a[64:67], a[36:39], v[4:7]
    ds_read_b64_tr_b16 a[90:91], v224 offset:30560
    s_add_u32 m0, s18, 69632
    v_mfma_f32_16x16x32_bf16 v[8:11], a[64:67], a[40:43], v[8:11]
    buffer_load_dwordx4 v234, s[12:15], s17 offen lds
    s_waitcnt vmcnt(14)
    v_mfma_f32_16x16x32_bf16 v[12:15], a[64:67], a[44:47], v[12:15]
    s_waitcnt lgkmcnt(10)
    v_mfma_f32_16x16x32_bf16 v[28:31], a[68:71], a[44:47], v[28:31]
    ds_read_b64_tr_b16 a[64:65], v224 offset:43104
    v_mfma_f32_16x16x32_bf16 v[24:27], a[68:71], a[40:43], v[24:27]
    ds_read_b64_tr_b16 a[66:67], v224 offset:44896
    v_mfma_f32_16x16x32_bf16 v[20:23], a[68:71], a[36:39], v[20:23]
    buffer_load_dwordx4 a[12:15], v227, s[8:11], s16 offen offset:256
    v_mfma_f32_16x16x32_bf16 v[16:19], a[68:71], a[32:35], v[16:19]
    s_waitcnt lgkmcnt(10)
    v_mfma_f32_16x16x32_bf16 v[32:35], a[72:75], a[32:35], v[32:35]
    ds_read_b64_tr_b16 a[68:69], v224 offset:28800
    v_mfma_f32_16x16x32_bf16 v[36:39], a[72:75], a[36:39], v[36:39]
    ds_read_b64_tr_b16 a[70:71], v224 offset:30592
    v_mfma_f32_16x16x32_bf16 v[40:43], a[72:75], a[40:43], v[40:43]
    v_mfma_f32_16x16x32_bf16 v[44:47], a[72:75], a[44:47], v[44:47]
    s_waitcnt lgkmcnt(10)
    v_mfma_f32_16x16x32_bf16 v[60:63], a[76:79], a[44:47], v[60:63]
    ds_read_b64_tr_b16 a[72:73], v224 offset:43136
    v_mfma_f32_16x16x32_bf16 v[56:59], a[76:79], a[40:43], v[56:59]
    ds_read_b64_tr_b16 a[74:75], v224 offset:44928
    v_mfma_f32_16x16x32_bf16 v[52:55], a[76:79], a[36:39], v[52:55]
    v_mfma_f32_16x16x32_bf16 v[48:51], a[76:79], a[32:35], v[48:51]
    s_waitcnt lgkmcnt(10)
    v_mfma_f32_16x16x32_bf16 v[64:67], a[80:83], a[32:35], v[64:67]
    ds_read_b64_tr_b16 a[76:77], v224 offset:28832
    v_mfma_f32_16x16x32_bf16 v[68:71], a[80:83], a[36:39], v[68:71]
    ds_read_b64_tr_b16 a[78:79], v224 offset:30624
    s_add_u32 m0, s18, 86016
    s_add_u32 s17, s17, 458752
    v_mfma_f32_16x16x32_bf16 v[72:75], a[80:83], a[40:43], v[72:75]
    buffer_load_dwordx4 v228, s[12:15], s17 offen lds
    v_mfma_f32_16x16x32_bf16 v[76:79], a[80:83], a[44:47], v[76:79]
    s_waitcnt lgkmcnt(10)
    v_mfma_f32_16x16x32_bf16 v[92:95], a[84:87], a[44:47], v[92:95]
    ds_read_b64_tr_b16 a[80:81], v224 offset:43168
    v_mfma_f32_16x16x32_bf16 v[88:91], a[84:87], a[40:43], v[88:91]
    ds_read_b64_tr_b16 a[82:83], v224 offset:44960
    v_mfma_f32_16x16x32_bf16 v[84:87], a[84:87], a[36:39], v[84:87]
    v_mfma_f32_16x16x32_bf16 v[80:83], a[84:87], a[32:35], v[80:83]
    s_waitcnt lgkmcnt(10)
    v_mfma_f32_16x16x32_bf16 v[96:99], a[88:91], a[32:35], v[96:99]
    ds_read_b64_tr_b16 a[84:85], v224 offset:28864
    v_mfma_f32_16x16x32_bf16 v[100:103], a[88:91], a[36:39], v[100:103]
    ds_read_b64_tr_b16 a[86:87], v224 offset:30656
    v_mfma_f32_16x16x32_bf16 v[104:107], a[88:91], a[40:43], v[104:107]
    v_mfma_f32_16x16x32_bf16 v[108:111], a[88:91], a[44:47], v[108:111]
    s_waitcnt lgkmcnt(10)
    v_mfma_f32_16x16x32_bf16 v[124:127], a[64:67], a[44:47], v[124:127]
    ds_read_b64_tr_b16 a[88:89], v224 offset:43200
    v_mfma_f32_16x16x32_bf16 v[120:123], a[64:67], a[40:43], v[120:123]
    ds_read_b64_tr_b16 a[90:91], v224 offset:44992
    v_mfma_f32_16x16x32_bf16 v[116:119], a[64:67], a[36:39], v[116:119]
    v_mfma_f32_16x16x32_bf16 v[112:115], a[64:67], a[32:35], v[112:115]
    s_waitcnt lgkmcnt(10)
    v_mfma_f32_16x16x32_bf16 v[128:131], a[68:71], a[32:35], v[128:131]
    ds_read_b64_tr_b16 a[64:65], v224 offset:35840
    v_mfma_f32_16x16x32_bf16 v[132:135], a[68:71], a[36:39], v[132:135]
    ds_read_b64_tr_b16 a[66:67], v224 offset:37632
    s_add_u32 m0, s18, 88064
    v_mfma_f32_16x16x32_bf16 v[136:139], a[68:71], a[40:43], v[136:139]
    buffer_load_dwordx4 v229, s[12:15], s17 offen lds
    v_mfma_f32_16x16x32_bf16 v[140:143], a[68:71], a[44:47], v[140:143]
    s_waitcnt lgkmcnt(10)
    v_mfma_f32_16x16x32_bf16 v[156:159], a[72:75], a[44:47], v[156:159]
    ds_read_b64_tr_b16 a[68:69], v224 offset:50176
    v_mfma_f32_16x16x32_bf16 v[152:155], a[72:75], a[40:43], v[152:155]
    ds_read_b64_tr_b16 a[70:71], v224 offset:51968
    v_mfma_f32_16x16x32_bf16 v[148:151], a[72:75], a[36:39], v[148:151]
    buffer_load_dwordx4 a[16:19], v227, s[4:7], s16 offen offset:2048
    v_mfma_f32_16x16x32_bf16 v[144:147], a[72:75], a[32:35], v[144:147]
    s_waitcnt lgkmcnt(10)
    v_mfma_f32_16x16x32_bf16 v[160:163], a[76:79], a[32:35], v[160:163]
    ds_read_b64_tr_b16 a[72:73], v224 offset:35872
    v_mfma_f32_16x16x32_bf16 v[164:167], a[76:79], a[36:39], v[164:167]
    ds_read_b64_tr_b16 a[74:75], v224 offset:37664
    v_mfma_f32_16x16x32_bf16 v[168:171], a[76:79], a[40:43], v[168:171]
    v_mfma_f32_16x16x32_bf16 v[172:175], a[76:79], a[44:47], v[172:175]
    s_waitcnt lgkmcnt(10)
    v_mfma_f32_16x16x32_bf16 v[188:191], a[80:83], a[44:47], v[188:191]
    ds_read_b64_tr_b16 a[76:77], v224 offset:50208
    v_mfma_f32_16x16x32_bf16 v[184:187], a[80:83], a[40:43], v[184:187]
    ds_read_b64_tr_b16 a[78:79], v224 offset:52000
    v_mfma_f32_16x16x32_bf16 v[180:183], a[80:83], a[36:39], v[180:183]
    buffer_load_dwordx4 a[20:23], v227, s[4:7], s16 offen offset:2304
    v_mfma_f32_16x16x32_bf16 v[176:179], a[80:83], a[32:35], v[176:179]
    s_waitcnt lgkmcnt(10)
    v_mfma_f32_16x16x32_bf16 v[192:195], a[84:87], a[32:35], v[192:195]
    ds_read_b64_tr_b16 a[80:81], v224 offset:35904
    v_mfma_f32_16x16x32_bf16 v[196:199], a[84:87], a[36:39], v[196:199]
    ds_read_b64_tr_b16 a[82:83], v224 offset:37696
    s_add_u32 m0, s18, 90112
    v_mfma_f32_16x16x32_bf16 v[200:203], a[84:87], a[40:43], v[200:203]
    buffer_load_dwordx4 v230, s[12:15], s17 offen lds
    v_mfma_f32_16x16x32_bf16 v[204:207], a[84:87], a[44:47], v[204:207]
    s_waitcnt lgkmcnt(10)
    v_mfma_f32_16x16x32_bf16 v[220:223], a[88:91], a[44:47], v[220:223]
    ds_read_b64_tr_b16 a[84:85], v224 offset:50240
    v_mfma_f32_16x16x32_bf16 v[216:219], a[88:91], a[40:43], v[216:219]
    ds_read_b64_tr_b16 a[86:87], v224 offset:52032
    v_mfma_f32_16x16x32_bf16 v[212:215], a[88:91], a[36:39], v[212:215]
    buffer_load_dwordx4 a[24:27], v227, s[8:11], s16 offen offset:2048
    v_mfma_f32_16x16x32_bf16 v[208:211], a[88:91], a[32:35], v[208:211]
    s_waitcnt vmcnt(18) lgkmcnt(10)
    v_mfma_f32_16x16x32_bf16 v[0:3], a[64:67], a[48:51], v[0:3]
    ds_read_b64_tr_b16 a[88:89], v224 offset:35936
    s_waitcnt vmcnt(17)
    v_mfma_f32_16x16x32_bf16 v[4:7], a[64:67], a[52:55], v[4:7]
    ds_read_b64_tr_b16 a[90:91], v224 offset:37728
    s_waitcnt vmcnt(15)
    v_mfma_f32_16x16x32_bf16 v[8:11], a[64:67], a[56:59], v[8:11]
    s_waitcnt vmcnt(14)
    v_mfma_f32_16x16x32_bf16 v[12:15], a[64:67], a[60:63], v[12:15]
    s_waitcnt lgkmcnt(10)
    v_mfma_f32_16x16x32_bf16 v[28:31], a[68:71], a[60:63], v[28:31]
    ds_read_b64_tr_b16 a[64:65], v224 offset:50272
    v_mfma_f32_16x16x32_bf16 v[24:27], a[68:71], a[56:59], v[24:27]
    ds_read_b64_tr_b16 a[66:67], v224 offset:52064
    v_mfma_f32_16x16x32_bf16 v[20:23], a[68:71], a[52:55], v[20:23]
    buffer_load_dwordx4 a[28:31], v227, s[8:11], s16 offen offset:2304
    v_mfma_f32_16x16x32_bf16 v[16:19], a[68:71], a[48:51], v[16:19]
    s_waitcnt lgkmcnt(10)
    v_mfma_f32_16x16x32_bf16 v[32:35], a[72:75], a[48:51], v[32:35]
    ds_read_b64_tr_b16 a[68:69], v224 offset:35968
    v_mfma_f32_16x16x32_bf16 v[36:39], a[72:75], a[52:55], v[36:39]
    ds_read_b64_tr_b16 a[70:71], v224 offset:37760
    s_add_u32 m0, s18, 92160
    v_mfma_f32_16x16x32_bf16 v[40:43], a[72:75], a[56:59], v[40:43]
    buffer_load_dwordx4 v231, s[12:15], s17 offen lds
    v_mfma_f32_16x16x32_bf16 v[44:47], a[72:75], a[60:63], v[44:47]
    s_waitcnt lgkmcnt(10)
    v_mfma_f32_16x16x32_bf16 v[60:63], a[76:79], a[60:63], v[60:63]
    ds_read_b64_tr_b16 a[72:73], v224 offset:50304
    v_mfma_f32_16x16x32_bf16 v[56:59], a[76:79], a[56:59], v[56:59]
    ds_read_b64_tr_b16 a[74:75], v224 offset:52096
    v_mfma_f32_16x16x32_bf16 v[52:55], a[76:79], a[52:55], v[52:55]
    v_mfma_f32_16x16x32_bf16 v[48:51], a[76:79], a[48:51], v[48:51]
    s_waitcnt lgkmcnt(10)
    v_mfma_f32_16x16x32_bf16 v[64:67], a[80:83], a[48:51], v[64:67]
    ds_read_b64_tr_b16 a[76:77], v224 offset:36000
    v_mfma_f32_16x16x32_bf16 v[68:71], a[80:83], a[52:55], v[68:71]
    ds_read_b64_tr_b16 a[78:79], v224 offset:37792
    v_mfma_f32_16x16x32_bf16 v[72:75], a[80:83], a[56:59], v[72:75]
    v_mfma_f32_16x16x32_bf16 v[76:79], a[80:83], a[60:63], v[76:79]
    s_waitcnt lgkmcnt(10)
    v_mfma_f32_16x16x32_bf16 v[92:95], a[84:87], a[60:63], v[92:95]
    ds_read_b64_tr_b16 a[80:81], v224 offset:50336
    v_mfma_f32_16x16x32_bf16 v[88:91], a[84:87], a[56:59], v[88:91]
    ds_read_b64_tr_b16 a[82:83], v224 offset:52128
    v_mfma_f32_16x16x32_bf16 v[84:87], a[84:87], a[52:55], v[84:87]
    v_mfma_f32_16x16x32_bf16 v[80:83], a[84:87], a[48:51], v[80:83]
    s_waitcnt lgkmcnt(10)
    v_mfma_f32_16x16x32_bf16 v[96:99], a[88:91], a[48:51], v[96:99]
    ds_read_b64_tr_b16 a[84:85], v224 offset:36032
    v_mfma_f32_16x16x32_bf16 v[100:103], a[88:91], a[52:55], v[100:103]
    ds_read_b64_tr_b16 a[86:87], v224 offset:37824
    s_add_u32 m0, s18, 94208
    v_mfma_f32_16x16x32_bf16 v[104:107], a[88:91], a[56:59], v[104:107]
    buffer_load_dwordx4 v232, s[12:15], s17 offen lds
    v_mfma_f32_16x16x32_bf16 v[108:111], a[88:91], a[60:63], v[108:111]
    s_waitcnt lgkmcnt(10)
    v_mfma_f32_16x16x32_bf16 v[124:127], a[64:67], a[60:63], v[124:127]
    ds_read_b64_tr_b16 a[88:89], v224 offset:50368
    v_mfma_f32_16x16x32_bf16 v[120:123], a[64:67], a[56:59], v[120:123]
    ds_read_b64_tr_b16 a[90:91], v224 offset:52160
    v_mfma_f32_16x16x32_bf16 v[116:119], a[64:67], a[52:55], v[116:119]
    v_mfma_f32_16x16x32_bf16 v[112:115], a[64:67], a[48:51], v[112:115]
    s_waitcnt vmcnt(10) lgkmcnt(10)
    s_barrier
    v_mfma_f32_16x16x32_bf16 v[128:131], a[68:71], a[48:51], v[128:131]
    ds_read_b64_tr_b16 a[64:65], v225 offset:0
    v_mfma_f32_16x16x32_bf16 v[132:135], a[68:71], a[52:55], v[132:135]
    ds_read_b64_tr_b16 a[66:67], v225 offset:1792
    v_mfma_f32_16x16x32_bf16 v[136:139], a[68:71], a[56:59], v[136:139]
    v_mfma_f32_16x16x32_bf16 v[140:143], a[68:71], a[60:63], v[140:143]
    s_waitcnt lgkmcnt(10)
    v_mfma_f32_16x16x32_bf16 v[156:159], a[72:75], a[60:63], v[156:159]
    ds_read_b64_tr_b16 a[68:69], v225 offset:14336
    v_mfma_f32_16x16x32_bf16 v[152:155], a[72:75], a[56:59], v[152:155]
    ds_read_b64_tr_b16 a[70:71], v225 offset:16128
    v_mfma_f32_16x16x32_bf16 v[148:151], a[72:75], a[52:55], v[148:151]
    s_add_u32 s16, s16, 4096
    buffer_load_dwordx4 a[32:35], v227, s[4:7], s16 offen offset:0
    v_mfma_f32_16x16x32_bf16 v[144:147], a[72:75], a[48:51], v[144:147]
    s_waitcnt lgkmcnt(10)
    v_mfma_f32_16x16x32_bf16 v[160:163], a[76:79], a[48:51], v[160:163]
    ds_read_b64_tr_b16 a[72:73], v225 offset:32
    v_mfma_f32_16x16x32_bf16 v[164:167], a[76:79], a[52:55], v[164:167]
    ds_read_b64_tr_b16 a[74:75], v225 offset:1824
    s_add_u32 m0, s18, 96256
    v_mfma_f32_16x16x32_bf16 v[168:171], a[76:79], a[56:59], v[168:171]
    buffer_load_dwordx4 v233, s[12:15], s17 offen lds
    v_mfma_f32_16x16x32_bf16 v[172:175], a[76:79], a[60:63], v[172:175]
    s_waitcnt lgkmcnt(10)
    v_mfma_f32_16x16x32_bf16 v[188:191], a[80:83], a[60:63], v[188:191]
    ds_read_b64_tr_b16 a[76:77], v225 offset:14368
    v_mfma_f32_16x16x32_bf16 v[184:187], a[80:83], a[56:59], v[184:187]
    ds_read_b64_tr_b16 a[78:79], v225 offset:16160
    v_mfma_f32_16x16x32_bf16 v[180:183], a[80:83], a[52:55], v[180:183]
    buffer_load_dwordx4 a[36:39], v227, s[4:7], s16 offen offset:256
    v_mfma_f32_16x16x32_bf16 v[176:179], a[80:83], a[48:51], v[176:179]
    s_waitcnt lgkmcnt(10)
    v_mfma_f32_16x16x32_bf16 v[192:195], a[84:87], a[48:51], v[192:195]
    ds_read_b64_tr_b16 a[80:81], v225 offset:64
    v_mfma_f32_16x16x32_bf16 v[196:199], a[84:87], a[52:55], v[196:199]
    ds_read_b64_tr_b16 a[82:83], v225 offset:1856
    v_mfma_f32_16x16x32_bf16 v[200:203], a[84:87], a[56:59], v[200:203]
    v_mfma_f32_16x16x32_bf16 v[204:207], a[84:87], a[60:63], v[204:207]
    s_waitcnt lgkmcnt(10)
    v_mfma_f32_16x16x32_bf16 v[220:223], a[88:91], a[60:63], v[220:223]
    ds_read_b64_tr_b16 a[84:85], v225 offset:14400
    v_mfma_f32_16x16x32_bf16 v[216:219], a[88:91], a[56:59], v[216:219]
    ds_read_b64_tr_b16 a[86:87], v225 offset:16192
    v_mfma_f32_16x16x32_bf16 v[212:215], a[88:91], a[52:55], v[212:215]
    buffer_load_dwordx4 a[40:43], v227, s[8:11], s16 offen offset:0
    v_mfma_f32_16x16x32_bf16 v[208:211], a[88:91], a[48:51], v[208:211]
    s_waitcnt lgkmcnt(10)
    v_mfma_f32_16x16x32_bf16 v[0:3], a[64:67], a[0:3], v[0:3]
    ds_read_b64_tr_b16 a[88:89], v225 offset:96
    v_mfma_f32_16x16x32_bf16 v[4:7], a[64:67], a[4:7], v[4:7]
    ds_read_b64_tr_b16 a[90:91], v225 offset:1888
    s_add_u32 m0, s18, 98304
    v_mfma_f32_16x16x32_bf16 v[8:11], a[64:67], a[8:11], v[8:11]
    buffer_load_dwordx4 v234, s[12:15], s17 offen lds
    s_waitcnt vmcnt(14)
    v_mfma_f32_16x16x32_bf16 v[12:15], a[64:67], a[12:15], v[12:15]
    s_waitcnt lgkmcnt(10)
    v_mfma_f32_16x16x32_bf16 v[28:31], a[68:71], a[12:15], v[28:31]
    ds_read_b64_tr_b16 a[64:65], v225 offset:14432
    v_mfma_f32_16x16x32_bf16 v[24:27], a[68:71], a[8:11], v[24:27]
    ds_read_b64_tr_b16 a[66:67], v225 offset:16224
    v_mfma_f32_16x16x32_bf16 v[20:23], a[68:71], a[4:7], v[20:23]
    buffer_load_dwordx4 a[44:47], v227, s[8:11], s16 offen offset:256
    v_mfma_f32_16x16x32_bf16 v[16:19], a[68:71], a[0:3], v[16:19]
    s_waitcnt lgkmcnt(10)
    v_mfma_f32_16x16x32_bf16 v[32:35], a[72:75], a[0:3], v[32:35]
    ds_read_b64_tr_b16 a[68:69], v225 offset:128
    v_mfma_f32_16x16x32_bf16 v[36:39], a[72:75], a[4:7], v[36:39]
    ds_read_b64_tr_b16 a[70:71], v225 offset:1920
    v_mfma_f32_16x16x32_bf16 v[40:43], a[72:75], a[8:11], v[40:43]
    v_mfma_f32_16x16x32_bf16 v[44:47], a[72:75], a[12:15], v[44:47]
    s_waitcnt lgkmcnt(10)
    v_mfma_f32_16x16x32_bf16 v[60:63], a[76:79], a[12:15], v[60:63]
    ds_read_b64_tr_b16 a[72:73], v225 offset:14464
    v_mfma_f32_16x16x32_bf16 v[56:59], a[76:79], a[8:11], v[56:59]
    ds_read_b64_tr_b16 a[74:75], v225 offset:16256
    v_mfma_f32_16x16x32_bf16 v[52:55], a[76:79], a[4:7], v[52:55]
    v_mfma_f32_16x16x32_bf16 v[48:51], a[76:79], a[0:3], v[48:51]
    s_waitcnt lgkmcnt(10)
    v_mfma_f32_16x16x32_bf16 v[64:67], a[80:83], a[0:3], v[64:67]
    ds_read_b64_tr_b16 a[76:77], v225 offset:160
    v_mfma_f32_16x16x32_bf16 v[68:71], a[80:83], a[4:7], v[68:71]
    ds_read_b64_tr_b16 a[78:79], v225 offset:1952
    s_add_u32 m0, s18, 0
    s_add_u32 s17, s17, 458752
    v_mfma_f32_16x16x32_bf16 v[72:75], a[80:83], a[8:11], v[72:75]
    buffer_load_dwordx4 v228, s[12:15], s17 offen lds
    v_mfma_f32_16x16x32_bf16 v[76:79], a[80:83], a[12:15], v[76:79]
    s_waitcnt lgkmcnt(10)
    v_mfma_f32_16x16x32_bf16 v[92:95], a[84:87], a[12:15], v[92:95]
    ds_read_b64_tr_b16 a[80:81], v225 offset:14496
    v_mfma_f32_16x16x32_bf16 v[88:91], a[84:87], a[8:11], v[88:91]
    ds_read_b64_tr_b16 a[82:83], v225 offset:16288
    v_mfma_f32_16x16x32_bf16 v[84:87], a[84:87], a[4:7], v[84:87]
    v_mfma_f32_16x16x32_bf16 v[80:83], a[84:87], a[0:3], v[80:83]
    s_waitcnt lgkmcnt(10)
    v_mfma_f32_16x16x32_bf16 v[96:99], a[88:91], a[0:3], v[96:99]
    ds_read_b64_tr_b16 a[84:85], v225 offset:192
    v_mfma_f32_16x16x32_bf16 v[100:103], a[88:91], a[4:7], v[100:103]
    ds_read_b64_tr_b16 a[86:87], v225 offset:1984
    v_mfma_f32_16x16x32_bf16 v[104:107], a[88:91], a[8:11], v[104:107]
    v_mfma_f32_16x16x32_bf16 v[108:111], a[88:91], a[12:15], v[108:111]
    s_waitcnt lgkmcnt(10)
    v_mfma_f32_16x16x32_bf16 v[124:127], a[64:67], a[12:15], v[124:127]
    ds_read_b64_tr_b16 a[88:89], v225 offset:14528
    v_mfma_f32_16x16x32_bf16 v[120:123], a[64:67], a[8:11], v[120:123]
    ds_read_b64_tr_b16 a[90:91], v225 offset:16320
    v_mfma_f32_16x16x32_bf16 v[116:119], a[64:67], a[4:7], v[116:119]
    v_mfma_f32_16x16x32_bf16 v[112:115], a[64:67], a[0:3], v[112:115]
    s_waitcnt lgkmcnt(10)
    v_mfma_f32_16x16x32_bf16 v[128:131], a[68:71], a[0:3], v[128:131]
    ds_read_b64_tr_b16 a[64:65], v225 offset:7168
    v_mfma_f32_16x16x32_bf16 v[132:135], a[68:71], a[4:7], v[132:135]
    ds_read_b64_tr_b16 a[66:67], v225 offset:8960
    s_add_u32 m0, s18, 2048
    v_mfma_f32_16x16x32_bf16 v[136:139], a[68:71], a[8:11], v[136:139]
    buffer_load_dwordx4 v229, s[12:15], s17 offen lds
    v_mfma_f32_16x16x32_bf16 v[140:143], a[68:71], a[12:15], v[140:143]
    s_waitcnt lgkmcnt(10)
    v_mfma_f32_16x16x32_bf16 v[156:159], a[72:75], a[12:15], v[156:159]
    ds_read_b64_tr_b16 a[68:69], v225 offset:21504
    v_mfma_f32_16x16x32_bf16 v[152:155], a[72:75], a[8:11], v[152:155]
    ds_read_b64_tr_b16 a[70:71], v225 offset:23296
    v_mfma_f32_16x16x32_bf16 v[148:151], a[72:75], a[4:7], v[148:151]
    buffer_load_dwordx4 a[48:51], v227, s[4:7], s16 offen offset:2048
    v_mfma_f32_16x16x32_bf16 v[144:147], a[72:75], a[0:3], v[144:147]
    s_waitcnt lgkmcnt(10)
    v_mfma_f32_16x16x32_bf16 v[160:163], a[76:79], a[0:3], v[160:163]
    ds_read_b64_tr_b16 a[72:73], v225 offset:7200
    v_mfma_f32_16x16x32_bf16 v[164:167], a[76:79], a[4:7], v[164:167]
    ds_read_b64_tr_b16 a[74:75], v225 offset:8992
    v_mfma_f32_16x16x32_bf16 v[168:171], a[76:79], a[8:11], v[168:171]
    v_mfma_f32_16x16x32_bf16 v[172:175], a[76:79], a[12:15], v[172:175]
    s_waitcnt lgkmcnt(10)
    v_mfma_f32_16x16x32_bf16 v[188:191], a[80:83], a[12:15], v[188:191]
    ds_read_b64_tr_b16 a[76:77], v225 offset:21536
    v_mfma_f32_16x16x32_bf16 v[184:187], a[80:83], a[8:11], v[184:187]
    ds_read_b64_tr_b16 a[78:79], v225 offset:23328
    v_mfma_f32_16x16x32_bf16 v[180:183], a[80:83], a[4:7], v[180:183]
    buffer_load_dwordx4 a[52:55], v227, s[4:7], s16 offen offset:2304
    v_mfma_f32_16x16x32_bf16 v[176:179], a[80:83], a[0:3], v[176:179]
    s_waitcnt lgkmcnt(10)
    v_mfma_f32_16x16x32_bf16 v[192:195], a[84:87], a[0:3], v[192:195]
    ds_read_b64_tr_b16 a[80:81], v225 offset:7232
    v_mfma_f32_16x16x32_bf16 v[196:199], a[84:87], a[4:7], v[196:199]
    ds_read_b64_tr_b16 a[82:83], v225 offset:9024
    s_add_u32 m0, s18, 4096
    v_mfma_f32_16x16x32_bf16 v[200:203], a[84:87], a[8:11], v[200:203]
    buffer_load_dwordx4 v230, s[12:15], s17 offen lds
    v_mfma_f32_16x16x32_bf16 v[204:207], a[84:87], a[12:15], v[204:207]
    s_waitcnt lgkmcnt(10)
    v_mfma_f32_16x16x32_bf16 v[220:223], a[88:91], a[12:15], v[220:223]
    ds_read_b64_tr_b16 a[84:85], v225 offset:21568
    v_mfma_f32_16x16x32_bf16 v[216:219], a[88:91], a[8:11], v[216:219]
    ds_read_b64_tr_b16 a[86:87], v225 offset:23360
    v_mfma_f32_16x16x32_bf16 v[212:215], a[88:91], a[4:7], v[212:215]
    buffer_load_dwordx4 a[56:59], v227, s[8:11], s16 offen offset:2048
    v_mfma_f32_16x16x32_bf16 v[208:211], a[88:91], a[0:3], v[208:211]
    s_waitcnt vmcnt(18) lgkmcnt(10)
    v_mfma_f32_16x16x32_bf16 v[0:3], a[64:67], a[16:19], v[0:3]
    ds_read_b64_tr_b16 a[88:89], v225 offset:7264
    s_waitcnt vmcnt(17)
    v_mfma_f32_16x16x32_bf16 v[4:7], a[64:67], a[20:23], v[4:7]
    ds_read_b64_tr_b16 a[90:91], v225 offset:9056
    s_waitcnt vmcnt(15)
    v_mfma_f32_16x16x32_bf16 v[8:11], a[64:67], a[24:27], v[8:11]
    s_waitcnt vmcnt(14)
    v_mfma_f32_16x16x32_bf16 v[12:15], a[64:67], a[28:31], v[12:15]
    s_waitcnt lgkmcnt(10)
    v_mfma_f32_16x16x32_bf16 v[28:31], a[68:71], a[28:31], v[28:31]
    ds_read_b64_tr_b16 a[64:65], v225 offset:21600
    v_mfma_f32_16x16x32_bf16 v[24:27], a[68:71], a[24:27], v[24:27]
    ds_read_b64_tr_b16 a[66:67], v225 offset:23392
    v_mfma_f32_16x16x32_bf16 v[20:23], a[68:71], a[20:23], v[20:23]
    buffer_load_dwordx4 a[60:63], v227, s[8:11], s16 offen offset:2304
    v_mfma_f32_16x16x32_bf16 v[16:19], a[68:71], a[16:19], v[16:19]
    s_waitcnt lgkmcnt(10)
    v_mfma_f32_16x16x32_bf16 v[32:35], a[72:75], a[16:19], v[32:35]
    ds_read_b64_tr_b16 a[68:69], v225 offset:7296
    v_mfma_f32_16x16x32_bf16 v[36:39], a[72:75], a[20:23], v[36:39]
    ds_read_b64_tr_b16 a[70:71], v225 offset:9088
    s_add_u32 m0, s18, 6144
    v_mfma_f32_16x16x32_bf16 v[40:43], a[72:75], a[24:27], v[40:43]
    buffer_load_dwordx4 v231, s[12:15], s17 offen lds
    v_mfma_f32_16x16x32_bf16 v[44:47], a[72:75], a[28:31], v[44:47]
    s_waitcnt lgkmcnt(10)
    v_mfma_f32_16x16x32_bf16 v[60:63], a[76:79], a[28:31], v[60:63]
    ds_read_b64_tr_b16 a[72:73], v225 offset:21632
    v_mfma_f32_16x16x32_bf16 v[56:59], a[76:79], a[24:27], v[56:59]
    ds_read_b64_tr_b16 a[74:75], v225 offset:23424
    v_mfma_f32_16x16x32_bf16 v[52:55], a[76:79], a[20:23], v[52:55]
    v_mfma_f32_16x16x32_bf16 v[48:51], a[76:79], a[16:19], v[48:51]
    s_waitcnt lgkmcnt(10)
    v_mfma_f32_16x16x32_bf16 v[64:67], a[80:83], a[16:19], v[64:67]
    ds_read_b64_tr_b16 a[76:77], v225 offset:7328
    v_mfma_f32_16x16x32_bf16 v[68:71], a[80:83], a[20:23], v[68:71]
    ds_read_b64_tr_b16 a[78:79], v225 offset:9120
    v_mfma_f32_16x16x32_bf16 v[72:75], a[80:83], a[24:27], v[72:75]
    v_mfma_f32_16x16x32_bf16 v[76:79], a[80:83], a[28:31], v[76:79]
    s_waitcnt lgkmcnt(10)
    v_mfma_f32_16x16x32_bf16 v[92:95], a[84:87], a[28:31], v[92:95]
    ds_read_b64_tr_b16 a[80:81], v225 offset:21664
    v_mfma_f32_16x16x32_bf16 v[88:91], a[84:87], a[24:27], v[88:91]
    ds_read_b64_tr_b16 a[82:83], v225 offset:23456
    v_mfma_f32_16x16x32_bf16 v[84:87], a[84:87], a[20:23], v[84:87]
    v_mfma_f32_16x16x32_bf16 v[80:83], a[84:87], a[16:19], v[80:83]
    s_waitcnt lgkmcnt(10)
    v_mfma_f32_16x16x32_bf16 v[96:99], a[88:91], a[16:19], v[96:99]
    ds_read_b64_tr_b16 a[84:85], v225 offset:7360
    v_mfma_f32_16x16x32_bf16 v[100:103], a[88:91], a[20:23], v[100:103]
    ds_read_b64_tr_b16 a[86:87], v225 offset:9152
    s_add_u32 m0, s18, 8192
    v_mfma_f32_16x16x32_bf16 v[104:107], a[88:91], a[24:27], v[104:107]
    buffer_load_dwordx4 v232, s[12:15], s17 offen lds
    v_mfma_f32_16x16x32_bf16 v[108:111], a[88:91], a[28:31], v[108:111]
    s_waitcnt lgkmcnt(10)
    v_mfma_f32_16x16x32_bf16 v[124:127], a[64:67], a[28:31], v[124:127]
    ds_read_b64_tr_b16 a[88:89], v225 offset:21696
    v_mfma_f32_16x16x32_bf16 v[120:123], a[64:67], a[24:27], v[120:123]
    ds_read_b64_tr_b16 a[90:91], v225 offset:23488
    v_mfma_f32_16x16x32_bf16 v[116:119], a[64:67], a[20:23], v[116:119]
    v_mfma_f32_16x16x32_bf16 v[112:115], a[64:67], a[16:19], v[112:115]
    s_waitcnt vmcnt(10) lgkmcnt(10)
    s_barrier
    v_mfma_f32_16x16x32_bf16 v[128:131], a[68:71], a[16:19], v[128:131]
    ds_read_b64_tr_b16 a[64:65], v225 offset:28672
    v_mfma_f32_16x16x32_bf16 v[132:135], a[68:71], a[20:23], v[132:135]
    ds_read_b64_tr_b16 a[66:67], v225 offset:30464
    v_mfma_f32_16x16x32_bf16 v[136:139], a[68:71], a[24:27], v[136:139]
    v_mfma_f32_16x16x32_bf16 v[140:143], a[68:71], a[28:31], v[140:143]
    s_waitcnt lgkmcnt(10)
    v_mfma_f32_16x16x32_bf16 v[156:159], a[72:75], a[28:31], v[156:159]
    ds_read_b64_tr_b16 a[68:69], v225 offset:43008
    v_mfma_f32_16x16x32_bf16 v[152:155], a[72:75], a[24:27], v[152:155]
    ds_read_b64_tr_b16 a[70:71], v225 offset:44800
    v_mfma_f32_16x16x32_bf16 v[148:151], a[72:75], a[20:23], v[148:151]
    s_add_u32 s16, s16, 4096
    buffer_load_dwordx4 a[0:3], v227, s[4:7], s16 offen offset:0
    v_mfma_f32_16x16x32_bf16 v[144:147], a[72:75], a[16:19], v[144:147]
    s_waitcnt lgkmcnt(10)
    v_mfma_f32_16x16x32_bf16 v[160:163], a[76:79], a[16:19], v[160:163]
    ds_read_b64_tr_b16 a[72:73], v225 offset:28704
    v_mfma_f32_16x16x32_bf16 v[164:167], a[76:79], a[20:23], v[164:167]
    ds_read_b64_tr_b16 a[74:75], v225 offset:30496
    s_add_u32 m0, s18, 10240
    v_mfma_f32_16x16x32_bf16 v[168:171], a[76:79], a[24:27], v[168:171]
    buffer_load_dwordx4 v233, s[12:15], s17 offen lds
    v_mfma_f32_16x16x32_bf16 v[172:175], a[76:79], a[28:31], v[172:175]
    s_waitcnt lgkmcnt(10)
    v_mfma_f32_16x16x32_bf16 v[188:191], a[80:83], a[28:31], v[188:191]
    ds_read_b64_tr_b16 a[76:77], v225 offset:43040
    v_mfma_f32_16x16x32_bf16 v[184:187], a[80:83], a[24:27], v[184:187]
    ds_read_b64_tr_b16 a[78:79], v225 offset:44832
    v_mfma_f32_16x16x32_bf16 v[180:183], a[80:83], a[20:23], v[180:183]
    buffer_load_dwordx4 a[4:7], v227, s[4:7], s16 offen offset:256
    v_mfma_f32_16x16x32_bf16 v[176:179], a[80:83], a[16:19], v[176:179]
    s_waitcnt lgkmcnt(10)
    v_mfma_f32_16x16x32_bf16 v[192:195], a[84:87], a[16:19], v[192:195]
    ds_read_b64_tr_b16 a[80:81], v225 offset:28736
    v_mfma_f32_16x16x32_bf16 v[196:199], a[84:87], a[20:23], v[196:199]
    ds_read_b64_tr_b16 a[82:83], v225 offset:30528
    v_mfma_f32_16x16x32_bf16 v[200:203], a[84:87], a[24:27], v[200:203]
    v_mfma_f32_16x16x32_bf16 v[204:207], a[84:87], a[28:31], v[204:207]
    s_waitcnt lgkmcnt(10)
    v_mfma_f32_16x16x32_bf16 v[220:223], a[88:91], a[28:31], v[220:223]
    ds_read_b64_tr_b16 a[84:85], v225 offset:43072
    v_mfma_f32_16x16x32_bf16 v[216:219], a[88:91], a[24:27], v[216:219]
    ds_read_b64_tr_b16 a[86:87], v225 offset:44864
    v_mfma_f32_16x16x32_bf16 v[212:215], a[88:91], a[20:23], v[212:215]
    buffer_load_dwordx4 a[8:11], v227, s[8:11], s16 offen offset:0
    v_mfma_f32_16x16x32_bf16 v[208:211], a[88:91], a[16:19], v[208:211]
    s_waitcnt lgkmcnt(10)
    v_mfma_f32_16x16x32_bf16 v[0:3], a[64:67], a[32:35], v[0:3]
    ds_read_b64_tr_b16 a[88:89], v225 offset:28768
    v_mfma_f32_16x16x32_bf16 v[4:7], a[64:67], a[36:39], v[4:7]
    ds_read_b64_tr_b16 a[90:91], v225 offset:30560
    s_add_u32 m0, s18, 12288
    v_mfma_f32_16x16x32_bf16 v[8:11], a[64:67], a[40:43], v[8:11]
    buffer_load_dwordx4 v234, s[12:15], s17 offen lds
    s_waitcnt vmcnt(14)
    v_mfma_f32_16x16x32_bf16 v[12:15], a[64:67], a[44:47], v[12:15]
    s_waitcnt lgkmcnt(10)
    v_mfma_f32_16x16x32_bf16 v[28:31], a[68:71], a[44:47], v[28:31]
    ds_read_b64_tr_b16 a[64:65], v225 offset:43104
    v_mfma_f32_16x16x32_bf16 v[24:27], a[68:71], a[40:43], v[24:27]
    ds_read_b64_tr_b16 a[66:67], v225 offset:44896
    v_mfma_f32_16x16x32_bf16 v[20:23], a[68:71], a[36:39], v[20:23]
    buffer_load_dwordx4 a[12:15], v227, s[8:11], s16 offen offset:256
    v_mfma_f32_16x16x32_bf16 v[16:19], a[68:71], a[32:35], v[16:19]
    s_waitcnt lgkmcnt(10)
    v_mfma_f32_16x16x32_bf16 v[32:35], a[72:75], a[32:35], v[32:35]
    ds_read_b64_tr_b16 a[68:69], v225 offset:28800
    v_mfma_f32_16x16x32_bf16 v[36:39], a[72:75], a[36:39], v[36:39]
    ds_read_b64_tr_b16 a[70:71], v225 offset:30592
    v_mfma_f32_16x16x32_bf16 v[40:43], a[72:75], a[40:43], v[40:43]
    v_mfma_f32_16x16x32_bf16 v[44:47], a[72:75], a[44:47], v[44:47]
    s_waitcnt lgkmcnt(10)
    v_mfma_f32_16x16x32_bf16 v[60:63], a[76:79], a[44:47], v[60:63]
    ds_read_b64_tr_b16 a[72:73], v225 offset:43136
    v_mfma_f32_16x16x32_bf16 v[56:59], a[76:79], a[40:43], v[56:59]
    ds_read_b64_tr_b16 a[74:75], v225 offset:44928
    v_mfma_f32_16x16x32_bf16 v[52:55], a[76:79], a[36:39], v[52:55]
    v_mfma_f32_16x16x32_bf16 v[48:51], a[76:79], a[32:35], v[48:51]
    s_waitcnt lgkmcnt(10)
    v_mfma_f32_16x16x32_bf16 v[64:67], a[80:83], a[32:35], v[64:67]
    ds_read_b64_tr_b16 a[76:77], v225 offset:28832
    v_mfma_f32_16x16x32_bf16 v[68:71], a[80:83], a[36:39], v[68:71]
    ds_read_b64_tr_b16 a[78:79], v225 offset:30624
    s_add_u32 m0, s18, 28672
    s_add_u32 s17, s17, 458752
    v_mfma_f32_16x16x32_bf16 v[72:75], a[80:83], a[40:43], v[72:75]
    buffer_load_dwordx4 v228, s[12:15], s17 offen lds
    v_mfma_f32_16x16x32_bf16 v[76:79], a[80:83], a[44:47], v[76:79]
    s_waitcnt lgkmcnt(10)
    v_mfma_f32_16x16x32_bf16 v[92:95], a[84:87], a[44:47], v[92:95]
    ds_read_b64_tr_b16 a[80:81], v225 offset:43168
    v_mfma_f32_16x16x32_bf16 v[88:91], a[84:87], a[40:43], v[88:91]
    ds_read_b64_tr_b16 a[82:83], v225 offset:44960
    v_mfma_f32_16x16x32_bf16 v[84:87], a[84:87], a[36:39], v[84:87]
    v_mfma_f32_16x16x32_bf16 v[80:83], a[84:87], a[32:35], v[80:83]
    s_waitcnt lgkmcnt(10)
    v_mfma_f32_16x16x32_bf16 v[96:99], a[88:91], a[32:35], v[96:99]
    ds_read_b64_tr_b16 a[84:85], v225 offset:28864
    v_mfma_f32_16x16x32_bf16 v[100:103], a[88:91], a[36:39], v[100:103]
    ds_read_b64_tr_b16 a[86:87], v225 offset:30656
    v_mfma_f32_16x16x32_bf16 v[104:107], a[88:91], a[40:43], v[104:107]
    v_mfma_f32_16x16x32_bf16 v[108:111], a[88:91], a[44:47], v[108:111]
    s_waitcnt lgkmcnt(10)
    v_mfma_f32_16x16x32_bf16 v[124:127], a[64:67], a[44:47], v[124:127]
    ds_read_b64_tr_b16 a[88:89], v225 offset:43200
    v_mfma_f32_16x16x32_bf16 v[120:123], a[64:67], a[40:43], v[120:123]
    ds_read_b64_tr_b16 a[90:91], v225 offset:44992
    v_mfma_f32_16x16x32_bf16 v[116:119], a[64:67], a[36:39], v[116:119]
    v_mfma_f32_16x16x32_bf16 v[112:115], a[64:67], a[32:35], v[112:115]
    s_waitcnt lgkmcnt(10)
    v_mfma_f32_16x16x32_bf16 v[128:131], a[68:71], a[32:35], v[128:131]
    ds_read_b64_tr_b16 a[64:65], v225 offset:35840
    v_mfma_f32_16x16x32_bf16 v[132:135], a[68:71], a[36:39], v[132:135]
    ds_read_b64_tr_b16 a[66:67], v225 offset:37632
    s_add_u32 m0, s18, 30720
    v_mfma_f32_16x16x32_bf16 v[136:139], a[68:71], a[40:43], v[136:139]
    buffer_load_dwordx4 v229, s[12:15], s17 offen lds
    v_mfma_f32_16x16x32_bf16 v[140:143], a[68:71], a[44:47], v[140:143]
    s_waitcnt lgkmcnt(10)
    v_mfma_f32_16x16x32_bf16 v[156:159], a[72:75], a[44:47], v[156:159]
    ds_read_b64_tr_b16 a[68:69], v225 offset:50176
    v_mfma_f32_16x16x32_bf16 v[152:155], a[72:75], a[40:43], v[152:155]
    ds_read_b64_tr_b16 a[70:71], v225 offset:51968
    v_mfma_f32_16x16x32_bf16 v[148:151], a[72:75], a[36:39], v[148:151]
    buffer_load_dwordx4 a[16:19], v227, s[4:7], s16 offen offset:2048
    v_mfma_f32_16x16x32_bf16 v[144:147], a[72:75], a[32:35], v[144:147]
    s_waitcnt lgkmcnt(10)
    v_mfma_f32_16x16x32_bf16 v[160:163], a[76:79], a[32:35], v[160:163]
    ds_read_b64_tr_b16 a[72:73], v225 offset:35872
    v_mfma_f32_16x16x32_bf16 v[164:167], a[76:79], a[36:39], v[164:167]
    ds_read_b64_tr_b16 a[74:75], v225 offset:37664
    v_mfma_f32_16x16x32_bf16 v[168:171], a[76:79], a[40:43], v[168:171]
    s_add_u32 s40, s30, 786432
    s_addc_u32 s41, s31, 0
    v_mfma_f32_16x16x32_bf16 v[172:175], a[76:79], a[44:47], v[172:175]
    s_mov_b32 s42, 262144
    s_waitcnt lgkmcnt(10)
    v_mfma_f32_16x16x32_bf16 v[188:191], a[80:83], a[44:47], v[188:191]
    ds_read_b64_tr_b16 a[76:77], v225 offset:50208
    v_mfma_f32_16x16x32_bf16 v[184:187], a[80:83], a[40:43], v[184:187]
    ds_read_b64_tr_b16 a[78:79], v225 offset:52000
    v_mfma_f32_16x16x32_bf16 v[180:183], a[80:83], a[36:39], v[180:183]
    s_mov_b32 s43, 0x20000
    buffer_load_dwordx4 a[20:23], v227, s[4:7], s16 offen offset:2304
    v_mfma_f32_16x16x32_bf16 v[176:179], a[80:83], a[32:35], v[176:179]
    s_add_u32 s36, s30, 524288
    s_addc_u32 s37, s31, 0
    s_waitcnt lgkmcnt(10)
    v_mfma_f32_16x16x32_bf16 v[192:195], a[84:87], a[32:35], v[192:195]
    ds_read_b64_tr_b16 a[80:81], v225 offset:35904
    v_mfma_f32_16x16x32_bf16 v[196:199], a[84:87], a[36:39], v[196:199]
    ds_read_b64_tr_b16 a[82:83], v225 offset:37696
    s_add_u32 m0, s18, 32768
    v_mfma_f32_16x16x32_bf16 v[200:203], a[84:87], a[40:43], v[200:203]
    s_mov_b32 s38, 114688
    buffer_load_dwordx4 v230, s[12:15], s17 offen lds
    v_mfma_f32_16x16x32_bf16 v[204:207], a[84:87], a[44:47], v[204:207]
    s_mov_b32 s39, 0x20000
    s_waitcnt lgkmcnt(10)
    v_mfma_f32_16x16x32_bf16 v[220:223], a[88:91], a[44:47], v[220:223]
    ds_read_b64_tr_b16 a[84:85], v225 offset:50240
    v_mfma_f32_16x16x32_bf16 v[216:219], a[88:91], a[40:43], v[216:219]
    ds_read_b64_tr_b16 a[86:87], v225 offset:52032
    v_mfma_f32_16x16x32_bf16 v[212:215], a[88:91], a[36:39], v[212:215]
    v_and_b32 v244, 31, v235
    buffer_load_dwordx4 a[24:27], v227, s[8:11], s16 offen offset:2048
    v_mfma_f32_16x16x32_bf16 v[208:211], a[88:91], a[32:35], v[208:211]
    v_lshlrev_b32 v243, 4, v244
    s_waitcnt vmcnt(18) lgkmcnt(10)
    v_mfma_f32_16x16x32_bf16 v[0:3], a[64:67], a[48:51], v[0:3]
    ds_read_b64_tr_b16 a[88:89], v225 offset:35936
    s_waitcnt vmcnt(17)
    v_mfma_f32_16x16x32_bf16 v[4:7], a[64:67], a[52:55], v[4:7]
    ds_read_b64_tr_b16 a[90:91], v225 offset:37728
    s_waitcnt vmcnt(15)
    v_mfma_f32_16x16x32_bf16 v[8:11], a[64:67], a[56:59], v[8:11]
    v_lshlrev_b32 v244, 3, v244
    s_waitcnt vmcnt(14)
    v_mfma_f32_16x16x32_bf16 v[12:15], a[64:67], a[60:63], v[12:15]
    v_lshrrev_b32 v245, 5, v235
    s_waitcnt lgkmcnt(10)
    v_mfma_f32_16x16x32_bf16 v[28:31], a[68:71], a[60:63], v[28:31]
    ds_read_b64_tr_b16 a[64:65], v225 offset:50272
    v_mfma_f32_16x16x32_bf16 v[24:27], a[68:71], a[56:59], v[24:27]
    ds_read_b64_tr_b16 a[66:67], v225 offset:52064
    v_mfma_f32_16x16x32_bf16 v[20:23], a[68:71], a[52:55], v[20:23]
    v_lshl_add_u32 v242, v245, 12, v244
    buffer_load_dwordx4 a[28:31], v227, s[8:11], s16 offen offset:2304
    v_mfma_f32_16x16x32_bf16 v[16:19], a[68:71], a[48:51], v[16:19]
    s_lshl_b32 s46, s24, 12
    s_waitcnt lgkmcnt(10)
    v_mfma_f32_16x16x32_bf16 v[32:35], a[72:75], a[48:51], v[32:35]
    ds_read_b64_tr_b16 a[68:69], v225 offset:35968
    v_mfma_f32_16x16x32_bf16 v[36:39], a[72:75], a[52:55], v[36:39]
    ds_read_b64_tr_b16 a[70:71], v225 offset:37760
    s_add_u32 m0, s18, 34816
    v_mfma_f32_16x16x32_bf16 v[40:43], a[72:75], a[56:59], v[40:43]
    s_mul_i32 s48, s23, 3584
    buffer_load_dwordx4 v231, s[12:15], s17 offen lds
    v_mfma_f32_16x16x32_bf16 v[44:47], a[72:75], a[60:63], v[44:47]
    s_waitcnt lgkmcnt(10)
    v_mfma_f32_16x16x32_bf16 v[60:63], a[76:79], a[60:63], v[60:63]
    ds_read_b64_tr_b16 a[72:73], v225 offset:50304
    v_mfma_f32_16x16x32_bf16 v[56:59], a[76:79], a[56:59], v[56:59]
    ds_read_b64_tr_b16 a[74:75], v225 offset:52096
    v_mfma_f32_16x16x32_bf16 v[52:55], a[76:79], a[52:55], v[52:55]
    v_mfma_f32_16x16x32_bf16 v[48:51], a[76:79], a[48:51], v[48:51]
    s_waitcnt lgkmcnt(10)
    v_mfma_f32_16x16x32_bf16 v[64:67], a[80:83], a[48:51], v[64:67]
    ds_read_b64_tr_b16 a[76:77], v225 offset:36000
    v_mfma_f32_16x16x32_bf16 v[68:71], a[80:83], a[52:55], v[68:71]
    ds_read_b64_tr_b16 a[78:79], v225 offset:37792
    v_mfma_f32_16x16x32_bf16 v[72:75], a[80:83], a[56:59], v[72:75]
    v_mfma_f32_16x16x32_bf16 v[76:79], a[80:83], a[60:63], v[76:79]
    s_waitcnt lgkmcnt(10)
    v_mfma_f32_16x16x32_bf16 v[92:95], a[84:87], a[60:63], v[92:95]
    ds_read_b64_tr_b16 a[80:81], v225 offset:50336
    v_mfma_f32_16x16x32_bf16 v[88:91], a[84:87], a[56:59], v[88:91]
    ds_read_b64_tr_b16 a[82:83], v225 offset:52128
    v_mfma_f32_16x16x32_bf16 v[84:87], a[84:87], a[52:55], v[84:87]
    v_mfma_f32_16x16x32_bf16 v[80:83], a[84:87], a[48:51], v[80:83]
    s_waitcnt lgkmcnt(10)
    v_mfma_f32_16x16x32_bf16 v[96:99], a[88:91], a[48:51], v[96:99]
    ds_read_b64_tr_b16 a[84:85], v225 offset:36032
    v_mfma_f32_16x16x32_bf16 v[100:103], a[88:91], a[52:55], v[100:103]
    ds_read_b64_tr_b16 a[86:87], v225 offset:37824
    s_add_u32 m0, s18, 36864
    v_mfma_f32_16x16x32_bf16 v[104:107], a[88:91], a[56:59], v[104:107]
    s_getpc_b64 s[92:93]
.Lpc4:
    s_add_u32 s92, s92, mlp_kernel_tailcode-.Lpc4
    s_addc_u32 s93, s93, 0
    buffer_load_dwordx4 v232, s[12:15], s17 offen lds
    v_mfma_f32_16x16x32_bf16 v[108:111], a[88:91], a[60:63], v[108:111]
    s_mov_b32 s94, mlp_kernel_end-mlp_kernel_tailcode
    s_waitcnt lgkmcnt(10)
    v_mfma_f32_16x16x32_bf16 v[124:127], a[64:67], a[60:63], v[124:127]
    ds_read_b64_tr_b16 a[88:89], v225 offset:50368
    v_mfma_f32_16x16x32_bf16 v[120:123], a[64:67], a[56:59], v[120:123]
    ds_read_b64_tr_b16 a[90:91], v225 offset:52160
    v_mfma_f32_16x16x32_bf16 v[116:119], a[64:67], a[52:55], v[116:119]
    s_mov_b32 s95, 0x20000
    v_mfma_f32_16x16x32_bf16 v[112:115], a[64:67], a[48:51], v[112:115]
    s_lshl_b32 s49, s21, 13
    s_waitcnt vmcnt(10) lgkmcnt(10)
    s_barrier
    v_mfma_f32_16x16x32_bf16 v[128:131], a[68:71], a[48:51], v[128:131]
    ds_read_b64_tr_b16 a[64:65], v224 offset:0
    v_mfma_f32_16x16x32_bf16 v[132:135], a[68:71], a[52:55], v[132:135]
    ds_read_b64_tr_b16 a[66:67], v224 offset:1792
    v_mfma_f32_16x16x32_bf16 v[136:139], a[68:71], a[56:59], v[136:139]
    v_mfma_f32_16x16x32_bf16 v[140:143], a[68:71], a[60:63], v[140:143]
    s_waitcnt lgkmcnt(10)
    v_mfma_f32_16x16x32_bf16 v[156:159], a[72:75], a[60:63], v[156:159]
    ds_read_b64_tr_b16 a[68:69], v224 offset:14336
    v_mfma_f32_16x16x32_bf16 v[152:155], a[72:75], a[56:59], v[152:155]
    ds_read_b64_tr_b16 a[70:71], v224 offset:16128
    v_mfma_f32_16x16x32_bf16 v[148:151], a[72:75], a[52:55], v[148:151]
    s_add_u32 s16, s16, 4096
    buffer_load_dwordx4 a[32:35], v227, s[4:7], s16 offen offset:0
    v_mfma_f32_16x16x32_bf16 v[144:147], a[72:75], a[48:51], v[144:147]
    s_waitcnt lgkmcnt(10)
    v_mfma_f32_16x16x32_bf16 v[160:163], a[76:79], a[48:51], v[160:163]
    ds_read_b64_tr_b16 a[72:73], v224 offset:32
    v_mfma_f32_16x16x32_bf16 v[164:167], a[76:79], a[52:55], v[164:167]
    ds_read_b64_tr_b16 a[74:75], v224 offset:1824
    s_add_u32 m0, s18, 38912
    v_mfma_f32_16x16x32_bf16 v[168:171], a[76:79], a[56:59], v[168:171]
    buffer_load_dwordx4 v233, s[12:15], s17 offen lds
    v_mfma_f32_16x16x32_bf16 v[172:175], a[76:79], a[60:63], v[172:175]
    s_waitcnt lgkmcnt(10)
    v_mfma_f32_16x16x32_bf16 v[188:191], a[80:83], a[60:63], v[188:191]
    ds_read_b64_tr_b16 a[76:77], v224 offset:14368
    v_mfma_f32_16x16x32_bf16 v[184:187], a[80:83], a[56:59], v[184:187]
    ds_read_b64_tr_b16 a[78:79], v224 offset:16160
    v_mfma_f32_16x16x32_bf16 v[180:183], a[80:83], a[52:55], v[180:183]
    buffer_load_dwordx4 a[36:39], v227, s[4:7], s16 offen offset:256
    v_mfma_f32_16x16x32_bf16 v[176:179], a[80:83], a[48:51], v[176:179]
    s_waitcnt lgkmcnt(10)
    v_mfma_f32_16x16x32_bf16 v[192:195], a[84:87], a[48:51], v[192:195]
    ds_read_b64_tr_b16 a[80:81], v224 offset:64
    v_mfma_f32_16x16x32_bf16 v[196:199], a[84:87], a[52:55], v[196:199]
    ds_read_b64_tr_b16 a[82:83], v224 offset:1856
    v_mfma_f32_16x16x32_bf16 v[200:203], a[84:87], a[56:59], v[200:203]
    v_mfma_f32_16x16x32_bf16 v[204:207], a[84:87], a[60:63], v[204:207]
    s_waitcnt lgkmcnt(10)
    v_mfma_f32_16x16x32_bf16 v[220:223], a[88:91], a[60:63], v[220:223]
    ds_read_b64_tr_b16 a[84:85], v224 offset:14400
    v_mfma_f32_16x16x32_bf16 v[216:219], a[88:91], a[56:59], v[216:219]
    ds_read_b64_tr_b16 a[86:87], v224 offset:16192
    v_mfma_f32_16x16x32_bf16 v[212:215], a[88:91], a[52:55], v[212:215]
    buffer_load_dwordx4 a[40:43], v227, s[8:11], s16 offen offset:0
    v_mfma_f32_16x16x32_bf16 v[208:211], a[88:91], a[48:51], v[208:211]
    s_mov_b32 s20, 2
mlp_kernel_loop:
    s_waitcnt lgkmcnt(10)
    v_mfma_f32_16x16x32_bf16 v[0:3], a[64:67], a[0:3], v[0:3]
    s_sub_u32 s20, s20, 1
    ds_read_b64_tr_b16 a[88:89], v224 offset:96
    v_mfma_f32_16x16x32_bf16 v[4:7], a[64:67], a[4:7], v[4:7]
    ds_read_b64_tr_b16 a[90:91], v224 offset:1888
    s_add_u32 m0, s18, 40960
    v_mfma_f32_16x16x32_bf16 v[8:11], a[64:67], a[8:11], v[8:11]
    buffer_load_dwordx4 v234, s[12:15], s17 offen lds
    s_waitcnt vmcnt(14)
    v_mfma_f32_16x16x32_bf16 v[12:15], a[64:67], a[12:15], v[12:15]
    s_waitcnt lgkmcnt(10)
    v_mfma_f32_16x16x32_bf16 v[28:31], a[68:71], a[12:15], v[28:31]
    ds_read_b64_tr_b16 a[64:65], v224 offset:14432
    v_mfma_f32_16x16x32_bf16 v[24:27], a[68:71], a[8:11], v[24:27]
    ds_read_b64_tr_b16 a[66:67], v224 offset:16224
    v_mfma_f32_16x16x32_bf16 v[20:23], a[68:71], a[4:7], v[20:23]
    buffer_load_dwordx4 a[44:47], v227, s[8:11], s16 offen offset:256
    v_mfma_f32_16x16x32_bf16 v[16:19], a[68:71], a[0:3], v[16:19]
    s_waitcnt lgkmcnt(10)
    v_mfma_f32_16x16x32_bf16 v[32:35], a[72:75], a[0:3], v[32:35]
    ds_read_b64_tr_b16 a[68:69], v224 offset:128
    v_mfma_f32_16x16x32_bf16 v[36:39], a[72:75], a[4:7], v[36:39]
    ds_read_b64_tr_b16 a[70:71], v224 offset:1920
    v_mfma_f32_16x16x32_bf16 v[40:43], a[72:75], a[8:11], v[40:43]
    v_mfma_f32_16x16x32_bf16 v[44:47], a[72:75], a[12:15], v[44:47]
    s_waitcnt lgkmcnt(10)
    v_mfma_f32_16x16x32_bf16 v[60:63], a[76:79], a[12:15], v[60:63]
    ds_read_b64_tr_b16 a[72:73], v224 offset:14464
    v_mfma_f32_16x16x32_bf16 v[56:59], a[76:79], a[8:11], v[56:59]
    ds_read_b64_tr_b16 a[74:75], v224 offset:16256
    v_mfma_f32_16x16x32_bf16 v[52:55], a[76:79], a[4:7], v[52:55]
    v_mfma_f32_16x16x32_bf16 v[48:51], a[76:79], a[0:3], v[48:51]
    s_waitcnt lgkmcnt(10)
    v_mfma_f32_16x16x32_bf16 v[64:67], a[80:83], a[0:3], v[64:67]
    ds_read_b64_tr_b16 a[76:77], v224 offset:160
    v_mfma_f32_16x16x32_bf16 v[68:71], a[80:83], a[4:7], v[68:71]
    ds_read_b64_tr_b16 a[78:79], v224 offset:1952
    s_add_u32 m0, s18, 57344
    s_add_u32 s17, s17, 458752
    v_mfma_f32_16x16x32_bf16 v[72:75], a[80:83], a[8:11], v[72:75]
    buffer_load_dwordx4 v228, s[12:15], s17 offen lds
    v_mfma_f32_16x16x32_bf16 v[76:79], a[80:83], a[12:15], v[76:79]
    s_waitcnt lgkmcnt(10)
    v_mfma_f32_16x16x32_bf16 v[92:95], a[84:87], a[12:15], v[92:95]
    ds_read_b64_tr_b16 a[80:81], v224 offset:14496
    v_mfma_f32_16x16x32_bf16 v[88:91], a[84:87], a[8:11], v[88:91]
    ds_read_b64_tr_b16 a[82:83], v224 offset:16288
    v_mfma_f32_16x16x32_bf16 v[84:87], a[84:87], a[4:7], v[84:87]
    v_mfma_f32_16x16x32_bf16 v[80:83], a[84:87], a[0:3], v[80:83]
    s_waitcnt lgkmcnt(10)
    v_mfma_f32_16x16x32_bf16 v[96:99], a[88:91], a[0:3], v[96:99]
    ds_read_b64_tr_b16 a[84:85], v224 offset:192
    v_mfma_f32_16x16x32_bf16 v[100:103], a[88:91], a[4:7], v[100:103]
    ds_read_b64_tr_b16 a[86:87], v224 offset:1984
    v_mfma_f32_16x16x32_bf16 v[104:107], a[88:91], a[8:11], v[104:107]
    v_mfma_f32_16x16x32_bf16 v[108:111], a[88:91], a[12:15], v[108:111]
    s_waitcnt lgkmcnt(10)
    v_mfma_f32_16x16x32_bf16 v[124:127], a[64:67], a[12:15], v[124:127]
    ds_read_b64_tr_b16 a[88:89], v224 offset:14528
    v_mfma_f32_16x16x32_bf16 v[120:123], a[64:67], a[8:11], v[120:123]
    ds_read_b64_tr_b16 a[90:91], v224 offset:16320
    v_mfma_f32_16x16x32_bf16 v[116:119], a[64:67], a[4:7], v[116:119]
    v_mfma_f32_16x16x32_bf16 v[112:115], a[64:67], a[0:3], v[112:115]
    s_waitcnt lgkmcnt(10)
    v_mfma_f32_16x16x32_bf16 v[128:131], a[68:71], a[0:3], v[128:131]
    ds_read_b64_tr_b16 a[64:65], v224 offset:7168
    v_mfma_f32_16x16x32_bf16 v[132:135], a[68:71], a[4:7], v[132:135]
    ds_read_b64_tr_b16 a[66:67], v224 offset:8960
    s_add_u32 m0, s18, 59392
    v_mfma_f32_16x16x32_bf16 v[136:139], a[68:71], a[8:11], v[136:139]
    buffer_load_dwordx4 v229, s[12:15], s17 offen lds
    v_mfma_f32_16x16x32_bf16 v[140:143], a[68:71], a[12:15], v[140:143]
    s_waitcnt lgkmcnt(10)
    v_mfma_f32_16x16x32_bf16 v[156:159], a[72:75], a[12:15], v[156:159]
    ds_read_b64_tr_b16 a[68:69], v224 offset:21504
    v_mfma_f32_16x16x32_bf16 v[152:155], a[72:75], a[8:11], v[152:155]
    ds_read_b64_tr_b16 a[70:71], v224 offset:23296
    v_mfma_f32_16x16x32_bf16 v[148:151], a[72:75], a[4:7], v[148:151]
    buffer_load_dwordx4 a[48:51], v227, s[4:7], s16 offen offset:2048
    v_mfma_f32_16x16x32_bf16 v[144:147], a[72:75], a[0:3], v[144:147]
    s_waitcnt lgkmcnt(10)
    v_mfma_f32_16x16x32_bf16 v[160:163], a[76:79], a[0:3], v[160:163]
    ds_read_b64_tr_b16 a[72:73], v224 offset:7200
    v_mfma_f32_16x16x32_bf16 v[164:167], a[76:79], a[4:7], v[164:167]
    ds_read_b64_tr_b16 a[74:75], v224 offset:8992
    v_mfma_f32_16x16x32_bf16 v[168:171], a[76:79], a[8:11], v[168:171]
    v_mfma_f32_16x16x32_bf16 v[172:175], a[76:79], a[12:15], v[172:175]
    s_waitcnt lgkmcnt(10)
    v_mfma_f32_16x16x32_bf16 v[188:191], a[80:83], a[12:15], v[188:191]
    ds_read_b64_tr_b16 a[76:77], v224 offset:21536
    v_mfma_f32_16x16x32_bf16 v[184:187], a[80:83], a[8:11], v[184:187]
    ds_read_b64_tr_b16 a[78:79], v224 offset:23328
    v_mfma_f32_16x16x32_bf16 v[180:183], a[80:83], a[4:7], v[180:183]
    buffer_load_dwordx4 a[52:55], v227, s[4:7], s16 offen offset:2304
    v_mfma_f32_16x16x32_bf16 v[176:179], a[80:83], a[0:3], v[176:179]
    s_waitcnt lgkmcnt(10)
    v_mfma_f32_16x16x32_bf16 v[192:195], a[84:87], a[0:3], v[192:195]
    ds_read_b64_tr_b16 a[80:81], v224 offset:7232
    v_mfma_f32_16x16x32_bf16 v[196:199], a[84:87], a[4:7], v[196:199]
    ds_read_b64_tr_b16 a[82:83], v224 offset:9024
    s_add_u32 m0, s18, 61440
    v_mfma_f32_16x16x32_bf16 v[200:203], a[84:87], a[8:11], v[200:203]
    buffer_load_dwordx4 v230, s[12:15], s17 offen lds
    v_mfma_f32_16x16x32_bf16 v[204:207], a[84:87], a[12:15], v[204:207]
    s_waitcnt lgkmcnt(10)
    v_mfma_f32_16x16x32_bf16 v[220:223], a[88:91], a[12:15], v[220:223]
    ds_read_b64_tr_b16 a[84:85], v224 offset:21568
    v_mfma_f32_16x16x32_bf16 v[216:219], a[88:91], a[8:11], v[216:219]
    ds_read_b64_tr_b16 a[86:87], v224 offset:23360
    v_mfma_f32_16x16x32_bf16 v[212:215], a[88:91], a[4:7], v[212:215]
    buffer_load_dwordx4 a[56:59], v227, s[8:11], s16 offen offset:2048
    v_mfma_f32_16x16x32_bf16 v[208:211], a[88:91], a[0:3], v[208:211]
    s_waitcnt vmcnt(18) lgkmcnt(10)
    v_mfma_f32_16x16x32_bf16 v[0:3], a[64:67], a[16:19], v[0:3]
    ds_read_b64_tr_b16 a[88:89], v224 offset:7264
    s_waitcnt vmcnt(17)
    v_mfma_f32_16x16x32_bf16 v[4:7], a[64:67], a[20:23], v[4:7]
    ds_read_b64_tr_b16 a[90:91], v224 offset:9056
    s_waitcnt vmcnt(15)
    v_mfma_f32_16x16x32_bf16 v[8:11], a[64:67], a[24:27], v[8:11]
    s_waitcnt vmcnt(14)
    v_mfma_f32_16x16x32_bf16 v[12:15], a[64:67], a[28:31], v[12:15]
    s_waitcnt lgkmcnt(10)
    v_mfma_f32_16x16x32_bf16 v[28:31], a[68:71], a[28:31], v[28:31]
    ds_read_b64_tr_b16 a[64:65], v224 offset:21600
    v_mfma_f32_16x16x32_bf16 v[24:27], a[68:71], a[24:27], v[24:27]
    ds_read_b64_tr_b16 a[66:67], v224 offset:23392
    v_mfma_f32_16x16x32_bf16 v[20:23], a[68:71], a[20:23], v[20:23]
    buffer_load_dwordx4 a[60:63], v227, s[8:11], s16 offen offset:2304
    v_mfma_f32_16x16x32_bf16 v[16:19], a[68:71], a[16:19], v[16:19]
    s_waitcnt lgkmcnt(10)
    v_mfma_f32_16x16x32_bf16 v[32:35], a[72:75], a[16:19], v[32:35]
    ds_read_b64_tr_b16 a[68:69], v224 offset:7296
    v_mfma_f32_16x16x32_bf16 v[36:39], a[72:75], a[20:23], v[36:39]
    ds_read_b64_tr_b16 a[70:71], v224 offset:9088
    s_add_u32 m0, s18, 63488
    v_mfma_f32_16x16x32_bf16 v[40:43], a[72:75], a[24:27], v[40:43]
    buffer_load_dwordx4 v231, s[12:15], s17 offen lds
    v_mfma_f32_16x16x32_bf16 v[44:47], a[72:75], a[28:31], v[44:47]
    s_waitcnt lgkmcnt(10)
    v_mfma_f32_16x16x32_bf16 v[60:63], a[76:79], a[28:31], v[60:63]
    ds_read_b64_tr_b16 a[72:73], v224 offset:21632
    v_mfma_f32_16x16x32_bf16 v[56:59], a[76:79], a[24:27], v[56:59]
    ds_read_b64_tr_b16 a[74:75], v224 offset:23424
    v_mfma_f32_16x16x32_bf16 v[52:55], a[76:79], a[20:23], v[52:55]
    v_mfma_f32_16x16x32_bf16 v[48:51], a[76:79], a[16:19], v[48:51]
    s_waitcnt lgkmcnt(10)
    v_mfma_f32_16x16x32_bf16 v[64:67], a[80:83], a[16:19], v[64:67]
    ds_read_b64_tr_b16 a[76:77], v224 offset:7328
    v_mfma_f32_16x16x32_bf16 v[68:71], a[80:83], a[20:23], v[68:71]
    ds_read_b64_tr_b16 a[78:79], v224 offset:9120
    v_mfma_f32_16x16x32_bf16 v[72:75], a[80:83], a[24:27], v[72:75]
    v_mfma_f32_16x16x32_bf16 v[76:79], a[80:83], a[28:31], v[76:79]
    s_waitcnt lgkmcnt(10)
    v_mfma_f32_16x16x32_bf16 v[92:95], a[84:87], a[28:31], v[92:95]
    ds_read_b64_tr_b16 a[80:81], v224 offset:21664
    v_mfma_f32_16x16x32_bf16 v[88:91], a[84:87], a[24:27], v[88:91]
    ds_read_b64_tr_b16 a[82:83], v224 offset:23456
    v_mfma_f32_16x16x32_bf16 v[84:87], a[84:87], a[20:23], v[84:87]
    v_mfma_f32_16x16x32_bf16 v[80:83], a[84:87], a[16:19], v[80:83]
    s_waitcnt lgkmcnt(10)
    v_mfma_f32_16x16x32_bf16 v[96:99], a[88:91], a[16:19], v[96:99]
    ds_read_b64_tr_b16 a[84:85], v224 offset:7360
    v_mfma_f32_16x16x32_bf16 v[100:103], a[88:91], a[20:23], v[100:103]
    ds_read_b64_tr_b16 a[86:87], v224 offset:9152
    s_add_u32 m0, s18, 65536
    v_mfma_f32_16x16x32_bf16 v[104:107], a[88:91], a[24:27], v[104:107]
    buffer_load_dwordx4 v232, s[12:15], s17 offen lds
    v_mfma_f32_16x16x32_bf16 v[108:111], a[88:91], a[28:31], v[108:111]
    s_waitcnt lgkmcnt(10)
    v_mfma_f32_16x16x32_bf16 v[124:127], a[64:67], a[28:31], v[124:127]
    ds_read_b64_tr_b16 a[88:89], v224 offset:21696
    v_mfma_f32_16x16x32_bf16 v[120:123], a[64:67], a[24:27], v[120:123]
    ds_read_b64_tr_b16 a[90:91], v224 offset:23488
    v_mfma_f32_16x16x32_bf16 v[116:119], a[64:67], a[20:23], v[116:119]
    v_mfma_f32_16x16x32_bf16 v[112:115], a[64:67], a[16:19], v[112:115]
    s_waitcnt vmcnt(10) lgkmcnt(10)
    s_barrier
    v_mfma_f32_16x16x32_bf16 v[128:131], a[68:71], a[16:19], v[128:131]
    ds_read_b64_tr_b16 a[64:65], v224 offset:28672
    v_mfma_f32_16x16x32_bf16 v[132:135], a[68:71], a[20:23], v[132:135]
    ds_read_b64_tr_b16 a[66:67], v224 offset:30464
    v_mfma_f32_16x16x32_bf16 v[136:139], a[68:71], a[24:27], v[136:139]
    v_mfma_f32_16x16x32_bf16 v[140:143], a[68:71], a[28:31], v[140:143]
    s_waitcnt lgkmcnt(10)
    v_mfma_f32_16x16x32_bf16 v[156:159], a[72:75], a[28:31], v[156:159]
    ds_read_b64_tr_b16 a[68:69], v224 offset:43008
    v_mfma_f32_16x16x32_bf16 v[152:155], a[72:75], a[24:27], v[152:155]
    ds_read_b64_tr_b16 a[70:71], v224 offset:44800
    v_mfma_f32_16x16x32_bf16 v[148:151], a[72:75], a[20:23], v[148:151]
    s_add_u32 s16, s16, 4096
    buffer_load_dwordx4 a[0:3], v227, s[4:7], s16 offen offset:0
    v_mfma_f32_16x16x32_bf16 v[144:147], a[72:75], a[16:19], v[144:147]
    s_waitcnt lgkmcnt(10)
    v_mfma_f32_16x16x32_bf16 v[160:163], a[76:79], a[16:19], v[160:163]
    ds_read_b64_tr_b16 a[72:73], v224 offset:28704
    v_mfma_f32_16x16x32_bf16 v[164:167], a[76:79], a[20:23], v[164:167]
    ds_read_b64_tr_b16 a[74:75], v224 offset:30496
    s_add_u32 m0, s18, 67584
    v_mfma_f32_16x16x32_bf16 v[168:171], a[76:79], a[24:27], v[168:171]
    buffer_load_dwordx4 v233, s[12:15], s17 offen lds
    v_mfma_f32_16x16x32_bf16 v[172:175], a[76:79], a[28:31], v[172:175]
    s_waitcnt lgkmcnt(10)
    v_mfma_f32_16x16x32_bf16 v[188:191], a[80:83], a[28:31], v[188:191]
    ds_read_b64_tr_b16 a[76:77], v224 offset:43040
    v_mfma_f32_16x16x32_bf16 v[184:187], a[80:83], a[24:27], v[184:187]
    ds_read_b64_tr_b16 a[78:79], v224 offset:44832
    v_mfma_f32_16x16x32_bf16 v[180:183], a[80:83], a[20:23], v[180:183]
    buffer_load_dwordx4 a[4:7], v227, s[4:7], s16 offen offset:256
    v_mfma_f32_16x16x32_bf16 v[176:179], a[80:83], a[16:19], v[176:179]
    s_waitcnt lgkmcnt(10)
    v_mfma_f32_16x16x32_bf16 v[192:195], a[84:87], a[16:19], v[192:195]
    ds_read_b64_tr_b16 a[80:81], v224 offset:28736
    v_mfma_f32_16x16x32_bf16 v[196:199], a[84:87], a[20:23], v[196:199]
    ds_read_b64_tr_b16 a[82:83], v224 offset:30528
    v_mfma_f32_16x16x32_bf16 v[200:203], a[84:87], a[24:27], v[200:203]
    v_mfma_f32_16x16x32_bf16 v[204:207], a[84:87], a[28:31], v[204:207]
    s_waitcnt lgkmcnt(10)
    v_mfma_f32_16x16x32_bf16 v[220:223], a[88:91], a[28:31], v[220:223]
    ds_read_b64_tr_b16 a[84:85], v224 offset:43072
    v_mfma_f32_16x16x32_bf16 v[216:219], a[88:91], a[24:27], v[216:219]
    ds_read_b64_tr_b16 a[86:87], v224 offset:44864
    v_mfma_f32_16x16x32_bf16 v[212:215], a[88:91], a[20:23], v[212:215]
    buffer_load_dwordx4 a[8:11], v227, s[8:11], s16 offen offset:0
    v_mfma_f32_16x16x32_bf16 v[208:211], a[88:91], a[16:19], v[208:211]
    s_waitcnt lgkmcnt(10)
    v_mfma_f32_16x16x32_bf16 v[0:3], a[64:67], a[32:35], v[0:3]
    ds_read_b64_tr_b16 a[88:89], v224 offset:28768
    v_mfma_f32_16x16x32_bf16 v[4:7], a[64:67], a[36:39], v[4:7]
    ds_read_b64_tr_b16 a[90:91], v224 offset:30560
    s_add_u32 m0, s18, 69632
    v_mfma_f32_16x16x32_bf16 v[8:11], a[64:67], a[40:43], v[8:11]
    buffer_load_dwordx4 v234, s[12:15], s17 offen lds
    s_waitcnt vmcnt(14)
    v_mfma_f32_16x16x32_bf16 v[12:15], a[64:67], a[44:47], v[12:15]
    s_waitcnt lgkmcnt(10)
    v_mfma_f32_16x16x32_bf16 v[28:31], a[68:71], a[44:47], v[28:31]
    ds_read_b64_tr_b16 a[64:65], v224 offset:43104
    v_mfma_f32_16x16x32_bf16 v[24:27], a[68:71], a[40:43], v[24:27]
    ds_read_b64_tr_b16 a[66:67], v224 offset:44896
    v_mfma_f32_16x16x32_bf16 v[20:23], a[68:71], a[36:39], v[20:23]
    buffer_load_dwordx4 a[12:15], v227, s[8:11], s16 offen offset:256
    v_mfma_f32_16x16x32_bf16 v[16:19], a[68:71], a[32:35], v[16:19]
    s_waitcnt lgkmcnt(10)
    v_mfma_f32_16x16x32_bf16 v[32:35], a[72:75], a[32:35], v[32:35]
    ds_read_b64_tr_b16 a[68:69], v224 offset:28800
    v_mfma_f32_16x16x32_bf16 v[36:39], a[72:75], a[36:39], v[36:39]
    ds_read_b64_tr_b16 a[70:71], v224 offset:30592
    v_mfma_f32_16x16x32_bf16 v[40:43], a[72:75], a[40:43], v[40:43]
    v_mfma_f32_16x16x32_bf16 v[44:47], a[72:75], a[44:47], v[44:47]
    s_waitcnt lgkmcnt(10)
    v_mfma_f32_16x16x32_bf16 v[60:63], a[76:79], a[44:47], v[60:63]
    ds_read_b64_tr_b16 a[72:73], v224 offset:43136
    v_mfma_f32_16x16x32_bf16 v[56:59], a[76:79], a[40:43], v[56:59]
    ds_read_b64_tr_b16 a[74:75], v224 offset:44928
    v_mfma_f32_16x16x32_bf16 v[52:55], a[76:79], a[36:39], v[52:55]
    v_mfma_f32_16x16x32_bf16 v[48:51], a[76:79], a[32:35], v[48:51]
    s_waitcnt lgkmcnt(10)
    v_mfma_f32_16x16x32_bf16 v[64:67], a[80:83], a[32:35], v[64:67]
    ds_read_b64_tr_b16 a[76:77], v224 offset:28832
    v_mfma_f32_16x16x32_bf16 v[68:71], a[80:83], a[36:39], v[68:71]
    ds_read_b64_tr_b16 a[78:79], v224 offset:30624
    s_add_u32 m0, s18, 86016
    s_add_u32 s17, s17, 458752
    v_mfma_f32_16x16x32_bf16 v[72:75], a[80:83], a[40:43], v[72:75]
    buffer_load_dwordx4 v228, s[12:15], s17 offen lds
    v_mfma_f32_16x16x32_bf16 v[76:79], a[80:83], a[44:47], v[76:79]
    s_waitcnt lgkmcnt(10)
    v_mfma_f32_16x16x32_bf16 v[92:95], a[84:87], a[44:47], v[92:95]
    ds_read_b64_tr_b16 a[80:81], v224 offset:43168
    v_mfma_f32_16x16x32_bf16 v[88:91], a[84:87], a[40:43], v[88:91]
    ds_read_b64_tr_b16 a[82:83], v224 offset:44960
    v_mfma_f32_16x16x32_bf16 v[84:87], a[84:87], a[36:39], v[84:87]
    v_mfma_f32_16x16x32_bf16 v[80:83], a[84:87], a[32:35], v[80:83]
    s_waitcnt lgkmcnt(10)
    v_mfma_f32_16x16x32_bf16 v[96:99], a[88:91], a[32:35], v[96:99]
    ds_read_b64_tr_b16 a[84:85], v224 offset:28864
    v_mfma_f32_16x16x32_bf16 v[100:103], a[88:91], a[36:39], v[100:103]
    ds_read_b64_tr_b16 a[86:87], v224 offset:30656
    v_mfma_f32_16x16x32_bf16 v[104:107], a[88:91], a[40:43], v[104:107]
    v_mfma_f32_16x16x32_bf16 v[108:111], a[88:91], a[44:47], v[108:111]
    s_waitcnt lgkmcnt(10)
    v_mfma_f32_16x16x32_bf16 v[124:127], a[64:67], a[44:47], v[124:127]
    ds_read_b64_tr_b16 a[88:89], v224 offset:43200
    v_mfma_f32_16x16x32_bf16 v[120:123], a[64:67], a[40:43], v[120:123]
    ds_read_b64_tr_b16 a[90:91], v224 offset:44992
    v_mfma_f32_16x16x32_bf16 v[116:119], a[64:67], a[36:39], v[116:119]
    v_mfma_f32_16x16x32_bf16 v[112:115], a[64:67], a[32:35], v[112:115]
    s_waitcnt lgkmcnt(10)
    v_mfma_f32_16x16x32_bf16 v[128:131], a[68:71], a[32:35], v[128:131]
    ds_read_b64_tr_b16 a[64:65], v224 offset:35840
    v_mfma_f32_16x16x32_bf16 v[132:135], a[68:71], a[36:39], v[132:135]
    ds_read_b64_tr_b16 a[66:67], v224 offset:37632
    s_add_u32 m0, s18, 88064
    v_mfma_f32_16x16x32_bf16 v[136:139], a[68:71], a[40:43], v[136:139]
    buffer_load_dwordx4 v229, s[12:15], s17 offen lds
    v_mfma_f32_16x16x32_bf16 v[140:143], a[68:71], a[44:47], v[140:143]
    s_waitcnt lgkmcnt(10)
    v_mfma_f32_16x16x32_bf16 v[156:159], a[72:75], a[44:47], v[156:159]
    ds_read_b64_tr_b16 a[68:69], v224 offset:50176
    v_mfma_f32_16x16x32_bf16 v[152:155], a[72:75], a[40:43], v[152:155]
    ds_read_b64_tr_b16 a[70:71], v224 offset:51968
    v_mfma_f32_16x16x32_bf16 v[148:151], a[72:75], a[36:39], v[148:151]
    buffer_load_dwordx4 a[16:19], v227, s[4:7], s16 offen offset:2048
    v_mfma_f32_16x16x32_bf16 v[144:147], a[72:75], a[32:35], v[144:147]
    s_waitcnt lgkmcnt(10)
    v_mfma_f32_16x16x32_bf16 v[160:163], a[76:79], a[32:35], v[160:163]
    ds_read_b64_tr_b16 a[72:73], v224 offset:35872
    v_mfma_f32_16x16x32_bf16 v[164:167], a[76:79], a[36:39], v[164:167]
    ds_read_b64_tr_b16 a[74:75], v224 offset:37664
    v_mfma_f32_16x16x32_bf16 v[168:171], a[76:79], a[40:43], v[168:171]
    v_mfma_f32_16x16x32_bf16 v[172:175], a[76:79], a[44:47], v[172:175]
    s_waitcnt lgkmcnt(10)
    v_mfma_f32_16x16x32_bf16 v[188:191], a[80:83], a[44:47], v[188:191]
    ds_read_b64_tr_b16 a[76:77], v224 offset:50208
    v_mfma_f32_16x16x32_bf16 v[184:187], a[80:83], a[40:43], v[184:187]
    ds_read_b64_tr_b16 a[78:79], v224 offset:52000
    v_mfma_f32_16x16x32_bf16 v[180:183], a[80:83], a[36:39], v[180:183]
    buffer_load_dwordx4 a[20:23], v227, s[4:7], s16 offen offset:2304
    v_mfma_f32_16x16x32_bf16 v[176:179], a[80:83], a[32:35], v[176:179]
    s_waitcnt lgkmcnt(10)
    v_mfma_f32_16x16x32_bf16 v[192:195], a[84:87], a[32:35], v[192:195]
    ds_read_b64_tr_b16 a[80:81], v224 offset:35904
    v_mfma_f32_16x16x32_bf16 v[196:199], a[84:87], a[36:39], v[196:199]
    ds_read_b64_tr_b16 a[82:83], v224 offset:37696
    s_add_u32 m0, s18, 90112
    v_mfma_f32_16x16x32_bf16 v[200:203], a[84:87], a[40:43], v[200:203]
    buffer_load_dwordx4 v230, s[12:15], s17 offen lds
    v_mfma_f32_16x16x32_bf16 v[204:207], a[84:87], a[44:47], v[204:207]
    s_waitcnt lgkmcnt(10)
    v_mfma_f32_16x16x32_bf16 v[220:223], a[88:91], a[44:47], v[220:223]
    ds_read_b64_tr_b16 a[84:85], v224 offset:50240
    v_mfma_f32_16x16x32_bf16 v[216:219], a[88:91], a[40:43], v[216:219]
    ds_read_b64_tr_b16 a[86:87], v224 offset:52032
    v_mfma_f32_16x16x32_bf16 v[212:215], a[88:91], a[36:39], v[212:215]
    buffer_load_dwordx4 a[24:27], v227, s[8:11], s16 offen offset:2048
    v_mfma_f32_16x16x32_bf16 v[208:211], a[88:91], a[32:35], v[208:211]
    s_waitcnt vmcnt(18) lgkmcnt(10)
    v_mfma_f32_16x16x32_bf16 v[0:3], a[64:67], a[48:51], v[0:3]
    ds_read_b64_tr_b16 a[88:89], v224 offset:35936
    s_waitcnt vmcnt(17)
    v_mfma_f32_16x16x32_bf16 v[4:7], a[64:67], a[52:55], v[4:7]
    ds_read_b64_tr_b16 a[90:91], v224 offset:37728
    s_waitcnt vmcnt(15)
    v_mfma_f32_16x16x32_bf16 v[8:11], a[64:67], a[56:59], v[8:11]
    s_waitcnt vmcnt(14)
    v_mfma_f32_16x16x32_bf16 v[12:15], a[64:67], a[60:63], v[12:15]
    s_waitcnt lgkmcnt(10)
    v_mfma_f32_16x16x32_bf16 v[28:31], a[68:71], a[60:63], v[28:31]
    ds_read_b64_tr_b16 a[64:65], v224 offset:50272
    v_mfma_f32_16x16x32_bf16 v[24:27], a[68:71], a[56:59], v[24:27]
    ds_read_b64_tr_b16 a[66:67], v224 offset:52064
    v_mfma_f32_16x16x32_bf16 v[20:23], a[68:71], a[52:55], v[20:23]
    buffer_load_dwordx4 a[28:31], v227, s[8:11], s16 offen offset:2304
    v_mfma_f32_16x16x32_bf16 v[16:19], a[68:71], a[48:51], v[16:19]
    s_waitcnt lgkmcnt(10)
    v_mfma_f32_16x16x32_bf16 v[32:35], a[72:75], a[48:51], v[32:35]
    ds_read_b64_tr_b16 a[68:69], v224 offset:35968
    v_mfma_f32_16x16x32_bf16 v[36:39], a[72:75], a[52:55], v[36:39]
    ds_read_b64_tr_b16 a[70:71], v224 offset:37760
    s_add_u32 m0, s18, 92160
    v_mfma_f32_16x16x32_bf16 v[40:43], a[72:75], a[56:59], v[40:43]
    buffer_load_dwordx4 v231, s[12:15], s17 offen lds
    v_mfma_f32_16x16x32_bf16 v[44:47], a[72:75], a[60:63], v[44:47]
    s_waitcnt lgkmcnt(10)
    v_mfma_f32_16x16x32_bf16 v[60:63], a[76:79], a[60:63], v[60:63]
    ds_read_b64_tr_b16 a[72:73], v224 offset:50304
    v_mfma_f32_16x16x32_bf16 v[56:59], a[76:79], a[56:59], v[56:59]
    ds_read_b64_tr_b16 a[74:75], v224 offset:52096
    v_mfma_f32_16x16x32_bf16 v[52:55], a[76:79], a[52:55], v[52:55]
    v_mfma_f32_16x16x32_bf16 v[48:51], a[76:79], a[48:51], v[48:51]
    s_waitcnt lgkmcnt(10)
    v_mfma_f32_16x16x32_bf16 v[64:67], a[80:83], a[48:51], v[64:67]
    ds_read_b64_tr_b16 a[76:77], v224 offset:36000
    v_mfma_f32_16x16x32_bf16 v[68:71], a[80:83], a[52:55], v[68:71]
    ds_read_b64_tr_b16 a[78:79], v224 offset:37792
    v_mfma_f32_16x16x32_bf16 v[72:75], a[80:83], a[56:59], v[72:75]
    v_mfma_f32_16x16x32_bf16 v[76:79], a[80:83], a[60:63], v[76:79]
    s_waitcnt lgkmcnt(10)
    v_mfma_f32_16x16x32_bf16 v[92:95], a[84:87], a[60:63], v[92:95]
    ds_read_b64_tr_b16 a[80:81], v224 offset:50336
    v_mfma_f32_16x16x32_bf16 v[88:91], a[84:87], a[56:59], v[88:91]
    ds_read_b64_tr_b16 a[82:83], v224 offset:52128
    v_mfma_f32_16x16x32_bf16 v[84:87], a[84:87], a[52:55], v[84:87]
    v_mfma_f32_16x16x32_bf16 v[80:83], a[84:87], a[48:51], v[80:83]
    s_waitcnt lgkmcnt(10)
    v_mfma_f32_16x16x32_bf16 v[96:99], a[88:91], a[48:51], v[96:99]
    ds_read_b64_tr_b16 a[84:85], v224 offset:36032
    v_mfma_f32_16x16x32_bf16 v[100:103], a[88:91], a[52:55], v[100:103]
    ds_read_b64_tr_b16 a[86:87], v224 offset:37824
    s_add_u32 m0, s18, 94208
    v_mfma_f32_16x16x32_bf16 v[104:107], a[88:91], a[56:59], v[104:107]
    buffer_load_dwordx4 v232, s[12:15], s17 offen lds
    v_mfma_f32_16x16x32_bf16 v[108:111], a[88:91], a[60:63], v[108:111]
    s_waitcnt lgkmcnt(10)
    v_mfma_f32_16x16x32_bf16 v[124:127], a[64:67], a[60:63], v[124:127]
    ds_read_b64_tr_b16 a[88:89], v224 offset:50368
    v_mfma_f32_16x16x32_bf16 v[120:123], a[64:67], a[56:59], v[120:123]
    ds_read_b64_tr_b16 a[90:91], v224 offset:52160
    v_mfma_f32_16x16x32_bf16 v[116:119], a[64:67], a[52:55], v[116:119]
    v_mfma_f32_16x16x32_bf16 v[112:115], a[64:67], a[48:51], v[112:115]
    s_waitcnt vmcnt(10) lgkmcnt(10)
    s_barrier
    v_mfma_f32_16x16x32_bf16 v[128:131], a[68:71], a[48:51], v[128:131]
    ds_read_b64_tr_b16 a[64:65], v225 offset:0
    v_mfma_f32_16x16x32_bf16 v[132:135], a[68:71], a[52:55], v[132:135]
    ds_read_b64_tr_b16 a[66:67], v225 offset:1792
    v_mfma_f32_16x16x32_bf16 v[136:139], a[68:71], a[56:59], v[136:139]
    v_mfma_f32_16x16x32_bf16 v[140:143], a[68:71], a[60:63], v[140:143]
    s_waitcnt lgkmcnt(10)
    v_mfma_f32_16x16x32_bf16 v[156:159], a[72:75], a[60:63], v[156:159]
    ds_read_b64_tr_b16 a[68:69], v225 offset:14336
    v_mfma_f32_16x16x32_bf16 v[152:155], a[72:75], a[56:59], v[152:155]
    ds_read_b64_tr_b16 a[70:71], v225 offset:16128
    v_mfma_f32_16x16x32_bf16 v[148:151], a[72:75], a[52:55], v[148:151]
    s_add_u32 s16, s16, 4096
    buffer_load_dwordx4 a[32:35], v227, s[4:7], s16 offen offset:0
    v_mfma_f32_16x16x32_bf16 v[144:147], a[72:75], a[48:51], v[144:147]
    s_waitcnt lgkmcnt(10)
    v_mfma_f32_16x16x32_bf16 v[160:163], a[76:79], a[48:51], v[160:163]
    ds_read_b64_tr_b16 a[72:73], v225 offset:32
    v_mfma_f32_16x16x32_bf16 v[164:167], a[76:79], a[52:55], v[164:167]
    ds_read_b64_tr_b16 a[74:75], v225 offset:1824
    s_add_u32 m0, s18, 96256
    v_mfma_f32_16x16x32_bf16 v[168:171], a[76:79], a[56:59], v[168:171]
    buffer_load_dwordx4 v233, s[12:15], s17 offen lds
    v_mfma_f32_16x16x32_bf16 v[172:175], a[76:79], a[60:63], v[172:175]
    s_waitcnt lgkmcnt(10)
    v_mfma_f32_16x16x32_bf16 v[188:191], a[80:83], a[60:63], v[188:191]
    ds_read_b64_tr_b16 a[76:77], v225 offset:14368
    v_mfma_f32_16x16x32_bf16 v[184:187], a[80:83], a[56:59], v[184:187]
    ds_read_b64_tr_b16 a[78:79], v225 offset:16160
    v_mfma_f32_16x16x32_bf16 v[180:183], a[80:83], a[52:55], v[180:183]
    buffer_load_dwordx4 a[36:39], v227, s[4:7], s16 offen offset:256
    v_mfma_f32_16x16x32_bf16 v[176:179], a[80:83], a[48:51], v[176:179]
    s_waitcnt lgkmcnt(10)
    v_mfma_f32_16x16x32_bf16 v[192:195], a[84:87], a[48:51], v[192:195]
    ds_read_b64_tr_b16 a[80:81], v225 offset:64
    v_mfma_f32_16x16x32_bf16 v[196:199], a[84:87], a[52:55], v[196:199]
    ds_read_b64_tr_b16 a[82:83], v225 offset:1856
    v_mfma_f32_16x16x32_bf16 v[200:203], a[84:87], a[56:59], v[200:203]
    v_mfma_f32_16x16x32_bf16 v[204:207], a[84:87], a[60:63], v[204:207]
    s_waitcnt lgkmcnt(10)
    v_mfma_f32_16x16x32_bf16 v[220:223], a[88:91], a[60:63], v[220:223]
    ds_read_b64_tr_b16 a[84:85], v225 offset:14400
    v_mfma_f32_16x16x32_bf16 v[216:219], a[88:91], a[56:59], v[216:219]
    ds_read_b64_tr_b16 a[86:87], v225 offset:16192
    v_mfma_f32_16x16x32_bf16 v[212:215], a[88:91], a[52:55], v[212:215]
    buffer_load_dwordx4 a[40:43], v227, s[8:11], s16 offen offset:0
    v_mfma_f32_16x16x32_bf16 v[208:211], a[88:91], a[48:51], v[208:211]
    s_waitcnt lgkmcnt(10)
    v_mfma_f32_16x16x32_bf16 v[0:3], a[64:67], a[0:3], v[0:3]
    ds_read_b64_tr_b16 a[88:89], v225 offset:96
    v_mfma_f32_16x16x32_bf16 v[4:7], a[64:67], a[4:7], v[4:7]
    ds_read_b64_tr_b16 a[90:91], v225 offset:1888
    s_add_u32 m0, s18, 98304
    v_mfma_f32_16x16x32_bf16 v[8:11], a[64:67], a[8:11], v[8:11]
    buffer_load_dwordx4 v234, s[12:15], s17 offen lds
    s_waitcnt vmcnt(14)
    v_mfma_f32_16x16x32_bf16 v[12:15], a[64:67], a[12:15], v[12:15]
    s_waitcnt lgkmcnt(10)
    v_mfma_f32_16x16x32_bf16 v[28:31], a[68:71], a[12:15], v[28:31]
    ds_read_b64_tr_b16 a[64:65], v225 offset:14432
    v_mfma_f32_16x16x32_bf16 v[24:27], a[68:71], a[8:11], v[24:27]
    ds_read_b64_tr_b16 a[66:67], v225 offset:16224
    v_mfma_f32_16x16x32_bf16 v[20:23], a[68:71], a[4:7], v[20:23]
    buffer_load_dwordx4 a[44:47], v227, s[8:11], s16 offen offset:256
    v_mfma_f32_16x16x32_bf16 v[16:19], a[68:71], a[0:3], v[16:19]
    s_waitcnt lgkmcnt(10)
    v_mfma_f32_16x16x32_bf16 v[32:35], a[72:75], a[0:3], v[32:35]
    ds_read_b64_tr_b16 a[68:69], v225 offset:128
    v_mfma_f32_16x16x32_bf16 v[36:39], a[72:75], a[4:7], v[36:39]
    ds_read_b64_tr_b16 a[70:71], v225 offset:1920
    v_mfma_f32_16x16x32_bf16 v[40:43], a[72:75], a[8:11], v[40:43]
    v_mfma_f32_16x16x32_bf16 v[44:47], a[72:75], a[12:15], v[44:47]
    s_waitcnt lgkmcnt(10)
    v_mfma_f32_16x16x32_bf16 v[60:63], a[76:79], a[12:15], v[60:63]
    ds_read_b64_tr_b16 a[72:73], v225 offset:14464
    v_mfma_f32_16x16x32_bf16 v[56:59], a[76:79], a[8:11], v[56:59]
    ds_read_b64_tr_b16 a[74:75], v225 offset:16256
    v_mfma_f32_16x16x32_bf16 v[52:55], a[76:79], a[4:7], v[52:55]
    v_mfma_f32_16x16x32_bf16 v[48:51], a[76:79], a[0:3], v[48:51]
    s_waitcnt lgkmcnt(10)
    v_mfma_f32_16x16x32_bf16 v[64:67], a[80:83], a[0:3], v[64:67]
    ds_read_b64_tr_b16 a[76:77], v225 offset:160
    v_mfma_f32_16x16x32_bf16 v[68:71], a[80:83], a[4:7], v[68:71]
    ds_read_b64_tr_b16 a[78:79], v225 offset:1952
    s_add_u32 m0, s18, 0
    s_add_u32 s17, s17, 458752
    v_mfma_f32_16x16x32_bf16 v[72:75], a[80:83], a[8:11], v[72:75]
    buffer_load_dwordx4 v228, s[12:15], s17 offen lds
    v_mfma_f32_16x16x32_bf16 v[76:79], a[80:83], a[12:15], v[76:79]
    s_waitcnt lgkmcnt(10)
    v_mfma_f32_16x16x32_bf16 v[92:95], a[84:87], a[12:15], v[92:95]
    ds_read_b64_tr_b16 a[80:81], v225 offset:14496
    v_mfma_f32_16x16x32_bf16 v[88:91], a[84:87], a[8:11], v[88:91]
    ds_read_b64_tr_b16 a[82:83], v225 offset:16288
    v_mfma_f32_16x16x32_bf16 v[84:87], a[84:87], a[4:7], v[84:87]
    v_mfma_f32_16x16x32_bf16 v[80:83], a[84:87], a[0:3], v[80:83]
    s_waitcnt lgkmcnt(10)
    v_mfma_f32_16x16x32_bf16 v[96:99], a[88:91], a[0:3], v[96:99]
    ds_read_b64_tr_b16 a[84:85], v225 offset:192
    v_mfma_f32_16x16x32_bf16 v[100:103], a[88:91], a[4:7], v[100:103]
    ds_read_b64_tr_b16 a[86:87], v225 offset:1984
    v_mfma_f32_16x16x32_bf16 v[104:107], a[88:91], a[8:11], v[104:107]
    v_mfma_f32_16x16x32_bf16 v[108:111], a[88:91], a[12:15], v[108:111]
    s_waitcnt lgkmcnt(10)
    v_mfma_f32_16x16x32_bf16 v[124:127], a[64:67], a[12:15], v[124:127]
    ds_read_b64_tr_b16 a[88:89], v225 offset:14528
    v_mfma_f32_16x16x32_bf16 v[120:123], a[64:67], a[8:11], v[120:123]
    ds_read_b64_tr_b16 a[90:91], v225 offset:16320
    v_mfma_f32_16x16x32_bf16 v[116:119], a[64:67], a[4:7], v[116:119]
    v_mfma_f32_16x16x32_bf16 v[112:115], a[64:67], a[0:3], v[112:115]
    s_waitcnt lgkmcnt(10)
    v_mfma_f32_16x16x32_bf16 v[128:131], a[68:71], a[0:3], v[128:131]
    ds_read_b64_tr_b16 a[64:65], v225 offset:7168
    v_mfma_f32_16x16x32_bf16 v[132:135], a[68:71], a[4:7], v[132:135]
    ds_read_b64_tr_b16 a[66:67], v225 offset:8960
    s_add_u32 m0, s18, 2048
    v_mfma_f32_16x16x32_bf16 v[136:139], a[68:71], a[8:11], v[136:139]
    buffer_load_dwordx4 v229, s[12:15], s17 offen lds
    v_mfma_f32_16x16x32_bf16 v[140:143], a[68:71], a[12:15], v[140:143]
    s_waitcnt lgkmcnt(10)
    v_mfma_f32_16x16x32_bf16 v[156:159], a[72:75], a[12:15], v[156:159]
    ds_read_b64_tr_b16 a[68:69], v225 offset:21504
    v_mfma_f32_16x16x32_bf16 v[152:155], a[72:75], a[8:11], v[152:155]
    ds_read_b64_tr_b16 a[70:71], v225 offset:23296
    v_mfma_f32_16x16x32_bf16 v[148:151], a[72:75], a[4:7], v[148:151]
    buffer_load_dwordx4 a[48:51], v227, s[4:7], s16 offen offset:2048
    v_mfma_f32_16x16x32_bf16 v[144:147], a[72:75], a[0:3], v[144:147]
    s_waitcnt lgkmcnt(10)
    v_mfma_f32_16x16x32_bf16 v[160:163], a[76:79], a[0:3], v[160:163]
    ds_read_b64_tr_b16 a[72:73], v225 offset:7200
    v_mfma_f32_16x16x32_bf16 v[164:167], a[76:79], a[4:7], v[164:167]
    ds_read_b64_tr_b16 a[74:75], v225 offset:8992
    v_mfma_f32_16x16x32_bf16 v[168:171], a[76:79], a[8:11], v[168:171]
    v_mfma_f32_16x16x32_bf16 v[172:175], a[76:79], a[12:15], v[172:175]
    s_waitcnt lgkmcnt(10)
    v_mfma_f32_16x16x32_bf16 v[188:191], a[80:83], a[12:15], v[188:191]
    ds_read_b64_tr_b16 a[76:77], v225 offset:21536
    v_mfma_f32_16x16x32_bf16 v[184:187], a[80:83], a[8:11], v[184:187]
    ds_read_b64_tr_b16 a[78:79], v225 offset:23328
    v_mfma_f32_16x16x32_bf16 v[180:183], a[80:83], a[4:7], v[180:183]
    buffer_load_dwordx4 a[52:55], v227, s[4:7], s16 offen offset:2304
    v_mfma_f32_16x16x32_bf16 v[176:179], a[80:83], a[0:3], v[176:179]
    s_waitcnt lgkmcnt(10)
    v_mfma_f32_16x16x32_bf16 v[192:195], a[84:87], a[0:3], v[192:195]
    ds_read_b64_tr_b16 a[80:81], v225 offset:7232
    v_mfma_f32_16x16x32_bf16 v[196:199], a[84:87], a[4:7], v[196:199]
    ds_read_b64_tr_b16 a[82:83], v225 offset:9024
    s_add_u32 m0, s18, 4096
    v_mfma_f32_16x16x32_bf16 v[200:203], a[84:87], a[8:11], v[200:203]
    buffer_load_dwordx4 v230, s[12:15], s17 offen lds
    v_mfma_f32_16x16x32_bf16 v[204:207], a[84:87], a[12:15], v[204:207]
    s_waitcnt lgkmcnt(10)
    v_mfma_f32_16x16x32_bf16 v[220:223], a[88:91], a[12:15], v[220:223]
    ds_read_b64_tr_b16 a[84:85], v225 offset:21568
    v_mfma_f32_16x16x32_bf16 v[216:219], a[88:91], a[8:11], v[216:219]
    ds_read_b64_tr_b16 a[86:87], v225 offset:23360
    v_mfma_f32_16x16x32_bf16 v[212:215], a[88:91], a[4:7], v[212:215]
    buffer_load_dwordx4 a[56:59], v227, s[8:11], s16 offen offset:2048
    v_mfma_f32_16x16x32_bf16 v[208:211], a[88:91], a[0:3], v[208:211]
    s_waitcnt vmcnt(18) lgkmcnt(10)
    v_mfma_f32_16x16x32_bf16 v[0:3], a[64:67], a[16:19], v[0:3]
    ds_read_b64_tr_b16 a[88:89], v225 offset:7264
    s_waitcnt vmcnt(17)
    v_mfma_f32_16x16x32_bf16 v[4:7], a[64:67], a[20:23], v[4:7]
    ds_read_b64_tr_b16 a[90:91], v225 offset:9056
    s_waitcnt vmcnt(15)
    v_mfma_f32_16x16x32_bf16 v[8:11], a[64:67], a[24:27], v[8:11]
    s_waitcnt vmcnt(14)
    v_mfma_f32_16x16x32_bf16 v[12:15], a[64:67], a[28:31], v[12:15]
    s_waitcnt lgkmcnt(10)
    v_mfma_f32_16x16x32_bf16 v[28:31], a[68:71], a[28:31], v[28:31]
    ds_read_b64_tr_b16 a[64:65], v225 offset:21600
    v_mfma_f32_16x16x32_bf16 v[24:27], a[68:71], a[24:27], v[24:27]
    ds_read_b64_tr_b16 a[66:67], v225 offset:23392
    v_mfma_f32_16x16x32_bf16 v[20:23], a[68:71], a[20:23], v[20:23]
    buffer_load_dwordx4 a[60:63], v227, s[8:11], s16 offen offset:2304
    v_mfma_f32_16x16x32_bf16 v[16:19], a[68:71], a[16:19], v[16:19]
    s_waitcnt lgkmcnt(10)
    v_mfma_f32_16x16x32_bf16 v[32:35], a[72:75], a[16:19], v[32:35]
    ds_read_b64_tr_b16 a[68:69], v225 offset:7296
    v_mfma_f32_16x16x32_bf16 v[36:39], a[72:75], a[20:23], v[36:39]
    ds_read_b64_tr_b16 a[70:71], v225 offset:9088
    s_add_u32 m0, s18, 6144
    v_mfma_f32_16x16x32_bf16 v[40:43], a[72:75], a[24:27], v[40:43]
    buffer_load_dwordx4 v231, s[12:15], s17 offen lds
    v_mfma_f32_16x16x32_bf16 v[44:47], a[72:75], a[28:31], v[44:47]
    s_waitcnt lgkmcnt(10)
    v_mfma_f32_16x16x32_bf16 v[60:63], a[76:79], a[28:31], v[60:63]
    ds_read_b64_tr_b16 a[72:73], v225 offset:21632
    v_mfma_f32_16x16x32_bf16 v[56:59], a[76:79], a[24:27], v[56:59]
    ds_read_b64_tr_b16 a[74:75], v225 offset:23424
    v_mfma_f32_16x16x32_bf16 v[52:55], a[76:79], a[20:23], v[52:55]
    v_mfma_f32_16x16x32_bf16 v[48:51], a[76:79], a[16:19], v[48:51]
    s_waitcnt lgkmcnt(10)
    v_mfma_f32_16x16x32_bf16 v[64:67], a[80:83], a[16:19], v[64:67]
    ds_read_b64_tr_b16 a[76:77], v225 offset:7328
    v_mfma_f32_16x16x32_bf16 v[68:71], a[80:83], a[20:23], v[68:71]
    ds_read_b64_tr_b16 a[78:79], v225 offset:9120
    v_mfma_f32_16x16x32_bf16 v[72:75], a[80:83], a[24:27], v[72:75]
    v_mfma_f32_16x16x32_bf16 v[76:79], a[80:83], a[28:31], v[76:79]
    s_waitcnt lgkmcnt(10)
    v_mfma_f32_16x16x32_bf16 v[92:95], a[84:87], a[28:31], v[92:95]
    ds_read_b64_tr_b16 a[80:81], v225 offset:21664
    v_mfma_f32_16x16x32_bf16 v[88:91], a[84:87], a[24:27], v[88:91]
    ds_read_b64_tr_b16 a[82:83], v225 offset:23456
    v_mfma_f32_16x16x32_bf16 v[84:87], a[84:87], a[20:23], v[84:87]
    v_mfma_f32_16x16x32_bf16 v[80:83], a[84:87], a[16:19], v[80:83]
    s_waitcnt lgkmcnt(10)
    v_mfma_f32_16x16x32_bf16 v[96:99], a[88:91], a[16:19], v[96:99]
    ds_read_b64_tr_b16 a[84:85], v225 offset:7360
    v_mfma_f32_16x16x32_bf16 v[100:103], a[88:91], a[20:23], v[100:103]
    ds_read_b64_tr_b16 a[86:87], v225 offset:9152
    s_add_u32 m0, s18, 8192
    v_mfma_f32_16x16x32_bf16 v[104:107], a[88:91], a[24:27], v[104:107]
    buffer_load_dwordx4 v232, s[12:15], s17 offen lds
    v_mfma_f32_16x16x32_bf16 v[108:111], a[88:91], a[28:31], v[108:111]
    s_waitcnt lgkmcnt(10)
    v_mfma_f32_16x16x32_bf16 v[124:127], a[64:67], a[28:31], v[124:127]
    ds_read_b64_tr_b16 a[88:89], v225 offset:21696
    v_mfma_f32_16x16x32_bf16 v[120:123], a[64:67], a[24:27], v[120:123]
    ds_read_b64_tr_b16 a[90:91], v225 offset:23488
    v_mfma_f32_16x16x32_bf16 v[116:119], a[64:67], a[20:23], v[116:119]
    v_mfma_f32_16x16x32_bf16 v[112:115], a[64:67], a[16:19], v[112:115]
    s_waitcnt vmcnt(10) lgkmcnt(10)
    s_barrier
    v_mfma_f32_16x16x32_bf16 v[128:131], a[68:71], a[16:19], v[128:131]
    ds_read_b64_tr_b16 a[64:65], v225 offset:28672
    v_mfma_f32_16x16x32_bf16 v[132:135], a[68:71], a[20:23], v[132:135]
    ds_read_b64_tr_b16 a[66:67], v225 offset:30464
    v_mfma_f32_16x16x32_bf16 v[136:139], a[68:71], a[24:27], v[136:139]
    v_mfma_f32_16x16x32_bf16 v[140:143], a[68:71], a[28:31], v[140:143]
    s_waitcnt lgkmcnt(10)
    v_mfma_f32_16x16x32_bf16 v[156:159], a[72:75], a[28:31], v[156:159]
    ds_read_b64_tr_b16 a[68:69], v225 offset:43008
    v_mfma_f32_16x16x32_bf16 v[152:155], a[72:75], a[24:27], v[152:155]
    ds_read_b64_tr_b16 a[70:71], v225 offset:44800
    v_mfma_f32_16x16x32_bf16 v[148:151], a[72:75], a[20:23], v[148:151]
    s_add_u32 s16, s16, 4096
    buffer_load_dwordx4 a[0:3], v227, s[4:7], s16 offen offset:0
    v_mfma_f32_16x16x32_bf16 v[144:147], a[72:75], a[16:19], v[144:147]
    s_waitcnt lgkmcnt(10)
    v_mfma_f32_16x16x32_bf16 v[160:163], a[76:79], a[16:19], v[160:163]
    ds_read_b64_tr_b16 a[72:73], v225 offset:28704
    v_mfma_f32_16x16x32_bf16 v[164:167], a[76:79], a[20:23], v[164:167]
    ds_read_b64_tr_b16 a[74:75], v225 offset:30496
    s_add_u32 m0, s18, 10240
    v_mfma_f32_16x16x32_bf16 v[168:171], a[76:79], a[24:27], v[168:171]
    buffer_load_dwordx4 v233, s[12:15], s17 offen lds
    v_mfma_f32_16x16x32_bf16 v[172:175], a[76:79], a[28:31], v[172:175]
    s_waitcnt lgkmcnt(10)
    v_mfma_f32_16x16x32_bf16 v[188:191], a[80:83], a[28:31], v[188:191]
    ds_read_b64_tr_b16 a[76:77], v225 offset:43040
    v_mfma_f32_16x16x32_bf16 v[184:187], a[80:83], a[24:27], v[184:187]
    ds_read_b64_tr_b16 a[78:79], v225 offset:44832
    v_mfma_f32_16x16x32_bf16 v[180:183], a[80:83], a[20:23], v[180:183]
    buffer_load_dwordx4 a[4:7], v227, s[4:7], s16 offen offset:256
    v_mfma_f32_16x16x32_bf16 v[176:179], a[80:83], a[16:19], v[176:179]
    s_waitcnt lgkmcnt(10)
    v_mfma_f32_16x16x32_bf16 v[192:195], a[84:87], a[16:19], v[192:195]
    ds_read_b64_tr_b16 a[80:81], v225 offset:28736
    v_mfma_f32_16x16x32_bf16 v[196:199], a[84:87], a[20:23], v[196:199]
    ds_read_b64_tr_b16 a[82:83], v225 offset:30528
    v_mfma_f32_16x16x32_bf16 v[200:203], a[84:87], a[24:27], v[200:203]
    v_mfma_f32_16x16x32_bf16 v[204:207], a[84:87], a[28:31], v[204:207]
    s_waitcnt lgkmcnt(10)
    v_mfma_f32_16x16x32_bf16 v[220:223], a[88:91], a[28:31], v[220:223]
    ds_read_b64_tr_b16 a[84:85], v225 offset:43072
    v_mfma_f32_16x16x32_bf16 v[216:219], a[88:91], a[24:27], v[216:219]
    ds_read_b64_tr_b16 a[86:87], v225 offset:44864
    v_mfma_f32_16x16x32_bf16 v[212:215], a[88:91], a[20:23], v[212:215]
    buffer_load_dwordx4 a[8:11], v227, s[8:11], s16 offen offset:0
    v_mfma_f32_16x16x32_bf16 v[208:211], a[88:91], a[16:19], v[208:211]
    s_waitcnt lgkmcnt(10)
    v_mfma_f32_16x16x32_bf16 v[0:3], a[64:67], a[32:35], v[0:3]
    ds_read_b64_tr_b16 a[88:89], v225 offset:28768
    v_mfma_f32_16x16x32_bf16 v[4:7], a[64:67], a[36:39], v[4:7]
    ds_read_b64_tr_b16 a[90:91], v225 offset:30560
    s_add_u32 m0, s18, 12288
    v_mfma_f32_16x16x32_bf16 v[8:11], a[64:67], a[40:43], v[8:11]
    buffer_load_dwordx4 v234, s[12:15], s17 offen lds
    s_waitcnt vmcnt(14)
    v_mfma_f32_16x16x32_bf16 v[12:15], a[64:67], a[44:47], v[12:15]
    s_waitcnt lgkmcnt(10)
    v_mfma_f32_16x16x32_bf16 v[28:31], a[68:71], a[44:47], v[28:31]
    ds_read_b64_tr_b16 a[64:65], v225 offset:43104
    v_mfma_f32_16x16x32_bf16 v[24:27], a[68:71], a[40:43], v[24:27]
    ds_read_b64_tr_b16 a[66:67], v225 offset:44896
    v_mfma_f32_16x16x32_bf16 v[20:23], a[68:71], a[36:39], v[20:23]
    buffer_load_dwordx4 a[12:15], v227, s[8:11], s16 offen offset:256
    v_mfma_f32_16x16x32_bf16 v[16:19], a[68:71], a[32:35], v[16:19]
    s_waitcnt lgkmcnt(10)
    v_mfma_f32_16x16x32_bf16 v[32:35], a[72:75], a[32:35], v[32:35]
    ds_read_b64_tr_b16 a[68:69], v225 offset:28800
    v_mfma_f32_16x16x32_bf16 v[36:39], a[72:75], a[36:39], v[36:39]
    ds_read_b64_tr_b16 a[70:71], v225 offset:30592
    v_mfma_f32_16x16x32_bf16 v[40:43], a[72:75], a[40:43], v[40:43]
    v_mfma_f32_16x16x32_bf16 v[44:47], a[72:75], a[44:47], v[44:47]
    s_waitcnt lgkmcnt(10)
    v_mfma_f32_16x16x32_bf16 v[60:63], a[76:79], a[44:47], v[60:63]
    ds_read_b64_tr_b16 a[72:73], v225 offset:43136
    v_mfma_f32_16x16x32_bf16 v[56:59], a[76:79], a[40:43], v[56:59]
    ds_read_b64_tr_b16 a[74:75], v225 offset:44928
    v_mfma_f32_16x16x32_bf16 v[52:55], a[76:79], a[36:39], v[52:55]
    v_mfma_f32_16x16x32_bf16 v[48:51], a[76:79], a[32:35], v[48:51]
    s_waitcnt lgkmcnt(10)
    v_mfma_f32_16x16x32_bf16 v[64:67], a[80:83], a[32:35], v[64:67]
    ds_read_b64_tr_b16 a[76:77], v225 offset:28832
    v_mfma_f32_16x16x32_bf16 v[68:71], a[80:83], a[36:39], v[68:71]
    ds_read_b64_tr_b16 a[78:79], v225 offset:30624
    s_add_u32 m0, s18, 28672
    s_add_u32 s17, s17, 458752
    v_mfma_f32_16x16x32_bf16 v[72:75], a[80:83], a[40:43], v[72:75]
    buffer_load_dwordx4 v228, s[12:15], s17 offen lds
    v_mfma_f32_16x16x32_bf16 v[76:79], a[80:83], a[44:47], v[76:79]
    s_waitcnt lgkmcnt(10)
    v_mfma_f32_16x16x32_bf16 v[92:95], a[84:87], a[44:47], v[92:95]
    ds_read_b64_tr_b16 a[80:81], v225 offset:43168
    v_mfma_f32_16x16x32_bf16 v[88:91], a[84:87], a[40:43], v[88:91]
    ds_read_b64_tr_b16 a[82:83], v225 offset:44960
    v_mfma_f32_16x16x32_bf16 v[84:87], a[84:87], a[36:39], v[84:87]
    v_mfma_f32_16x16x32_bf16 v[80:83], a[84:87], a[32:35], v[80:83]
    s_waitcnt lgkmcnt(10)
    v_mfma_f32_16x16x32_bf16 v[96:99], a[88:91], a[32:35], v[96:99]
    ds_read_b64_tr_b16 a[84:85], v225 offset:28864
    v_mfma_f32_16x16x32_bf16 v[100:103], a[88:91], a[36:39], v[100:103]
    ds_read_b64_tr_b16 a[86:87], v225 offset:30656
    v_mfma_f32_16x16x32_bf16 v[104:107], a[88:91], a[40:43], v[104:107]
    v_mfma_f32_16x16x32_bf16 v[108:111], a[88:91], a[44:47], v[108:111]
    s_waitcnt lgkmcnt(10)
    v_mfma_f32_16x16x32_bf16 v[124:127], a[64:67], a[44:47], v[124:127]
    ds_read_b64_tr_b16 a[88:89], v225 offset:43200
    v_mfma_f32_16x16x32_bf16 v[120:123], a[64:67], a[40:43], v[120:123]
    ds_read_b64_tr_b16 a[90:91], v225 offset:44992
    v_mfma_f32_16x16x32_bf16 v[116:119], a[64:67], a[36:39], v[116:119]
    v_mfma_f32_16x16x32_bf16 v[112:115], a[64:67], a[32:35], v[112:115]
    s_waitcnt lgkmcnt(10)
    v_mfma_f32_16x16x32_bf16 v[128:131], a[68:71], a[32:35], v[128:131]
    ds_read_b64_tr_b16 a[64:65], v225 offset:35840
    v_mfma_f32_16x16x32_bf16 v[132:135], a[68:71], a[36:39], v[132:135]
    ds_read_b64_tr_b16 a[66:67], v225 offset:37632
    s_add_u32 m0, s18, 30720
    v_mfma_f32_16x16x32_bf16 v[136:139], a[68:71], a[40:43], v[136:139]
    buffer_load_dwordx4 v229, s[12:15], s17 offen lds
    v_mfma_f32_16x16x32_bf16 v[140:143], a[68:71], a[44:47], v[140:143]
    s_waitcnt lgkmcnt(10)
    v_mfma_f32_16x16x32_bf16 v[156:159], a[72:75], a[44:47], v[156:159]
    ds_read_b64_tr_b16 a[68:69], v225 offset:50176
    v_mfma_f32_16x16x32_bf16 v[152:155], a[72:75], a[40:43], v[152:155]
    ds_read_b64_tr_b16 a[70:71], v225 offset:51968
    v_mfma_f32_16x16x32_bf16 v[148:151], a[72:75], a[36:39], v[148:151]
    buffer_load_dwordx4 a[16:19], v227, s[4:7], s16 offen offset:2048
    v_mfma_f32_16x16x32_bf16 v[144:147], a[72:75], a[32:35], v[144:147]
    s_waitcnt lgkmcnt(10)
    v_mfma_f32_16x16x32_bf16 v[160:163], a[76:79], a[32:35], v[160:163]
    ds_read_b64_tr_b16 a[72:73], v225 offset:35872
    v_mfma_f32_16x16x32_bf16 v[164:167], a[76:79], a[36:39], v[164:167]
    ds_read_b64_tr_b16 a[74:75], v225 offset:37664
    v_mfma_f32_16x16x32_bf16 v[168:171], a[76:79], a[40:43], v[168:171]
    v_mfma_f32_16x16x32_bf16 v[172:175], a[76:79], a[44:47], v[172:175]
    s_waitcnt lgkmcnt(10)
    v_mfma_f32_16x16x32_bf16 v[188:191], a[80:83], a[44:47], v[188:191]
    ds_read_b64_tr_b16 a[76:77], v225 offset:50208
    v_mfma_f32_16x16x32_bf16 v[184:187], a[80:83], a[40:43], v[184:187]
    ds_read_b64_tr_b16 a[78:79], v225 offset:52000
    v_mfma_f32_16x16x32_bf16 v[180:183], a[80:83], a[36:39], v[180:183]
    buffer_load_dwordx4 a[20:23], v227, s[4:7], s16 offen offset:2304
    v_mfma_f32_16x16x32_bf16 v[176:179], a[80:83], a[32:35], v[176:179]
    s_waitcnt lgkmcnt(10)
    v_mfma_f32_16x16x32_bf16 v[192:195], a[84:87], a[32:35], v[192:195]
    ds_read_b64_tr_b16 a[80:81], v225 offset:35904
    v_mfma_f32_16x16x32_bf16 v[196:199], a[84:87], a[36:39], v[196:199]
    ds_read_b64_tr_b16 a[82:83], v225 offset:37696
    s_add_u32 m0, s18, 32768
    v_mfma_f32_16x16x32_bf16 v[200:203], a[84:87], a[40:43], v[200:203]
    buffer_load_dwordx4 v230, s[12:15], s17 offen lds
    v_mfma_f32_16x16x32_bf16 v[204:207], a[84:87], a[44:47], v[204:207]
    s_waitcnt lgkmcnt(10)
    v_mfma_f32_16x16x32_bf16 v[220:223], a[88:91], a[44:47], v[220:223]
    ds_read_b64_tr_b16 a[84:85], v225 offset:50240
    v_mfma_f32_16x16x32_bf16 v[216:219], a[88:91], a[40:43], v[216:219]
    ds_read_b64_tr_b16 a[86:87], v225 offset:52032
    v_mfma_f32_16x16x32_bf16 v[212:215], a[88:91], a[36:39], v[212:215]
    buffer_load_dwordx4 a[24:27], v227, s[8:11], s16 offen offset:2048
    v_mfma_f32_16x16x32_bf16 v[208:211], a[88:91], a[32:35], v[208:211]
    s_waitcnt vmcnt(18) lgkmcnt(10)
    v_mfma_f32_16x16x32_bf16 v[0:3], a[64:67], a[48:51], v[0:3]
    ds_read_b64_tr_b16 a[88:89], v225 offset:35936
    s_waitcnt vmcnt(17)
    v_mfma_f32_16x16x32_bf16 v[4:7], a[64:67], a[52:55], v[4:7]
    ds_read_b64_tr_b16 a[90:91], v225 offset:37728
    s_waitcnt vmcnt(15)
    v_mfma_f32_16x16x32_bf16 v[8:11], a[64:67], a[56:59], v[8:11]
    s_waitcnt vmcnt(14)
    v_mfma_f32_16x16x32_bf16 v[12:15], a[64:67], a[60:63], v[12:15]
    s_waitcnt lgkmcnt(10)
    v_mfma_f32_16x16x32_bf16 v[28:31], a[68:71], a[60:63], v[28:31]
    ds_read_b64_tr_b16 a[64:65], v225 offset:50272
    v_mfma_f32_16x16x32_bf16 v[24:27], a[68:71], a[56:59], v[24:27]
    ds_read_b64_tr_b16 a[66:67], v225 offset:52064
    v_mfma_f32_16x16x32_bf16 v[20:23], a[68:71], a[52:55], v[20:23]
    buffer_load_dwordx4 a[28:31], v227, s[8:11], s16 offen offset:2304
    v_mfma_f32_16x16x32_bf16 v[16:19], a[68:71], a[48:51], v[16:19]
    s_waitcnt lgkmcnt(10)
    v_mfma_f32_16x16x32_bf16 v[32:35], a[72:75], a[48:51], v[32:35]
    ds_read_b64_tr_b16 a[68:69], v225 offset:35968
    v_mfma_f32_16x16x32_bf16 v[36:39], a[72:75], a[52:55], v[36:39]
    ds_read_b64_tr_b16 a[70:71], v225 offset:37760
    s_add_u32 m0, s18, 34816
    v_mfma_f32_16x16x32_bf16 v[40:43], a[72:75], a[56:59], v[40:43]
    buffer_load_dwordx4 v231, s[12:15], s17 offen lds
    v_mfma_f32_16x16x32_bf16 v[44:47], a[72:75], a[60:63], v[44:47]
    s_waitcnt lgkmcnt(10)
    v_mfma_f32_16x16x32_bf16 v[60:63], a[76:79], a[60:63], v[60:63]
    ds_read_b64_tr_b16 a[72:73], v225 offset:50304
    v_mfma_f32_16x16x32_bf16 v[56:59], a[76:79], a[56:59], v[56:59]
    ds_read_b64_tr_b16 a[74:75], v225 offset:52096
    v_mfma_f32_16x16x32_bf16 v[52:55], a[76:79], a[52:55], v[52:55]
    v_mfma_f32_16x16x32_bf16 v[48:51], a[76:79], a[48:51], v[48:51]
    s_waitcnt lgkmcnt(10)
    v_mfma_f32_16x16x32_bf16 v[64:67], a[80:83], a[48:51], v[64:67]
    ds_read_b64_tr_b16 a[76:77], v225 offset:36000
    v_mfma_f32_16x16x32_bf16 v[68:71], a[80:83], a[52:55], v[68:71]
    ds_read_b64_tr_b16 a[78:79], v225 offset:37792
    v_mfma_f32_16x16x32_bf16 v[72:75], a[80:83], a[56:59], v[72:75]
    v_mfma_f32_16x16x32_bf16 v[76:79], a[80:83], a[60:63], v[76:79]
    s_waitcnt lgkmcnt(10)
    v_mfma_f32_16x16x32_bf16 v[92:95], a[84:87], a[60:63], v[92:95]
    ds_read_b64_tr_b16 a[80:81], v225 offset:50336
    v_mfma_f32_16x16x32_bf16 v[88:91], a[84:87], a[56:59], v[88:91]
    ds_read_b64_tr_b16 a[82:83], v225 offset:52128
    v_mfma_f32_16x16x32_bf16 v[84:87], a[84:87], a[52:55], v[84:87]
    v_mfma_f32_16x16x32_bf16 v[80:83], a[84:87], a[48:51], v[80:83]
    s_waitcnt lgkmcnt(10)
    v_mfma_f32_16x16x32_bf16 v[96:99], a[88:91], a[48:51], v[96:99]
    ds_read_b64_tr_b16 a[84:85], v225 offset:36032
    v_mfma_f32_16x16x32_bf16 v[100:103], a[88:91], a[52:55], v[100:103]
    ds_read_b64_tr_b16 a[86:87], v225 offset:37824
    s_add_u32 m0, s18, 36864
    v_mfma_f32_16x16x32_bf16 v[104:107], a[88:91], a[56:59], v[104:107]
    buffer_load_dwordx4 v232, s[12:15], s17 offen lds
    v_mfma_f32_16x16x32_bf16 v[108:111], a[88:91], a[60:63], v[108:111]
    s_waitcnt lgkmcnt(10)
    v_mfma_f32_16x16x32_bf16 v[124:127], a[64:67], a[60:63], v[124:127]
    ds_read_b64_tr_b16 a[88:89], v225 offset:50368
    v_mfma_f32_16x16x32_bf16 v[120:123], a[64:67], a[56:59], v[120:123]
    ds_read_b64_tr_b16 a[90:91], v225 offset:52160
    v_mfma_f32_16x16x32_bf16 v[116:119], a[64:67], a[52:55], v[116:119]
    v_mfma_f32_16x16x32_bf16 v[112:115], a[64:67], a[48:51], v[112:115]
    s_waitcnt vmcnt(10) lgkmcnt(10)
    s_barrier
    v_mfma_f32_16x16x32_bf16 v[128:131], a[68:71], a[48:51], v[128:131]
    ds_read_b64_tr_b16 a[64:65], v224 offset:0
    v_mfma_f32_16x16x32_bf16 v[132:135], a[68:71], a[52:55], v[132:135]
    ds_read_b64_tr_b16 a[66:67], v224 offset:1792
    v_mfma_f32_16x16x32_bf16 v[136:139], a[68:71], a[56:59], v[136:139]
    v_mfma_f32_16x16x32_bf16 v[140:143], a[68:71], a[60:63], v[140:143]
    s_waitcnt lgkmcnt(10)
    v_mfma_f32_16x16x32_bf16 v[156:159], a[72:75], a[60:63], v[156:159]
    ds_read_b64_tr_b16 a[68:69], v224 offset:14336
    v_mfma_f32_16x16x32_bf16 v[152:155], a[72:75], a[56:59], v[152:155]
    ds_read_b64_tr_b16 a[70:71], v224 offset:16128
    v_mfma_f32_16x16x32_bf16 v[148:151], a[72:75], a[52:55], v[148:151]
    s_add_u32 s16, s16, 4096
    buffer_load_dwordx4 a[32:35], v227, s[4:7], s16 offen offset:0
    v_mfma_f32_16x16x32_bf16 v[144:147], a[72:75], a[48:51], v[144:147]
    s_waitcnt lgkmcnt(10)
    v_mfma_f32_16x16x32_bf16 v[160:163], a[76:79], a[48:51], v[160:163]
    ds_read_b64_tr_b16 a[72:73], v224 offset:32
    v_mfma_f32_16x16x32_bf16 v[164:167], a[76:79], a[52:55], v[164:167]
    ds_read_b64_tr_b16 a[74:75], v224 offset:1824
    s_add_u32 m0, s18, 38912
    v_mfma_f32_16x16x32_bf16 v[168:171], a[76:79], a[56:59], v[168:171]
    buffer_load_dwordx4 v233, s[12:15], s17 offen lds
    v_mfma_f32_16x16x32_bf16 v[172:175], a[76:79], a[60:63], v[172:175]
    s_waitcnt lgkmcnt(10)
    v_mfma_f32_16x16x32_bf16 v[188:191], a[80:83], a[60:63], v[188:191]
    ds_read_b64_tr_b16 a[76:77], v224 offset:14368
    v_mfma_f32_16x16x32_bf16 v[184:187], a[80:83], a[56:59], v[184:187]
    ds_read_b64_tr_b16 a[78:79], v224 offset:16160
    v_mfma_f32_16x16x32_bf16 v[180:183], a[80:83], a[52:55], v[180:183]
    buffer_load_dwordx4 a[36:39], v227, s[4:7], s16 offen offset:256
    v_mfma_f32_16x16x32_bf16 v[176:179], a[80:83], a[48:51], v[176:179]
    s_waitcnt lgkmcnt(10)
    v_mfma_f32_16x16x32_bf16 v[192:195], a[84:87], a[48:51], v[192:195]
    ds_read_b64_tr_b16 a[80:81], v224 offset:64
    v_mfma_f32_16x16x32_bf16 v[196:199], a[84:87], a[52:55], v[196:199]
    ds_read_b64_tr_b16 a[82:83], v224 offset:1856
    v_mfma_f32_16x16x32_bf16 v[200:203], a[84:87], a[56:59], v[200:203]
    v_mfma_f32_16x16x32_bf16 v[204:207], a[84:87], a[60:63], v[204:207]
    s_waitcnt lgkmcnt(10)
    v_mfma_f32_16x16x32_bf16 v[220:223], a[88:91], a[60:63], v[220:223]
    ds_read_b64_tr_b16 a[84:85], v224 offset:14400
    v_mfma_f32_16x16x32_bf16 v[216:219], a[88:91], a[56:59], v[216:219]
    ds_read_b64_tr_b16 a[86:87], v224 offset:16192
    v_mfma_f32_16x16x32_bf16 v[212:215], a[88:91], a[52:55], v[212:215]
    buffer_load_dwordx4 a[40:43], v227, s[8:11], s16 offen offset:0
    v_mfma_f32_16x16x32_bf16 v[208:211], a[88:91], a[48:51], v[208:211]
    s_cmp_lg_u32 s20, 0
    s_cbranch_scc1 mlp_kernel_loop
    s_waitcnt lgkmcnt(10)
    v_mfma_f32_16x16x32_bf16 v[0:3], a[64:67], a[0:3], v[0:3]
    ds_read_b64_tr_b16 a[88:89], v224 offset:96
    v_mfma_f32_16x16x32_bf16 v[4:7], a[64:67], a[4:7], v[4:7]
    ds_read_b64_tr_b16 a[90:91], v224 offset:1888
    v_lshlrev_b32 v251, 7, v235
    buffer_load_dword a216, v251, s[92:95], s49 offen
    s_add_u32 m0, s18, 40960
    v_mfma_f32_16x16x32_bf16 v[8:11], a[64:67], a[8:11], v[8:11]
    buffer_load_dwordx4 v234, s[12:15], s17 offen lds
    s_waitcnt vmcnt(15)
    v_mfma_f32_16x16x32_bf16 v[12:15], a[64:67], a[12:15], v[12:15]
    s_waitcnt lgkmcnt(10)
    v_mfma_f32_16x16x32_bf16 v[28:31], a[68:71], a[12:15], v[28:31]
    ds_read_b64_tr_b16 a[64:65], v224 offset:14432
    v_mfma_f32_16x16x32_bf16 v[24:27], a[68:71], a[8:11], v[24:27]
    ds_read_b64_tr_b16 a[66:67], v224 offset:16224
    v_mfma_f32_16x16x32_bf16 v[20:23], a[68:71], a[4:7], v[20:23]
    buffer_load_dwordx4 a[44:47], v227, s[8:11], s16 offen offset:256
    v_mfma_f32_16x16x32_bf16 v[16:19], a[68:71], a[0:3], v[16:19]
    buffer_load_dwordx2 a[92:93], v242, s[40:43], s46 offen offset:0
    s_waitcnt lgkmcnt(10)
    v_mfma_f32_16x16x32_bf16 v[32:35], a[72:75], a[0:3], v[32:35]
    ds_read_b64_tr_b16 a[68:69], v224 offset:128
    v_mfma_f32_16x16x32_bf16 v[36:39], a[72:75], a[4:7], v[36:39]
    ds_read_b64_tr_b16 a[70:71], v224 offset:1920
    v_mfma_f32_16x16x32_bf16 v[40:43], a[72:75], a[8:11], v[40:43]
    v_mfma_f32_16x16x32_bf16 v[44:47], a[72:75], a[12:15], v[44:47]
    s_waitcnt lgkmcnt(10)
    v_mfma_f32_16x16x32_bf16 v[60:63], a[76:79], a[12:15], v[60:63]
    ds_read_b64_tr_b16 a[72:73], v224 offset:14464
    v_mfma_f32_16x16x32_bf16 v[56:59], a[76:79], a[8:11], v[56:59]
    ds_read_b64_tr_b16 a[74:75], v224 offset:16256
    v_mfma_f32_16x16x32_bf16 v[52:55], a[76:79], a[4:7], v[52:55]
    v_mfma_f32_16x16x32_bf16 v[48:51], a[76:79], a[0:3], v[48:51]
    buffer_load_dwordx2 a[94:95], v242, s[40:43], s46 offen offset:256
    s_waitcnt lgkmcnt(10)
    v_mfma_f32_16x16x32_bf16 v[64:67], a[80:83], a[0:3], v[64:67]
    ds_read_b64_tr_b16 a[76:77], v224 offset:160
    v_mfma_f32_16x16x32_bf16 v[68:71], a[80:83], a[4:7], v[68:71]
    ds_read_b64_tr_b16 a[78:79], v224 offset:1952
    s_add_u32 m0, s18, 57344
    s_add_u32 s17, s17, 458752
    v_mfma_f32_16x16x32_bf16 v[72:75], a[80:83], a[8:11], v[72:75]
    buffer_load_dwordx4 v228, s[12:15], s17 offen lds
    v_mfma_f32_16x16x32_bf16 v[76:79], a[80:83], a[12:15], v[76:79]
    s_waitcnt lgkmcnt(10)
    v_mfma_f32_16x16x32_bf16 v[92:95], a[84:87], a[12:15], v[92:95]
    ds_read_b64_tr_b16 a[80:81], v224 offset:14496
    v_mfma_f32_16x16x32_bf16 v[88:91], a[84:87], a[8:11], v[88:91]
    ds_read_b64_tr_b16 a[82:83], v224 offset:16288
    v_mfma_f32_16x16x32_bf16 v[84:87], a[84:87], a[4:7], v[84:87]
    v_mfma_f32_16x16x32_bf16 v[80:83], a[84:87], a[0:3], v[80:83]
    buffer_load_dwordx2 a[96:97], v242, s[40:43], s46 offen offset:512
    s_waitcnt lgkmcnt(10)
    v_mfma_f32_16x16x32_bf16 v[96:99], a[88:91], a[0:3], v[96:99]
    ds_read_b64_tr_b16 a[84:85], v224 offset:192
    v_mfma_f32_16x16x32_bf16 v[100:103], a[88:91], a[4:7], v[100:103]
    ds_read_b64_tr_b16 a[86:87], v224 offset:1984
    v_mfma_f32_16x16x32_bf16 v[104:107], a[88:91], a[8:11], v[104:107]
    v_mfma_f32_16x16x32_bf16 v[108:111], a[88:91], a[12:15], v[108:111]
    s_waitcnt lgkmcnt(10)
    v_mfma_f32_16x16x32_bf16 v[124:127], a[64:67], a[12:15], v[124:127]
    ds_read_b64_tr_b16 a[88:89], v224 offset:14528
    v_mfma_f32_16x16x32_bf16 v[120:123], a[64:67], a[8:11], v[120:123]
    ds_read_b64_tr_b16 a[90:91], v224 offset:16320
    v_mfma_f32_16x16x32_bf16 v[116:119], a[64:67], a[4:7], v[116:119]
    v_mfma_f32_16x16x32_bf16 v[112:115], a[64:67], a[0:3], v[112:115]
    buffer_load_dwordx2 a[98:99], v242, s[40:43], s46 offen offset:768
    s_waitcnt lgkmcnt(10)
    v_mfma_f32_16x16x32_bf16 v[128:131], a[68:71], a[0:3], v[128:131]
    ds_read_b64_tr_b16 a[64:65], v224 offset:7168
    v_mfma_f32_16x16x32_bf16 v[132:135], a[68:71], a[4:7], v[132:135]
    ds_read_b64_tr_b16 a[66:67], v224 offset:8960
    s_add_u32 m0, s18, 59392
    v_mfma_f32_16x16x32_bf16 v[136:139], a[68:71], a[8:11], v[136:139]
    buffer_load_dwordx4 v229, s[12:15], s17 offen lds
    v_mfma_f32_16x16x32_bf16 v[140:143], a[68:71], a[12:15], v[140:143]
    s_waitcnt lgkmcnt(10)
    v_mfma_f32_16x16x32_bf16 v[156:159], a[72:75], a[12:15], v[156:159]
    ds_read_b64_tr_b16 a[68:69], v224 offset:21504
    v_mfma_f32_16x16x32_bf16 v[152:155], a[72:75], a[8:11], v[152:155]
    ds_read_b64_tr_b16 a[70:71], v224 offset:23296
    v_mfma_f32_16x16x32_bf16 v[148:151], a[72:75], a[4:7], v[148:151]
    buffer_load_dwordx4 a[48:51], v227, s[4:7], s16 offen offset:2048
    v_mfma_f32_16x16x32_bf16 v[144:147], a[72:75], a[0:3], v[144:147]
    buffer_load_dwordx2 a[100:101], v242, s[40:43], s46 offen offset:1024
    s_waitcnt lgkmcnt(10)
    v_mfma_f32_16x16x32_bf16 v[160:163], a[76:79], a[0:3], v[160:163]
    ds_read_b64_tr_b16 a[72:73], v224 offset:7200
    v_mfma_f32_16x16x32_bf16 v[164:167], a[76:79], a[4:7], v[164:167]
    ds_read_b64_tr_b16 a[74:75], v224 offset:8992
    v_mfma_f32_16x16x32_bf16 v[168:171], a[76:79], a[8:11], v[168:171]
    v_mfma_f32_16x16x32_bf16 v[172:175], a[76:79], a[12:15], v[172:175]
    s_waitcnt lgkmcnt(10)
    v_mfma_f32_16x16x32_bf16 v[188:191], a[80:83], a[12:15], v[188:191]
    ds_read_b64_tr_b16 a[76:77], v224 offset:21536
    v_mfma_f32_16x16x32_bf16 v[184:187], a[80:83], a[8:11], v[184:187]
    ds_read_b64_tr_b16 a[78:79], v224 offset:23328
    v_mfma_f32_16x16x32_bf16 v[180:183], a[80:83], a[4:7], v[180:183]
    buffer_load_dwordx4 a[52:55], v227, s[4:7], s16 offen offset:2304
    v_mfma_f32_16x16x32_bf16 v[176:179], a[80:83], a[0:3], v[176:179]
    buffer_load_dwordx2 a[102:103], v242, s[40:43], s46 offen offset:1280
    s_waitcnt lgkmcnt(10)
    v_mfma_f32_16x16x32_bf16 v[192:195], a[84:87], a[0:3], v[192:195]
    ds_read_b64_tr_b16 a[80:81], v224 offset:7232
    v_mfma_f32_16x16x32_bf16 v[196:199], a[84:87], a[4:7], v[196:199]
    ds_read_b64_tr_b16 a[82:83], v224 offset:9024
    s_add_u32 m0, s18, 61440
    v_mfma_f32_16x16x32_bf16 v[200:203], a[84:87], a[8:11], v[200:203]
    buffer_load_dwordx4 v230, s[12:15], s17 offen lds
    v_mfma_f32_16x16x32_bf16 v[204:207], a[84:87], a[12:15], v[204:207]
    s_waitcnt lgkmcnt(10)
    v_mfma_f32_16x16x32_bf16 v[220:223], a[88:91], a[12:15], v[220:223]
    ds_read_b64_tr_b16 a[84:85], v224 offset:21568
    v_mfma_f32_16x16x32_bf16 v[216:219], a[88:91], a[8:11], v[216:219]
    ds_read_b64_tr_b16 a[86:87], v224 offset:23360
    v_mfma_f32_16x16x32_bf16 v[212:215], a[88:91], a[4:7], v[212:215]
    buffer_load_dwordx4 a[56:59], v227, s[8:11], s16 offen offset:2048
    v_mfma_f32_16x16x32_bf16 v[208:211], a[88:91], a[0:3], v[208:211]
    buffer_load_dwordx2 a[104:105], v242, s[40:43], s46 offen offset:1536
    s_waitcnt vmcnt(26) lgkmcnt(10)
    v_mfma_f32_16x16x32_bf16 v[0:3], a[64:67], a[16:19], v[0:3]
    ds_read_b64_tr_b16 a[88:89], v224 offset:7264
    s_waitcnt vmcnt(25)
    v_mfma_f32_16x16x32_bf16 v[4:7], a[64:67], a[20:23], v[4:7]
    ds_read_b64_tr_b16 a[90:91], v224 offset:9056
    s_waitcnt vmcnt(23)
    v_mfma_f32_16x16x32_bf16 v[8:11], a[64:67], a[24:27], v[8:11]
    s_waitcnt vmcnt(22)
    v_mfma_f32_16x16x32_bf16 v[12:15], a[64:67], a[28:31], v[12:15]
    s_waitcnt lgkmcnt(10)
    v_mfma_f32_16x16x32_bf16 v[28:31], a[68:71], a[28:31], v[28:31]
    ds_read_b64_tr_b16 a[64:65], v224 offset:21600
    v_mfma_f32_16x16x32_bf16 v[24:27], a[68:71], a[24:27], v[24:27]
    ds_read_b64_tr_b16 a[66:67], v224 offset:23392
    v_mfma_f32_16x16x32_bf16 v[20:23], a[68:71], a[20:23], v[20:23]
    buffer_load_dwordx4 a[60:63], v227, s[8:11], s16 offen offset:2304
    v_mfma_f32_16x16x32_bf16 v[16:19], a[68:71], a[16:19], v[16:19]
    buffer_load_dwordx2 a[106:107], v242, s[40:43], s46 offen offset:1792
    s_waitcnt lgkmcnt(10)
    v_mfma_f32_16x16x32_bf16 v[32:35], a[72:75], a[16:19], v[32:35]
    ds_read_b64_tr_b16 a[68:69], v224 offset:7296
    v_mfma_f32_16x16x32_bf16 v[36:39], a[72:75], a[20:23], v[36:39]
    ds_read_b64_tr_b16 a[70:71], v224 offset:9088
    s_add_u32 m0, s18, 63488
    v_mfma_f32_16x16x32_bf16 v[40:43], a[72:75], a[24:27], v[40:43]
    buffer_load_dwordx4 v231, s[12:15], s17 offen lds
    v_mfma_f32_16x16x32_bf16 v[44:47], a[72:75], a[28:31], v[44:47]
    s_waitcnt lgkmcnt(10)
    v_mfma_f32_16x16x32_bf16 v[60:63], a[76:79], a[28:31], v[60:63]
    ds_read_b64_tr_b16 a[72:73], v224 offset:21632
    v_mfma_f32_16x16x32_bf16 v[56:59], a[76:79], a[24:27], v[56:59]
    ds_read_b64_tr_b16 a[74:75], v224 offset:23424
    v_mfma_f32_16x16x32_bf16 v[52:55], a[76:79], a[20:23], v[52:55]
    v_mfma_f32_16x16x32_bf16 v[48:51], a[76:79], a[16:19], v[48:51]
    buffer_load_dwordx2 a[108:109], v242, s[40:43], s46 offen offset:2048
    s_waitcnt vmcnt(16)
    v_accvgpr_read_b32 v244, a92
    s_waitcnt lgkmcnt(10)
    v_mfma_f32_16x16x32_bf16 v[64:67], a[80:83], a[16:19], v[64:67]
    ds_read_b64_tr_b16 a[76:77], v224 offset:7328
    v_mfma_f32_16x16x32_bf16 v[68:71], a[80:83], a[20:23], v[68:71]
    ds_read_b64_tr_b16 a[78:79], v224 offset:9120
    v_mfma_f32_16x16x32_bf16 v[72:75], a[80:83], a[24:27], v[72:75]
    v_accvgpr_read_b32 v245, a93
    v_mfma_f32_16x16x32_bf16 v[76:79], a[80:83], a[28:31], v[76:79]
    s_waitcnt vmcnt(15)
    v_accvgpr_read_b32 v246, a94
    s_waitcnt lgkmcnt(10)
    v_mfma_f32_16x16x32_bf16 v[92:95], a[84:87], a[28:31], v[92:95]
    ds_read_b64_tr_b16 a[80:81], v224 offset:21664
    v_mfma_f32_16x16x32_bf16 v[88:91], a[84:87], a[24:27], v[88:91]
    ds_read_b64_tr_b16 a[82:83], v224 offset:23456
    v_mfma_f32_16x16x32_bf16 v[84:87], a[84:87], a[20:23], v[84:87]
    v_accvgpr_read_b32 v247, a95
    v_mfma_f32_16x16x32_bf16 v[80:83], a[84:87], a[16:19], v[80:83]
    buffer_load_dwordx2 a[110:111], v242, s[40:43], s46 offen offset:2304
    v_add_f32 v244, v244, v246
    s_waitcnt lgkmcnt(10)
    v_mfma_f32_16x16x32_bf16 v[96:99], a[88:91], a[16:19], v[96:99]
    ds_read_b64_tr_b16 a[84:85], v224 offset:7360
    v_mfma_f32_16x16x32_bf16 v[100:103], a[88:91], a[20:23], v[100:103]
    ds_read_b64_tr_b16 a[86:87], v224 offset:9152
    s_add_u32 m0, s18, 65536
    v_mfma_f32_16x16x32_bf16 v[104:107], a[88:91], a[24:27], v[104:107]
    v_add_f32 v245, v245, v247
    buffer_load_dwordx4 v232, s[12:15], s17 offen lds
    v_mfma_f32_16x16x32_bf16 v[108:111], a[88:91], a[28:31], v[108:111]
    s_waitcnt vmcnt(15)
    v_accvgpr_read_b32 v246, a96
    s_waitcnt lgkmcnt(10)
    v_mfma_f32_16x16x32_bf16 v[124:127], a[64:67], a[28:31], v[124:127]
    ds_read_b64_tr_b16 a[88:89], v224 offset:21696
    v_mfma_f32_16x16x32_bf16 v[120:123], a[64:67], a[24:27], v[120:123]
    ds_read_b64_tr_b16 a[90:91], v224 offset:23488
    v_mfma_f32_16x16x32_bf16 v[116:119], a[64:67], a[20:23], v[116:119]
    v_accvgpr_read_b32 v247, a97
    v_mfma_f32_16x16x32_bf16 v[112:115], a[64:67], a[16:19], v[112:115]
    buffer_load_dwordx2 a[112:113], v242, s[40:43], s46 offen offset:2560
    v_add_f32 v244, v244, v246
    s_waitcnt lgkmcnt(10)
    s_barrier
    v_mfma_f32_16x16x32_bf16 v[128:131], a[68:71], a[16:19], v[128:131]
    ds_read_b64_tr_b16 a[64:65], v224 offset:28672
    v_mfma_f32_16x16x32_bf16 v[132:135], a[68:71], a[20:23], v[132:135]
    ds_read_b64_tr_b16 a[66:67], v224 offset:30464
    v_mfma_f32_16x16x32_bf16 v[136:139], a[68:71], a[24:27], v[136:139]
    v_add_f32 v245, v245, v247
    v_mfma_f32_16x16x32_bf16 v[140:143], a[68:71], a[28:31], v[140:143]
    s_waitcnt vmcnt(15)
    v_accvgpr_read_b32 v246, a98
    s_waitcnt lgkmcnt(10)
    v_mfma_f32_16x16x32_bf16 v[156:159], a[72:75], a[28:31], v[156:159]
    ds_read_b64_tr_b16 a[68:69], v224 offset:43008
    v_mfma_f32_16x16x32_bf16 v[152:155], a[72:75], a[24:27], v[152:155]
    ds_read_b64_tr_b16 a[70:71], v224 offset:44800
    v_mfma_f32_16x16x32_bf16 v[148:151], a[72:75], a[20:23], v[148:151]
    v_accvgpr_read_b32 v247, a99
    s_add_u32 s16, s16, 4096
    buffer_load_dwordx4 a[0:3], v227, s[4:7], s16 offen offset:0
    v_mfma_f32_16x16x32_bf16 v[144:147], a[72:75], a[16:19], v[144:147]
    buffer_load_dwordx2 a[114:115], v242, s[40:43], s46 offen offset:2816
    v_add_f32 v244, v244, v246
    s_waitcnt lgkmcnt(10)
    v_mfma_f32_16x16x32_bf16 v[160:163], a[76:79], a[16:19], v[160:163]
    ds_read_b64_tr_b16 a[72:73], v224 offset:28704
    v_mfma_f32_16x16x32_bf16 v[164:167], a[76:79], a[20:23], v[164:167]
    ds_read_b64_tr_b16 a[74:75], v224 offset:30496
    s_add_u32 m0, s18, 67584
    v_mfma_f32_16x16x32_bf16 v[168:171], a[76:79], a[24:27], v[168:171]
    v_add_f32 v245, v245, v247
    buffer_load_dwordx4 v233, s[12:15], s17 offen lds
    v_mfma_f32_16x16x32_bf16 v[172:175], a[76:79], a[28:31], v[172:175]
    s_waitcnt vmcnt(15)
    v_accvgpr_read_b32 v246, a100
    s_waitcnt lgkmcnt(10)
    v_mfma_f32_16x16x32_bf16 v[188:191], a[80:83], a[28:31], v[188:191]
    ds_read_b64_tr_b16 a[76:77], v224 offset:43040
    v_mfma_f32_16x16x32_bf16 v[184:187], a[80:83], a[24:27], v[184:187]
    ds_read_b64_tr_b16 a[78:79], v224 offset:44832
    v_mfma_f32_16x16x32_bf16 v[180:183], a[80:83], a[20:23], v[180:183]
    v_accvgpr_read_b32 v247, a101
    buffer_load_dwordx4 a[4:7], v227, s[4:7], s16 offen offset:256
    v_mfma_f32_16x16x32_bf16 v[176:179], a[80:83], a[16:19], v[176:179]
    buffer_load_dwordx2 a[116:117], v242, s[40:43], s46 offen offset:3072
    v_add_f32 v244, v244, v246
    s_waitcnt lgkmcnt(10)
    v_mfma_f32_16x16x32_bf16 v[192:195], a[84:87], a[16:19], v[192:195]
    ds_read_b64_tr_b16 a[80:81], v224 offset:28736
    v_mfma_f32_16x16x32_bf16 v[196:199], a[84:87], a[20:23], v[196:199]
    ds_read_b64_tr_b16 a[82:83], v224 offset:30528
    v_mfma_f32_16x16x32_bf16 v[200:203], a[84:87], a[24:27], v[200:203]
    v_add_f32 v245, v245, v247
    v_mfma_f32_16x16x32_bf16 v[204:207], a[84:87], a[28:31], v[204:207]
    s_waitcnt vmcnt(15)
    v_accvgpr_read_b32 v246, a102
    s_waitcnt lgkmcnt(10)
    v_mfma_f32_16x16x32_bf16 v[220:223], a[88:91], a[28:31], v[220:223]
    ds_read_b64_tr_b16 a[84:85], v224 offset:43072
    v_mfma_f32_16x16x32_bf16 v[216:219], a[88:91], a[24:27], v[216:219]
    ds_read_b64_tr_b16 a[86:87], v224 offset:44864
    v_mfma_f32_16x16x32_bf16 v[212:215], a[88:91], a[20:23], v[212:215]
    v_accvgpr_read_b32 v247, a103
    buffer_load_dwordx4 a[8:11], v227, s[8:11], s16 offen offset:0
    v_mfma_f32_16x16x32_bf16 v[208:211], a[88:91], a[16:19], v[208:211]
    buffer_load_dwordx2 a[118:119], v242, s[40:43], s46 offen offset:3328
    v_add_f32 v244, v244, v246
mlp_kernel_tailcode:
    s_waitcnt lgkmcnt(10)
    v_mfma_f32_16x16x32_bf16 v[0:3], a[64:67], a[32:35], v[0:3]
    ds_read_b64_tr_b16 a[88:89], v224 offset:28768
    v_mfma_f32_16x16x32_bf16 v[4:7], a[64:67], a[36:39], v[4:7]
    ds_read_b64_tr_b16 a[90:91], v224 offset:30560
    s_add_u32 m0, s18, 69632
    v_mfma_f32_16x16x32_bf16 v[8:11], a[64:67], a[40:43], v[8:11]
    v_add_f32 v245, v245, v247
    buffer_load_dwordx4 v234, s[12:15], s17 offen lds
    v_mfma_f32_16x16x32_bf16 v[12:15], a[64:67], a[44:47], v[12:15]
    s_waitcnt vmcnt(15)
    v_accvgpr_read_b32 v246, a104
    s_waitcnt lgkmcnt(10)
    v_mfma_f32_16x16x32_bf16 v[28:31], a[68:71], a[44:47], v[28:31]
    ds_read_b64_tr_b16 a[64:65], v224 offset:43104
    v_mfma_f32_16x16x32_bf16 v[24:27], a[68:71], a[40:43], v[24:27]
    ds_read_b64_tr_b16 a[66:67], v224 offset:44896
    v_mfma_f32_16x16x32_bf16 v[20:23], a[68:71], a[36:39], v[20:23]
    v_accvgpr_read_b32 v247, a105
    buffer_load_dwordx4 a[12:15], v227, s[8:11], s16 offen offset:256
    v_mfma_f32_16x16x32_bf16 v[16:19], a[68:71], a[32:35], v[16:19]
    buffer_load_dwordx2 a[120:121], v242, s[40:43], s46 offen offset:3584
    v_add_f32 v244, v244, v246
    s_waitcnt lgkmcnt(10)
    v_mfma_f32_16x16x32_bf16 v[32:35], a[72:75], a[32:35], v[32:35]
    ds_read_b64_tr_b16 a[68:69], v224 offset:28800
    v_mfma_f32_16x16x32_bf16 v[36:39], a[72:75], a[36:39], v[36:39]
    ds_read_b64_tr_b16 a[70:71], v224 offset:30592
    v_mfma_f32_16x16x32_bf16 v[40:43], a[72:75], a[40:43], v[40:43]
    v_add_f32 v245, v245, v247
    v_mfma_f32_16x16x32_bf16 v[44:47], a[72:75], a[44:47], v[44:47]
    s_waitcnt vmcnt(15)
    v_accvgpr_read_b32 v246, a106
    s_waitcnt lgkmcnt(10)
    v_mfma_f32_16x16x32_bf16 v[60:63], a[76:79], a[44:47], v[60:63]
    ds_read_b64_tr_b16 a[72:73], v224 offset:43136
    v_mfma_f32_16x16x32_bf16 v[56:59], a[76:79], a[40:43], v[56:59]
    ds_read_b64_tr_b16 a[74:75], v224 offset:44928
    v_mfma_f32_16x16x32_bf16 v[52:55], a[76:79], a[36:39], v[52:55]
    v_accvgpr_read_b32 v247, a107
    v_mfma_f32_16x16x32_bf16 v[48:51], a[76:79], a[32:35], v[48:51]
    buffer_load_dwordx2 a[122:123], v242, s[40:43], s46 offen offset:3840
    v_add_f32 v244, v244, v246
    s_waitcnt lgkmcnt(10)
    v_mfma_f32_16x16x32_bf16 v[64:67], a[80:83], a[32:35], v[64:67]
    ds_read_b64_tr_b16 a[76:77], v224 offset:28832
    v_mfma_f32_16x16x32_bf16 v[68:71], a[80:83], a[36:39], v[68:71]
    ds_read_b64_tr_b16 a[78:79], v224 offset:30624
    s_add_u32 m0, s18, 86016
    s_add_u32 s17, s17, 458752
    v_mfma_f32_16x16x32_bf16 v[72:75], a[80:83], a[40:43], v[72:75]
    v_add_f32 v245, v245, v247
    buffer_load_dwordx4 v228, s[12:15], s17 offen lds
    v_mfma_f32_16x16x32_bf16 v[76:79], a[80:83], a[44:47], v[76:79]
    s_waitcnt vmcnt(15)
    v_accvgpr_read_b32 v246, a108
    s_waitcnt lgkmcnt(10)
    v_mfma_f32_16x16x32_bf16 v[92:95], a[84:87], a[44:47], v[92:95]
    ds_read_b64_tr_b16 a[80:81], v224 offset:43168
    v_mfma_f32_16x16x32_bf16 v[88:91], a[84:87], a[40:43], v[88:91]
    ds_read_b64_tr_b16 a[82:83], v224 offset:44960
    v_mfma_f32_16x16x32_bf16 v[84:87], a[84:87], a[36:39], v[84:87]
    v_accvgpr_read_b32 v247, a109
    v_mfma_f32_16x16x32_bf16 v[80:83], a[84:87], a[32:35], v[80:83]
    buffer_load_dwordx4 a[124:127], v243, s[36:39], s48 offen offset:0
    v_add_f32 v244, v244, v246
    s_waitcnt lgkmcnt(10)
    v_mfma_f32_16x16x32_bf16 v[96:99], a[88:91], a[32:35], v[96:99]
    ds_read_b64_tr_b16 a[84:85], v224 offset:28864
    v_mfma_f32_16x16x32_bf16 v[100:103], a[88:91], a[36:39], v[100:103]
    ds_read_b64_tr_b16 a[86:87], v224 offset:30656
    v_mfma_f32_16x16x32_bf16 v[104:107], a[88:91], a[40:43], v[104:107]
    v_add_f32 v245, v245, v247
    v_mfma_f32_16x16x32_bf16 v[108:111], a[88:91], a[44:47], v[108:111]
    s_waitcnt vmcnt(15)
    v_accvgpr_read_b32 v246, a110
    s_waitcnt lgkmcnt(10)
    v_mfma_f32_16x16x32_bf16 v[124:127], a[64:67], a[44:47], v[124:127]
    ds_read_b64_tr_b16 a[88:89], v224 offset:43200
    v_mfma_f32_16x16x32_bf16 v[120:123], a[64:67], a[40:43], v[120:123]
    ds_read_b64_tr_b16 a[90:91], v224 offset:44992
    v_mfma_f32_16x16x32_bf16 v[116:119], a[64:67], a[36:39], v[116:119]
    v_accvgpr_read_b32 v247, a111
    v_mfma_f32_16x16x32_bf16 v[112:115], a[64:67], a[32:35], v[112:115]
    buffer_load_dwordx4 a[128:131], v243, s[36:39], s48 offen offset:512
    v_add_f32 v244, v244, v246
    s_waitcnt lgkmcnt(10)
    v_mfma_f32_16x16x32_bf16 v[128:131], a[68:71], a[32:35], v[128:131]
    ds_read_b64_tr_b16 a[64:65], v224 offset:35840
    v_mfma_f32_16x16x32_bf16 v[132:135], a[68:71], a[36:39], v[132:135]
    ds_read_b64_tr_b16 a[66:67], v224 offset:37632
    s_add_u32 m0, s18, 88064
    v_mfma_f32_16x16x32_bf16 v[136:139], a[68:71], a[40:43], v[136:139]
    v_add_f32 v245, v245, v247
    buffer_load_dwordx4 v229, s[12:15], s17 offen lds
    v_mfma_f32_16x16x32_bf16 v[140:143], a[68:71], a[44:47], v[140:143]
    s_waitcnt vmcnt(15)
    v_accvgpr_read_b32 v246, a112
    s_waitcnt lgkmcnt(10)
    v_mfma_f32_16x16x32_bf16 v[156:159], a[72:75], a[44:47], v[156:159]
    ds_read_b64_tr_b16 a[68:69], v224 offset:50176
    v_mfma_f32_16x16x32_bf16 v[152:155], a[72:75], a[40:43], v[152:155]
    ds_read_b64_tr_b16 a[70:71], v224 offset:51968
    v_mfma_f32_16x16x32_bf16 v[148:151], a[72:75], a[36:39], v[148:151]
    v_accvgpr_read_b32 v247, a113
    buffer_load_dwordx4 a[16:19], v227, s[4:7], s16 offen offset:2048
    v_mfma_f32_16x16x32_bf16 v[144:147], a[72:75], a[32:35], v[144:147]
    buffer_load_dwordx4 a[132:135], v243, s[36:39], s48 offen offset:1024
    v_add_f32 v244, v244, v246
    s_waitcnt lgkmcnt(10)
    v_mfma_f32_16x16x32_bf16 v[160:163], a[76:79], a[32:35], v[160:163]
    ds_read_b64_tr_b16 a[72:73], v224 offset:35872
    v_mfma_f32_16x16x32_bf16 v[164:167], a[76:79], a[36:39], v[164:167]
    ds_read_b64_tr_b16 a[74:75], v224 offset:37664
    v_mfma_f32_16x16x32_bf16 v[168:171], a[76:79], a[40:43], v[168:171]
    v_add_f32 v245, v245, v247
    v_mfma_f32_16x16x32_bf16 v[172:175], a[76:79], a[44:47], v[172:175]
    s_waitcnt vmcnt(15)
    v_accvgpr_read_b32 v246, a114
    s_waitcnt lgkmcnt(10)
    v_mfma_f32_16x16x32_bf16 v[188:191], a[80:83], a[44:47], v[188:191]
    ds_read_b64_tr_b16 a[76:77], v224 offset:50208
    v_mfma_f32_16x16x32_bf16 v[184:187], a[80:83], a[40:43], v[184:187]
    ds_read_b64_tr_b16 a[78:79], v224 offset:52000
    v_mfma_f32_16x16x32_bf16 v[180:183], a[80:83], a[36:39], v[180:183]
    v_accvgpr_read_b32 v247, a115
    buffer_load_dwordx4 a[20:23], v227, s[4:7], s16 offen offset:2304
    v_mfma_f32_16x16x32_bf16 v[176:179], a[80:83], a[32:35], v[176:179]
    buffer_load_dwordx4 a[136:139], v243, s[36:39], s48 offen offset:1536
    v_add_f32 v244, v244, v246
    s_waitcnt lgkmcnt(10)
    v_mfma_f32_16x16x32_bf16 v[192:195], a[84:87], a[32:35], v[192:195]
    ds_read_b64_tr_b16 a[80:81], v224 offset:35904
    v_mfma_f32_16x16x32_bf16 v[196:199], a[84:87], a[36:39], v[196:199]
    ds_read_b64_tr_b16 a[82:83], v224 offset:37696
    s_add_u32 m0, s18, 90112
    v_mfma_f32_16x16x32_bf16 v[200:203], a[84:87], a[40:43], v[200:203]
    v_add_f32 v245, v245, v247
    buffer_load_dwordx4 v230, s[12:15], s17 offen lds
    v_mfma_f32_16x16x32_bf16 v[204:207], a[84:87], a[44:47], v[204:207]
    s_waitcnt vmcnt(15)
    v_accvgpr_read_b32 v246, a116
    s_waitcnt lgkmcnt(10)
    v_mfma_f32_16x16x32_bf16 v[220:223], a[88:91], a[44:47], v[220:223]
    ds_read_b64_tr_b16 a[84:85], v224 offset:50240
    v_mfma_f32_16x16x32_bf16 v[216:219], a[88:91], a[40:43], v[216:219]
    ds_read_b64_tr_b16 a[86:87], v224 offset:52032
    v_mfma_f32_16x16x32_bf16 v[212:215], a[88:91], a[36:39], v[212:215]
    v_accvgpr_read_b32 v247, a117
    buffer_load_dwordx4 a[24:27], v227, s[8:11], s16 offen offset:2048
    v_mfma_f32_16x16x32_bf16 v[208:211], a[88:91], a[32:35], v[208:211]
    buffer_load_dwordx4 a[140:143], v243, s[36:39], s48 offen offset:2048
    v_add_f32 v244, v244, v246
    s_waitcnt lgkmcnt(10)
    v_mfma_f32_16x16x32_bf16 v[0:3], a[64:67], a[48:51], v[0:3]
    ds_read_b64_tr_b16 a[88:89], v224 offset:35936
    v_mfma_f32_16x16x32_bf16 v[4:7], a[64:67], a[52:55], v[4:7]
    ds_read_b64_tr_b16 a[90:91], v224 offset:37728
    v_mfma_f32_16x16x32_bf16 v[8:11], a[64:67], a[56:59], v[8:11]
    v_add_f32 v245, v245, v247
    v_mfma_f32_16x16x32_bf16 v[12:15], a[64:67], a[60:63], v[12:15]
    s_waitcnt vmcnt(15)
    v_accvgpr_read_b32 v246, a118
    s_waitcnt lgkmcnt(10)
    v_mfma_f32_16x16x32_bf16 v[28:31], a[68:71], a[60:63], v[28:31]
    ds_read_b64_tr_b16 a[64:65], v224 offset:50272
    v_mfma_f32_16x16x32_bf16 v[24:27], a[68:71], a[56:59], v[24:27]
    ds_read_b64_tr_b16 a[66:67], v224 offset:52064
    v_mfma_f32_16x16x32_bf16 v[20:23], a[68:71], a[52:55], v[20:23]
    v_accvgpr_read_b32 v247, a119
    buffer_load_dwordx4 a[28:31], v227, s[8:11], s16 offen offset:2304
    v_mfma_f32_16x16x32_bf16 v[16:19], a[68:71], a[48:51], v[16:19]
    buffer_load_dwordx4 a[144:147], v243, s[36:39], s48 offen offset:2560
    v_add_f32 v244, v244, v246
    s_waitcnt lgkmcnt(10)
    v_mfma_f32_16x16x32_bf16 v[32:35], a[72:75], a[48:51], v[32:35]
    ds_read_b64_tr_b16 a[68:69], v224 offset:35968
    v_mfma_f32_16x16x32_bf16 v[36:39], a[72:75], a[52:55], v[36:39]
    ds_read_b64_tr_b16 a[70:71], v224 offset:37760
    s_add_u32 m0, s18, 92160
    v_mfma_f32_16x16x32_bf16 v[40:43], a[72:75], a[56:59], v[40:43]
    v_add_f32 v245, v245, v247
    buffer_load_dwordx4 v231, s[12:15], s17 offen lds
    v_mfma_f32_16x16x32_bf16 v[44:47], a[72:75], a[60:63], v[44:47]
    s_waitcnt vmcnt(15)
    v_accvgpr_read_b32 v246, a120
    s_waitcnt lgkmcnt(10)
    v_mfma_f32_16x16x32_bf16 v[60:63], a[76:79], a[60:63], v[60:63]
    ds_read_b64_tr_b16 a[72:73], v224 offset:50304
    v_mfma_f32_16x16x32_bf16 v[56:59], a[76:79], a[56:59], v[56:59]
    ds_read_b64_tr_b16 a[74:75], v224 offset:52096
    v_mfma_f32_16x16x32_bf16 v[52:55], a[76:79], a[52:55], v[52:55]
    v_accvgpr_read_b32 v247, a121
    v_mfma_f32_16x16x32_bf16 v[48:51], a[76:79], a[48:51], v[48:51]
    buffer_load_dwordx4 a[148:151], v243, s[36:39], s48 offen offset:3072
    v_add_f32 v244, v244, v246
    s_waitcnt lgkmcnt(10)
    v_mfma_f32_16x16x32_bf16 v[64:67], a[80:83], a[48:51], v[64:67]
    ds_read_b64_tr_b16 a[76:77], v224 offset:36000
    v_mfma_f32_16x16x32_bf16 v[68:71], a[80:83], a[52:55], v[68:71]
    ds_read_b64_tr_b16 a[78:79], v224 offset:37792
    v_mfma_f32_16x16x32_bf16 v[72:75], a[80:83], a[56:59], v[72:75]
    v_add_f32 v245, v245, v247
    v_mfma_f32_16x16x32_bf16 v[76:79], a[80:83], a[60:63], v[76:79]
    s_waitcnt vmcnt(15)
    v_accvgpr_read_b32 v246, a122
    s_waitcnt lgkmcnt(10)
    v_mfma_f32_16x16x32_bf16 v[92:95], a[84:87], a[60:63], v[92:95]
    ds_read_b64_tr_b16 a[80:81], v224 offset:50336
    v_mfma_f32_16x16x32_bf16 v[88:91], a[84:87], a[56:59], v[88:91]
    ds_read_b64_tr_b16 a[82:83], v224 offset:52128
    v_mfma_f32_16x16x32_bf16 v[84:87], a[84:87], a[52:55], v[84:87]
    v_accvgpr_read_b32 v247, a123
    v_mfma_f32_16x16x32_bf16 v[80:83], a[84:87], a[48:51], v[80:83]
    v_add_f32 v244, v244, v246
    s_waitcnt lgkmcnt(10)
    v_mfma_f32_16x16x32_bf16 v[96:99], a[88:91], a[48:51], v[96:99]
    ds_read_b64_tr_b16 a[84:85], v224 offset:36032
    v_mfma_f32_16x16x32_bf16 v[100:103], a[88:91], a[52:55], v[100:103]
    ds_read_b64_tr_b16 a[86:87], v224 offset:37824
    s_add_u32 m0, s18, 94208
    v_mfma_f32_16x16x32_bf16 v[104:107], a[88:91], a[56:59], v[104:107]
    v_add_f32 v245, v245, v247
    buffer_load_dwordx4 v232, s[12:15], s17 offen lds
    v_mfma_f32_16x16x32_bf16 v[108:111], a[88:91], a[60:63], v[108:111]
    v_mul_f32 v244, 0xba800000, v244
    s_waitcnt lgkmcnt(10)
    v_mfma_f32_16x16x32_bf16 v[124:127], a[64:67], a[60:63], v[124:127]
    ds_read_b64_tr_b16 a[88:89], v224 offset:50368
    v_mfma_f32_16x16x32_bf16 v[120:123], a[64:67], a[56:59], v[120:123]
    ds_read_b64_tr_b16 a[90:91], v224 offset:52160
    v_mfma_f32_16x16x32_bf16 v[116:119], a[64:67], a[52:55], v[116:119]
    v_mul_f32 v245, 0x3a800000, v245
    v_mfma_f32_16x16x32_bf16 v[112:115], a[64:67], a[48:51], v[112:115]
    v_fma_f32 v245, -v244, v244, v245
    s_waitcnt lgkmcnt(10)
    s_barrier
    v_mfma_f32_16x16x32_bf16 v[128:131], a[68:71], a[48:51], v[128:131]
    ds_read_b64_tr_b16 a[64:65], v225 offset:0
    v_mfma_f32_16x16x32_bf16 v[132:135], a[68:71], a[52:55], v[132:135]
    ds_read_b64_tr_b16 a[66:67], v225 offset:1792
    v_mfma_f32_16x16x32_bf16 v[136:139], a[68:71], a[56:59], v[136:139]
    v_max_f32 v245, 0, v245
    v_mfma_f32_16x16x32_bf16 v[140:143], a[68:71], a[60:63], v[140:143]
    v_cvt_pk_bf16_f32 v245, v245, v245
    s_waitcnt lgkmcnt(10)
    v_mfma_f32_16x16x32_bf16 v[156:159], a[72:75], a[60:63], v[156:159]
    ds_read_b64_tr_b16 a[68:69], v225 offset:14336
    v_mfma_f32_16x16x32_bf16 v[152:155], a[72:75], a[56:59], v[152:155]
    ds_read_b64_tr_b16 a[70:71], v225 offset:16128
    v_mfma_f32_16x16x32_bf16 v[148:151], a[72:75], a[52:55], v[148:151]
    v_and_b32 v245, s19, v245
    s_add_u32 s16, s16, 4096
    buffer_load_dwordx4 a[32:35], v227, s[4:7], s16 offen offset:0
    v_mfma_f32_16x16x32_bf16 v[144:147], a[72:75], a[48:51], v[144:147]
    v_add_f32 v245, 0x3727c5ac, v245
    s_waitcnt lgkmcnt(10)
    v_mfma_f32_16x16x32_bf16 v[160:163], a[76:79], a[48:51], v[160:163]
    ds_read_b64_tr_b16 a[72:73], v225 offset:32
    v_mfma_f32_16x16x32_bf16 v[164:167], a[76:79], a[52:55], v[164:167]
    ds_read_b64_tr_b16 a[74:75], v225 offset:1824
    s_add_u32 m0, s18, 96256
    v_mfma_f32_16x16x32_bf16 v[168:171], a[76:79], a[56:59], v[168:171]
    v_cvt_pk_bf16_f32 v245, v245, v245
    buffer_load_dwordx4 v233, s[12:15], s17 offen lds
    v_mfma_f32_16x16x32_bf16 v[172:175], a[76:79], a[60:63], v[172:175]
    v_and_b32 v245, s19, v245
    s_waitcnt lgkmcnt(10)
    v_mfma_f32_16x16x32_bf16 v[188:191], a[80:83], a[60:63], v[188:191]
    ds_read_b64_tr_b16 a[76:77], v225 offset:14368
    v_mfma_f32_16x16x32_bf16 v[184:187], a[80:83], a[56:59], v[184:187]
    ds_read_b64_tr_b16 a[78:79], v225 offset:16160
    v_mfma_f32_16x16x32_bf16 v[180:183], a[80:83], a[52:55], v[180:183]
    v_sqrt_f32 v245, v245
    buffer_load_dwordx4 a[36:39], v227, s[4:7], s16 offen offset:256
    v_mfma_f32_16x16x32_bf16 v[176:179], a[80:83], a[48:51], v[176:179]
    v_cvt_pk_bf16_f32 v237, v245, v245
    s_waitcnt lgkmcnt(10)
    v_mfma_f32_16x16x32_bf16 v[192:195], a[84:87], a[48:51], v[192:195]
    ds_read_b64_tr_b16 a[80:81], v225 offset:64
    v_mfma_f32_16x16x32_bf16 v[196:199], a[84:87], a[52:55], v[196:199]
    ds_read_b64_tr_b16 a[82:83], v225 offset:1856
    v_mfma_f32_16x16x32_bf16 v[200:203], a[84:87], a[56:59], v[200:203]
    v_and_b32 v237, s19, v237
    v_mfma_f32_16x16x32_bf16 v[204:207], a[84:87], a[60:63], v[204:207]
    v_rcp_f32 v236, v237
    s_waitcnt lgkmcnt(10)
    v_mfma_f32_16x16x32_bf16 v[220:223], a[88:91], a[60:63], v[220:223]
    ds_read_b64_tr_b16 a[84:85], v225 offset:14400
    v_mfma_f32_16x16x32_bf16 v[216:219], a[88:91], a[56:59], v[216:219]
    ds_read_b64_tr_b16 a[86:87], v225 offset:16192
    v_mfma_f32_16x16x32_bf16 v[212:215], a[88:91], a[52:55], v[212:215]
    v_cvt_pk_bf16_f32 v248, v244, v244
    buffer_load_dwordx4 a[40:43], v227, s[8:11], s16 offen offset:0
    v_mfma_f32_16x16x32_bf16 v[208:211], a[88:91], a[48:51], v[208:211]
    v_and_b32 v248, s19, v248
    s_waitcnt lgkmcnt(10)
    v_mfma_f32_16x16x32_bf16 v[0:3], a[64:67], a[0:3], v[0:3]
    ds_read_b64_tr_b16 a[88:89], v225 offset:96
    v_mfma_f32_16x16x32_bf16 v[4:7], a[64:67], a[4:7], v[4:7]
    ds_read_b64_tr_b16 a[90:91], v225 offset:1888
    s_add_u32 m0, s18, 98304
    v_mfma_f32_16x16x32_bf16 v[8:11], a[64:67], a[8:11], v[8:11]
    v_sub_f32 v249, v244, v248
    buffer_load_dwordx4 v234, s[12:15], s17 offen lds
    v_mfma_f32_16x16x32_bf16 v[12:15], a[64:67], a[12:15], v[12:15]
    v_cvt_pk_bf16_f32 v250, v249, v249
    s_lshl_b32 s18, s21, 11
    s_waitcnt lgkmcnt(10)
    v_mfma_f32_16x16x32_bf16 v[28:31], a[68:71], a[12:15], v[28:31]
    ds_read_b64_tr_b16 a[64:65], v225 offset:14432
    v_mfma_f32_16x16x32_bf16 v[24:27], a[68:71], a[8:11], v[24:27]
    ds_read_b64_tr_b16 a[66:67], v225 offset:16224
    v_mfma_f32_16x16x32_bf16 v[20:23], a[68:71], a[4:7], v[20:23]
    v_and_b32 v250, s19, v250
    buffer_load_dwordx4 a[44:47], v227, s[8:11], s16 offen offset:256
    v_mfma_f32_16x16x32_bf16 v[16:19], a[68:71], a[0:3], v[16:19]
    v_sub_f32 v251, v249, v250
    s_waitcnt lgkmcnt(10)
    v_mfma_f32_16x16x32_bf16 v[32:35], a[72:75], a[0:3], v[32:35]
    ds_read_b64_tr_b16 a[68:69], v225 offset:128
    v_mfma_f32_16x16x32_bf16 v[36:39], a[72:75], a[4:7], v[36:39]
    ds_read_b64_tr_b16 a[70:71], v225 offset:1920
    s_add_u32 m0, s18, 114688
    v_mfma_f32_16x16x32_bf16 v[40:43], a[72:75], a[8:11], v[40:43]
    v_cvt_pk_bf16_f32 v244, v248, v250
    buffer_load_dwordx4 v226, s[56:59], s54 offen offset:0 lds
    v_mfma_f32_16x16x32_bf16 v[44:47], a[72:75], a[12:15], v[44:47]
    v_cvt_pk_bf16_f32 v246, v248, v251
    s_waitcnt lgkmcnt(10)
    v_mfma_f32_16x16x32_bf16 v[60:63], a[76:79], a[12:15], v[60:63]
    ds_read_b64_tr_b16 a[72:73], v225 offset:14464
    v_mfma_f32_16x16x32_bf16 v[56:59], a[76:79], a[8:11], v[56:59]
    ds_read_b64_tr_b16 a[74:75], v225 offset:16256
    v_mfma_f32_16x16x32_bf16 v[52:55], a[76:79], a[4:7], v[52:55]
    v_mul_f32 v236, 0xbfb8aa3b, v236
    v_mfma_f32_16x16x32_bf16 v[48:51], a[76:79], a[0:3], v[48:51]
    v_mov_b32 v241, v237
    s_waitcnt lgkmcnt(10)
    v_mfma_f32_16x16x32_bf16 v[64:67], a[80:83], a[0:3], v[64:67]
    ds_read_b64_tr_b16 a[76:77], v225 offset:160
    v_mfma_f32_16x16x32_bf16 v[68:71], a[80:83], a[4:7], v[68:71]
    ds_read_b64_tr_b16 a[78:79], v225 offset:1952
    v_mfma_f32_16x16x32_bf16 v[72:75], a[80:83], a[8:11], v[72:75]
    v_mov_b32 v245, v244
    buffer_load_dwordx4 v226, s[56:59], s54 offen offset:1024 lds
    v_mfma_f32_16x16x32_bf16 v[76:79], a[80:83], a[12:15], v[76:79]
    v_mov_b32 v247, v246
    s_waitcnt lgkmcnt(10)
    v_mfma_f32_16x16x32_bf16 v[92:95], a[84:87], a[12:15], v[92:95]
    ds_read_b64_tr_b16 a[80:81], v225 offset:14496
    v_mfma_f32_16x16x32_bf16 v[88:91], a[84:87], a[8:11], v[88:91]
    ds_read_b64_tr_b16 a[82:83], v225 offset:16288
    v_mfma_f32_16x16x32_bf16 v[84:87], a[84:87], a[4:7], v[84:87]
    v_mov_b32 v240, v236
    v_mfma_f32_16x16x32_bf16 v[80:83], a[84:87], a[0:3], v[80:83]
    v_permlane32_swap_b32 v237, v241
    s_waitcnt lgkmcnt(10)
    v_mfma_f32_16x16x32_bf16 v[96:99], a[88:91], a[0:3], v[96:99]
    ds_read_b64_tr_b16 a[84:85], v225 offset:192
    v_mfma_f32_16x16x32_bf16 v[100:103], a[88:91], a[4:7], v[100:103]
    ds_read_b64_tr_b16 a[86:87], v225 offset:1984
    s_add_u32 m0, s18, 122880
    s_add_u32 s54, s54, 8192
    v_mfma_f32_16x16x32_bf16 v[104:107], a[88:91], a[8:11], v[104:107]
    v_permlane16_swap_b32 v244, v245
    buffer_load_dwordx4 v226, s[56:59], s54 offen offset:0 lds
    v_mfma_f32_16x16x32_bf16 v[108:111], a[88:91], a[12:15], v[108:111]
    v_permlane16_swap_b32 v246, v247
    s_waitcnt lgkmcnt(10)
    v_mfma_f32_16x16x32_bf16 v[124:127], a[64:67], a[12:15], v[124:127]
    ds_read_b64_tr_b16 a[88:89], v225 offset:14528
    v_mfma_f32_16x16x32_bf16 v[120:123], a[64:67], a[8:11], v[120:123]
    ds_read_b64_tr_b16 a[90:91], v225 offset:16320
    v_mfma_f32_16x16x32_bf16 v[116:119], a[64:67], a[4:7], v[116:119]
    v_permlane32_swap_b32 v236, v240
    v_mfma_f32_16x16x32_bf16 v[112:115], a[64:67], a[0:3], v[112:115]
    s_waitcnt vmcnt(10)
    v_mov_b32 v239, v237
    s_waitcnt lgkmcnt(10)
    v_mfma_f32_16x16x32_bf16 v[128:131], a[68:71], a[0:3], v[128:131]
    ds_read_b64_tr_b16 a[64:65], v225 offset:7168
    v_mfma_f32_16x16x32_bf16 v[132:135], a[68:71], a[4:7], v[132:135]
    ds_read_b64_tr_b16 a[66:67], v225 offset:8960
    v_mfma_f32_16x16x32_bf16 v[136:139], a[68:71], a[8:11], v[136:139]
    v_mov_b32 v243, v241
    buffer_load_dwordx4 v226, s[56:59], s54 offen offset:1024 lds
    v_mfma_f32_16x16x32_bf16 v[140:143], a[68:71], a[12:15], v[140:143]
    v_mov_b32 v238, v236
    s_waitcnt lgkmcnt(10)
    v_mfma_f32_16x16x32_bf16 v[156:159], a[72:75], a[12:15], v[156:159]
    ds_read_b64_tr_b16 a[68:69], v225 offset:21504
    v_mfma_f32_16x16x32_bf16 v[152:155], a[72:75], a[8:11], v[152:155]
    ds_read_b64_tr_b16 a[70:71], v225 offset:23296
    v_mfma_f32_16x16x32_bf16 v[148:151], a[72:75], a[4:7], v[148:151]
    v_mov_b32 v242, v240
    buffer_load_dwordx4 a[48:51], v227, s[4:7], s16 offen offset:2048
    v_mfma_f32_16x16x32_bf16 v[144:147], a[72:75], a[0:3], v[144:147]
    v_permlane16_swap_b32 v237, v239
    s_waitcnt lgkmcnt(10)
    v_mfma_f32_16x16x32_bf16 v[160:163], a[76:79], a[0:3], v[160:163]
    ds_read_b64_tr_b16 a[72:73], v225 offset:7200
    v_mfma_f32_16x16x32_bf16 v[164:167], a[76:79], a[4:7], v[164:167]
    ds_read_b64_tr_b16 a[74:75], v225 offset:8992
    s_add_u32 m0, s18, 131072
    s_add_u32 s54, s54, 8192
    v_mfma_f32_16x16x32_bf16 v[168:171], a[76:79], a[8:11], v[168:171]
    v_permlane16_swap_b32 v241, v243
    buffer_load_dwordx4 v226, s[56:59], s54 offen offset:0 lds
    v_mfma_f32_16x16x32_bf16 v[172:175], a[76:79], a[12:15], v[172:175]
    v_permlane16_swap_b32 v236, v238
    s_waitcnt lgkmcnt(10)
    v_mfma_f32_16x16x32_bf16 v[188:191], a[80:83], a[12:15], v[188:191]
    ds_read_b64_tr_b16 a[76:77], v225 offset:21536
    v_mfma_f32_16x16x32_bf16 v[184:187], a[80:83], a[8:11], v[184:187]
    ds_read_b64_tr_b16 a[78:79], v225 offset:23328
    v_mfma_f32_16x16x32_bf16 v[180:183], a[80:83], a[4:7], v[180:183]
    v_permlane16_swap_b32 v240, v242
    buffer_load_dwordx4 a[52:55], v227, s[4:7], s16 offen offset:2304
    v_mfma_f32_16x16x32_bf16 v[176:179], a[80:83], a[0:3], v[176:179]
    s_mov_b32 exec_lo, 0xffff
    s_mov_b32 exec_hi, 0x0
    v_accvgpr_write_b32 a152, v244
    v_accvgpr_write_b32 a153, v244
    v_accvgpr_write_b32 a154, v246
    s_mov_b64 exec, -1
    s_waitcnt lgkmcnt(10)
    v_mfma_f32_16x16x32_bf16 v[192:195], a[84:87], a[0:3], v[192:195]
    ds_read_b64_tr_b16 a[80:81], v225 offset:7232
    v_mfma_f32_16x16x32_bf16 v[196:199], a[84:87], a[4:7], v[196:199]
    ds_read_b64_tr_b16 a[82:83], v225 offset:9024
    v_mfma_f32_16x16x32_bf16 v[200:203], a[84:87], a[8:11], v[200:203]
    s_mov_b32 exec_lo, 0xffff
    s_mov_b32 exec_hi, 0x0
    v_accvgpr_write_b32 a156, v245
    v_accvgpr_write_b32 a157, v245
    v_accvgpr_write_b32 a158, v247
    s_mov_b64 exec, -1
    buffer_load_dwordx4 v226, s[56:59], s54 offen offset:1024 lds
    v_mfma_f32_16x16x32_bf16 v[204:207], a[84:87], a[12:15], v[204:207]
    s_mov_b32 exec_lo, 0xffff0000
    s_mov_b32 exec_hi, 0x0
    v_accvgpr_write_b32 a168, v244
    v_accvgpr_write_b32 a169, v244
    v_accvgpr_write_b32 a170, v246
    s_mov_b64 exec, -1
    s_waitcnt lgkmcnt(10)
    v_mfma_f32_16x16x32_bf16 v[220:223], a[88:91], a[12:15], v[220:223]
    ds_read_b64_tr_b16 a[84:85], v225 offset:21568
    v_mfma_f32_16x16x32_bf16 v[216:219], a[88:91], a[8:11], v[216:219]
    ds_read_b64_tr_b16 a[86:87], v225 offset:23360
    v_mfma_f32_16x16x32_bf16 v[212:215], a[88:91], a[4:7], v[212:215]
    s_mov_b32 exec_lo, 0xffff0000
    s_mov_b32 exec_hi, 0x0
    v_accvgpr_write_b32 a172, v245
    v_accvgpr_write_b32 a173, v245
    v_accvgpr_write_b32 a174, v247
    s_mov_b64 exec, -1
    buffer_load_dwordx4 a[56:59], v227, s[8:11], s16 offen offset:2048
    v_mfma_f32_16x16x32_bf16 v[208:211], a[88:91], a[0:3], v[208:211]
    s_mov_b32 exec_lo, 0x0
    s_mov_b32 exec_hi, 0xffff
    v_accvgpr_write_b32 a160, v244
    v_accvgpr_write_b32 a161, v244
    v_accvgpr_write_b32 a162, v246
    s_mov_b64 exec, -1
    s_waitcnt lgkmcnt(10)
    v_mfma_f32_16x16x32_bf16 v[0:3], a[64:67], a[16:19], v[0:3]
    ds_read_b64_tr_b16 a[88:89], v225 offset:7264
    v_mfma_f32_16x16x32_bf16 v[4:7], a[64:67], a[20:23], v[4:7]
    ds_read_b64_tr_b16 a[90:91], v225 offset:9056
    s_add_u32 m0, s18, 139264
    s_add_u32 s54, s54, 8192
    v_mfma_f32_16x16x32_bf16 v[8:11], a[64:67], a[24:27], v[8:11]
    s_mov_b32 exec_lo, 0x0
    s_mov_b32 exec_hi, 0xffff
    v_accvgpr_write_b32 a164, v245
    v_accvgpr_write_b32 a165, v245
    v_accvgpr_write_b32 a166, v247
    s_mov_b64 exec, -1
    buffer_load_dwordx4 v226, s[56:59], s54 offen offset:0 lds
    v_mfma_f32_16x16x32_bf16 v[12:15], a[64:67], a[28:31], v[12:15]
    s_mov_b32 exec_lo, 0x0
    s_mov_b32 exec_hi, 0xffff0000
    v_accvgpr_write_b32 a176, v244
    v_accvgpr_write_b32 a177, v244
    v_accvgpr_write_b32 a178, v246
    s_mov_b64 exec, -1
    s_waitcnt lgkmcnt(10)
    v_mfma_f32_16x16x32_bf16 v[28:31], a[68:71], a[28:31], v[28:31]
    ds_read_b64_tr_b16 a[64:65], v225 offset:21600
    v_mfma_f32_16x16x32_bf16 v[24:27], a[68:71], a[24:27], v[24:27]
    ds_read_b64_tr_b16 a[66:67], v225 offset:23392
    v_mfma_f32_16x16x32_bf16 v[20:23], a[68:71], a[20:23], v[20:23]
    s_mov_b32 exec_lo, 0x0
    s_mov_b32 exec_hi, 0xffff0000
    v_accvgpr_write_b32 a180, v245
    v_accvgpr_write_b32 a181, v245
    v_accvgpr_write_b32 a182, v247
    s_mov_b64 exec, -1
    buffer_load_dwordx4 a[60:63], v227, s[8:11], s16 offen offset:2304
    v_mfma_f32_16x16x32_bf16 v[16:19], a[68:71], a[16:19], v[16:19]
    s_waitcnt lgkmcnt(10)
    v_mfma_f32_16x16x32_bf16 v[32:35], a[72:75], a[16:19], v[32:35]
    ds_read_b64_tr_b16 a[68:69], v225 offset:7296
    v_mfma_f32_16x16x32_bf16 v[36:39], a[72:75], a[20:23], v[36:39]
    ds_read_b64_tr_b16 a[70:71], v225 offset:9088
    v_mfma_f32_16x16x32_bf16 v[40:43], a[72:75], a[24:27], v[40:43]
    buffer_load_dwordx4 v226, s[56:59], s54 offen offset:1024 lds
    v_mfma_f32_16x16x32_bf16 v[44:47], a[72:75], a[28:31], v[44:47]
    s_waitcnt lgkmcnt(10)
    v_mfma_f32_16x16x32_bf16 v[60:63], a[76:79], a[28:31], v[60:63]
    ds_read_b64_tr_b16 a[72:73], v225 offset:21632
    v_mfma_f32_16x16x32_bf16 v[56:59], a[76:79], a[24:27], v[56:59]
    ds_read_b64_tr_b16 a[74:75], v225 offset:23424
    v_mfma_f32_16x16x32_bf16 v[52:55], a[76:79], a[20:23], v[52:55]
    v_mfma_f32_16x16x32_bf16 v[48:51], a[76:79], a[16:19], v[48:51]
    s_waitcnt lgkmcnt(10)
    v_mfma_f32_16x16x32_bf16 v[64:67], a[80:83], a[16:19], v[64:67]
    ds_read_b64_tr_b16 a[76:77], v225 offset:7328
    v_mfma_f32_16x16x32_bf16 v[68:71], a[80:83], a[20:23], v[68:71]
    ds_read_b64_tr_b16 a[78:79], v225 offset:9120
    s_add_u32 m0, s18, 147456
    s_add_u32 s54, s54, 8192
    v_mfma_f32_16x16x32_bf16 v[72:75], a[80:83], a[24:27], v[72:75]
    buffer_load_dwordx4 v226, s[56:59], s54 offen offset:0 lds
    v_mfma_f32_16x16x32_bf16 v[76:79], a[80:83], a[28:31], v[76:79]
    s_waitcnt lgkmcnt(10)
    v_mfma_f32_16x16x32_bf16 v[92:95], a[84:87], a[28:31], v[92:95]
    ds_read_b64_tr_b16 a[80:81], v225 offset:21664
    v_mfma_f32_16x16x32_bf16 v[88:91], a[84:87], a[24:27], v[88:91]
    ds_read_b64_tr_b16 a[82:83], v225 offset:23456
    v_mfma_f32_16x16x32_bf16 v[84:87], a[84:87], a[20:23], v[84:87]
    v_mfma_f32_16x16x32_bf16 v[80:83], a[84:87], a[16:19], v[80:83]
    s_waitcnt lgkmcnt(10)
    v_mfma_f32_16x16x32_bf16 v[96:99], a[88:91], a[16:19], v[96:99]
    ds_read_b64_tr_b16 a[84:85], v225 offset:7360
    v_mfma_f32_16x16x32_bf16 v[100:103], a[88:91], a[20:23], v[100:103]
    ds_read_b64_tr_b16 a[86:87], v225 offset:9152
    v_mfma_f32_16x16x32_bf16 v[104:107], a[88:91], a[24:27], v[104:107]
    buffer_load_dwordx4 v226, s[56:59], s54 offen offset:1024 lds
    v_mfma_f32_16x16x32_bf16 v[108:111], a[88:91], a[28:31], v[108:111]
    s_waitcnt lgkmcnt(10)
    v_mfma_f32_16x16x32_bf16 v[124:127], a[64:67], a[28:31], v[124:127]
    ds_read_b64_tr_b16 a[88:89], v225 offset:21696
    v_mfma_f32_16x16x32_bf16 v[120:123], a[64:67], a[24:27], v[120:123]
    ds_read_b64_tr_b16 a[90:91], v225 offset:23488
    v_mfma_f32_16x16x32_bf16 v[116:119], a[64:67], a[20:23], v[116:119]
    v_mfma_f32_16x16x32_bf16 v[112:115], a[64:67], a[16:19], v[112:115]
    s_waitcnt vmcnt(15) lgkmcnt(10)
    s_barrier
    v_mfma_f32_16x16x32_bf16 v[128:131], a[68:71], a[16:19], v[128:131]
    ds_read_b64_tr_b16 a[64:65], v225 offset:28672
    v_mfma_f32_16x16x32_bf16 v[132:135], a[68:71], a[20:23], v[132:135]
    ds_read_b64_tr_b16 a[66:67], v225 offset:30464
    s_add_u32 m0, s18, 155648
    s_add_u32 s54, s54, 8192
    v_mfma_f32_16x16x32_bf16 v[136:139], a[68:71], a[24:27], v[136:139]
    buffer_load_dwordx4 v226, s[56:59], s54 offen offset:0 lds
    v_mfma_f32_16x16x32_bf16 v[140:143], a[68:71], a[28:31], v[140:143]
    s_waitcnt lgkmcnt(10)
    v_mfma_f32_16x16x32_bf16 v[156:159], a[72:75], a[28:31], v[156:159]
    ds_read_b64_tr_b16 a[68:69], v225 offset:43008
    v_mfma_f32_16x16x32_bf16 v[152:155], a[72:75], a[24:27], v[152:155]
    ds_read_b64_tr_b16 a[70:71], v225 offset:44800
    v_mfma_f32_16x16x32_bf16 v[148:151], a[72:75], a[20:23], v[148:151]
    v_mfma_f32_16x16x32_bf16 v[144:147], a[72:75], a[16:19], v[144:147]
    s_waitcnt lgkmcnt(10)
    v_mfma_f32_16x16x32_bf16 v[160:163], a[76:79], a[16:19], v[160:163]
    ds_read_b64_tr_b16 a[72:73], v225 offset:28704
    v_mfma_f32_16x16x32_bf16 v[164:167], a[76:79], a[20:23], v[164:167]
    ds_read_b64_tr_b16 a[74:75], v225 offset:30496
    v_mfma_f32_16x16x32_bf16 v[168:171], a[76:79], a[24:27], v[168:171]
    buffer_load_dwordx4 v226, s[56:59], s54 offen offset:1024 lds
    v_mfma_f32_16x16x32_bf16 v[172:175], a[76:79], a[28:31], v[172:175]
    s_waitcnt lgkmcnt(10)
    v_mfma_f32_16x16x32_bf16 v[188:191], a[80:83], a[28:31], v[188:191]
    ds_read_b64_tr_b16 a[76:77], v225 offset:43040
    v_mfma_f32_16x16x32_bf16 v[184:187], a[80:83], a[24:27], v[184:187]
    ds_read_b64_tr_b16 a[78:79], v225 offset:44832
    v_mfma_f32_16x16x32_bf16 v[180:183], a[80:83], a[20:23], v[180:183]
    v_mfma_f32_16x16x32_bf16 v[176:179], a[80:83], a[16:19], v[176:179]
    s_waitcnt lgkmcnt(10)
    v_mfma_f32_16x16x32_bf16 v[192:195], a[84:87], a[16:19], v[192:195]
    ds_read_b64_tr_b16 a[80:81], v225 offset:28736
    v_mfma_f32_16x16x32_bf16 v[196:199], a[84:87], a[20:23], v[196:199]
    ds_read_b64_tr_b16 a[82:83], v225 offset:30528
    s_add_u32 m0, s18, 0
    s_add_u32 s54, s54, 8192
    v_mfma_f32_16x16x32_bf16 v[200:203], a[84:87], a[24:27], v[200:203]
    buffer_load_dwordx4 v226, s[56:59], s54 offen offset:0 lds
    v_mfma_f32_16x16x32_bf16 v[204:207], a[84:87], a[28:31], v[204:207]
    s_waitcnt lgkmcnt(10)
    v_mfma_f32_16x16x32_bf16 v[220:223], a[88:91], a[28:31], v[220:223]
    ds_read_b64_tr_b16 a[84:85], v225 offset:43072
    v_mfma_f32_16x16x32_bf16 v[216:219], a[88:91], a[24:27], v[216:219]
    ds_read_b64_tr_b16 a[86:87], v225 offset:44864
    v_mfma_f32_16x16x32_bf16 v[212:215], a[88:91], a[20:23], v[212:215]
    v_mfma_f32_16x16x32_bf16 v[208:211], a[88:91], a[16:19], v[208:211]
    s_waitcnt lgkmcnt(10)
    v_mfma_f32_16x16x32_bf16 v[0:3], a[64:67], a[32:35], v[0:3]
    ds_read_b64_tr_b16 a[88:89], v225 offset:28768
    v_mfma_f32_16x16x32_bf16 v[4:7], a[64:67], a[36:39], v[4:7]
    ds_read_b64_tr_b16 a[90:91], v225 offset:30560
    v_mfma_f32_16x16x32_bf16 v[8:11], a[64:67], a[40:43], v[8:11]
    buffer_load_dwordx4 v226, s[56:59], s54 offen offset:1024 lds
    s_waitcnt vmcnt(18)
    v_mfma_f32_16x16x32_bf16 v[12:15], a[64:67], a[44:47], v[12:15]
    s_waitcnt lgkmcnt(10)
    v_mfma_f32_16x16x32_bf16 v[28:31], a[68:71], a[44:47], v[28:31]
    ds_read_b64_tr_b16 a[64:65], v225 offset:43104
    v_mfma_f32_16x16x32_bf16 v[24:27], a[68:71], a[40:43], v[24:27]
    ds_read_b64_tr_b16 a[66:67], v225 offset:44896
    v_mfma_f32_16x16x32_bf16 v[20:23], a[68:71], a[36:39], v[20:23]
    v_mfma_f32_16x16x32_bf16 v[16:19], a[68:71], a[32:35], v[16:19]
    s_waitcnt lgkmcnt(10)
    v_mfma_f32_16x16x32_bf16 v[32:35], a[72:75], a[32:35], v[32:35]
    ds_read_b64_tr_b16 a[68:69], v225 offset:28800
    v_mfma_f32_16x16x32_bf16 v[36:39], a[72:75], a[36:39], v[36:39]
    ds_read_b64_tr_b16 a[70:71], v225 offset:30592
    s_add_u32 m0, s18, 8192
    s_add_u32 s54, s54, 8192
    v_mfma_f32_16x16x32_bf16 v[40:43], a[72:75], a[40:43], v[40:43]
    buffer_load_dwordx4 v226, s[56:59], s54 offen offset:0 lds
    v_mfma_f32_16x16x32_bf16 v[44:47], a[72:75], a[44:47], v[44:47]
    s_waitcnt lgkmcnt(10)
    v_mfma_f32_16x16x32_bf16 v[60:63], a[76:79], a[44:47], v[60:63]
    ds_read_b64_tr_b16 a[72:73], v225 offset:43136
    v_mfma_f32_16x16x32_bf16 v[56:59], a[76:79], a[40:43], v[56:59]
    ds_read_b64_tr_b16 a[74:75], v225 offset:44928
    v_mfma_f32_16x16x32_bf16 v[52:55], a[76:79], a[36:39], v[52:55]
    v_mfma_f32_16x16x32_bf16 v[48:51], a[76:79], a[32:35], v[48:51]
    s_waitcnt lgkmcnt(10)
    v_mfma_f32_16x16x32_bf16 v[64:67], a[80:83], a[32:35], v[64:67]
    ds_read_b64_tr_b16 a[76:77], v225 offset:28832
    v_mfma_f32_16x16x32_bf16 v[68:71], a[80:83], a[36:39], v[68:71]
    ds_read_b64_tr_b16 a[78:79], v225 offset:30624
    v_mfma_f32_16x16x32_bf16 v[72:75], a[80:83], a[40:43], v[72:75]
    buffer_load_dwordx4 v226, s[56:59], s54 offen offset:1024 lds
    v_mfma_f32_16x16x32_bf16 v[76:79], a[80:83], a[44:47], v[76:79]
    s_waitcnt lgkmcnt(10)
    v_mfma_f32_16x16x32_bf16 v[92:95], a[84:87], a[44:47], v[92:95]
    ds_read_b64_tr_b16 a[80:81], v225 offset:43168
    v_mfma_f32_16x16x32_bf16 v[88:91], a[84:87], a[40:43], v[88:91]
    ds_read_b64_tr_b16 a[82:83], v225 offset:44960
    v_mfma_f32_16x16x32_bf16 v[84:87], a[84:87], a[36:39], v[84:87]
    v_mfma_f32_16x16x32_bf16 v[80:83], a[84:87], a[32:35], v[80:83]
    s_waitcnt lgkmcnt(10)
    v_mfma_f32_16x16x32_bf16 v[96:99], a[88:91], a[32:35], v[96:99]
    ds_read_b64_tr_b16 a[84:85], v225 offset:28864
    v_mfma_f32_16x16x32_bf16 v[100:103], a[88:91], a[36:39], v[100:103]
    ds_read_b64_tr_b16 a[86:87], v225 offset:30656
    s_add_u32 m0, s18, 16384
    s_add_u32 s54, s54, 8192
    v_mfma_f32_16x16x32_bf16 v[104:107], a[88:91], a[40:43], v[104:107]
    buffer_load_dwordx4 v226, s[56:59], s54 offen offset:0 lds
    v_mfma_f32_16x16x32_bf16 v[108:111], a[88:91], a[44:47], v[108:111]
    s_waitcnt lgkmcnt(10)
    v_mfma_f32_16x16x32_bf16 v[124:127], a[64:67], a[44:47], v[124:127]
    ds_read_b64_tr_b16 a[88:89], v225 offset:43200
    v_mfma_f32_16x16x32_bf16 v[120:123], a[64:67], a[40:43], v[120:123]
    ds_read_b64_tr_b16 a[90:91], v225 offset:44992
    v_mfma_f32_16x16x32_bf16 v[116:119], a[64:67], a[36:39], v[116:119]
    v_mfma_f32_16x16x32_bf16 v[112:115], a[64:67], a[32:35], v[112:115]
    s_waitcnt lgkmcnt(10)
    v_mfma_f32_16x16x32_bf16 v[128:131], a[68:71], a[32:35], v[128:131]
    ds_read_b64_tr_b16 a[64:65], v225 offset:35840
    v_mfma_f32_16x16x32_bf16 v[132:135], a[68:71], a[36:39], v[132:135]
    ds_read_b64_tr_b16 a[66:67], v225 offset:37632
    v_mfma_f32_16x16x32_bf16 v[136:139], a[68:71], a[40:43], v[136:139]
    buffer_load_dwordx4 v226, s[56:59], s54 offen offset:1024 lds
    v_mfma_f32_16x16x32_bf16 v[140:143], a[68:71], a[44:47], v[140:143]
    s_waitcnt lgkmcnt(10)
    v_mfma_f32_16x16x32_bf16 v[156:159], a[72:75], a[44:47], v[156:159]
    ds_read_b64_tr_b16 a[68:69], v225 offset:50176
    v_mfma_f32_16x16x32_bf16 v[152:155], a[72:75], a[40:43], v[152:155]
    ds_read_b64_tr_b16 a[70:71], v225 offset:51968
    v_mfma_f32_16x16x32_bf16 v[148:151], a[72:75], a[36:39], v[148:151]
    v_mfma_f32_16x16x32_bf16 v[144:147], a[72:75], a[32:35], v[144:147]
    s_waitcnt lgkmcnt(10)
    v_mfma_f32_16x16x32_bf16 v[160:163], a[76:79], a[32:35], v[160:163]
    ds_read_b64_tr_b16 a[72:73], v225 offset:35872
    v_mfma_f32_16x16x32_bf16 v[164:167], a[76:79], a[36:39], v[164:167]
    ds_read_b64_tr_b16 a[74:75], v225 offset:37664
    s_add_u32 m0, s18, 24576
    s_add_u32 s54, s54, 8192
    v_mfma_f32_16x16x32_bf16 v[168:171], a[76:79], a[40:43], v[168:171]
    buffer_load_dwordx4 v226, s[56:59], s54 offen offset:0 lds
    v_mfma_f32_16x16x32_bf16 v[172:175], a[76:79], a[44:47], v[172:175]
    s_add_u32 s36, s30, 4194304
    s_addc_u32 s37, s31, 0
    s_waitcnt lgkmcnt(10)
    v_mfma_f32_16x16x32_bf16 v[188:191], a[80:83], a[44:47], v[188:191]
    ds_read_b64_tr_b16 a[76:77], v225 offset:50208
    v_mfma_f32_16x16x32_bf16 v[184:187], a[80:83], a[40:43], v[184:187]
    ds_read_b64_tr_b16 a[78:79], v225 offset:52000
    v_mfma_f32_16x16x32_bf16 v[180:183], a[80:83], a[36:39], v[180:183]
    v_mfma_f32_16x16x32_bf16 v[176:179], a[80:83], a[32:35], v[176:179]
    s_mov_b32 s38, 14680064
    s_waitcnt lgkmcnt(10)
    v_mfma_f32_16x16x32_bf16 v[192:195], a[84:87], a[32:35], v[192:195]
    ds_read_b64_tr_b16 a[80:81], v225 offset:35904
    v_mfma_f32_16x16x32_bf16 v[196:199], a[84:87], a[36:39], v[196:199]
    ds_read_b64_tr_b16 a[82:83], v225 offset:37696
    v_mfma_f32_16x16x32_bf16 v[200:203], a[84:87], a[40:43], v[200:203]
    buffer_load_dwordx4 v226, s[56:59], s54 offen offset:1024 lds
    v_mfma_f32_16x16x32_bf16 v[204:207], a[84:87], a[44:47], v[204:207]
    s_mov_b32 s39, 0x20000
    s_waitcnt lgkmcnt(10)
    v_mfma_f32_16x16x32_bf16 v[220:223], a[88:91], a[44:47], v[220:223]
    ds_read_b64_tr_b16 a[84:85], v225 offset:50240
    v_mfma_f32_16x16x32_bf16 v[216:219], a[88:91], a[40:43], v[216:219]
    ds_read_b64_tr_b16 a[86:87], v225 offset:52032
    v_mfma_f32_16x16x32_bf16 v[212:215], a[88:91], a[36:39], v[212:215]
    v_mfma_f32_16x16x32_bf16 v[208:211], a[88:91], a[32:35], v[208:211]
    s_waitcnt vmcnt(19) lgkmcnt(10)
    v_mfma_f32_16x16x32_bf16 v[0:3], a[64:67], a[48:51], v[0:3]
    ds_read_b64_tr_b16 a[88:89], v225 offset:35936
    s_waitcnt vmcnt(17)
    v_mfma_f32_16x16x32_bf16 v[4:7], a[64:67], a[52:55], v[4:7]
    ds_read_b64_tr_b16 a[90:91], v225 offset:37728
    s_waitcnt vmcnt(15)
    s_add_u32 m0, s18, 32768
    s_add_u32 s54, s54, 8192
    v_mfma_f32_16x16x32_bf16 v[8:11], a[64:67], a[56:59], v[8:11]
    buffer_load_dwordx4 v226, s[56:59], s54 offen offset:0 lds
    s_waitcnt vmcnt(14)
    v_mfma_f32_16x16x32_bf16 v[12:15], a[64:67], a[60:63], v[12:15]
    s_waitcnt lgkmcnt(10)
    v_mfma_f32_16x16x32_bf16 v[28:31], a[68:71], a[60:63], v[28:31]
    ds_read_b64_tr_b16 a[64:65], v225 offset:50272
    v_mfma_f32_16x16x32_bf16 v[24:27], a[68:71], a[56:59], v[24:27]
    ds_read_b64_tr_b16 a[66:67], v225 offset:52064
    v_mfma_f32_16x16x32_bf16 v[20:23], a[68:71], a[52:55], v[20:23]
    v_mfma_f32_16x16x32_bf16 v[16:19], a[68:71], a[48:51], v[16:19]
    s_waitcnt lgkmcnt(10)
    v_mfma_f32_16x16x32_bf16 v[32:35], a[72:75], a[48:51], v[32:35]
    ds_read_b64_tr_b16 a[68:69], v225 offset:35968
    v_mfma_f32_16x16x32_bf16 v[36:39], a[72:75], a[52:55], v[36:39]
    ds_read_b64_tr_b16 a[70:71], v225 offset:37760
    v_mfma_f32_16x16x32_bf16 v[40:43], a[72:75], a[56:59], v[40:43]
    buffer_load_dwordx4 v226, s[56:59], s54 offen offset:1024 lds
    v_mfma_f32_16x16x32_bf16 v[44:47], a[72:75], a[60:63], v[44:47]
    s_waitcnt lgkmcnt(10)
    v_mfma_f32_16x16x32_bf16 v[60:63], a[76:79], a[60:63], v[60:63]
    ds_read_b64_tr_b16 a[72:73], v225 offset:50304
    v_mfma_f32_16x16x32_bf16 v[56:59], a[76:79], a[56:59], v[56:59]
    ds_read_b64_tr_b16 a[74:75], v225 offset:52096
    v_mfma_f32_16x16x32_bf16 v[52:55], a[76:79], a[52:55], v[52:55]
    v_mfma_f32_16x16x32_bf16 v[48:51], a[76:79], a[48:51], v[48:51]
    s_waitcnt lgkmcnt(10)
    v_mfma_f32_16x16x32_bf16 v[64:67], a[80:83], a[48:51], v[64:67]
    ds_read_b64_tr_b16 a[76:77], v225 offset:36000
    v_mfma_f32_16x16x32_bf16 v[68:71], a[80:83], a[52:55], v[68:71]
    ds_read_b64_tr_b16 a[78:79], v225 offset:37792
    s_add_u32 m0, s18, 40960
    v_mfma_f32_16x16x32_bf16 v[72:75], a[80:83], a[56:59], v[72:75]
    buffer_load_dwordx4 v226, s[56:59], s3 offen offset:0 lds
    v_mfma_f32_16x16x32_bf16 v[76:79], a[80:83], a[60:63], v[76:79]
    s_waitcnt lgkmcnt(10)
    v_mfma_f32_16x16x32_bf16 v[92:95], a[84:87], a[60:63], v[92:95]
    ds_read_b64_tr_b16 a[80:81], v225 offset:50336
    v_mfma_f32_16x16x32_bf16 v[88:91], a[84:87], a[56:59], v[88:91]
    ds_read_b64_tr_b16 a[82:83], v225 offset:52128
    v_mfma_f32_16x16x32_bf16 v[84:87], a[84:87], a[52:55], v[84:87]
    v_mfma_f32_16x16x32_bf16 v[80:83], a[84:87], a[48:51], v[80:83]
    s_waitcnt lgkmcnt(10)
    v_mfma_f32_16x16x32_bf16 v[96:99], a[88:91], a[48:51], v[96:99]
    ds_read_b64_tr_b16 a[84:85], v225 offset:36032
    v_mfma_f32_16x16x32_bf16 v[100:103], a[88:91], a[52:55], v[100:103]
    ds_read_b64_tr_b16 a[86:87], v225 offset:37824
    v_mfma_f32_16x16x32_bf16 v[104:107], a[88:91], a[56:59], v[104:107]
    buffer_load_dwordx4 v226, s[56:59], s3 offen offset:1024 lds
    v_mfma_f32_16x16x32_bf16 v[108:111], a[88:91], a[60:63], v[108:111]
    s_waitcnt lgkmcnt(10)
    v_mfma_f32_16x16x32_bf16 v[124:127], a[64:67], a[60:63], v[124:127]
    ds_read_b64_tr_b16 a[88:89], v225 offset:50368
    v_mfma_f32_16x16x32_bf16 v[120:123], a[64:67], a[56:59], v[120:123]
    ds_read_b64_tr_b16 a[90:91], v225 offset:52160
    v_mfma_f32_16x16x32_bf16 v[116:119], a[64:67], a[52:55], v[116:119]
    v_mfma_f32_16x16x32_bf16 v[112:115], a[64:67], a[48:51], v[112:115]
    s_waitcnt lgkmcnt(10)
    v_mfma_f32_16x16x32_bf16 v[128:131], a[68:71], a[48:51], v[128:131]
    v_mfma_f32_16x16x32_bf16 v[132:135], a[68:71], a[52:55], v[132:135]
    s_add_u32 m0, s18, 49152
    s_add_u32 s54, s54, 8192
    v_mfma_f32_16x16x32_bf16 v[136:139], a[68:71], a[56:59], v[136:139]
    buffer_load_dwordx4 v226, s[56:59], s54 offen offset:0 lds
    v_mfma_f32_16x16x32_bf16 v[140:143], a[68:71], a[60:63], v[140:143]
    s_waitcnt lgkmcnt(8)
    v_mfma_f32_16x16x32_bf16 v[156:159], a[72:75], a[60:63], v[156:159]
    v_mfma_f32_16x16x32_bf16 v[152:155], a[72:75], a[56:59], v[152:155]
    v_mfma_f32_16x16x32_bf16 v[148:151], a[72:75], a[52:55], v[148:151]
    v_mfma_f32_16x16x32_bf16 v[144:147], a[72:75], a[48:51], v[144:147]
    s_waitcnt lgkmcnt(6)
    v_mfma_f32_16x16x32_bf16 v[160:163], a[76:79], a[48:51], v[160:163]
    v_mfma_f32_16x16x32_bf16 v[164:167], a[76:79], a[52:55], v[164:167]
    v_mfma_f32_16x16x32_bf16 v[168:171], a[76:79], a[56:59], v[168:171]
    buffer_load_dwordx4 v226, s[56:59], s54 offen offset:1024 lds
    v_mfma_f32_16x16x32_bf16 v[172:175], a[76:79], a[60:63], v[172:175]
    s_waitcnt lgkmcnt(4)
    v_mfma_f32_16x16x32_bf16 v[188:191], a[80:83], a[60:63], v[188:191]
    v_mfma_f32_16x16x32_bf16 v[184:187], a[80:83], a[56:59], v[184:187]
    v_mfma_f32_16x16x32_bf16 v[180:183], a[80:83], a[52:55], v[180:183]
    v_mfma_f32_16x16x32_bf16 v[176:179], a[80:83], a[48:51], v[176:179]
    s_waitcnt lgkmcnt(2)
    v_mfma_f32_16x16x32_bf16 v[192:195], a[84:87], a[48:51], v[192:195]
    v_mfma_f32_16x16x32_bf16 v[196:199], a[84:87], a[52:55], v[196:199]
    v_mfma_f32_16x16x32_bf16 v[200:203], a[84:87], a[56:59], v[200:203]
    v_mfma_f32_16x16x32_bf16 v[204:207], a[84:87], a[60:63], v[204:207]
    s_waitcnt lgkmcnt(0)
    v_mfma_f32_16x16x32_bf16 v[220:223], a[88:91], a[60:63], v[220:223]
    v_mfma_f32_16x16x32_bf16 v[216:219], a[88:91], a[56:59], v[216:219]
    v_mfma_f32_16x16x32_bf16 v[212:215], a[88:91], a[52:55], v[212:215]
    v_mfma_f32_16x16x32_bf16 v[208:211], a[88:91], a[48:51], v[208:211]
    s_barrier
    v_mfma_f32_16x16x32_bf16 v[0:3], a[124:127], a[152:155], v[0:3]
    v_mfma_f32_16x16x32_bf16 v[4:7], a[124:127], a[156:159], v[4:7]
    v_mfma_f32_16x16x32_bf16 v[8:11], a[124:127], a[160:163], v[8:11]
    v_mfma_f32_16x16x32_bf16 v[12:15], a[124:127], a[164:167], v[12:15]
    v_mfma_f32_16x16x32_bf16 v[16:19], a[124:127], a[168:171], v[16:19]
    v_mfma_f32_16x16x32_bf16 v[20:23], a[124:127], a[172:175], v[20:23]
    v_mfma_f32_16x16x32_bf16 v[24:27], a[124:127], a[176:179], v[24:27]
    v_mfma_f32_16x16x32_bf16 v[28:31], a[124:127], a[180:183], v[28:31]
    s_add_u32 m0, s18, 57344
    s_add_u32 s3, s3, 8192
    buffer_load_dwordx4 v226, s[56:59], s3 offen offset:0 lds
    buffer_load_dwordx4 v226, s[56:59], s3 offen offset:1024 lds
    s_nop 3
    v_pk_mul_f32 v[0:1], v[0:1], v[236:237] op_sel_hi:[1,0]
    v_pk_mul_f32 v[2:3], v[2:3], v[236:237] op_sel_hi:[1,0]
    v_pk_mul_f32 v[4:5], v[4:5], v[238:239] op_sel_hi:[1,0]
    v_pk_mul_f32 v[6:7], v[6:7], v[238:239] op_sel_hi:[1,0]
    v_exp_f32 v0, v0
    v_mfma_f32_16x16x32_bf16 v[32:35], a[128:131], a[152:155], v[32:35]
    v_exp_f32 v1, v1
    s_lshl_b32 s24, s52, 2
    v_exp_f32 v2, v2
    v_mfma_f32_16x16x32_bf16 v[36:39], a[128:131], a[156:159], v[36:39]
    v_exp_f32 v3, v3
    s_add_u32 s24, s24, s21
    v_exp_f32 v4, v4
    v_mfma_f32_16x16x32_bf16 v[40:43], a[128:131], a[160:163], v[40:43]
    v_exp_f32 v5, v5
    s_mul_i32 s48, s24, 229376
    v_exp_f32 v6, v6
    v_mfma_f32_16x16x32_bf16 v[44:47], a[128:131], a[164:167], v[44:47]
    v_exp_f32 v7, v7
    s_mul_i32 s47, s55, 114688
    v_pk_fma_f32 v[0:1], v[0:1], v[236:237], v[236:237] op_sel:[0,1,1] op_sel_hi:[1,1,1]
    v_pk_fma_f32 v[2:3], v[2:3], v[236:237], v[236:237] op_sel:[0,1,1] op_sel_hi:[1,1,1]
    v_pk_fma_f32 v[4:5], v[4:5], v[238:239], v[238:239] op_sel:[0,1,1] op_sel_hi:[1,1,1]
    v_pk_fma_f32 v[6:7], v[6:7], v[238:239], v[238:239] op_sel:[0,1,1] op_sel_hi:[1,1,1]
    v_rcp_f32 v0, v0
    v_mfma_f32_16x16x32_bf16 v[48:51], a[128:131], a[168:171], v[48:51]
    v_rcp_f32 v1, v1
    s_add_u32 s48, s48, s47
    v_rcp_f32 v2, v2
    v_mfma_f32_16x16x32_bf16 v[52:55], a[128:131], a[172:175], v[52:55]
    v_rcp_f32 v3, v3
    s_add_u32 s48, s48, 4194304
    v_rcp_f32 v4, v4
    v_mfma_f32_16x16x32_bf16 v[56:59], a[128:131], a[176:179], v[56:59]
    s_add_u32 m0, s18, 65536
    s_add_u32 s54, s54, 8192
    buffer_load_dwordx4 v226, s[56:59], s54 offen offset:0 lds
    v_rcp_f32 v5, v5
    s_lshl_b32 s46, s22, 3
    v_rcp_f32 v6, v6
    v_mfma_f32_16x16x32_bf16 v[60:63], a[128:131], a[180:183], v[60:63]
    v_rcp_f32 v7, v7
    s_lshr_b32 s47, s23, 2
    v_pk_mul_f32 v[16:17], v[0:1], v[16:17]
    v_pk_mul_f32 v[18:19], v[2:3], v[18:19]
    v_pk_mul_f32 v[20:21], v[4:5], v[20:21]
    v_pk_mul_f32 v[22:23], v[6:7], v[22:23]
    v_cvt_pk_bf16_f32 v0, v16, v17
    v_cvt_pk_bf16_f32 v1, v18, v19
    v_cvt_pk_bf16_f32 v2, v20, v21
    v_cvt_pk_bf16_f32 v3, v22, v23
    s_nop 1
    v_permlane16_swap_b32 v0, v2
    v_permlane16_swap_b32 v1, v3
    buffer_store_dwordx4 v[0:3], v226, s[36:39], s34 offen offset:0 sc1
    v_pk_mul_f32 v[8:9], v[8:9], v[240:241] op_sel_hi:[1,0]
    v_pk_mul_f32 v[10:11], v[10:11], v[240:241] op_sel_hi:[1,0]
    v_pk_mul_f32 v[12:13], v[12:13], v[242:243] op_sel_hi:[1,0]
    v_pk_mul_f32 v[14:15], v[14:15], v[242:243] op_sel_hi:[1,0]
    v_exp_f32 v8, v8
    v_exp_f32 v9, v9
    s_add_u32 s46, s46, s47
    v_exp_f32 v10, v10
    v_exp_f32 v11, v11
    s_lshl_b32 s46, s46, 7
    v_exp_f32 v12, v12
    buffer_load_dwordx4 v226, s[56:59], s54 offen offset:1024 lds
    v_exp_f32 v13, v13
    s_and_b32 s47, s23, 3
    v_exp_f32 v14, v14
    v_exp_f32 v15, v15
    s_lshl_b32 s47, s47, 2
    v_pk_fma_f32 v[8:9], v[8:9], v[240:241], v[240:241] op_sel:[0,1,1] op_sel_hi:[1,1,1]
    v_pk_fma_f32 v[10:11], v[10:11], v[240:241], v[240:241] op_sel:[0,1,1] op_sel_hi:[1,1,1]
    v_pk_fma_f32 v[12:13], v[12:13], v[242:243], v[242:243] op_sel:[0,1,1] op_sel_hi:[1,1,1]
    v_pk_fma_f32 v[14:15], v[14:15], v[242:243], v[242:243] op_sel:[0,1,1] op_sel_hi:[1,1,1]
    v_rcp_f32 v8, v8
    v_rcp_f32 v9, v9
    s_add_u32 s46, s46, s47
    v_rcp_f32 v10, v10
    v_rcp_f32 v11, v11
    s_lshr_b32 s47, s52, 1
    v_rcp_f32 v12, v12
    v_rcp_f32 v13, v13
    s_lshl_b32 s47, s47, 1
    v_rcp_f32 v14, v14
    v_rcp_f32 v15, v15
    s_add_u32 s47, s47, s55
    v_pk_mul_f32 v[24:25], v[8:9], v[24:25]
    v_pk_mul_f32 v[26:27], v[10:11], v[26:27]
    v_pk_mul_f32 v[28:29], v[12:13], v[28:29]
    v_pk_mul_f32 v[30:31], v[14:15], v[30:31]
    v_cvt_pk_bf16_f32 v8, v24, v25
    v_cvt_pk_bf16_f32 v9, v26, v27
    v_cvt_pk_bf16_f32 v10, v28, v29
    v_cvt_pk_bf16_f32 v11, v30, v31
    s_nop 1
    s_add_u32 m0, s18, 73728
    s_add_u32 s3, s3, 8192
    buffer_load_dwordx4 v226, s[56:59], s3 offen offset:0 lds
    v_permlane16_swap_b32 v8, v10
    v_permlane16_swap_b32 v9, v11
    buffer_store_dwordx4 v[8:11], v226, s[36:39], s35 offen offset:0 sc1
    v_pk_mul_f32 v[32:33], v[32:33], v[236:237] op_sel_hi:[1,0]
    v_pk_mul_f32 v[34:35], v[34:35], v[236:237] op_sel_hi:[1,0]
    v_pk_mul_f32 v[36:37], v[36:37], v[238:239] op_sel_hi:[1,0]
    v_pk_mul_f32 v[38:39], v[38:39], v[238:239] op_sel_hi:[1,0]
    v_exp_f32 v32, v32
    v_mfma_f32_16x16x32_bf16 v[64:67], a[132:135], a[152:155], v[64:67]
    v_exp_f32 v33, v33
    s_lshl_b32 s47, s47, 9
    v_exp_f32 v34, v34
    v_mfma_f32_16x16x32_bf16 v[68:71], a[132:135], a[156:159], v[68:71]
    v_exp_f32 v35, v35
    v_bfe_u32 v244, v235, 2, 2
    v_exp_f32 v36, v36
    v_mfma_f32_16x16x32_bf16 v[72:75], a[132:135], a[160:163], v[72:75]
    v_exp_f32 v37, v37
    v_lshlrev_b32 v244, 7, v244
    v_exp_f32 v38, v38
    v_mfma_f32_16x16x32_bf16 v[76:79], a[132:135], a[164:167], v[76:79]
    v_exp_f32 v39, v39
    v_and_b32 v245, 3, v235
    v_pk_fma_f32 v[32:33], v[32:33], v[236:237], v[236:237] op_sel:[0,1,1] op_sel_hi:[1,1,1]
    v_pk_fma_f32 v[34:35], v[34:35], v[236:237], v[236:237] op_sel:[0,1,1] op_sel_hi:[1,1,1]
    v_pk_fma_f32 v[36:37], v[36:37], v[238:239], v[238:239] op_sel:[0,1,1] op_sel_hi:[1,1,1]
    v_pk_fma_f32 v[38:39], v[38:39], v[238:239], v[238:239] op_sel:[0,1,1] op_sel_hi:[1,1,1]
    v_rcp_f32 v32, v32
    v_mfma_f32_16x16x32_bf16 v[80:83], a[132:135], a[168:171], v[80:83]
    v_rcp_f32 v33, v33
    v_lshl_add_u32 v244, v245, 2, v244
    v_rcp_f32 v34, v34
    v_mfma_f32_16x16x32_bf16 v[84:87], a[132:135], a[172:175], v[84:87]
    v_rcp_f32 v35, v35
    v_mov_b32 v246, 0
    v_rcp_f32 v36, v36
    v_mfma_f32_16x16x32_bf16 v[88:91], a[132:135], a[176:179], v[88:91]
    buffer_load_dwordx4 v226, s[56:59], s3 offen offset:1024 lds
    v_rcp_f32 v37, v37
    v_mov_b32 v247, 1
    v_rcp_f32 v38, v38
    v_mfma_f32_16x16x32_bf16 v[92:95], a[132:135], a[180:183], v[92:95]
    v_rcp_f32 v39, v39
    v_add_u32 v227, 4096, v226
    v_pk_mul_f32 v[48:49], v[32:33], v[48:49]
    v_pk_mul_f32 v[50:51], v[34:35], v[50:51]
    v_pk_mul_f32 v[52:53], v[36:37], v[52:53]
    v_pk_mul_f32 v[54:55], v[38:39], v[54:55]
    v_cvt_pk_bf16_f32 v32, v48, v49
    v_cvt_pk_bf16_f32 v33, v50, v51
    v_cvt_pk_bf16_f32 v34, v52, v53
    v_cvt_pk_bf16_f32 v35, v54, v55
    s_nop 1
    v_permlane16_swap_b32 v32, v34
    v_permlane16_swap_b32 v33, v35
    buffer_store_dwordx4 v[32:35], v226, s[36:39], s34 offen offset:1024 sc1
    v_pk_mul_f32 v[40:41], v[40:41], v[240:241] op_sel_hi:[1,0]
    v_pk_mul_f32 v[42:43], v[42:43], v[240:241] op_sel_hi:[1,0]
    v_pk_mul_f32 v[44:45], v[44:45], v[242:243] op_sel_hi:[1,0]
    v_pk_mul_f32 v[46:47], v[46:47], v[242:243] op_sel_hi:[1,0]
    v_exp_f32 v40, v40
    v_exp_f32 v41, v41
    s_lshl_b32 s49, s24, 16
    v_exp_f32 v42, v42
    v_exp_f32 v43, v43
    s_lshl_b32 s50, s53, 12
    v_exp_f32 v44, v44
    s_add_u32 m0, s18, 81920
    s_add_u32 s54, s54, 8192
    buffer_load_dwordx4 v226, s[56:59], s54 offen offset:0 lds
    v_exp_f32 v45, v45
    s_add_u32 s50, s50, s49
    v_exp_f32 v46, v46
    v_exp_f32 v47, v47
    s_mov_b32 s16, 0
    v_pk_fma_f32 v[40:41], v[40:41], v[240:241], v[240:241] op_sel:[0,1,1] op_sel_hi:[1,1,1]
    v_pk_fma_f32 v[42:43], v[42:43], v[240:241], v[240:241] op_sel:[0,1,1] op_sel_hi:[1,1,1]
    v_pk_fma_f32 v[44:45], v[44:45], v[242:243], v[242:243] op_sel:[0,1,1] op_sel_hi:[1,1,1]
    v_pk_fma_f32 v[46:47], v[46:47], v[242:243], v[242:243] op_sel:[0,1,1] op_sel_hi:[1,1,1]
    v_rcp_f32 v40, v40
    v_rcp_f32 v41, v41
    s_add_u32 s12, s30, 1638400
    s_addc_u32 s13, s31, 0
    v_rcp_f32 v42, v42
    v_rcp_f32 v43, v43
    s_mov_b32 s14, 32768
    v_rcp_f32 v44, v44
    v_rcp_f32 v45, v45
    s_mov_b32 s15, 0x20000
    v_rcp_f32 v46, v46
    v_rcp_f32 v47, v47
    s_add_u32 s40, s30, 20971520
    s_addc_u32 s41, s31, 0
    v_pk_mul_f32 v[56:57], v[40:41], v[56:57]
    v_pk_mul_f32 v[58:59], v[42:43], v[58:59]
    v_pk_mul_f32 v[60:61], v[44:45], v[60:61]
    v_pk_mul_f32 v[62:63], v[46:47], v[62:63]
    v_cvt_pk_bf16_f32 v40, v56, v57
    v_cvt_pk_bf16_f32 v41, v58, v59
    v_cvt_pk_bf16_f32 v42, v60, v61
    v_cvt_pk_bf16_f32 v43, v62, v63
    s_nop 1
    buffer_load_dwordx4 v226, s[56:59], s54 offen offset:1024 lds
    v_permlane16_swap_b32 v40, v42
    v_permlane16_swap_b32 v41, v43
    buffer_store_dwordx4 v[40:43], v226, s[36:39], s35 offen offset:1024 sc1
    v_pk_mul_f32 v[64:65], v[64:65], v[236:237] op_sel_hi:[1,0]
    v_pk_mul_f32 v[66:67], v[66:67], v[236:237] op_sel_hi:[1,0]
    v_pk_mul_f32 v[68:69], v[68:69], v[238:239] op_sel_hi:[1,0]
    v_pk_mul_f32 v[70:71], v[70:71], v[238:239] op_sel_hi:[1,0]
    v_exp_f32 v64, v64
    v_mfma_f32_16x16x32_bf16 v[96:99], a[136:139], a[152:155], v[96:99]
    v_exp_f32 v65, v65
    s_mov_b32 s42, 4194304
    v_exp_f32 v66, v66
    v_mfma_f32_16x16x32_bf16 v[100:103], a[136:139], a[156:159], v[100:103]
    v_exp_f32 v67, v67
    s_mov_b32 s43, 0x20000
    v_exp_f32 v68, v68
    v_mfma_f32_16x16x32_bf16 v[104:107], a[136:139], a[160:163], v[104:107]
    v_exp_f32 v69, v69
    s_add_u32 s4, s30, s48
    s_addc_u32 s5, s31, 0
    v_exp_f32 v70, v70
    v_mfma_f32_16x16x32_bf16 v[108:111], a[136:139], a[164:167], v[108:111]
    v_exp_f32 v71, v71
    s_mov_b32 s6, 114688
    v_pk_fma_f32 v[64:65], v[64:65], v[236:237], v[236:237] op_sel:[0,1,1] op_sel_hi:[1,1,1]
    v_pk_fma_f32 v[66:67], v[66:67], v[236:237], v[236:237] op_sel:[0,1,1] op_sel_hi:[1,1,1]
    v_pk_fma_f32 v[68:69], v[68:69], v[238:239], v[238:239] op_sel:[0,1,1] op_sel_hi:[1,1,1]
    v_pk_fma_f32 v[70:71], v[70:71], v[238:239], v[238:239] op_sel:[0,1,1] op_sel_hi:[1,1,1]
    v_rcp_f32 v64, v64
    v_mfma_f32_16x16x32_bf16 v[112:115], a[136:139], a[168:171], v[112:115]
    v_rcp_f32 v65, v65
    v_rcp_f32 v66, v66
    v_mfma_f32_16x16x32_bf16 v[116:119], a[136:139], a[172:175], v[116:119]
    v_rcp_f32 v67, v67
    v_rcp_f32 v68, v68
    v_mfma_f32_16x16x32_bf16 v[120:123], a[136:139], a[176:179], v[120:123]
    s_add_u32 m0, s18, 90112
    s_add_u32 s3, s3, 8192
    buffer_load_dwordx4 v226, s[56:59], s3 offen offset:0 lds
    v_rcp_f32 v69, v69
    v_rcp_f32 v70, v70
    v_mfma_f32_16x16x32_bf16 v[124:127], a[136:139], a[180:183], v[124:127]
    v_rcp_f32 v71, v71
    v_pk_mul_f32 v[80:81], v[64:65], v[80:81]
    v_pk_mul_f32 v[82:83], v[66:67], v[82:83]
    v_pk_mul_f32 v[84:85], v[68:69], v[84:85]
    v_pk_mul_f32 v[86:87], v[70:71], v[86:87]
    v_cvt_pk_bf16_f32 v64, v80, v81
    v_cvt_pk_bf16_f32 v65, v82, v83
    v_cvt_pk_bf16_f32 v66, v84, v85
    v_cvt_pk_bf16_f32 v67, v86, v87
    s_nop 1
    v_permlane16_swap_b32 v64, v66
    v_permlane16_swap_b32 v65, v67
    buffer_store_dwordx4 v[64:67], v226, s[36:39], s34 offen offset:2048 sc1
    v_pk_mul_f32 v[72:73], v[72:73], v[240:241] op_sel_hi:[1,0]
    v_pk_mul_f32 v[74:75], v[74:75], v[240:241] op_sel_hi:[1,0]
    v_pk_mul_f32 v[76:77], v[76:77], v[242:243] op_sel_hi:[1,0]
    v_pk_mul_f32 v[78:79], v[78:79], v[242:243] op_sel_hi:[1,0]
    v_exp_f32 v72, v72
    v_exp_f32 v73, v73
    v_exp_f32 v74, v74
    v_exp_f32 v75, v75
    v_exp_f32 v76, v76
    buffer_load_dwordx4 v226, s[56:59], s3 offen offset:1024 lds
    v_exp_f32 v77, v77
    v_exp_f32 v78, v78
    v_exp_f32 v79, v79
    v_pk_fma_f32 v[72:73], v[72:73], v[240:241], v[240:241] op_sel:[0,1,1] op_sel_hi:[1,1,1]
    v_pk_fma_f32 v[74:75], v[74:75], v[240:241], v[240:241] op_sel:[0,1,1] op_sel_hi:[1,1,1]
    v_pk_fma_f32 v[76:77], v[76:77], v[242:243], v[242:243] op_sel:[0,1,1] op_sel_hi:[1,1,1]
    v_pk_fma_f32 v[78:79], v[78:79], v[242:243], v[242:243] op_sel:[0,1,1] op_sel_hi:[1,1,1]
    v_rcp_f32 v72, v72
    v_rcp_f32 v73, v73
    v_rcp_f32 v74, v74
    v_rcp_f32 v75, v75
    v_rcp_f32 v76, v76
    v_rcp_f32 v77, v77
    v_rcp_f32 v78, v78
    v_rcp_f32 v79, v79
    v_pk_mul_f32 v[88:89], v[72:73], v[88:89]
    v_pk_mul_f32 v[90:91], v[74:75], v[90:91]
    v_pk_mul_f32 v[92:93], v[76:77], v[92:93]
    v_pk_mul_f32 v[94:95], v[78:79], v[94:95]
    v_cvt_pk_bf16_f32 v72, v88, v89
    v_cvt_pk_bf16_f32 v73, v90, v91
    v_cvt_pk_bf16_f32 v74, v92, v93
    v_cvt_pk_bf16_f32 v75, v94, v95
    s_nop 1
    s_add_u32 m0, s18, 98304
    s_add_u32 s54, s54, 8192
    buffer_load_dwordx4 v226, s[56:59], s54 offen offset:0 lds
    v_permlane16_swap_b32 v72, v74
    v_permlane16_swap_b32 v73, v75
    buffer_store_dwordx4 v[72:75], v226, s[36:39], s35 offen offset:2048 sc1
    v_pk_mul_f32 v[96:97], v[96:97], v[236:237] op_sel_hi:[1,0]
    v_pk_mul_f32 v[98:99], v[98:99], v[236:237] op_sel_hi:[1,0]
    v_pk_mul_f32 v[100:101], v[100:101], v[238:239] op_sel_hi:[1,0]
    v_pk_mul_f32 v[102:103], v[102:103], v[238:239] op_sel_hi:[1,0]
    v_exp_f32 v96, v96
    v_mfma_f32_16x16x32_bf16 v[128:131], a[140:143], a[152:155], v[128:131]
    v_exp_f32 v97, v97
    v_exp_f32 v98, v98
    v_mfma_f32_16x16x32_bf16 v[132:135], a[140:143], a[156:159], v[132:135]
    v_exp_f32 v99, v99
    v_exp_f32 v100, v100
    v_mfma_f32_16x16x32_bf16 v[136:139], a[140:143], a[160:163], v[136:139]
    v_exp_f32 v101, v101
    v_exp_f32 v102, v102
    v_mfma_f32_16x16x32_bf16 v[140:143], a[140:143], a[164:167], v[140:143]
    v_exp_f32 v103, v103
    v_pk_fma_f32 v[96:97], v[96:97], v[236:237], v[236:237] op_sel:[0,1,1] op_sel_hi:[1,1,1]
    v_pk_fma_f32 v[98:99], v[98:99], v[236:237], v[236:237] op_sel:[0,1,1] op_sel_hi:[1,1,1]
    v_pk_fma_f32 v[100:101], v[100:101], v[238:239], v[238:239] op_sel:[0,1,1] op_sel_hi:[1,1,1]
    v_pk_fma_f32 v[102:103], v[102:103], v[238:239], v[238:239] op_sel:[0,1,1] op_sel_hi:[1,1,1]
    v_rcp_f32 v96, v96
    v_mfma_f32_16x16x32_bf16 v[144:147], a[140:143], a[168:171], v[144:147]
    v_rcp_f32 v97, v97
    v_rcp_f32 v98, v98
    v_mfma_f32_16x16x32_bf16 v[148:151], a[140:143], a[172:175], v[148:151]
    v_rcp_f32 v99, v99
    v_rcp_f32 v100, v100
    v_mfma_f32_16x16x32_bf16 v[152:155], a[140:143], a[176:179], v[152:155]
    buffer_load_dwordx4 v226, s[56:59], s54 offen offset:1024 lds
    v_rcp_f32 v101, v101
    v_rcp_f32 v102, v102
    v_mfma_f32_16x16x32_bf16 v[156:159], a[140:143], a[180:183], v[156:159]
    v_rcp_f32 v103, v103
    v_pk_mul_f32 v[112:113], v[96:97], v[112:113]
    v_pk_mul_f32 v[114:115], v[98:99], v[114:115]
    v_pk_mul_f32 v[116:117], v[100:101], v[116:117]
    v_pk_mul_f32 v[118:119], v[102:103], v[118:119]
    v_cvt_pk_bf16_f32 v96, v112, v113
    v_cvt_pk_bf16_f32 v97, v114, v115
    v_cvt_pk_bf16_f32 v98, v116, v117
    v_cvt_pk_bf16_f32 v99, v118, v119
    s_nop 1
    v_permlane16_swap_b32 v96, v98
    v_permlane16_swap_b32 v97, v99
    s_add_u32 s34, s34, s25
    buffer_store_dwordx4 v[96:99], v226, s[36:39], s34 offen offset:0 sc1
    v_pk_mul_f32 v[104:105], v[104:105], v[240:241] op_sel_hi:[1,0]
    v_pk_mul_f32 v[106:107], v[106:107], v[240:241] op_sel_hi:[1,0]
    v_pk_mul_f32 v[108:109], v[108:109], v[242:243] op_sel_hi:[1,0]
    v_pk_mul_f32 v[110:111], v[110:111], v[242:243] op_sel_hi:[1,0]
    v_exp_f32 v104, v104
    v_exp_f32 v105, v105
    v_exp_f32 v106, v106
    v_exp_f32 v107, v107
    v_exp_f32 v108, v108
    s_add_u32 m0, s18, 106496
    s_add_u32 s3, s3, 8192
    buffer_load_dwordx4 v226, s[56:59], s3 offen offset:0 lds
    v_exp_f32 v109, v109
    v_exp_f32 v110, v110
    v_exp_f32 v111, v111
    v_pk_fma_f32 v[104:105], v[104:105], v[240:241], v[240:241] op_sel:[0,1,1] op_sel_hi:[1,1,1]
    v_pk_fma_f32 v[106:107], v[106:107], v[240:241], v[240:241] op_sel:[0,1,1] op_sel_hi:[1,1,1]
    v_pk_fma_f32 v[108:109], v[108:109], v[242:243], v[242:243] op_sel:[0,1,1] op_sel_hi:[1,1,1]
    v_pk_fma_f32 v[110:111], v[110:111], v[242:243], v[242:243] op_sel:[0,1,1] op_sel_hi:[1,1,1]
    v_rcp_f32 v104, v104
    v_rcp_f32 v105, v105
    v_rcp_f32 v106, v106
    v_rcp_f32 v107, v107
    v_rcp_f32 v108, v108
    v_rcp_f32 v109, v109
    v_rcp_f32 v110, v110
    v_rcp_f32 v111, v111
    v_pk_mul_f32 v[120:121], v[104:105], v[120:121]
    v_pk_mul_f32 v[122:123], v[106:107], v[122:123]
    v_pk_mul_f32 v[124:125], v[108:109], v[124:125]
    v_pk_mul_f32 v[126:127], v[110:111], v[126:127]
    v_cvt_pk_bf16_f32 v104, v120, v121
    v_cvt_pk_bf16_f32 v105, v122, v123
    v_cvt_pk_bf16_f32 v106, v124, v125
    v_cvt_pk_bf16_f32 v107, v126, v127
    s_nop 1
    buffer_load_dwordx4 v226, s[56:59], s3 offen offset:1024 lds
    v_permlane16_swap_b32 v104, v106
    v_permlane16_swap_b32 v105, v107
    s_add_u32 s35, s35, s25
    buffer_store_dwordx4 v[104:107], v226, s[36:39], s35 offen offset:0 sc1
    s_waitcnt vmcnt(5)
    s_barrier
    s_cmp_lg_u32 s21, 0
    s_cbranch_scc1 mlp_kernel_noflagA
    s_mov_b64 exec, 1
    buffer_store_dword v247, v246, s[12:15], s46 offen sc1
    s_mov_b64 exec, -1
mlp_kernel_noflagA:
    v_pk_mul_f32 v[128:129], v[128:129], v[236:237] op_sel_hi:[1,0]
    v_pk_mul_f32 v[130:131], v[130:131], v[236:237] op_sel_hi:[1,0]
    v_pk_mul_f32 v[132:133], v[132:133], v[238:239] op_sel_hi:[1,0]
    v_pk_mul_f32 v[134:135], v[134:135], v[238:239] op_sel_hi:[1,0]
    v_exp_f32 v128, v128
    v_mfma_f32_16x16x32_bf16 v[160:163], a[144:147], a[152:155], v[160:163]
    v_exp_f32 v129, v129
    v_exp_f32 v130, v130
    v_mfma_f32_16x16x32_bf16 v[164:167], a[144:147], a[156:159], v[164:167]
    v_exp_f32 v131, v131
    v_exp_f32 v132, v132
    v_mfma_f32_16x16x32_bf16 v[168:171], a[144:147], a[160:163], v[168:171]
    v_exp_f32 v133, v133
    v_exp_f32 v134, v134
    v_mfma_f32_16x16x32_bf16 v[172:175], a[144:147], a[164:167], v[172:175]
    v_exp_f32 v135, v135
    v_pk_fma_f32 v[128:129], v[128:129], v[236:237], v[236:237] op_sel:[0,1,1] op_sel_hi:[1,1,1]
    v_pk_fma_f32 v[130:131], v[130:131], v[236:237], v[236:237] op_sel:[0,1,1] op_sel_hi:[1,1,1]
    v_pk_fma_f32 v[132:133], v[132:133], v[238:239], v[238:239] op_sel:[0,1,1] op_sel_hi:[1,1,1]
    v_pk_fma_f32 v[134:135], v[134:135], v[238:239], v[238:239] op_sel:[0,1,1] op_sel_hi:[1,1,1]
    v_rcp_f32 v128, v128
    v_mfma_f32_16x16x32_bf16 v[176:179], a[144:147], a[168:171], v[176:179]
    v_rcp_f32 v129, v129
    v_rcp_f32 v130, v130
    v_mfma_f32_16x16x32_bf16 v[180:183], a[144:147], a[172:175], v[180:183]
    v_rcp_f32 v131, v131
    v_rcp_f32 v132, v132
    v_mfma_f32_16x16x32_bf16 v[184:187], a[144:147], a[176:179], v[184:187]
    v_rcp_f32 v133, v133
    v_rcp_f32 v134, v134
    v_mfma_f32_16x16x32_bf16 v[188:191], a[144:147], a[180:183], v[188:191]
    v_rcp_f32 v135, v135
    v_pk_mul_f32 v[144:145], v[128:129], v[144:145]
    v_pk_mul_f32 v[146:147], v[130:131], v[146:147]
    v_pk_mul_f32 v[148:149], v[132:133], v[148:149]
    v_pk_mul_f32 v[150:151], v[134:135], v[150:151]
    v_cvt_pk_bf16_f32 v128, v144, v145
    v_cvt_pk_bf16_f32 v129, v146, v147
    v_cvt_pk_bf16_f32 v130, v148, v149
    v_cvt_pk_bf16_f32 v131, v150, v151
    s_nop 1
    v_permlane16_swap_b32 v128, v130
    v_permlane16_swap_b32 v129, v131
    buffer_store_dwordx4 v[128:131], v226, s[36:39], s34 offen offset:1024 sc1
    v_pk_mul_f32 v[136:137], v[136:137], v[240:241] op_sel_hi:[1,0]
    v_pk_mul_f32 v[138:139], v[138:139], v[240:241] op_sel_hi:[1,0]
    v_pk_mul_f32 v[140:141], v[140:141], v[242:243] op_sel_hi:[1,0]
    v_pk_mul_f32 v[142:143], v[142:143], v[242:243] op_sel_hi:[1,0]
    v_exp_f32 v136, v136
    v_exp_f32 v137, v137
    v_exp_f32 v138, v138
    v_exp_f32 v139, v139
    v_exp_f32 v140, v140
    v_exp_f32 v141, v141
    v_exp_f32 v142, v142
    v_exp_f32 v143, v143
    v_pk_fma_f32 v[136:137], v[136:137], v[240:241], v[240:241] op_sel:[0,1,1] op_sel_hi:[1,1,1]
    v_pk_fma_f32 v[138:139], v[138:139], v[240:241], v[240:241] op_sel:[0,1,1] op_sel_hi:[1,1,1]
    v_pk_fma_f32 v[140:141], v[140:141], v[242:243], v[242:243] op_sel:[0,1,1] op_sel_hi:[1,1,1]
    v_pk_fma_f32 v[142:143], v[142:143], v[242:243], v[242:243] op_sel:[0,1,1] op_sel_hi:[1,1,1]
    v_rcp_f32 v136, v136
    v_rcp_f32 v137, v137
    v_rcp_f32 v138, v138
    v_rcp_f32 v139, v139
    v_rcp_f32 v140, v140
    v_rcp_f32 v141, v141
    v_rcp_f32 v142, v142
    v_rcp_f32 v143, v143
    v_pk_mul_f32 v[152:153], v[136:137], v[152:153]
    v_pk_mul_f32 v[154:155], v[138:139], v[154:155]
    v_pk_mul_f32 v[156:157], v[140:141], v[156:157]
    v_pk_mul_f32 v[158:159], v[142:143], v[158:159]
    v_cvt_pk_bf16_f32 v136, v152, v153
    v_cvt_pk_bf16_f32 v137, v154, v155
    v_cvt_pk_bf16_f32 v138, v156, v157
    v_cvt_pk_bf16_f32 v139, v158, v159
    s_nop 1
    v_permlane16_swap_b32 v136, v138
    v_permlane16_swap_b32 v137, v139
    buffer_store_dwordx4 v[136:139], v226, s[36:39], s35 offen offset:1024 sc1
    v_pk_mul_f32 v[160:161], v[160:161], v[236:237] op_sel_hi:[1,0]
    v_pk_mul_f32 v[162:163], v[162:163], v[236:237] op_sel_hi:[1,0]
    v_pk_mul_f32 v[164:165], v[164:165], v[238:239] op_sel_hi:[1,0]
    v_pk_mul_f32 v[166:167], v[166:167], v[238:239] op_sel_hi:[1,0]
    v_exp_f32 v160, v160
    v_mfma_f32_16x16x32_bf16 v[192:195], a[148:151], a[152:155], v[192:195]
    v_exp_f32 v161, v161
    v_exp_f32 v162, v162
    v_mfma_f32_16x16x32_bf16 v[196:199], a[148:151], a[156:159], v[196:199]
    v_exp_f32 v163, v163
    v_exp_f32 v164, v164
    v_mfma_f32_16x16x32_bf16 v[200:203], a[148:151], a[160:163], v[200:203]
    v_exp_f32 v165, v165
    v_exp_f32 v166, v166
    v_mfma_f32_16x16x32_bf16 v[204:207], a[148:151], a[164:167], v[204:207]
    v_exp_f32 v167, v167
    v_pk_fma_f32 v[160:161], v[160:161], v[236:237], v[236:237] op_sel:[0,1,1] op_sel_hi:[1,1,1]
    v_pk_fma_f32 v[162:163], v[162:163], v[236:237], v[236:237] op_sel:[0,1,1] op_sel_hi:[1,1,1]
    v_pk_fma_f32 v[164:165], v[164:165], v[238:239], v[238:239] op_sel:[0,1,1] op_sel_hi:[1,1,1]
    v_pk_fma_f32 v[166:167], v[166:167], v[238:239], v[238:239] op_sel:[0,1,1] op_sel_hi:[1,1,1]
    v_rcp_f32 v160, v160
    v_mfma_f32_16x16x32_bf16 v[208:211], a[148:151], a[168:171], v[208:211]
    v_rcp_f32 v161, v161
    v_rcp_f32 v162, v162
    v_mfma_f32_16x16x32_bf16 v[212:215], a[148:151], a[172:175], v[212:215]
    v_rcp_f32 v163, v163
    v_rcp_f32 v164, v164
    v_mfma_f32_16x16x32_bf16 v[216:219], a[148:151], a[176:179], v[216:219]
    v_rcp_f32 v165, v165
    v_rcp_f32 v166, v166
    v_mfma_f32_16x16x32_bf16 v[220:223], a[148:151], a[180:183], v[220:223]
    v_rcp_f32 v167, v167
    v_pk_mul_f32 v[176:177], v[160:161], v[176:177]
    v_pk_mul_f32 v[178:179], v[162:163], v[178:179]
    v_pk_mul_f32 v[180:181], v[164:165], v[180:181]
    v_pk_mul_f32 v[182:183], v[166:167], v[182:183]
    v_cvt_pk_bf16_f32 v160, v176, v177
    v_cvt_pk_bf16_f32 v161, v178, v179
    v_cvt_pk_bf16_f32 v162, v180, v181
    v_cvt_pk_bf16_f32 v163, v182, v183
    s_nop 1
    v_permlane16_swap_b32 v160, v162
    v_permlane16_swap_b32 v161, v163
    buffer_store_dwordx4 v[160:163], v226, s[36:39], s34 offen offset:2048 sc1
    v_pk_mul_f32 v[168:169], v[168:169], v[240:241] op_sel_hi:[1,0]
    v_pk_mul_f32 v[170:171], v[170:171], v[240:241] op_sel_hi:[1,0]
    v_pk_mul_f32 v[172:173], v[172:173], v[242:243] op_sel_hi:[1,0]
    v_pk_mul_f32 v[174:175], v[174:175], v[242:243] op_sel_hi:[1,0]
    v_exp_f32 v168, v168
    v_exp_f32 v169, v169
    v_exp_f32 v170, v170
    v_exp_f32 v171, v171
    v_exp_f32 v172, v172
    v_exp_f32 v173, v173
    v_exp_f32 v174, v174
    v_exp_f32 v175, v175
    v_pk_fma_f32 v[168:169], v[168:169], v[240:241], v[240:241] op_sel:[0,1,1] op_sel_hi:[1,1,1]
    v_pk_fma_f32 v[170:171], v[170:171], v[240:241], v[240:241] op_sel:[0,1,1] op_sel_hi:[1,1,1]
    v_pk_fma_f32 v[172:173], v[172:173], v[242:243], v[242:243] op_sel:[0,1,1] op_sel_hi:[1,1,1]
    v_pk_fma_f32 v[174:175], v[174:175], v[242:243], v[242:243] op_sel:[0,1,1] op_sel_hi:[1,1,1]
    v_rcp_f32 v168, v168
    v_rcp_f32 v169, v169
    v_rcp_f32 v170, v170
    v_rcp_f32 v171, v171
    v_rcp_f32 v172, v172
    v_rcp_f32 v173, v173
    v_rcp_f32 v174, v174
    v_rcp_f32 v175, v175
    v_pk_mul_f32 v[184:185], v[168:169], v[184:185]
    v_pk_mul_f32 v[186:187], v[170:171], v[186:187]
    v_pk_mul_f32 v[188:189], v[172:173], v[188:189]
    v_pk_mul_f32 v[190:191], v[174:175], v[190:191]
    v_cvt_pk_bf16_f32 v168, v184, v185
    v_cvt_pk_bf16_f32 v169, v186, v187
    v_cvt_pk_bf16_f32 v170, v188, v189
    v_cvt_pk_bf16_f32 v171, v190, v191
    s_nop 1
    v_permlane16_swap_b32 v168, v170
    v_permlane16_swap_b32 v169, v171
    buffer_store_dwordx4 v[168:171], v226, s[36:39], s35 offen offset:2048 sc1
    v_bfe_u32 v249, v235, 2, 2
    v_lshrrev_b32 v250, 5, v235
    v_lshl_add_u32 v249, v250, 3, v249
    v_lshlrev_b32 v249, 7, v249
    v_and_b32 v250, 3, v235
    v_lshl_add_u32 v249, v250, 3, v249
    v_bfe_u32 v250, v235, 4, 1
    v_lshl_add_u32 v249, v250, 5, v249
    v_bfe_u32 v250, v235, 3, 1
    v_lshl_add_u32 v96, v250, 6, v249
    v_xor_b32 v97, 64, v96
    v_add_u32 v98, 65536, v96
    v_add_u32 v99, 65536, v97
    v_add_u32 v100, 114688, v96
    v_add_u32 v101, 114688, v97
    v_pk_mul_f32 v[192:193], v[192:193], v[236:237] op_sel_hi:[1,0]
    v_pk_mul_f32 v[194:195], v[194:195], v[236:237] op_sel_hi:[1,0]
    v_pk_mul_f32 v[196:197], v[196:197], v[238:239] op_sel_hi:[1,0]
    v_pk_mul_f32 v[198:199], v[198:199], v[238:239] op_sel_hi:[1,0]
    v_exp_f32 v192, v192
    v_exp_f32 v193, v193
    v_exp_f32 v194, v194
    v_exp_f32 v195, v195
    v_exp_f32 v196, v196
    v_exp_f32 v197, v197
    v_exp_f32 v198, v198
    v_exp_f32 v199, v199
    v_pk_fma_f32 v[192:193], v[192:193], v[236:237], v[236:237] op_sel:[0,1,1] op_sel_hi:[1,1,1]
    v_pk_fma_f32 v[194:195], v[194:195], v[236:237], v[236:237] op_sel:[0,1,1] op_sel_hi:[1,1,1]
    v_pk_fma_f32 v[196:197], v[196:197], v[238:239], v[238:239] op_sel:[0,1,1] op_sel_hi:[1,1,1]
    v_pk_fma_f32 v[198:199], v[198:199], v[238:239], v[238:239] op_sel:[0,1,1] op_sel_hi:[1,1,1]
    v_rcp_f32 v192, v192
    v_rcp_f32 v193, v193
    v_rcp_f32 v194, v194
    v_rcp_f32 v195, v195
    v_rcp_f32 v196, v196
    v_rcp_f32 v197, v197
    v_rcp_f32 v198, v198
    v_rcp_f32 v199, v199
    v_pk_mul_f32 v[208:209], v[192:193], v[208:209]
    v_pk_mul_f32 v[210:211], v[194:195], v[210:211]
    v_pk_mul_f32 v[212:213], v[196:197], v[212:213]
    v_pk_mul_f32 v[214:215], v[198:199], v[214:215]
    v_cvt_pk_bf16_f32 v192, v208, v209
    v_cvt_pk_bf16_f32 v193, v210, v211
    v_cvt_pk_bf16_f32 v194, v212, v213
    v_cvt_pk_bf16_f32 v195, v214, v215
    s_nop 1
    v_permlane16_swap_b32 v192, v194
    v_permlane16_swap_b32 v193, v195
    buffer_store_dwordx4 v[192:195], v226, s[36:39], s34 offen offset:3072 sc1
    v_pk_mul_f32 v[200:201], v[200:201], v[240:241] op_sel_hi:[1,0]
    v_pk_mul_f32 v[202:203], v[202:203], v[240:241] op_sel_hi:[1,0]
    v_pk_mul_f32 v[204:205], v[204:205], v[242:243] op_sel_hi:[1,0]
    v_pk_mul_f32 v[206:207], v[206:207], v[242:243] op_sel_hi:[1,0]
    v_exp_f32 v200, v200
    buffer_load_dword v248, v244, s[12:15], s47 offen sc1
    v_exp_f32 v201, v201
    v_exp_f32 v202, v202
    v_exp_f32 v203, v203
    v_exp_f32 v204, v204
    v_exp_f32 v205, v205
    v_exp_f32 v206, v206
    v_exp_f32 v207, v207
    v_pk_fma_f32 v[200:201], v[200:201], v[240:241], v[240:241] op_sel:[0,1,1] op_sel_hi:[1,1,1]
    v_pk_fma_f32 v[202:203], v[202:203], v[240:241], v[240:241] op_sel:[0,1,1] op_sel_hi:[1,1,1]
    v_pk_fma_f32 v[204:205], v[204:205], v[242:243], v[242:243] op_sel:[0,1,1] op_sel_hi:[1,1,1]
    v_pk_fma_f32 v[206:207], v[206:207], v[242:243], v[242:243] op_sel:[0,1,1] op_sel_hi:[1,1,1]
    v_rcp_f32 v200, v200
    v_rcp_f32 v201, v201
    v_rcp_f32 v202, v202
    v_rcp_f32 v203, v203
    v_rcp_f32 v204, v204
    v_rcp_f32 v205, v205
    v_rcp_f32 v206, v206
    v_rcp_f32 v207, v207
    v_pk_mul_f32 v[216:217], v[200:201], v[216:217]
    v_pk_mul_f32 v[218:219], v[202:203], v[218:219]
    v_pk_mul_f32 v[220:221], v[204:205], v[220:221]
    v_pk_mul_f32 v[222:223], v[206:207], v[222:223]
    v_cvt_pk_bf16_f32 v200, v216, v217
    v_cvt_pk_bf16_f32 v201, v218, v219
    v_cvt_pk_bf16_f32 v202, v220, v221
    v_cvt_pk_bf16_f32 v203, v222, v223
    s_nop 1
    v_permlane16_swap_b32 v200, v202
    v_permlane16_swap_b32 v201, v203
    buffer_store_dwordx4 v[200:203], v226, s[36:39], s35 offen offset:3072 sc1
    ds_read_b64_tr_b16 v[128:129], v100 offset:0
    ds_read_b64_tr_b16 v[130:131], v100 offset:512
    ds_read_b64_tr_b16 v[132:133], v101 offset:0
    ds_read_b64_tr_b16 v[134:135], v101 offset:512
    ds_read_b64_tr_b16 v[136:137], v100 offset:2048
    ds_read_b64_tr_b16 v[138:139], v100 offset:2560
    ds_read_b64_tr_b16 v[140:141], v101 offset:2048
    ds_read_b64_tr_b16 v[142:143], v101 offset:2560
    ds_read_b64_tr_b16 v[144:145], v100 offset:4096
    ds_read_b64_tr_b16 v[146:147], v100 offset:4608
    ds_read_b64_tr_b16 v[148:149], v101 offset:4096
    ds_read_b64_tr_b16 v[150:151], v101 offset:4608
    ds_read_b64_tr_b16 v[152:153], v100 offset:6144
    ds_read_b64_tr_b16 v[154:155], v100 offset:6656
    ds_read_b64_tr_b16 v[156:157], v101 offset:6144
    ds_read_b64_tr_b16 v[158:159], v101 offset:6656
    s_waitcnt vmcnt(1)
    v_cmp_eq_u32 vcc, 1, v248
    s_nop 1
    s_cmp_eq_u64 vcc, -1
    s_cbranch_scc0 mlp_kernel_pollA_slow
mlp_kernel_pollA_go:
    buffer_load_dwordx4 a[0:3], v226, s[4:7], s16 offen offset:0 sc1
    buffer_load_dwordx4 a[4:7], v226, s[4:7], s16 offen offset:1024 sc1
    buffer_load_dwordx4 a[8:11], v226, s[4:7], s16 offen offset:2048 sc1
    buffer_load_dwordx4 a[12:15], v226, s[4:7], s16 offen offset:3072 sc1
    s_add_u32 s16, s16, 4096
    buffer_load_dwordx4 a[16:19], v226, s[4:7], s16 offen offset:0 sc1
    buffer_load_dwordx4 a[20:23], v226, s[4:7], s16 offen offset:1024 sc1
    buffer_load_dwordx4 a[24:27], v226, s[4:7], s16 offen offset:2048 sc1
    buffer_load_dwordx4 a[28:31], v226, s[4:7], s16 offen offset:3072 sc1
    s_add_u32 s16, s16, 4096
    buffer_load_dwordx4 a[32:35], v226, s[4:7], s16 offen offset:0 sc1
    buffer_load_dwordx4 a[36:39], v226, s[4:7], s16 offen offset:1024 sc1
    buffer_load_dwordx4 a[40:43], v226, s[4:7], s16 offen offset:2048 sc1
    buffer_load_dwordx4 a[44:47], v226, s[4:7], s16 offen offset:3072 sc1
    s_add_u32 s16, s16, 4096
    buffer_load_dwordx4 a[48:51], v226, s[4:7], s16 offen offset:0 sc1
    buffer_load_dwordx4 a[52:55], v226, s[4:7], s16 offen offset:1024 sc1
    buffer_load_dwordx4 a[56:59], v226, s[4:7], s16 offen offset:2048 sc1
    buffer_load_dwordx4 a[60:63], v226, s[4:7], s16 offen offset:3072 sc1
    s_waitcnt vmcnt(15) lgkmcnt(12)
    v_mfma_f32_32x32x16_bf16 v[32:47], v[128:131], a[0:3], 0
    ds_read_b64_tr_b16 v[128:129], v100 offset:8192
    ds_read_b64_tr_b16 v[130:131], v100 offset:8704
    v_mfma_f32_32x32x16_bf16 v[48:63], v[132:135], a[0:3], 0
    ds_read_b64_tr_b16 v[132:133], v101 offset:8192
    ds_read_b64_tr_b16 v[134:135], v101 offset:8704
    s_add_u32 s16, s16, 4096
    buffer_load_dwordx4 a[64:67], v226, s[4:7], s16 offen offset:0 sc1
    s_waitcnt vmcnt(15) lgkmcnt(12)
    v_mfma_f32_32x32x16_bf16 v[32:47], v[136:139], a[4:7], v[32:47]
    ds_read_b64_tr_b16 v[136:137], v100 offset:10240
    ds_read_b64_tr_b16 v[138:139], v100 offset:10752
    v_mfma_f32_32x32x16_bf16 v[48:63], v[140:143], a[4:7], v[48:63]
    ds_read_b64_tr_b16 v[140:141], v101 offset:10240
    ds_read_b64_tr_b16 v[142:143], v101 offset:10752
    buffer_load_dwordx4 a[68:71], v226, s[4:7], s16 offen offset:1024 sc1
    s_waitcnt vmcnt(15) lgkmcnt(12)
    v_mfma_f32_32x32x16_bf16 v[32:47], v[144:147], a[8:11], v[32:47]
    ds_read_b64_tr_b16 v[144:145], v100 offset:12288
    ds_read_b64_tr_b16 v[146:147], v100 offset:12800
    v_mfma_f32_32x32x16_bf16 v[48:63], v[148:151], a[8:11], v[48:63]
    ds_read_b64_tr_b16 v[148:149], v101 offset:12288
    ds_read_b64_tr_b16 v[150:151], v101 offset:12800
    buffer_load_dwordx4 a[72:75], v226, s[4:7], s16 offen offset:2048 sc1
    s_waitcnt vmcnt(15) lgkmcnt(12)
    v_mfma_f32_32x32x16_bf16 v[32:47], v[152:155], a[12:15], v[32:47]
    ds_read_b64_tr_b16 v[152:153], v100 offset:14336
    ds_read_b64_tr_b16 v[154:155], v100 offset:14848
    v_mfma_f32_32x32x16_bf16 v[48:63], v[156:159], a[12:15], v[48:63]
    ds_read_b64_tr_b16 v[156:157], v101 offset:14336
    ds_read_b64_tr_b16 v[158:159], v101 offset:14848
    buffer_load_dwordx4 a[76:79], v226, s[4:7], s16 offen offset:3072 sc1
    s_waitcnt vmcnt(15) lgkmcnt(12)
    v_mfma_f32_32x32x16_bf16 v[32:47], v[128:131], a[16:19], v[32:47]
    ds_read_b64_tr_b16 v[128:129], v100 offset:16384
    ds_read_b64_tr_b16 v[130:131], v100 offset:16896
    v_mfma_f32_32x32x16_bf16 v[48:63], v[132:135], a[16:19], v[48:63]
    ds_read_b64_tr_b16 v[132:133], v101 offset:16384
    ds_read_b64_tr_b16 v[134:135], v101 offset:16896
    s_add_u32 s16, s16, 4096
    buffer_load_dwordx4 a[80:83], v226, s[4:7], s16 offen offset:0 sc1
    s_waitcnt vmcnt(15) lgkmcnt(12)
    v_mfma_f32_32x32x16_bf16 v[32:47], v[136:139], a[20:23], v[32:47]
    ds_read_b64_tr_b16 v[136:137], v100 offset:18432
    ds_read_b64_tr_b16 v[138:139], v100 offset:18944
    v_mfma_f32_32x32x16_bf16 v[48:63], v[140:143], a[20:23], v[48:63]
    ds_read_b64_tr_b16 v[140:141], v101 offset:18432
    ds_read_b64_tr_b16 v[142:143], v101 offset:18944
    buffer_load_dwordx4 a[84:87], v226, s[4:7], s16 offen offset:1024 sc1
    s_waitcnt vmcnt(15) lgkmcnt(12)
    v_mfma_f32_32x32x16_bf16 v[32:47], v[144:147], a[24:27], v[32:47]
    ds_read_b64_tr_b16 v[144:145], v100 offset:20480
    ds_read_b64_tr_b16 v[146:147], v100 offset:20992
    v_mfma_f32_32x32x16_bf16 v[48:63], v[148:151], a[24:27], v[48:63]
    ds_read_b64_tr_b16 v[148:149], v101 offset:20480
    ds_read_b64_tr_b16 v[150:151], v101 offset:20992
    buffer_load_dwordx4 a[88:91], v226, s[4:7], s16 offen offset:2048 sc1
    s_waitcnt vmcnt(15) lgkmcnt(12)
    v_mfma_f32_32x32x16_bf16 v[32:47], v[152:155], a[28:31], v[32:47]
    ds_read_b64_tr_b16 v[152:153], v100 offset:22528
    ds_read_b64_tr_b16 v[154:155], v100 offset:23040
    v_mfma_f32_32x32x16_bf16 v[48:63], v[156:159], a[28:31], v[48:63]
    ds_read_b64_tr_b16 v[156:157], v101 offset:22528
    ds_read_b64_tr_b16 v[158:159], v101 offset:23040
    buffer_load_dwordx4 a[92:95], v226, s[4:7], s16 offen offset:3072 sc1
    s_waitcnt vmcnt(15) lgkmcnt(12)
    s_barrier
    v_mfma_f32_32x32x16_bf16 v[32:47], v[128:131], a[32:35], v[32:47]
    ds_read_b64_tr_b16 v[128:129], v100 offset:24576
    ds_read_b64_tr_b16 v[130:131], v100 offset:25088
    s_cmp_lg_u32 s21, 0
    s_cbranch_scc1 mlp_kernel_noflagB
    s_mov_b64 exec, 1
    s_add_u32 s46, s46, 8192
    buffer_store_dword v247, v246, s[12:15], s46 offen sc1
    s_mov_b64 exec, -1
mlp_kernel_noflagB:
    v_mfma_f32_32x32x16_bf16 v[48:63], v[132:135], a[32:35], v[48:63]
    s_add_u32 m0, s18, 114688
    ds_read_b64_tr_b16 v[132:133], v101 offset:24576
    ds_read_b64_tr_b16 v[134:135], v101 offset:25088
    s_add_u32 s16, s16, 4096
    buffer_load_dwordx4 a[96:99], v226, s[4:7], s16 offen offset:0 sc1
    s_add_u32 s54, s54, 8192
    buffer_load_dwordx4 v226, s[56:59], s54 offen offset:0 lds
    s_waitcnt vmcnt(16) lgkmcnt(12)
    v_mfma_f32_32x32x16_bf16 v[32:47], v[136:139], a[36:39], v[32:47]
    ds_read_b64_tr_b16 v[136:137], v100 offset:26624
    ds_read_b64_tr_b16 v[138:139], v100 offset:27136
    v_mfma_f32_32x32x16_bf16 v[48:63], v[140:143], a[36:39], v[48:63]
    ds_read_b64_tr_b16 v[140:141], v101 offset:26624
    ds_read_b64_tr_b16 v[142:143], v101 offset:27136
    buffer_load_dwordx4 a[100:103], v226, s[4:7], s16 offen offset:1024 sc1
    s_waitcnt vmcnt(16) lgkmcnt(12)
    v_mfma_f32_32x32x16_bf16 v[32:47], v[144:147], a[40:43], v[32:47]
    ds_read_b64_tr_b16 v[144:145], v100 offset:28672
    ds_read_b64_tr_b16 v[146:147], v100 offset:29184
    buffer_load_dwordx4 v226, s[56:59], s54 offen offset:1024 lds
    v_mfma_f32_32x32x16_bf16 v[48:63], v[148:151], a[40:43], v[48:63]
    ds_read_b64_tr_b16 v[148:149], v101 offset:28672
    ds_read_b64_tr_b16 v[150:151], v101 offset:29184
    buffer_load_dwordx4 a[104:107], v226, s[4:7], s16 offen offset:2048 sc1
    s_waitcnt vmcnt(17) lgkmcnt(12)
    v_mfma_f32_32x32x16_bf16 v[32:47], v[152:155], a[44:47], v[32:47]
    ds_read_b64_tr_b16 v[152:153], v100 offset:30720
    ds_read_b64_tr_b16 v[154:155], v100 offset:31232
    v_mfma_f32_32x32x16_bf16 v[48:63], v[156:159], a[44:47], v[48:63]
    ds_read_b64_tr_b16 v[156:157], v101 offset:30720
    ds_read_b64_tr_b16 v[158:159], v101 offset:31232
    buffer_load_dwordx4 a[108:111], v226, s[4:7], s16 offen offset:3072 sc1
    s_waitcnt vmcnt(17) lgkmcnt(12)
    v_mfma_f32_32x32x16_bf16 v[32:47], v[128:131], a[48:51], v[32:47]
    ds_read_b64_tr_b16 v[128:129], v100 offset:32768
    ds_read_b64_tr_b16 v[130:131], v100 offset:33280
    buffer_load_dwordx4 v[160:163], v226, s[40:43], s50 offen offset:0
    buffer_load_dwordx4 v[164:167], v226, s[40:43], s50 offen offset:1024
    buffer_load_dwordx4 v[168:171], v226, s[40:43], s50 offen offset:2048
    buffer_load_dwordx4 v[172:175], v226, s[40:43], s50 offen offset:3072
    v_mfma_f32_32x32x16_bf16 v[48:63], v[132:135], a[48:51], v[48:63]
    s_add_u32 m0, s18, 122880
    ds_read_b64_tr_b16 v[132:133], v101 offset:32768
    ds_read_b64_tr_b16 v[134:135], v101 offset:33280
    s_add_u32 s16, s16, 4096
    buffer_load_dwordx4 a[112:115], v226, s[4:7], s16 offen offset:0 sc1
    s_add_u32 s3, s3, 8192
    buffer_load_dwordx4 v226, s[56:59], s3 offen offset:0 lds
    s_waitcnt vmcnt(22) lgkmcnt(12)
    v_mfma_f32_32x32x16_bf16 v[32:47], v[136:139], a[52:55], v[32:47]
    ds_read_b64_tr_b16 v[136:137], v100 offset:34816
    ds_read_b64_tr_b16 v[138:139], v100 offset:35328
    v_mfma_f32_32x32x16_bf16 v[48:63], v[140:143], a[52:55], v[48:63]
    ds_read_b64_tr_b16 v[140:141], v101 offset:34816
    ds_read_b64_tr_b16 v[142:143], v101 offset:35328
    buffer_load_dwordx4 a[116:119], v226, s[4:7], s16 offen offset:1024 sc1
    s_waitcnt vmcnt(22) lgkmcnt(12)
    v_mfma_f32_32x32x16_bf16 v[32:47], v[144:147], a[56:59], v[32:47]
    ds_read_b64_tr_b16 v[144:145], v100 offset:36864
    ds_read_b64_tr_b16 v[146:147], v100 offset:37376
    buffer_load_dwordx4 v226, s[56:59], s3 offen offset:1024 lds
    v_mfma_f32_32x32x16_bf16 v[48:63], v[148:151], a[56:59], v[48:63]
    ds_read_b64_tr_b16 v[148:149], v101 offset:36864
    ds_read_b64_tr_b16 v[150:151], v101 offset:37376
    buffer_load_dwordx4 a[120:123], v226, s[4:7], s16 offen offset:2048 sc1
    s_waitcnt vmcnt(23) lgkmcnt(12)
    v_mfma_f32_32x32x16_bf16 v[32:47], v[152:155], a[60:63], v[32:47]
    ds_read_b64_tr_b16 v[152:153], v100 offset:38912
    ds_read_b64_tr_b16 v[154:155], v100 offset:39424
    v_mfma_f32_32x32x16_bf16 v[48:63], v[156:159], a[60:63], v[48:63]
    ds_read_b64_tr_b16 v[156:157], v101 offset:38912
    ds_read_b64_tr_b16 v[158:159], v101 offset:39424
    buffer_load_dwordx4 a[124:127], v226, s[4:7], s16 offen offset:3072 sc1
    s_waitcnt vmcnt(23) lgkmcnt(12)
    s_barrier
    v_mfma_f32_32x32x16_bf16 v[32:47], v[128:131], a[64:67], v[32:47]
    ds_read_b64_tr_b16 v[128:129], v100 offset:40960
    ds_read_b64_tr_b16 v[130:131], v100 offset:41472
    v_mfma_f32_32x32x16_bf16 v[48:63], v[132:135], a[64:67], v[48:63]
    s_add_u32 m0, s18, 131072
    ds_read_b64_tr_b16 v[132:133], v101 offset:40960
    ds_read_b64_tr_b16 v[134:135], v101 offset:41472
    s_add_u32 s16, s16, 4096
    buffer_load_dwordx4 a[128:131], v226, s[4:7], s16 offen offset:0 sc1
    s_add_u32 s54, s54, 8192
    buffer_load_dwordx4 v226, s[56:59], s54 offen offset:0 lds
    s_waitcnt vmcnt(24) lgkmcnt(12)
    v_mfma_f32_32x32x16_bf16 v[32:47], v[136:139], a[68:71], v[32:47]
    ds_read_b64_tr_b16 v[136:137], v100 offset:43008
    ds_read_b64_tr_b16 v[138:139], v100 offset:43520
    v_mfma_f32_32x32x16_bf16 v[48:63], v[140:143], a[68:71], v[48:63]
    ds_read_b64_tr_b16 v[140:141], v101 offset:43008
    ds_read_b64_tr_b16 v[142:143], v101 offset:43520
    buffer_load_dwordx4 a[132:135], v226, s[4:7], s16 offen offset:1024 sc1
    s_waitcnt vmcnt(24) lgkmcnt(12)
    v_mfma_f32_32x32x16_bf16 v[32:47], v[144:147], a[72:75], v[32:47]
    ds_read_b64_tr_b16 v[144:145], v100 offset:45056
    ds_read_b64_tr_b16 v[146:147], v100 offset:45568
    buffer_load_dwordx4 v226, s[56:59], s54 offen offset:1024 lds
    v_mfma_f32_32x32x16_bf16 v[48:63], v[148:151], a[72:75], v[48:63]
    ds_read_b64_tr_b16 v[148:149], v101 offset:45056
    ds_read_b64_tr_b16 v[150:151], v101 offset:45568
    buffer_load_dwordx4 a[136:139], v226, s[4:7], s16 offen offset:2048 sc1
    s_waitcnt vmcnt(25) lgkmcnt(12)
    v_mfma_f32_32x32x16_bf16 v[32:47], v[152:155], a[76:79], v[32:47]
    ds_read_b64_tr_b16 v[152:153], v100 offset:47104
    ds_read_b64_tr_b16 v[154:155], v100 offset:47616
    v_mfma_f32_32x32x16_bf16 v[48:63], v[156:159], a[76:79], v[48:63]
    ds_read_b64_tr_b16 v[156:157], v101 offset:47104
    ds_read_b64_tr_b16 v[158:159], v101 offset:47616
    buffer_load_dwordx4 a[140:143], v226, s[4:7], s16 offen offset:3072 sc1
    s_waitcnt vmcnt(25) lgkmcnt(12)
    v_mfma_f32_32x32x16_bf16 v[32:47], v[128:131], a[80:83], v[32:47]
    ds_read_b64_tr_b16 v[128:129], v96 offset:0
    ds_read_b64_tr_b16 v[130:131], v96 offset:512
    v_mfma_f32_32x32x16_bf16 v[48:63], v[132:135], a[80:83], v[48:63]
    s_add_u32 m0, s18, 139264
    ds_read_b64_tr_b16 v[132:133], v97 offset:0
    ds_read_b64_tr_b16 v[134:135], v97 offset:512
    s_add_u32 s16, s16, 4096
    buffer_load_dwordx4 a[144:147], v226, s[4:7], s16 offen offset:0 sc1
    s_add_u32 s3, s3, 8192
    buffer_load_dwordx4 v226, s[56:59], s3 offen offset:0 lds
    s_waitcnt vmcnt(26) lgkmcnt(12)
    v_mfma_f32_32x32x16_bf16 v[32:47], v[136:139], a[84:87], v[32:47]
    ds_read_b64_tr_b16 v[136:137], v96 offset:2048
    ds_read_b64_tr_b16 v[138:139], v96 offset:2560
    v_mfma_f32_32x32x16_bf16 v[48:63], v[140:143], a[84:87], v[48:63]
    ds_read_b64_tr_b16 v[140:141], v97 offset:2048
    ds_read_b64_tr_b16 v[142:143], v97 offset:2560
    buffer_load_dwordx4 a[148:151], v226, s[4:7], s16 offen offset:1024 sc1
    s_waitcnt vmcnt(26) lgkmcnt(12)
    v_mfma_f32_32x32x16_bf16 v[32:47], v[144:147], a[88:91], v[32:47]
    ds_read_b64_tr_b16 v[144:145], v96 offset:4096
    ds_read_b64_tr_b16 v[146:147], v96 offset:4608
    s_add_u32 s47, s47, 8192
    buffer_load_dword v248, v244, s[12:15], s47 offen sc1
    buffer_load_dwordx4 v226, s[56:59], s3 offen offset:1024 lds
    v_mfma_f32_32x32x16_bf16 v[48:63], v[148:151], a[88:91], v[48:63]
    ds_read_b64_tr_b16 v[148:149], v97 offset:4096
    ds_read_b64_tr_b16 v[150:151], v97 offset:4608
    buffer_load_dwordx4 a[152:155], v226, s[4:7], s16 offen offset:2048 sc1
    s_waitcnt vmcnt(28) lgkmcnt(12)
    v_mfma_f32_32x32x16_bf16 v[32:47], v[152:155], a[92:95], v[32:47]
    ds_read_b64_tr_b16 v[152:153], v96 offset:6144
    ds_read_b64_tr_b16 v[154:155], v96 offset:6656
    v_mfma_f32_32x32x16_bf16 v[48:63], v[156:159], a[92:95], v[48:63]
    ds_read_b64_tr_b16 v[156:157], v97 offset:6144
    ds_read_b64_tr_b16 v[158:159], v97 offset:6656
    buffer_load_dwordx4 a[156:159], v226, s[4:7], s16 offen offset:3072 sc1
    s_waitcnt vmcnt(28) lgkmcnt(12)
    s_barrier
    v_mfma_f32_32x32x16_bf16 v[32:47], v[128:131], a[96:99], v[32:47]
    ds_read_b64_tr_b16 v[128:129], v96 offset:8192
    ds_read_b64_tr_b16 v[130:131], v96 offset:8704
    v_mfma_f32_32x32x16_bf16 v[48:63], v[132:135], a[96:99], v[48:63]
    s_add_u32 m0, s18, 147456
    ds_read_b64_tr_b16 v[132:133], v97 offset:8192
    ds_read_b64_tr_b16 v[134:135], v97 offset:8704
    s_add_u32 s16, s16, 4096
    buffer_load_dwordx4 a[160:163], v226, s[4:7], s16 offen offset:0 sc1
    s_add_u32 s54, s54, 8192
    buffer_load_dwordx4 v226, s[56:59], s54 offen offset:0 lds
    s_waitcnt vmcnt(28) lgkmcnt(12)
    v_mfma_f32_32x32x16_bf16 v[32:47], v[136:139], a[100:103], v[32:47]
    ds_read_b64_tr_b16 v[136:137], v96 offset:10240
    ds_read_b64_tr_b16 v[138:139], v96 offset:10752
    v_mfma_f32_32x32x16_bf16 v[48:63], v[140:143], a[100:103], v[48:63]
    ds_read_b64_tr_b16 v[140:141], v97 offset:10240
    ds_read_b64_tr_b16 v[142:143], v97 offset:10752
    buffer_load_dwordx4 a[164:167], v226, s[4:7], s16 offen offset:1024 sc1
    s_waitcnt vmcnt(27) lgkmcnt(12)
    v_mfma_f32_32x32x16_bf16 v[32:47], v[144:147], a[104:107], v[32:47]
    ds_read_b64_tr_b16 v[144:145], v96 offset:12288
    ds_read_b64_tr_b16 v[146:147], v96 offset:12800
    buffer_load_dwordx4 v226, s[56:59], s54 offen offset:1024 lds
    v_mfma_f32_32x32x16_bf16 v[48:63], v[148:151], a[104:107], v[48:63]
    ds_read_b64_tr_b16 v[148:149], v97 offset:12288
    ds_read_b64_tr_b16 v[150:151], v97 offset:12800
    buffer_load_dwordx4 a[168:171], v226, s[4:7], s16 offen offset:2048 sc1
    s_waitcnt vmcnt(28) lgkmcnt(12)
    v_mfma_f32_32x32x16_bf16 v[32:47], v[152:155], a[108:111], v[32:47]
    ds_read_b64_tr_b16 v[152:153], v96 offset:14336
    ds_read_b64_tr_b16 v[154:155], v96 offset:14848
    v_mfma_f32_32x32x16_bf16 v[48:63], v[156:159], a[108:111], v[48:63]
    ds_read_b64_tr_b16 v[156:157], v97 offset:14336
    ds_read_b64_tr_b16 v[158:159], v97 offset:14848
    buffer_load_dwordx4 a[172:175], v226, s[4:7], s16 offen offset:3072 sc1
    s_waitcnt vmcnt(24) lgkmcnt(12)
    v_mfma_f32_32x32x16_bf16 v[32:47], v[128:131], a[112:115], v[32:47]
    ds_read_b64_tr_b16 v[128:129], v96 offset:16384
    ds_read_b64_tr_b16 v[130:131], v96 offset:16896
    v_mfma_f32_32x32x16_bf16 v[48:63], v[132:135], a[112:115], v[48:63]
    s_add_u32 m0, s18, 155648
    ds_read_b64_tr_b16 v[132:133], v97 offset:16384
    ds_read_b64_tr_b16 v[134:135], v97 offset:16896
    s_add_u32 s16, s16, 4096
    buffer_load_dwordx4 a[176:179], v226, s[4:7], s16 offen offset:0 sc1
    s_add_u32 s3, s3, 8192
    buffer_load_dwordx4 v226, s[56:59], s3 offen offset:0 lds
    s_waitcnt vmcnt(24) lgkmcnt(12)
    v_mfma_f32_32x32x16_bf16 v[32:47], v[136:139], a[116:119], v[32:47]
    ds_read_b64_tr_b16 v[136:137], v96 offset:18432
    ds_read_b64_tr_b16 v[138:139], v96 offset:18944
    v_mfma_f32_32x32x16_bf16 v[48:63], v[140:143], a[116:119], v[48:63]
    ds_read_b64_tr_b16 v[140:141], v97 offset:18432
    ds_read_b64_tr_b16 v[142:143], v97 offset:18944
    buffer_load_dwordx4 a[180:183], v226, s[4:7], s16 offen offset:1024 sc1
    s_waitcnt vmcnt(23) lgkmcnt(12)
    v_mfma_f32_32x32x16_bf16 v[32:47], v[144:147], a[120:123], v[32:47]
    ds_read_b64_tr_b16 v[144:145], v96 offset:20480
    ds_read_b64_tr_b16 v[146:147], v96 offset:20992
    v_lshlrev_b32 v0, 16, v160
    buffer_load_dwordx4 v226, s[56:59], s3 offen offset:1024 lds
    v_mfma_f32_32x32x16_bf16 v[48:63], v[148:151], a[120:123], v[48:63]
    ds_read_b64_tr_b16 v[148:149], v97 offset:20480
    ds_read_b64_tr_b16 v[150:151], v97 offset:20992
    v_and_b32 v1, s19, v160
    v_lshlrev_b32 v2, 16, v161
    buffer_load_dwordx4 a[184:187], v226, s[4:7], s16 offen offset:2048 sc1
    s_waitcnt vmcnt(24) lgkmcnt(12)
    v_mfma_f32_32x32x16_bf16 v[32:47], v[152:155], a[124:127], v[32:47]
    ds_read_b64_tr_b16 v[152:153], v96 offset:22528
    ds_read_b64_tr_b16 v[154:155], v96 offset:23040
    v_and_b32 v3, s19, v161
    v_lshlrev_b32 v4, 16, v162
    v_mfma_f32_32x32x16_bf16 v[48:63], v[156:159], a[124:127], v[48:63]
    ds_read_b64_tr_b16 v[156:157], v97 offset:22528
    ds_read_b64_tr_b16 v[158:159], v97 offset:23040
    v_and_b32 v5, s19, v162
    v_lshlrev_b32 v6, 16, v163
    buffer_load_dwordx4 a[188:191], v226, s[4:7], s16 offen offset:3072 sc1
    s_waitcnt vmcnt(24) lgkmcnt(12)
    s_barrier
    v_mfma_f32_32x32x16_bf16 v[32:47], v[128:131], a[128:131], v[32:47]
    ds_read_b64_tr_b16 v[128:129], v96 offset:24576
    ds_read_b64_tr_b16 v[130:131], v96 offset:25088
    s_waitcnt vmcnt(15)
    v_cmp_eq_u32 vcc, 1, v248
    s_nop 1
    s_cmp_eq_u64 vcc, -1
    s_cbranch_scc0 mlp_kernel_pollB_slow
mlp_kernel_pollB_go:
    v_and_b32 v7, s19, v163
    v_lshlrev_b32 v8, 16, v164
    v_mfma_f32_32x32x16_bf16 v[48:63], v[132:135], a[128:131], v[48:63]
    s_add_u32 m0, s18, 0
    ds_read_b64_tr_b16 v[132:133], v97 offset:24576
    ds_read_b64_tr_b16 v[134:135], v97 offset:25088
    v_and_b32 v9, s19, v164
    v_lshlrev_b32 v10, 16, v165
    s_add_u32 s16, s16, 4096
    buffer_load_dwordx4 a[192:195], v226, s[4:7], s16 offen offset:0 sc1
    s_add_u32 s54, s54, 8192
    buffer_load_dwordx4 v226, s[56:59], s54 offen offset:0 lds
    s_waitcnt lgkmcnt(12)
    v_mfma_f32_32x32x16_bf16 v[32:47], v[136:139], a[132:135], v[32:47]
    ds_read_b64_tr_b16 v[136:137], v96 offset:26624
    ds_read_b64_tr_b16 v[138:139], v96 offset:27136
    v_and_b32 v11, s19, v165
    v_lshlrev_b32 v12, 16, v166
    v_mfma_f32_32x32x16_bf16 v[48:63], v[140:143], a[132:135], v[48:63]
    ds_read_b64_tr_b16 v[140:141], v97 offset:26624
    ds_read_b64_tr_b16 v[142:143], v97 offset:27136
    v_and_b32 v13, s19, v166
    v_lshlrev_b32 v14, 16, v167
    buffer_load_dwordx4 a[196:199], v226, s[4:7], s16 offen offset:1024 sc1
    s_waitcnt lgkmcnt(12)
    v_mfma_f32_32x32x16_bf16 v[32:47], v[144:147], a[136:139], v[32:47]
    ds_read_b64_tr_b16 v[144:145], v96 offset:28672
    ds_read_b64_tr_b16 v[146:147], v96 offset:29184
    v_and_b32 v15, s19, v167
    v_lshlrev_b32 v16, 16, v168
    buffer_load_dwordx4 v226, s[56:59], s54 offen offset:1024 lds
    v_mfma_f32_32x32x16_bf16 v[48:63], v[148:151], a[136:139], v[48:63]
    ds_read_b64_tr_b16 v[148:149], v97 offset:28672
    ds_read_b64_tr_b16 v[150:151], v97 offset:29184
    v_and_b32 v17, s19, v168
    v_lshlrev_b32 v18, 16, v169
    buffer_load_dwordx4 a[200:203], v226, s[4:7], s16 offen offset:2048 sc1
    s_waitcnt lgkmcnt(12)
    v_mfma_f32_32x32x16_bf16 v[32:47], v[152:155], a[140:143], v[32:47]
    ds_read_b64_tr_b16 v[152:153], v96 offset:30720
    ds_read_b64_tr_b16 v[154:155], v96 offset:31232
    v_and_b32 v19, s19, v169
    v_lshlrev_b32 v20, 16, v170
    v_mfma_f32_32x32x16_bf16 v[48:63], v[156:159], a[140:143], v[48:63]
    ds_read_b64_tr_b16 v[156:157], v97 offset:30720
    ds_read_b64_tr_b16 v[158:159], v97 offset:31232
    v_and_b32 v21, s19, v170
    v_lshlrev_b32 v22, 16, v171
    buffer_load_dwordx4 a[204:207], v226, s[4:7], s16 offen offset:3072 sc1
    s_waitcnt lgkmcnt(12)
    v_mfma_f32_32x32x16_bf16 v[32:47], v[128:131], a[144:147], v[32:47]
    ds_read_b64_tr_b16 v[128:129], v96 offset:32768
    ds_read_b64_tr_b16 v[130:131], v96 offset:33280
    v_and_b32 v23, s19, v171
    v_lshlrev_b32 v24, 16, v172
    v_mfma_f32_32x32x16_bf16 v[48:63], v[132:135], a[144:147], v[48:63]
    s_add_u32 m0, s18, 8192
    ds_read_b64_tr_b16 v[132:133], v97 offset:32768
    ds_read_b64_tr_b16 v[134:135], v97 offset:33280
    v_and_b32 v25, s19, v172
    v_lshlrev_b32 v26, 16, v173
    s_add_u32 s16, s16, 4096
    buffer_load_dwordx4 a[208:211], v226, s[4:7], s16 offen offset:0 sc1
    s_add_u32 s3, s3, 8192
    buffer_load_dwordx4 v226, s[56:59], s3 offen offset:0 lds
    s_waitcnt lgkmcnt(12)
    v_mfma_f32_32x32x16_bf16 v[32:47], v[136:139], a[148:151], v[32:47]
    ds_read_b64_tr_b16 v[136:137], v96 offset:40960
    ds_read_b64_tr_b16 v[138:139], v96 offset:41472
    v_and_b32 v27, s19, v173
    v_lshlrev_b32 v28, 16, v174
    v_mfma_f32_32x32x16_bf16 v[48:63], v[140:143], a[148:151], v[48:63]
    ds_read_b64_tr_b16 v[140:141], v97 offset:40960
    ds_read_b64_tr_b16 v[142:143], v97 offset:41472
    v_and_b32 v29, s19, v174
    v_lshlrev_b32 v30, 16, v175
    buffer_load_dwordx4 a[212:215], v226, s[4:7], s16 offen offset:1024 sc1
    s_waitcnt vmcnt(22) lgkmcnt(12)
    v_mfma_f32_32x32x16_bf16 v[32:47], v[144:147], a[152:155], v[32:47]
    ds_read_b64_tr_b16 v[144:145], v96 offset:34816
    ds_read_b64_tr_b16 v[146:147], v96 offset:35328
    v_and_b32 v31, s19, v175
    buffer_load_dwordx4 v226, s[56:59], s3 offen offset:1024 lds
    v_mfma_f32_32x32x16_bf16 v[48:63], v[148:151], a[152:155], v[48:63]
    ds_read_b64_tr_b16 v[148:149], v97 offset:34816
    ds_read_b64_tr_b16 v[150:151], v97 offset:35328
    buffer_load_dwordx4 a[216:219], v226, s[4:7], s16 offen offset:2048 sc1
    s_waitcnt vmcnt(23) lgkmcnt(12)
    v_mfma_f32_32x32x16_bf16 v[32:47], v[152:155], a[156:159], v[32:47]
    ds_read_b64_tr_b16 v[152:153], v96 offset:43008
    ds_read_b64_tr_b16 v[154:155], v96 offset:43520
    v_mfma_f32_32x32x16_bf16 v[48:63], v[156:159], a[156:159], v[48:63]
    ds_read_b64_tr_b16 v[156:157], v97 offset:43008
    ds_read_b64_tr_b16 v[158:159], v97 offset:43520
    buffer_load_dwordx4 a[220:223], v226, s[4:7], s16 offen offset:3072 sc1
    s_waitcnt vmcnt(23) lgkmcnt(12)
    s_barrier
    v_mfma_f32_32x32x16_bf16 v[32:47], v[128:131], a[160:163], v[32:47]
    ds_read_b64_tr_b16 v[128:129], v96 offset:36864
    ds_read_b64_tr_b16 v[130:131], v96 offset:37376
    v_mfma_f32_32x32x16_bf16 v[48:63], v[132:135], a[160:163], v[48:63]
    s_add_u32 m0, s18, 16384
    s_add_u32 s54, s54, 8192
    ds_read_b64_tr_b16 v[132:133], v97 offset:36864
    ds_read_b64_tr_b16 v[134:135], v97 offset:37376
    buffer_load_dwordx4 v226, s[56:59], s54 offen offset:0 lds
    s_waitcnt lgkmcnt(12)
    v_mfma_f32_32x32x16_bf16 v[0:15], v[136:139], a[0:3], v[0:15]
    ds_read_b64_tr_b16 v[136:137], v96 offset:45056
    ds_read_b64_tr_b16 v[138:139], v96 offset:45568
    v_mfma_f32_32x32x16_bf16 v[16:31], v[140:143], a[0:3], v[16:31]
    ds_read_b64_tr_b16 v[140:141], v97 offset:45056
    ds_read_b64_tr_b16 v[142:143], v97 offset:45568
    s_add_u32 s16, s16, 4096
    buffer_load_dwordx4 a[0:3], v226, s[4:7], s16 offen offset:0 sc1
    s_waitcnt vmcnt(23) lgkmcnt(12)
    v_mfma_f32_32x32x16_bf16 v[32:47], v[144:147], a[164:167], v[32:47]
    ds_read_b64_tr_b16 v[144:145], v96 offset:38912
    ds_read_b64_tr_b16 v[146:147], v96 offset:39424
    buffer_load_dwordx4 v226, s[56:59], s54 offen offset:1024 lds
    v_mfma_f32_32x32x16_bf16 v[48:63], v[148:151], a[164:167], v[48:63]
    ds_read_b64_tr_b16 v[148:149], v97 offset:38912
    ds_read_b64_tr_b16 v[150:151], v97 offset:39424
    s_waitcnt lgkmcnt(12)
    v_mfma_f32_32x32x16_bf16 v[0:15], v[152:155], a[4:7], v[0:15]
    ds_read_b64_tr_b16 v[152:153], v96 offset:47104
    ds_read_b64_tr_b16 v[154:155], v96 offset:47616
    v_mfma_f32_32x32x16_bf16 v[16:31], v[156:159], a[4:7], v[16:31]
    ds_read_b64_tr_b16 v[156:157], v97 offset:47104
    ds_read_b64_tr_b16 v[158:159], v97 offset:47616
    buffer_load_dwordx4 a[4:7], v226, s[4:7], s16 offen offset:1024 sc1
    s_waitcnt vmcnt(23) lgkmcnt(12)
    v_mfma_f32_32x32x16_bf16 v[32:47], v[128:131], a[168:171], v[32:47]
    ds_read_b64_tr_b16 v[128:129], v96 offset:49152
    ds_read_b64_tr_b16 v[130:131], v96 offset:49664
    v_mfma_f32_32x32x16_bf16 v[48:63], v[132:135], a[168:171], v[48:63]
    s_add_u32 m0, s18, 24576
    s_add_u32 s3, s3, 8192
    ds_read_b64_tr_b16 v[132:133], v97 offset:49152
    ds_read_b64_tr_b16 v[134:135], v97 offset:49664
    buffer_load_dwordx4 v226, s[56:59], s3 offen offset:0 lds
    s_waitcnt lgkmcnt(12)
    v_mfma_f32_32x32x16_bf16 v[0:15], v[136:139], a[8:11], v[0:15]
    ds_read_b64_tr_b16 v[136:137], v96 offset:57344
    ds_read_b64_tr_b16 v[138:139], v96 offset:57856
    v_mfma_f32_32x32x16_bf16 v[16:31], v[140:143], a[8:11], v[16:31]
    ds_read_b64_tr_b16 v[140:141], v97 offset:57344
    ds_read_b64_tr_b16 v[142:143], v97 offset:57856
    buffer_load_dwordx4 a[8:11], v226, s[4:7], s16 offen offset:2048 sc1
    s_waitcnt vmcnt(24) lgkmcnt(12)
    v_mfma_f32_32x32x16_bf16 v[32:47], v[144:147], a[172:175], v[32:47]
    ds_read_b64_tr_b16 v[144:145], v96 offset:51200
    ds_read_b64_tr_b16 v[146:147], v96 offset:51712
    buffer_load_dwordx4 v226, s[56:59], s3 offen offset:1024 lds
    v_mfma_f32_32x32x16_bf16 v[48:63], v[148:151], a[172:175], v[48:63]
    ds_read_b64_tr_b16 v[148:149], v97 offset:51200
    ds_read_b64_tr_b16 v[150:151], v97 offset:51712
    s_waitcnt lgkmcnt(12)
    v_mfma_f32_32x32x16_bf16 v[0:15], v[152:155], a[12:15], v[0:15]
    ds_read_b64_tr_b16 v[152:153], v96 offset:59392
    ds_read_b64_tr_b16 v[154:155], v96 offset:59904
    v_mfma_f32_32x32x16_bf16 v[16:31], v[156:159], a[12:15], v[16:31]
    ds_read_b64_tr_b16 v[156:157], v97 offset:59392
    ds_read_b64_tr_b16 v[158:159], v97 offset:59904
    buffer_load_dwordx4 a[12:15], v226, s[4:7], s16 offen offset:3072 sc1
    s_waitcnt vmcnt(25) lgkmcnt(12)
    v_mfma_f32_32x32x16_bf16 v[32:47], v[128:131], a[176:179], v[32:47]
    ds_read_b64_tr_b16 v[128:129], v96 offset:53248
    ds_read_b64_tr_b16 v[130:131], v96 offset:53760
    v_mfma_f32_32x32x16_bf16 v[48:63], v[132:135], a[176:179], v[48:63]
    ds_read_b64_tr_b16 v[132:133], v97 offset:53248
    ds_read_b64_tr_b16 v[134:135], v97 offset:53760
    s_waitcnt lgkmcnt(12)
    v_mfma_f32_32x32x16_bf16 v[0:15], v[136:139], a[16:19], v[0:15]
    ds_read_b64_tr_b16 v[136:137], v96 offset:61440
    ds_read_b64_tr_b16 v[138:139], v96 offset:61952
    v_mfma_f32_32x32x16_bf16 v[16:31], v[140:143], a[16:19], v[16:31]
    ds_read_b64_tr_b16 v[140:141], v97 offset:61440
    ds_read_b64_tr_b16 v[142:143], v97 offset:61952
    s_add_u32 s16, s16, 4096
    buffer_load_dwordx4 a[16:19], v226, s[4:7], s16 offen offset:0 sc1
    s_waitcnt vmcnt(24) lgkmcnt(12)
    v_mfma_f32_32x32x16_bf16 v[32:47], v[144:147], a[180:183], v[32:47]
    ds_read_b64_tr_b16 v[144:145], v96 offset:55296
    ds_read_b64_tr_b16 v[146:147], v96 offset:55808
    v_mfma_f32_32x32x16_bf16 v[48:63], v[148:151], a[180:183], v[48:63]
    ds_read_b64_tr_b16 v[148:149], v97 offset:55296
    ds_read_b64_tr_b16 v[150:151], v97 offset:55808
    s_waitcnt lgkmcnt(12)
    v_mfma_f32_32x32x16_bf16 v[0:15], v[152:155], a[20:23], v[0:15]
    ds_read_b64_tr_b16 v[152:153], v96 offset:63488
    ds_read_b64_tr_b16 v[154:155], v96 offset:64000
    v_mfma_f32_32x32x16_bf16 v[16:31], v[156:159], a[20:23], v[16:31]
    ds_read_b64_tr_b16 v[156:157], v97 offset:63488
    ds_read_b64_tr_b16 v[158:159], v97 offset:64000
    buffer_load_dwordx4 a[20:23], v226, s[4:7], s16 offen offset:1024 sc1
    s_waitcnt vmcnt(23) lgkmcnt(12)
    v_mfma_f32_32x32x16_bf16 v[32:47], v[128:131], a[184:187], v[32:47]
    ds_read_b64_tr_b16 v[128:129], v98 offset:0
    ds_read_b64_tr_b16 v[130:131], v98 offset:512
    v_mfma_f32_32x32x16_bf16 v[48:63], v[132:135], a[184:187], v[48:63]
    ds_read_b64_tr_b16 v[132:133], v99 offset:0
    ds_read_b64_tr_b16 v[134:135], v99 offset:512
    s_waitcnt lgkmcnt(12)
    v_mfma_f32_32x32x16_bf16 v[0:15], v[136:139], a[24:27], v[0:15]
    ds_read_b64_tr_b16 v[136:137], v98 offset:8192
    ds_read_b64_tr_b16 v[138:139], v98 offset:8704
    v_mfma_f32_32x32x16_bf16 v[16:31], v[140:143], a[24:27], v[16:31]
    ds_read_b64_tr_b16 v[140:141], v99 offset:8192
    ds_read_b64_tr_b16 v[142:143], v99 offset:8704
    buffer_load_dwordx4 a[24:27], v226, s[4:7], s16 offen offset:2048 sc1
    s_waitcnt vmcnt(23) lgkmcnt(12)
    v_mfma_f32_32x32x16_bf16 v[32:47], v[144:147], a[188:191], v[32:47]
    ds_read_b64_tr_b16 v[144:145], v98 offset:2048
    ds_read_b64_tr_b16 v[146:147], v98 offset:2560
    v_mfma_f32_32x32x16_bf16 v[48:63], v[148:151], a[188:191], v[48:63]
    ds_read_b64_tr_b16 v[148:149], v99 offset:2048
    ds_read_b64_tr_b16 v[150:151], v99 offset:2560
    s_waitcnt lgkmcnt(12)
    v_mfma_f32_32x32x16_bf16 v[0:15], v[152:155], a[28:31], v[0:15]
    ds_read_b64_tr_b16 v[152:153], v98 offset:10240
    ds_read_b64_tr_b16 v[154:155], v98 offset:10752
    v_mfma_f32_32x32x16_bf16 v[16:31], v[156:159], a[28:31], v[16:31]
    ds_read_b64_tr_b16 v[156:157], v99 offset:10240
    ds_read_b64_tr_b16 v[158:159], v99 offset:10752
    buffer_load_dwordx4 a[28:31], v226, s[4:7], s16 offen offset:3072 sc1
    s_waitcnt vmcnt(23) lgkmcnt(12)
    s_barrier
    v_mfma_f32_32x32x16_bf16 v[32:47], v[128:131], a[192:195], v[32:47]
    ds_read_b64_tr_b16 v[128:129], v98 offset:4096
    ds_read_b64_tr_b16 v[130:131], v98 offset:4608
    v_mfma_f32_32x32x16_bf16 v[48:63], v[132:135], a[192:195], v[48:63]
    s_add_u32 m0, s18, 32768
    s_add_u32 s54, s54, 8192
    ds_read_b64_tr_b16 v[132:133], v99 offset:4096
    ds_read_b64_tr_b16 v[134:135], v99 offset:4608
    buffer_load_dwordx4 v226, s[56:59], s54 offen offset:0 lds
    s_waitcnt lgkmcnt(12)
    v_mfma_f32_32x32x16_bf16 v[0:15], v[136:139], a[32:35], v[0:15]
    ds_read_b64_tr_b16 v[136:137], v98 offset:12288
    ds_read_b64_tr_b16 v[138:139], v98 offset:12800
    v_mfma_f32_32x32x16_bf16 v[16:31], v[140:143], a[32:35], v[16:31]
    ds_read_b64_tr_b16 v[140:141], v99 offset:12288
    ds_read_b64_tr_b16 v[142:143], v99 offset:12800
    s_add_u32 s16, s16, 4096
    buffer_load_dwordx4 a[32:35], v226, s[4:7], s16 offen offset:0 sc1
    s_waitcnt vmcnt(23) lgkmcnt(12)
    v_mfma_f32_32x32x16_bf16 v[32:47], v[144:147], a[196:199], v[32:47]
    ds_read_b64_tr_b16 v[144:145], v98 offset:6144
    ds_read_b64_tr_b16 v[146:147], v98 offset:6656
    buffer_load_dwordx4 v226, s[56:59], s54 offen offset:1024 lds
    v_mfma_f32_32x32x16_bf16 v[48:63], v[148:151], a[196:199], v[48:63]
    ds_read_b64_tr_b16 v[148:149], v99 offset:6144
    ds_read_b64_tr_b16 v[150:151], v99 offset:6656
    s_waitcnt lgkmcnt(12)
    v_mfma_f32_32x32x16_bf16 v[0:15], v[152:155], a[36:39], v[0:15]
    ds_read_b64_tr_b16 v[152:153], v98 offset:14336
    ds_read_b64_tr_b16 v[154:155], v98 offset:14848
    v_mfma_f32_32x32x16_bf16 v[16:31], v[156:159], a[36:39], v[16:31]
    ds_read_b64_tr_b16 v[156:157], v99 offset:14336
    ds_read_b64_tr_b16 v[158:159], v99 offset:14848
    buffer_load_dwordx4 a[36:39], v226, s[4:7], s16 offen offset:1024 sc1
    s_waitcnt vmcnt(23) lgkmcnt(12)
    v_mfma_f32_32x32x16_bf16 v[32:47], v[128:131], a[200:203], v[32:47]
    ds_read_b64_tr_b16 v[128:129], v98 offset:16384
    ds_read_b64_tr_b16 v[130:131], v98 offset:16896
    v_mfma_f32_32x32x16_bf16 v[48:63], v[132:135], a[200:203], v[48:63]
    s_add_u32 m0, s18, 40960
    s_add_u32 s3, s3, 8192
    ds_read_b64_tr_b16 v[132:133], v99 offset:16384
    ds_read_b64_tr_b16 v[134:135], v99 offset:16896
    buffer_load_dwordx4 v226, s[56:59], s3 offen offset:0 lds
    s_waitcnt lgkmcnt(12)
    v_mfma_f32_32x32x16_bf16 v[0:15], v[136:139], a[40:43], v[0:15]
    ds_read_b64_tr_b16 v[136:137], v98 offset:24576
    ds_read_b64_tr_b16 v[138:139], v98 offset:25088
    v_mfma_f32_32x32x16_bf16 v[16:31], v[140:143], a[40:43], v[16:31]
    ds_read_b64_tr_b16 v[140:141], v99 offset:24576
    ds_read_b64_tr_b16 v[142:143], v99 offset:25088
    buffer_load_dwordx4 a[40:43], v226, s[4:7], s16 offen offset:2048 sc1
    s_waitcnt vmcnt(24) lgkmcnt(12)
    v_mfma_f32_32x32x16_bf16 v[32:47], v[144:147], a[204:207], v[32:47]
    ds_read_b64_tr_b16 v[144:145], v98 offset:18432
    ds_read_b64_tr_b16 v[146:147], v98 offset:18944
    buffer_load_dwordx4 v226, s[56:59], s3 offen offset:1024 lds
    v_mfma_f32_32x32x16_bf16 v[48:63], v[148:151], a[204:207], v[48:63]
    ds_read_b64_tr_b16 v[148:149], v99 offset:18432
    ds_read_b64_tr_b16 v[150:151], v99 offset:18944
    s_waitcnt lgkmcnt(12)
    v_mfma_f32_32x32x16_bf16 v[0:15], v[152:155], a[44:47], v[0:15]
    ds_read_b64_tr_b16 v[152:153], v98 offset:26624
    ds_read_b64_tr_b16 v[154:155], v98 offset:27136
    v_mfma_f32_32x32x16_bf16 v[16:31], v[156:159], a[44:47], v[16:31]
    ds_read_b64_tr_b16 v[156:157], v99 offset:26624
    ds_read_b64_tr_b16 v[158:159], v99 offset:27136
    buffer_load_dwordx4 a[44:47], v226, s[4:7], s16 offen offset:3072 sc1
    s_waitcnt vmcnt(25) lgkmcnt(12)
    v_mfma_f32_32x32x16_bf16 v[32:47], v[128:131], a[208:211], v[32:47]
    ds_read_b64_tr_b16 v[128:129], v98 offset:20480
    ds_read_b64_tr_b16 v[130:131], v98 offset:20992
    v_mfma_f32_32x32x16_bf16 v[48:63], v[132:135], a[208:211], v[48:63]
    s_add_u32 m0, s18, 49152
    s_add_u32 s54, s54, 8192
    ds_read_b64_tr_b16 v[132:133], v99 offset:20480
    ds_read_b64_tr_b16 v[134:135], v99 offset:20992
    buffer_load_dwordx4 v226, s[56:59], s54 offen offset:0 lds
    s_waitcnt lgkmcnt(12)
    v_mfma_f32_32x32x16_bf16 v[0:15], v[136:139], a[48:51], v[0:15]
    ds_read_b64_tr_b16 v[136:137], v98 offset:28672
    ds_read_b64_tr_b16 v[138:139], v98 offset:29184
    v_mfma_f32_32x32x16_bf16 v[16:31], v[140:143], a[48:51], v[16:31]
    ds_read_b64_tr_b16 v[140:141], v99 offset:28672
    ds_read_b64_tr_b16 v[142:143], v99 offset:29184
    s_add_u32 s16, s16, 4096
    buffer_load_dwordx4 a[48:51], v226, s[4:7], s16 offen offset:0 sc1
    s_waitcnt vmcnt(25) lgkmcnt(12)
    v_mfma_f32_32x32x16_bf16 v[32:47], v[144:147], a[212:215], v[32:47]
    ds_read_b64_tr_b16 v[144:145], v98 offset:22528
    ds_read_b64_tr_b16 v[146:147], v98 offset:23040
    buffer_load_dwordx4 v226, s[56:59], s54 offen offset:1024 lds
    v_mfma_f32_32x32x16_bf16 v[48:63], v[148:151], a[212:215], v[48:63]
    ds_read_b64_tr_b16 v[148:149], v99 offset:22528
    ds_read_b64_tr_b16 v[150:151], v99 offset:23040
    s_waitcnt lgkmcnt(12)
    v_mfma_f32_32x32x16_bf16 v[0:15], v[152:155], a[52:55], v[0:15]
    ds_read_b64_tr_b16 v[152:153], v98 offset:30720
    ds_read_b64_tr_b16 v[154:155], v98 offset:31232
    v_mfma_f32_32x32x16_bf16 v[16:31], v[156:159], a[52:55], v[16:31]
    ds_read_b64_tr_b16 v[156:157], v99 offset:30720
    ds_read_b64_tr_b16 v[158:159], v99 offset:31232
    buffer_load_dwordx4 a[52:55], v226, s[4:7], s16 offen offset:1024 sc1
    s_waitcnt vmcnt(25) lgkmcnt(12)
    v_mfma_f32_32x32x16_bf16 v[32:47], v[128:131], a[216:219], v[32:47]
    ds_read_b64_tr_b16 v[128:129], v98 offset:32768
    ds_read_b64_tr_b16 v[130:131], v98 offset:33280
    v_mfma_f32_32x32x16_bf16 v[48:63], v[132:135], a[216:219], v[48:63]
    s_add_u32 m0, s18, 57344
    s_add_u32 s3, s3, 8192
    ds_read_b64_tr_b16 v[132:133], v99 offset:32768
    ds_read_b64_tr_b16 v[134:135], v99 offset:33280
    buffer_load_dwordx4 v226, s[56:59], s3 offen offset:0 lds
    s_waitcnt lgkmcnt(12)
    v_mfma_f32_32x32x16_bf16 v[0:15], v[136:139], a[56:59], v[0:15]
    ds_read_b64_tr_b16 v[136:137], v98 offset:40960
    ds_read_b64_tr_b16 v[138:139], v98 offset:41472
    v_mfma_f32_32x32x16_bf16 v[16:31], v[140:143], a[56:59], v[16:31]
    ds_read_b64_tr_b16 v[140:141], v99 offset:40960
    ds_read_b64_tr_b16 v[142:143], v99 offset:41472
    buffer_load_dwordx4 a[56:59], v226, s[4:7], s16 offen offset:2048 sc1
    s_waitcnt vmcnt(26) lgkmcnt(12)
    v_mfma_f32_32x32x16_bf16 v[32:47], v[144:147], a[220:223], v[32:47]
    ds_read_b64_tr_b16 v[144:145], v98 offset:34816
    ds_read_b64_tr_b16 v[146:147], v98 offset:35328
    buffer_load_dwordx4 v226, s[56:59], s3 offen offset:1024 lds
    v_mfma_f32_32x32x16_bf16 v[48:63], v[148:151], a[220:223], v[48:63]
    ds_read_b64_tr_b16 v[148:149], v99 offset:34816
    ds_read_b64_tr_b16 v[150:151], v99 offset:35328
    s_waitcnt lgkmcnt(12)
    v_mfma_f32_32x32x16_bf16 v[0:15], v[152:155], a[60:63], v[0:15]
    ds_read_b64_tr_b16 v[152:153], v98 offset:43008
    ds_read_b64_tr_b16 v[154:155], v98 offset:43520
    v_mfma_f32_32x32x16_bf16 v[16:31], v[156:159], a[60:63], v[16:31]
    ds_read_b64_tr_b16 v[156:157], v99 offset:43008
    ds_read_b64_tr_b16 v[158:159], v99 offset:43520
    buffer_load_dwordx4 a[60:63], v226, s[4:7], s16 offen offset:3072 sc1
    s_waitcnt vmcnt(26) lgkmcnt(12)
    s_barrier
    v_mfma_f32_32x32x16_bf16 v[32:47], v[128:131], a[0:3], v[32:47]
    ds_read_b64_tr_b16 v[128:129], v98 offset:36864
    ds_read_b64_tr_b16 v[130:131], v98 offset:37376
    v_mfma_f32_32x32x16_bf16 v[48:63], v[132:135], a[0:3], v[48:63]
    s_add_u32 m0, s18, 65536
    s_add_u32 s54, s54, 8192
    ds_read_b64_tr_b16 v[132:133], v99 offset:36864
    ds_read_b64_tr_b16 v[134:135], v99 offset:37376
    buffer_load_dwordx4 v226, s[56:59], s54 offen offset:0 lds
    s_waitcnt lgkmcnt(12)
    v_mfma_f32_32x32x16_bf16 v[0:15], v[136:139], a[64:67], v[0:15]
    ds_read_b64_tr_b16 v[136:137], v98 offset:45056
    ds_read_b64_tr_b16 v[138:139], v98 offset:45568
    v_mfma_f32_32x32x16_bf16 v[16:31], v[140:143], a[64:67], v[16:31]
    ds_read_b64_tr_b16 v[140:141], v99 offset:45056
    ds_read_b64_tr_b16 v[142:143], v99 offset:45568
    s_add_u32 s16, s16, 4096
    buffer_load_dwordx4 a[64:67], v226, s[4:7], s16 offen offset:0 sc1
    s_waitcnt vmcnt(26) lgkmcnt(12)
    v_mfma_f32_32x32x16_bf16 v[32:47], v[144:147], a[4:7], v[32:47]
    ds_read_b64_tr_b16 v[144:145], v98 offset:38912
    ds_read_b64_tr_b16 v[146:147], v98 offset:39424
    buffer_load_dwordx4 v226, s[56:59], s54 offen offset:1024 lds
    v_mfma_f32_32x32x16_bf16 v[48:63], v[148:151], a[4:7], v[48:63]
    ds_read_b64_tr_b16 v[148:149], v99 offset:38912
    ds_read_b64_tr_b16 v[150:151], v99 offset:39424
    s_waitcnt lgkmcnt(12)
    v_mfma_f32_32x32x16_bf16 v[0:15], v[152:155], a[68:71], v[0:15]
    ds_read_b64_tr_b16 v[152:153], v98 offset:47104
    ds_read_b64_tr_b16 v[154:155], v98 offset:47616
    v_mfma_f32_32x32x16_bf16 v[16:31], v[156:159], a[68:71], v[16:31]
    ds_read_b64_tr_b16 v[156:157], v99 offset:47104
    ds_read_b64_tr_b16 v[158:159], v99 offset:47616
    buffer_load_dwordx4 a[68:71], v226, s[4:7], s16 offen offset:1024 sc1
    s_waitcnt vmcnt(26) lgkmcnt(12)
    v_mfma_f32_32x32x16_bf16 v[32:47], v[128:131], a[8:11], v[32:47]
    ds_read_b64_tr_b16 v[128:129], v100 offset:0
    ds_read_b64_tr_b16 v[130:131], v100 offset:512
    v_mfma_f32_32x32x16_bf16 v[48:63], v[132:135], a[8:11], v[48:63]
    s_add_u32 m0, s18, 73728
    s_add_u32 s3, s3, 8192
    ds_read_b64_tr_b16 v[132:133], v101 offset:0
    ds_read_b64_tr_b16 v[134:135], v101 offset:512
    buffer_load_dwordx4 v226, s[56:59], s3 offen offset:0 lds
    s_waitcnt lgkmcnt(12)
    v_mfma_f32_32x32x16_bf16 v[0:15], v[136:139], a[72:75], v[0:15]
    ds_read_b64_tr_b16 v[136:137], v100 offset:8192
    ds_read_b64_tr_b16 v[138:139], v100 offset:8704
    v_mfma_f32_32x32x16_bf16 v[16:31], v[140:143], a[72:75], v[16:31]
    ds_read_b64_tr_b16 v[140:141], v101 offset:8192
    ds_read_b64_tr_b16 v[142:143], v101 offset:8704
    buffer_load_dwordx4 a[72:75], v226, s[4:7], s16 offen offset:2048 sc1
    s_waitcnt vmcnt(26) lgkmcnt(12)
    v_mfma_f32_32x32x16_bf16 v[32:47], v[144:147], a[12:15], v[32:47]
    ds_read_b64_tr_b16 v[144:145], v100 offset:2048
    ds_read_b64_tr_b16 v[146:147], v100 offset:2560
    buffer_load_dwordx4 v226, s[56:59], s3 offen offset:1024 lds
    v_mfma_f32_32x32x16_bf16 v[48:63], v[148:151], a[12:15], v[48:63]
    ds_read_b64_tr_b16 v[148:149], v101 offset:2048
    ds_read_b64_tr_b16 v[150:151], v101 offset:2560
    s_waitcnt lgkmcnt(12)
    v_mfma_f32_32x32x16_bf16 v[0:15], v[152:155], a[76:79], v[0:15]
    ds_read_b64_tr_b16 v[152:153], v100 offset:10240
    ds_read_b64_tr_b16 v[154:155], v100 offset:10752
    v_mfma_f32_32x32x16_bf16 v[16:31], v[156:159], a[76:79], v[16:31]
    ds_read_b64_tr_b16 v[156:157], v101 offset:10240
    ds_read_b64_tr_b16 v[158:159], v101 offset:10752
    buffer_load_dwordx4 a[76:79], v226, s[4:7], s16 offen offset:3072 sc1
    s_waitcnt vmcnt(27) lgkmcnt(12)
    v_mfma_f32_32x32x16_bf16 v[32:47], v[128:131], a[16:19], v[32:47]
    ds_read_b64_tr_b16 v[128:129], v100 offset:4096
    ds_read_b64_tr_b16 v[130:131], v100 offset:4608
    v_mfma_f32_32x32x16_bf16 v[48:63], v[132:135], a[16:19], v[48:63]
    s_add_u32 m0, s18, 81920
    s_add_u32 s54, s54, 8192
    ds_read_b64_tr_b16 v[132:133], v101 offset:4096
    ds_read_b64_tr_b16 v[134:135], v101 offset:4608
    buffer_load_dwordx4 v226, s[56:59], s54 offen offset:0 lds
    s_waitcnt lgkmcnt(12)
    v_mfma_f32_32x32x16_bf16 v[0:15], v[136:139], a[80:83], v[0:15]
    ds_read_b64_tr_b16 v[136:137], v100 offset:12288
    ds_read_b64_tr_b16 v[138:139], v100 offset:12800
    v_mfma_f32_32x32x16_bf16 v[16:31], v[140:143], a[80:83], v[16:31]
    ds_read_b64_tr_b16 v[140:141], v101 offset:12288
    ds_read_b64_tr_b16 v[142:143], v101 offset:12800
    s_add_u32 s16, s16, 4096
    buffer_load_dwordx4 a[80:83], v226, s[4:7], s16 offen offset:0 sc1
    s_waitcnt vmcnt(28) lgkmcnt(12)
    v_mfma_f32_32x32x16_bf16 v[32:47], v[144:147], a[20:23], v[32:47]
    ds_read_b64_tr_b16 v[144:145], v100 offset:6144
    ds_read_b64_tr_b16 v[146:147], v100 offset:6656
    buffer_load_dwordx4 v226, s[56:59], s54 offen offset:1024 lds
    v_mfma_f32_32x32x16_bf16 v[48:63], v[148:151], a[20:23], v[48:63]
    ds_read_b64_tr_b16 v[148:149], v101 offset:6144
    ds_read_b64_tr_b16 v[150:151], v101 offset:6656
    s_waitcnt lgkmcnt(12)
    v_mfma_f32_32x32x16_bf16 v[0:15], v[152:155], a[84:87], v[0:15]
    ds_read_b64_tr_b16 v[152:153], v100 offset:14336
    ds_read_b64_tr_b16 v[154:155], v100 offset:14848
    v_mfma_f32_32x32x16_bf16 v[16:31], v[156:159], a[84:87], v[16:31]
    ds_read_b64_tr_b16 v[156:157], v101 offset:14336
    ds_read_b64_tr_b16 v[158:159], v101 offset:14848
    buffer_load_dwordx4 a[84:87], v226, s[4:7], s16 offen offset:1024 sc1
    s_waitcnt vmcnt(29) lgkmcnt(12)
    v_mfma_f32_32x32x16_bf16 v[32:47], v[128:131], a[24:27], v[32:47]
    ds_read_b64_tr_b16 v[128:129], v100 offset:16384
    ds_read_b64_tr_b16 v[130:131], v100 offset:16896
    v_mfma_f32_32x32x16_bf16 v[48:63], v[132:135], a[24:27], v[48:63]
    s_add_u32 m0, s18, 90112
    s_add_u32 s3, s3, 8192
    ds_read_b64_tr_b16 v[132:133], v101 offset:16384
    ds_read_b64_tr_b16 v[134:135], v101 offset:16896
    buffer_load_dwordx4 v226, s[56:59], s3 offen offset:0 lds
    s_waitcnt lgkmcnt(12)
    v_mfma_f32_32x32x16_bf16 v[0:15], v[136:139], a[88:91], v[0:15]
    ds_read_b64_tr_b16 v[136:137], v100 offset:24576
    ds_read_b64_tr_b16 v[138:139], v100 offset:25088
    v_mfma_f32_32x32x16_bf16 v[16:31], v[140:143], a[88:91], v[16:31]
    ds_read_b64_tr_b16 v[140:141], v101 offset:24576
    ds_read_b64_tr_b16 v[142:143], v101 offset:25088
    buffer_load_dwordx4 a[88:91], v226, s[4:7], s16 offen offset:2048 sc1
    s_waitcnt vmcnt(30) lgkmcnt(12)
    v_mfma_f32_32x32x16_bf16 v[32:47], v[144:147], a[28:31], v[32:47]
    ds_read_b64_tr_b16 v[144:145], v100 offset:18432
    ds_read_b64_tr_b16 v[146:147], v100 offset:18944
    buffer_load_dwordx4 v226, s[56:59], s3 offen offset:1024 lds
    v_mfma_f32_32x32x16_bf16 v[48:63], v[148:151], a[28:31], v[48:63]
    ds_read_b64_tr_b16 v[148:149], v101 offset:18432
    ds_read_b64_tr_b16 v[150:151], v101 offset:18944
    s_waitcnt lgkmcnt(12)
    v_mfma_f32_32x32x16_bf16 v[0:15], v[152:155], a[92:95], v[0:15]
    ds_read_b64_tr_b16 v[152:153], v100 offset:26624
    ds_read_b64_tr_b16 v[154:155], v100 offset:27136
    v_mfma_f32_32x32x16_bf16 v[16:31], v[156:159], a[92:95], v[16:31]
    ds_read_b64_tr_b16 v[156:157], v101 offset:26624
    ds_read_b64_tr_b16 v[158:159], v101 offset:27136
    buffer_load_dwordx4 a[92:95], v226, s[4:7], s16 offen offset:3072 sc1
    s_waitcnt vmcnt(30) lgkmcnt(12)
    s_barrier
    v_mfma_f32_32x32x16_bf16 v[32:47], v[128:131], a[32:35], v[32:47]
    ds_read_b64_tr_b16 v[128:129], v100 offset:20480
    ds_read_b64_tr_b16 v[130:131], v100 offset:20992
    v_mfma_f32_32x32x16_bf16 v[48:63], v[132:135], a[32:35], v[48:63]
    s_add_u32 m0, s18, 98304
    s_add_u32 s54, s54, 8192
    ds_read_b64_tr_b16 v[132:133], v101 offset:20480
    ds_read_b64_tr_b16 v[134:135], v101 offset:20992
    buffer_load_dwordx4 v226, s[56:59], s54 offen offset:0 lds
    s_waitcnt lgkmcnt(12)
    v_mfma_f32_32x32x16_bf16 v[0:15], v[136:139], a[96:99], v[0:15]
    ds_read_b64_tr_b16 v[136:137], v100 offset:28672
    ds_read_b64_tr_b16 v[138:139], v100 offset:29184
    v_mfma_f32_32x32x16_bf16 v[16:31], v[140:143], a[96:99], v[16:31]
    ds_read_b64_tr_b16 v[140:141], v101 offset:28672
    ds_read_b64_tr_b16 v[142:143], v101 offset:29184
    s_add_u32 s16, s16, 4096
    buffer_load_dwordx4 a[96:99], v226, s[4:7], s16 offen offset:0 sc1
    s_waitcnt vmcnt(30) lgkmcnt(12)
    v_mfma_f32_32x32x16_bf16 v[32:47], v[144:147], a[36:39], v[32:47]
    ds_read_b64_tr_b16 v[144:145], v100 offset:22528
    ds_read_b64_tr_b16 v[146:147], v100 offset:23040
    buffer_load_dwordx4 v226, s[56:59], s54 offen offset:1024 lds
    v_mfma_f32_32x32x16_bf16 v[48:63], v[148:151], a[36:39], v[48:63]
    ds_read_b64_tr_b16 v[148:149], v101 offset:22528
    ds_read_b64_tr_b16 v[150:151], v101 offset:23040
    s_waitcnt lgkmcnt(12)
    v_mfma_f32_32x32x16_bf16 v[0:15], v[152:155], a[100:103], v[0:15]
    ds_read_b64_tr_b16 v[152:153], v100 offset:30720
    ds_read_b64_tr_b16 v[154:155], v100 offset:31232
    v_mfma_f32_32x32x16_bf16 v[16:31], v[156:159], a[100:103], v[16:31]
    ds_read_b64_tr_b16 v[156:157], v101 offset:30720
    ds_read_b64_tr_b16 v[158:159], v101 offset:31232
    buffer_load_dwordx4 a[100:103], v226, s[4:7], s16 offen offset:1024 sc1
    s_waitcnt vmcnt(30) lgkmcnt(12)
    v_mfma_f32_32x32x16_bf16 v[32:47], v[128:131], a[40:43], v[32:47]
    ds_read_b64_tr_b16 v[128:129], v100 offset:32768
    ds_read_b64_tr_b16 v[130:131], v100 offset:33280
    v_mfma_f32_32x32x16_bf16 v[48:63], v[132:135], a[40:43], v[48:63]
    s_add_u32 m0, s18, 106496
    s_add_u32 s3, s3, 8192
    ds_read_b64_tr_b16 v[132:133], v101 offset:32768
    ds_read_b64_tr_b16 v[134:135], v101 offset:33280
    buffer_load_dwordx4 v226, s[56:59], s3 offen offset:0 lds
    s_waitcnt lgkmcnt(12)
    v_mfma_f32_32x32x16_bf16 v[0:15], v[136:139], a[104:107], v[0:15]
    ds_read_b64_tr_b16 v[136:137], v100 offset:40960
    ds_read_b64_tr_b16 v[138:139], v100 offset:41472
    v_mfma_f32_32x32x16_bf16 v[16:31], v[140:143], a[104:107], v[16:31]
    ds_read_b64_tr_b16 v[140:141], v101 offset:40960
    ds_read_b64_tr_b16 v[142:143], v101 offset:41472
    buffer_load_dwordx4 a[104:107], v226, s[4:7], s16 offen offset:2048 sc1
    s_waitcnt vmcnt(30) lgkmcnt(12)
    v_mfma_f32_32x32x16_bf16 v[32:47], v[144:147], a[44:47], v[32:47]
    ds_read_b64_tr_b16 v[144:145], v100 offset:34816
    ds_read_b64_tr_b16 v[146:147], v100 offset:35328
    buffer_load_dwordx4 v226, s[56:59], s3 offen offset:1024 lds
    v_mfma_f32_32x32x16_bf16 v[48:63], v[148:151], a[44:47], v[48:63]
    ds_read_b64_tr_b16 v[148:149], v101 offset:34816
    ds_read_b64_tr_b16 v[150:151], v101 offset:35328
    s_waitcnt lgkmcnt(12)
    v_mfma_f32_32x32x16_bf16 v[0:15], v[152:155], a[108:111], v[0:15]
    ds_read_b64_tr_b16 v[152:153], v100 offset:43008
    ds_read_b64_tr_b16 v[154:155], v100 offset:43520
    v_mfma_f32_32x32x16_bf16 v[16:31], v[156:159], a[108:111], v[16:31]
    ds_read_b64_tr_b16 v[156:157], v101 offset:43008
    ds_read_b64_tr_b16 v[158:159], v101 offset:43520
    buffer_load_dwordx4 a[108:111], v226, s[4:7], s16 offen offset:3072 sc1
    s_waitcnt vmcnt(30) lgkmcnt(12)
    v_mfma_f32_32x32x16_bf16 v[32:47], v[128:131], a[48:51], v[32:47]
    ds_read_b64_tr_b16 v[128:129], v100 offset:36864
    ds_read_b64_tr_b16 v[130:131], v100 offset:37376
    v_mfma_f32_32x32x16_bf16 v[48:63], v[132:135], a[48:51], v[48:63]
    s_add_u32 m0, s18, 114688
    s_add_u32 s54, s54, 8192
    ds_read_b64_tr_b16 v[132:133], v101 offset:36864
    ds_read_b64_tr_b16 v[134:135], v101 offset:37376
    buffer_load_dwordx4 v226, s[56:59], s54 offen offset:0 lds
    s_waitcnt lgkmcnt(12)
    v_mfma_f32_32x32x16_bf16 v[0:15], v[136:139], a[112:115], v[0:15]
    ds_read_b64_tr_b16 v[136:137], v100 offset:45056
    ds_read_b64_tr_b16 v[138:139], v100 offset:45568
    v_mfma_f32_32x32x16_bf16 v[16:31], v[140:143], a[112:115], v[16:31]
    ds_read_b64_tr_b16 v[140:141], v101 offset:45056
    ds_read_b64_tr_b16 v[142:143], v101 offset:45568
    s_add_u32 s16, s16, 4096
    buffer_load_dwordx4 a[112:115], v226, s[4:7], s16 offen offset:0 sc1
    s_waitcnt vmcnt(30) lgkmcnt(12)
    v_mfma_f32_32x32x16_bf16 v[32:47], v[144:147], a[52:55], v[32:47]
    ds_read_b64_tr_b16 v[144:145], v100 offset:38912
    ds_read_b64_tr_b16 v[146:147], v100 offset:39424
    buffer_load_dwordx4 v226, s[56:59], s54 offen offset:1024 lds
    v_mfma_f32_32x32x16_bf16 v[48:63], v[148:151], a[52:55], v[48:63]
    ds_read_b64_tr_b16 v[148:149], v101 offset:38912
    ds_read_b64_tr_b16 v[150:151], v101 offset:39424
    s_waitcnt lgkmcnt(12)
    v_mfma_f32_32x32x16_bf16 v[0:15], v[152:155], a[116:119], v[0:15]
    ds_read_b64_tr_b16 v[152:153], v100 offset:47104
    ds_read_b64_tr_b16 v[154:155], v100 offset:47616
    v_mfma_f32_32x32x16_bf16 v[16:31], v[156:159], a[116:119], v[16:31]
    ds_read_b64_tr_b16 v[156:157], v101 offset:47104
    ds_read_b64_tr_b16 v[158:159], v101 offset:47616
    buffer_load_dwordx4 a[116:119], v226, s[4:7], s16 offen offset:1024 sc1
    s_waitcnt vmcnt(30) lgkmcnt(12)
    v_mfma_f32_32x32x16_bf16 v[32:47], v[128:131], a[56:59], v[32:47]
    ds_read_b64_tr_b16 v[128:129], v96 offset:0
    ds_read_b64_tr_b16 v[130:131], v96 offset:512
    v_mfma_f32_32x32x16_bf16 v[48:63], v[132:135], a[56:59], v[48:63]
    s_add_u32 m0, s18, 122880
    s_add_u32 s3, s3, 8192
    ds_read_b64_tr_b16 v[132:133], v97 offset:0
    ds_read_b64_tr_b16 v[134:135], v97 offset:512
    buffer_load_dwordx4 v226, s[56:59], s3 offen offset:0 lds
    s_waitcnt lgkmcnt(12)
    v_mfma_f32_32x32x16_bf16 v[0:15], v[136:139], a[120:123], v[0:15]
    ds_read_b64_tr_b16 v[136:137], v96 offset:8192
    ds_read_b64_tr_b16 v[138:139], v96 offset:8704
    v_mfma_f32_32x32x16_bf16 v[16:31], v[140:143], a[120:123], v[16:31]
    ds_read_b64_tr_b16 v[140:141], v97 offset:8192
    ds_read_b64_tr_b16 v[142:143], v97 offset:8704
    buffer_load_dwordx4 a[120:123], v226, s[4:7], s16 offen offset:2048 sc1
    s_waitcnt vmcnt(30) lgkmcnt(12)
    v_mfma_f32_32x32x16_bf16 v[32:47], v[144:147], a[60:63], v[32:47]
    ds_read_b64_tr_b16 v[144:145], v96 offset:2048
    ds_read_b64_tr_b16 v[146:147], v96 offset:2560
    buffer_load_dwordx4 v226, s[56:59], s3 offen offset:1024 lds
    v_mfma_f32_32x32x16_bf16 v[48:63], v[148:151], a[60:63], v[48:63]
    ds_read_b64_tr_b16 v[148:149], v97 offset:2048
    ds_read_b64_tr_b16 v[150:151], v97 offset:2560
    s_waitcnt lgkmcnt(12)
    v_mfma_f32_32x32x16_bf16 v[0:15], v[152:155], a[124:127], v[0:15]
    ds_read_b64_tr_b16 v[152:153], v96 offset:10240
    ds_read_b64_tr_b16 v[154:155], v96 offset:10752
    v_mfma_f32_32x32x16_bf16 v[16:31], v[156:159], a[124:127], v[16:31]
    ds_read_b64_tr_b16 v[156:157], v97 offset:10240
    ds_read_b64_tr_b16 v[158:159], v97 offset:10752
    buffer_load_dwordx4 a[124:127], v226, s[4:7], s16 offen offset:3072 sc1
    s_waitcnt vmcnt(30) lgkmcnt(12)
    s_barrier
    v_mfma_f32_32x32x16_bf16 v[32:47], v[128:131], a[64:67], v[32:47]
    ds_read_b64_tr_b16 v[128:129], v96 offset:4096
    ds_read_b64_tr_b16 v[130:131], v96 offset:4608
    v_mfma_f32_32x32x16_bf16 v[48:63], v[132:135], a[64:67], v[48:63]
    s_add_u32 m0, s18, 131072
    s_add_u32 s54, s54, 8192
    ds_read_b64_tr_b16 v[132:133], v97 offset:4096
    ds_read_b64_tr_b16 v[134:135], v97 offset:4608
    buffer_load_dwordx4 v226, s[56:59], s54 offen offset:0 lds
    s_waitcnt lgkmcnt(12)
    v_mfma_f32_32x32x16_bf16 v[0:15], v[136:139], a[128:131], v[0:15]
    ds_read_b64_tr_b16 v[136:137], v96 offset:12288
    ds_read_b64_tr_b16 v[138:139], v96 offset:12800
    v_mfma_f32_32x32x16_bf16 v[16:31], v[140:143], a[128:131], v[16:31]
    ds_read_b64_tr_b16 v[140:141], v97 offset:12288
    ds_read_b64_tr_b16 v[142:143], v97 offset:12800
    s_add_u32 s16, s16, 4096
    buffer_load_dwordx4 a[128:131], v226, s[4:7], s16 offen offset:0 sc1
    s_waitcnt vmcnt(30) lgkmcnt(12)
    v_mfma_f32_32x32x16_bf16 v[32:47], v[144:147], a[68:71], v[32:47]
    ds_read_b64_tr_b16 v[144:145], v96 offset:6144
    ds_read_b64_tr_b16 v[146:147], v96 offset:6656
    buffer_load_dwordx4 v226, s[56:59], s54 offen offset:1024 lds
    v_mfma_f32_32x32x16_bf16 v[48:63], v[148:151], a[68:71], v[48:63]
    ds_read_b64_tr_b16 v[148:149], v97 offset:6144
    ds_read_b64_tr_b16 v[150:151], v97 offset:6656
    s_waitcnt lgkmcnt(12)
    v_mfma_f32_32x32x16_bf16 v[0:15], v[152:155], a[132:135], v[0:15]
    ds_read_b64_tr_b16 v[152:153], v96 offset:14336
    ds_read_b64_tr_b16 v[154:155], v96 offset:14848
    v_mfma_f32_32x32x16_bf16 v[16:31], v[156:159], a[132:135], v[16:31]
    ds_read_b64_tr_b16 v[156:157], v97 offset:14336
    ds_read_b64_tr_b16 v[158:159], v97 offset:14848
    buffer_load_dwordx4 a[132:135], v226, s[4:7], s16 offen offset:1024 sc1
    s_waitcnt vmcnt(30) lgkmcnt(12)
    v_mfma_f32_32x32x16_bf16 v[32:47], v[128:131], a[72:75], v[32:47]
    ds_read_b64_tr_b16 v[128:129], v96 offset:16384
    ds_read_b64_tr_b16 v[130:131], v96 offset:16896
    v_mfma_f32_32x32x16_bf16 v[48:63], v[132:135], a[72:75], v[48:63]
    s_add_u32 m0, s18, 139264
    s_add_u32 s3, s3, 8192
    ds_read_b64_tr_b16 v[132:133], v97 offset:16384
    ds_read_b64_tr_b16 v[134:135], v97 offset:16896
    buffer_load_dwordx4 v226, s[56:59], s3 offen offset:0 lds
    s_waitcnt lgkmcnt(12)
    v_mfma_f32_32x32x16_bf16 v[0:15], v[136:139], a[136:139], v[0:15]
    ds_read_b64_tr_b16 v[136:137], v96 offset:24576
    ds_read_b64_tr_b16 v[138:139], v96 offset:25088
    v_mfma_f32_32x32x16_bf16 v[16:31], v[140:143], a[136:139], v[16:31]
    ds_read_b64_tr_b16 v[140:141], v97 offset:24576
    ds_read_b64_tr_b16 v[142:143], v97 offset:25088
    buffer_load_dwordx4 a[136:139], v226, s[4:7], s16 offen offset:2048 sc1
    s_waitcnt vmcnt(30) lgkmcnt(12)
    v_mfma_f32_32x32x16_bf16 v[32:47], v[144:147], a[76:79], v[32:47]
    ds_read_b64_tr_b16 v[144:145], v96 offset:18432
    ds_read_b64_tr_b16 v[146:147], v96 offset:18944
    buffer_load_dwordx4 v226, s[56:59], s3 offen offset:1024 lds
    v_mfma_f32_32x32x16_bf16 v[48:63], v[148:151], a[76:79], v[48:63]
    ds_read_b64_tr_b16 v[148:149], v97 offset:18432
    ds_read_b64_tr_b16 v[150:151], v97 offset:18944
    s_waitcnt lgkmcnt(12)
    v_mfma_f32_32x32x16_bf16 v[0:15], v[152:155], a[140:143], v[0:15]
    ds_read_b64_tr_b16 v[152:153], v96 offset:26624
    ds_read_b64_tr_b16 v[154:155], v96 offset:27136
    v_mfma_f32_32x32x16_bf16 v[16:31], v[156:159], a[140:143], v[16:31]
    ds_read_b64_tr_b16 v[156:157], v97 offset:26624
    ds_read_b64_tr_b16 v[158:159], v97 offset:27136
    buffer_load_dwordx4 a[140:143], v226, s[4:7], s16 offen offset:3072 sc1
    s_waitcnt vmcnt(30) lgkmcnt(12)
    v_mfma_f32_32x32x16_bf16 v[32:47], v[128:131], a[80:83], v[32:47]
    ds_read_b64_tr_b16 v[128:129], v96 offset:20480
    ds_read_b64_tr_b16 v[130:131], v96 offset:20992
    v_mfma_f32_32x32x16_bf16 v[48:63], v[132:135], a[80:83], v[48:63]
    s_add_u32 m0, s18, 147456
    s_add_u32 s54, s54, 8192
    ds_read_b64_tr_b16 v[132:133], v97 offset:20480
    ds_read_b64_tr_b16 v[134:135], v97 offset:20992
    buffer_load_dwordx4 v226, s[56:59], s54 offen offset:0 lds
    s_waitcnt lgkmcnt(12)
    v_mfma_f32_32x32x16_bf16 v[0:15], v[136:139], a[144:147], v[0:15]
    ds_read_b64_tr_b16 v[136:137], v96 offset:28672
    ds_read_b64_tr_b16 v[138:139], v96 offset:29184
    v_mfma_f32_32x32x16_bf16 v[16:31], v[140:143], a[144:147], v[16:31]
    ds_read_b64_tr_b16 v[140:141], v97 offset:28672
    ds_read_b64_tr_b16 v[142:143], v97 offset:29184
    s_add_u32 s16, s16, 4096
    buffer_load_dwordx4 a[144:147], v226, s[4:7], s16 offen offset:0 sc1
    s_waitcnt vmcnt(30) lgkmcnt(12)
    v_mfma_f32_32x32x16_bf16 v[32:47], v[144:147], a[84:87], v[32:47]
    ds_read_b64_tr_b16 v[144:145], v96 offset:22528
    ds_read_b64_tr_b16 v[146:147], v96 offset:23040
    buffer_load_dwordx4 v226, s[56:59], s54 offen offset:1024 lds
    v_mfma_f32_32x32x16_bf16 v[48:63], v[148:151], a[84:87], v[48:63]
    ds_read_b64_tr_b16 v[148:149], v97 offset:22528
    ds_read_b64_tr_b16 v[150:151], v97 offset:23040
    s_waitcnt lgkmcnt(12)
    v_mfma_f32_32x32x16_bf16 v[0:15], v[152:155], a[148:151], v[0:15]
    ds_read_b64_tr_b16 v[152:153], v96 offset:30720
    ds_read_b64_tr_b16 v[154:155], v96 offset:31232
    v_mfma_f32_32x32x16_bf16 v[16:31], v[156:159], a[148:151], v[16:31]
    ds_read_b64_tr_b16 v[156:157], v97 offset:30720
    ds_read_b64_tr_b16 v[158:159], v97 offset:31232
    buffer_load_dwordx4 a[148:151], v226, s[4:7], s16 offen offset:1024 sc1
    s_waitcnt vmcnt(30) lgkmcnt(12)
    v_mfma_f32_32x32x16_bf16 v[32:47], v[128:131], a[88:91], v[32:47]
    ds_read_b64_tr_b16 v[128:129], v96 offset:32768
    ds_read_b64_tr_b16 v[130:131], v96 offset:33280
    v_mfma_f32_32x32x16_bf16 v[48:63], v[132:135], a[88:91], v[48:63]
    s_add_u32 m0, s18, 155648
    s_add_u32 s3, s3, 8192
    ds_read_b64_tr_b16 v[132:133], v97 offset:32768
    ds_read_b64_tr_b16 v[134:135], v97 offset:33280
    buffer_load_dwordx4 v226, s[56:59], s3 offen offset:0 lds
    s_waitcnt lgkmcnt(12)
    v_mfma_f32_32x32x16_bf16 v[0:15], v[136:139], a[152:155], v[0:15]
    ds_read_b64_tr_b16 v[136:137], v96 offset:40960
    ds_read_b64_tr_b16 v[138:139], v96 offset:41472
    v_mfma_f32_32x32x16_bf16 v[16:31], v[140:143], a[152:155], v[16:31]
    ds_read_b64_tr_b16 v[140:141], v97 offset:40960
    ds_read_b64_tr_b16 v[142:143], v97 offset:41472
    buffer_load_dwordx4 a[152:155], v226, s[4:7], s16 offen offset:2048 sc1
    s_waitcnt vmcnt(30) lgkmcnt(12)
    v_mfma_f32_32x32x16_bf16 v[32:47], v[144:147], a[92:95], v[32:47]
    ds_read_b64_tr_b16 v[144:145], v96 offset:34816
    ds_read_b64_tr_b16 v[146:147], v96 offset:35328
    buffer_load_dwordx4 v226, s[56:59], s3 offen offset:1024 lds
    v_mfma_f32_32x32x16_bf16 v[48:63], v[148:151], a[92:95], v[48:63]
    ds_read_b64_tr_b16 v[148:149], v97 offset:34816
    ds_read_b64_tr_b16 v[150:151], v97 offset:35328
    s_waitcnt lgkmcnt(12)
    v_mfma_f32_32x32x16_bf16 v[0:15], v[152:155], a[156:159], v[0:15]
    ds_read_b64_tr_b16 v[152:153], v96 offset:43008
    ds_read_b64_tr_b16 v[154:155], v96 offset:43520
    v_mfma_f32_32x32x16_bf16 v[16:31], v[156:159], a[156:159], v[16:31]
    ds_read_b64_tr_b16 v[156:157], v97 offset:43008
    ds_read_b64_tr_b16 v[158:159], v97 offset:43520
    buffer_load_dwordx4 a[156:159], v226, s[4:7], s16 offen offset:3072 sc1
    s_waitcnt vmcnt(30) lgkmcnt(12)
    s_barrier
    v_mfma_f32_32x32x16_bf16 v[32:47], v[128:131], a[96:99], v[32:47]
    ds_read_b64_tr_b16 v[128:129], v96 offset:36864
    ds_read_b64_tr_b16 v[130:131], v96 offset:37376
    v_mfma_f32_32x32x16_bf16 v[48:63], v[132:135], a[96:99], v[48:63]
    s_add_u32 m0, s18, 0
    s_add_u32 s3, s3, 8192
    ds_read_b64_tr_b16 v[132:133], v97 offset:36864
    ds_read_b64_tr_b16 v[134:135], v97 offset:37376
    buffer_load_dwordx4 v226, s[56:59], s3 offen offset:0 lds
    s_waitcnt lgkmcnt(12)
    v_mfma_f32_32x32x16_bf16 v[0:15], v[136:139], a[160:163], v[0:15]
    ds_read_b64_tr_b16 v[136:137], v96 offset:45056
    ds_read_b64_tr_b16 v[138:139], v96 offset:45568
    v_mfma_f32_32x32x16_bf16 v[16:31], v[140:143], a[160:163], v[16:31]
    ds_read_b64_tr_b16 v[140:141], v97 offset:45056
    ds_read_b64_tr_b16 v[142:143], v97 offset:45568
    s_add_u32 s16, s16, 4096
    buffer_load_dwordx4 a[160:163], v226, s[4:7], s16 offen offset:0 sc1
    s_waitcnt vmcnt(30) lgkmcnt(12)
    v_mfma_f32_32x32x16_bf16 v[32:47], v[144:147], a[100:103], v[32:47]
    ds_read_b64_tr_b16 v[144:145], v96 offset:38912
    ds_read_b64_tr_b16 v[146:147], v96 offset:39424
    buffer_load_dwordx4 v226, s[56:59], s3 offen offset:1024 lds
    v_mfma_f32_32x32x16_bf16 v[48:63], v[148:151], a[100:103], v[48:63]
    ds_read_b64_tr_b16 v[148:149], v97 offset:38912
    ds_read_b64_tr_b16 v[150:151], v97 offset:39424
    s_waitcnt lgkmcnt(12)
    v_mfma_f32_32x32x16_bf16 v[0:15], v[152:155], a[164:167], v[0:15]
    ds_read_b64_tr_b16 v[152:153], v96 offset:47104
    ds_read_b64_tr_b16 v[154:155], v96 offset:47616
    v_mfma_f32_32x32x16_bf16 v[16:31], v[156:159], a[164:167], v[16:31]
    ds_read_b64_tr_b16 v[156:157], v97 offset:47104
    ds_read_b64_tr_b16 v[158:159], v97 offset:47616
    buffer_load_dwordx4 a[164:167], v226, s[4:7], s16 offen offset:1024 sc1
    s_waitcnt vmcnt(30) lgkmcnt(12)
    v_mfma_f32_32x32x16_bf16 v[32:47], v[128:131], a[104:107], v[32:47]
    ds_read_b64_tr_b16 v[128:129], v96 offset:49152
    ds_read_b64_tr_b16 v[130:131], v96 offset:49664
    v_mfma_f32_32x32x16_bf16 v[48:63], v[132:135], a[104:107], v[48:63]
    s_add_u32 m0, s18, 8192
    s_add_u32 s3, s3, 8192
    ds_read_b64_tr_b16 v[132:133], v97 offset:49152
    ds_read_b64_tr_b16 v[134:135], v97 offset:49664
    buffer_load_dwordx4 v226, s[56:59], s3 offen offset:0 lds
    s_waitcnt lgkmcnt(12)
    v_mfma_f32_32x32x16_bf16 v[0:15], v[136:139], a[168:171], v[0:15]
    ds_read_b64_tr_b16 v[136:137], v96 offset:57344
    ds_read_b64_tr_b16 v[138:139], v96 offset:57856
    v_mfma_f32_32x32x16_bf16 v[16:31], v[140:143], a[168:171], v[16:31]
    ds_read_b64_tr_b16 v[140:141], v97 offset:57344
    ds_read_b64_tr_b16 v[142:143], v97 offset:57856
    buffer_load_dwordx4 a[168:171], v226, s[4:7], s16 offen offset:2048 sc1
    s_waitcnt vmcnt(30) lgkmcnt(12)
    v_mfma_f32_32x32x16_bf16 v[32:47], v[144:147], a[108:111], v[32:47]
    ds_read_b64_tr_b16 v[144:145], v96 offset:51200
    ds_read_b64_tr_b16 v[146:147], v96 offset:51712
    buffer_load_dwordx4 v226, s[56:59], s3 offen offset:1024 lds
    v_mfma_f32_32x32x16_bf16 v[48:63], v[148:151], a[108:111], v[48:63]
    ds_read_b64_tr_b16 v[148:149], v97 offset:51200
    ds_read_b64_tr_b16 v[150:151], v97 offset:51712
    s_waitcnt lgkmcnt(12)
    v_mfma_f32_32x32x16_bf16 v[0:15], v[152:155], a[172:175], v[0:15]
    ds_read_b64_tr_b16 v[152:153], v96 offset:59392
    ds_read_b64_tr_b16 v[154:155], v96 offset:59904
    v_mfma_f32_32x32x16_bf16 v[16:31], v[156:159], a[172:175], v[16:31]
    ds_read_b64_tr_b16 v[156:157], v97 offset:59392
    ds_read_b64_tr_b16 v[158:159], v97 offset:59904
    buffer_load_dwordx4 a[172:175], v226, s[4:7], s16 offen offset:3072 sc1
    s_waitcnt vmcnt(30) lgkmcnt(12)
    v_mfma_f32_32x32x16_bf16 v[32:47], v[128:131], a[112:115], v[32:47]
    ds_read_b64_tr_b16 v[128:129], v96 offset:53248
    ds_read_b64_tr_b16 v[130:131], v96 offset:53760
    v_mfma_f32_32x32x16_bf16 v[48:63], v[132:135], a[112:115], v[48:63]
    s_add_u32 m0, s18, 16384
    s_add_u32 s3, s3, 8192
    ds_read_b64_tr_b16 v[132:133], v97 offset:53248
    ds_read_b64_tr_b16 v[134:135], v97 offset:53760
    buffer_load_dwordx4 v226, s[56:59], s3 offen offset:0 lds
    s_waitcnt lgkmcnt(12)
    v_mfma_f32_32x32x16_bf16 v[0:15], v[136:139], a[176:179], v[0:15]
    ds_read_b64_tr_b16 v[136:137], v96 offset:61440
    ds_read_b64_tr_b16 v[138:139], v96 offset:61952
    v_mfma_f32_32x32x16_bf16 v[16:31], v[140:143], a[176:179], v[16:31]
    ds_read_b64_tr_b16 v[140:141], v97 offset:61440
    ds_read_b64_tr_b16 v[142:143], v97 offset:61952
    s_add_u32 s16, s16, 4096
    buffer_load_dwordx4 a[176:179], v226, s[4:7], s16 offen offset:0 sc1
    s_waitcnt vmcnt(30) lgkmcnt(12)
    v_mfma_f32_32x32x16_bf16 v[32:47], v[144:147], a[116:119], v[32:47]
    ds_read_b64_tr_b16 v[144:145], v96 offset:55296
    ds_read_b64_tr_b16 v[146:147], v96 offset:55808
    buffer_load_dwordx4 v226, s[56:59], s3 offen offset:1024 lds
    v_mfma_f32_32x32x16_bf16 v[48:63], v[148:151], a[116:119], v[48:63]
    ds_read_b64_tr_b16 v[148:149], v97 offset:55296
    ds_read_b64_tr_b16 v[150:151], v97 offset:55808
    s_waitcnt lgkmcnt(12)
    v_mfma_f32_32x32x16_bf16 v[0:15], v[152:155], a[180:183], v[0:15]
    ds_read_b64_tr_b16 v[152:153], v96 offset:63488
    ds_read_b64_tr_b16 v[154:155], v96 offset:64000
    v_mfma_f32_32x32x16_bf16 v[16:31], v[156:159], a[180:183], v[16:31]
    ds_read_b64_tr_b16 v[156:157], v97 offset:63488
    ds_read_b64_tr_b16 v[158:159], v97 offset:64000
    buffer_load_dwordx4 a[180:183], v226, s[4:7], s16 offen offset:1024 sc1
    s_waitcnt vmcnt(30) lgkmcnt(12)
    v_mfma_f32_32x32x16_bf16 v[32:47], v[128:131], a[120:123], v[32:47]
    ds_read_b64_tr_b16 v[128:129], v98 offset:0
    ds_read_b64_tr_b16 v[130:131], v98 offset:512
    v_mfma_f32_32x32x16_bf16 v[48:63], v[132:135], a[120:123], v[48:63]
    s_add_u32 m0, s18, 24576
    s_add_u32 s3, s3, 8192
    ds_read_b64_tr_b16 v[132:133], v99 offset:0
    ds_read_b64_tr_b16 v[134:135], v99 offset:512
    buffer_load_dwordx4 v226, s[56:59], s3 offen offset:0 lds
    s_waitcnt lgkmcnt(12)
    v_mfma_f32_32x32x16_bf16 v[0:15], v[136:139], a[184:187], v[0:15]
    ds_read_b64_tr_b16 v[136:137], v98 offset:8192
    ds_read_b64_tr_b16 v[138:139], v98 offset:8704
    v_mfma_f32_32x32x16_bf16 v[16:31], v[140:143], a[184:187], v[16:31]
    ds_read_b64_tr_b16 v[140:141], v99 offset:8192
    ds_read_b64_tr_b16 v[142:143], v99 offset:8704
    buffer_load_dwordx4 a[184:187], v226, s[4:7], s16 offen offset:2048 sc1
    s_waitcnt vmcnt(30) lgkmcnt(12)
    v_mfma_f32_32x32x16_bf16 v[32:47], v[144:147], a[124:127], v[32:47]
    ds_read_b64_tr_b16 v[144:145], v98 offset:2048
    ds_read_b64_tr_b16 v[146:147], v98 offset:2560
    buffer_load_dwordx4 v226, s[56:59], s3 offen offset:1024 lds
    v_mfma_f32_32x32x16_bf16 v[48:63], v[148:151], a[124:127], v[48:63]
    ds_read_b64_tr_b16 v[148:149], v99 offset:2048
    ds_read_b64_tr_b16 v[150:151], v99 offset:2560
    s_waitcnt lgkmcnt(12)
    v_mfma_f32_32x32x16_bf16 v[0:15], v[152:155], a[188:191], v[0:15]
    ds_read_b64_tr_b16 v[152:153], v98 offset:10240
    ds_read_b64_tr_b16 v[154:155], v98 offset:10752
    v_mfma_f32_32x32x16_bf16 v[16:31], v[156:159], a[188:191], v[16:31]
    ds_read_b64_tr_b16 v[156:157], v99 offset:10240
    ds_read_b64_tr_b16 v[158:159], v99 offset:10752
    buffer_load_dwordx4 a[188:191], v226, s[4:7], s16 offen offset:3072 sc1
    s_waitcnt vmcnt(30) lgkmcnt(12)
    s_barrier
    v_mfma_f32_32x32x16_bf16 v[32:47], v[128:131], a[128:131], v[32:47]
    ds_read_b64_tr_b16 v[128:129], v98 offset:4096
    ds_read_b64_tr_b16 v[130:131], v98 offset:4608
    v_mfma_f32_32x32x16_bf16 v[48:63], v[132:135], a[128:131], v[48:63]
    s_add_u32 m0, s18, 32768
    s_add_u32 s3, s3, 8192
    ds_read_b64_tr_b16 v[132:133], v99 offset:4096
    ds_read_b64_tr_b16 v[134:135], v99 offset:4608
    buffer_load_dwordx4 v226, s[56:59], s3 offen offset:0 lds
    s_waitcnt lgkmcnt(12)
    v_mfma_f32_32x32x16_bf16 v[0:15], v[136:139], a[192:195], v[0:15]
    ds_read_b64_tr_b16 v[136:137], v98 offset:12288
    ds_read_b64_tr_b16 v[138:139], v98 offset:12800
    v_mfma_f32_32x32x16_bf16 v[16:31], v[140:143], a[192:195], v[16:31]
    ds_read_b64_tr_b16 v[140:141], v99 offset:12288
    ds_read_b64_tr_b16 v[142:143], v99 offset:12800
    s_add_u32 s16, s16, 4096
    buffer_load_dwordx4 a[192:195], v226, s[4:7], s16 offen offset:0 sc1
    s_waitcnt vmcnt(30) lgkmcnt(12)
    v_mfma_f32_32x32x16_bf16 v[32:47], v[144:147], a[132:135], v[32:47]
    ds_read_b64_tr_b16 v[144:145], v98 offset:6144
    ds_read_b64_tr_b16 v[146:147], v98 offset:6656
    buffer_load_dwordx4 v226, s[56:59], s3 offen offset:1024 lds
    v_mfma_f32_32x32x16_bf16 v[48:63], v[148:151], a[132:135], v[48:63]
    ds_read_b64_tr_b16 v[148:149], v99 offset:6144
    ds_read_b64_tr_b16 v[150:151], v99 offset:6656
    s_waitcnt lgkmcnt(12)
    v_mfma_f32_32x32x16_bf16 v[0:15], v[152:155], a[196:199], v[0:15]
    ds_read_b64_tr_b16 v[152:153], v98 offset:14336
    ds_read_b64_tr_b16 v[154:155], v98 offset:14848
    v_mfma_f32_32x32x16_bf16 v[16:31], v[156:159], a[196:199], v[16:31]
    ds_read_b64_tr_b16 v[156:157], v99 offset:14336
    ds_read_b64_tr_b16 v[158:159], v99 offset:14848
    buffer_load_dwordx4 a[196:199], v226, s[4:7], s16 offen offset:1024 sc1
    s_waitcnt vmcnt(30) lgkmcnt(12)
    v_mfma_f32_32x32x16_bf16 v[32:47], v[128:131], a[136:139], v[32:47]
    ds_read_b64_tr_b16 v[128:129], v98 offset:16384
    ds_read_b64_tr_b16 v[130:131], v98 offset:16896
    v_mfma_f32_32x32x16_bf16 v[48:63], v[132:135], a[136:139], v[48:63]
    s_add_u32 m0, s18, 40960
    s_add_u32 s3, s3, 8192
    ds_read_b64_tr_b16 v[132:133], v99 offset:16384
    ds_read_b64_tr_b16 v[134:135], v99 offset:16896
    buffer_load_dwordx4 v226, s[56:59], s3 offen offset:0 lds
    s_waitcnt lgkmcnt(12)
    v_mfma_f32_32x32x16_bf16 v[0:15], v[136:139], a[200:203], v[0:15]
    ds_read_b64_tr_b16 v[136:137], v98 offset:24576
    ds_read_b64_tr_b16 v[138:139], v98 offset:25088
    v_mfma_f32_32x32x16_bf16 v[16:31], v[140:143], a[200:203], v[16:31]
    ds_read_b64_tr_b16 v[140:141], v99 offset:24576
    ds_read_b64_tr_b16 v[142:143], v99 offset:25088
    buffer_load_dwordx4 a[200:203], v226, s[4:7], s16 offen offset:2048 sc1
    s_waitcnt vmcnt(30) lgkmcnt(12)
    v_mfma_f32_32x32x16_bf16 v[32:47], v[144:147], a[140:143], v[32:47]
    ds_read_b64_tr_b16 v[144:145], v98 offset:18432
    ds_read_b64_tr_b16 v[146:147], v98 offset:18944
    buffer_load_dwordx4 v226, s[56:59], s3 offen offset:1024 lds
    v_mfma_f32_32x32x16_bf16 v[48:63], v[148:151], a[140:143], v[48:63]
    ds_read_b64_tr_b16 v[148:149], v99 offset:18432
    ds_read_b64_tr_b16 v[150:151], v99 offset:18944
    s_waitcnt lgkmcnt(12)
    v_mfma_f32_32x32x16_bf16 v[0:15], v[152:155], a[204:207], v[0:15]
    ds_read_b64_tr_b16 v[152:153], v98 offset:26624
    ds_read_b64_tr_b16 v[154:155], v98 offset:27136
    v_mfma_f32_32x32x16_bf16 v[16:31], v[156:159], a[204:207], v[16:31]
    ds_read_b64_tr_b16 v[156:157], v99 offset:26624
    ds_read_b64_tr_b16 v[158:159], v99 offset:27136
    buffer_load_dwordx4 a[204:207], v226, s[4:7], s16 offen offset:3072 sc1
    s_waitcnt vmcnt(30) lgkmcnt(12)
    v_mfma_f32_32x32x16_bf16 v[32:47], v[128:131], a[144:147], v[32:47]
    ds_read_b64_tr_b16 v[128:129], v98 offset:20480
    ds_read_b64_tr_b16 v[130:131], v98 offset:20992
    v_mfma_f32_32x32x16_bf16 v[48:63], v[132:135], a[144:147], v[48:63]
    s_add_u32 m0, s18, 49152
    s_add_u32 s3, s3, 8192
    ds_read_b64_tr_b16 v[132:133], v99 offset:20480
    ds_read_b64_tr_b16 v[134:135], v99 offset:20992
    buffer_load_dwordx4 v226, s[56:59], s3 offen offset:0 lds
    s_waitcnt lgkmcnt(12)
    v_mfma_f32_32x32x16_bf16 v[0:15], v[136:139], a[208:211], v[0:15]
    ds_read_b64_tr_b16 v[136:137], v98 offset:28672
    ds_read_b64_tr_b16 v[138:139], v98 offset:29184
    v_mfma_f32_32x32x16_bf16 v[16:31], v[140:143], a[208:211], v[16:31]
    ds_read_b64_tr_b16 v[140:141], v99 offset:28672
    ds_read_b64_tr_b16 v[142:143], v99 offset:29184
    s_add_u32 s16, s16, 4096
    buffer_load_dwordx4 a[208:211], v226, s[4:7], s16 offen offset:0 sc1
    s_waitcnt vmcnt(30) lgkmcnt(12)
    v_mfma_f32_32x32x16_bf16 v[32:47], v[144:147], a[148:151], v[32:47]
    ds_read_b64_tr_b16 v[144:145], v98 offset:22528
    ds_read_b64_tr_b16 v[146:147], v98 offset:23040
    buffer_load_dwordx4 v226, s[56:59], s3 offen offset:1024 lds
    v_mfma_f32_32x32x16_bf16 v[48:63], v[148:151], a[148:151], v[48:63]
    ds_read_b64_tr_b16 v[148:149], v99 offset:22528
    ds_read_b64_tr_b16 v[150:151], v99 offset:23040
    s_waitcnt lgkmcnt(12)
    v_mfma_f32_32x32x16_bf16 v[0:15], v[152:155], a[212:215], v[0:15]
    ds_read_b64_tr_b16 v[152:153], v98 offset:30720
    ds_read_b64_tr_b16 v[154:155], v98 offset:31232
    v_mfma_f32_32x32x16_bf16 v[16:31], v[156:159], a[212:215], v[16:31]
    ds_read_b64_tr_b16 v[156:157], v99 offset:30720
    ds_read_b64_tr_b16 v[158:159], v99 offset:31232
    buffer_load_dwordx4 a[212:215], v226, s[4:7], s16 offen offset:1024 sc1
    s_waitcnt vmcnt(30) lgkmcnt(12)
    v_mfma_f32_32x32x16_bf16 v[32:47], v[128:131], a[152:155], v[32:47]
    ds_read_b64_tr_b16 v[128:129], v98 offset:32768
    ds_read_b64_tr_b16 v[130:131], v98 offset:33280
    v_mfma_f32_32x32x16_bf16 v[48:63], v[132:135], a[152:155], v[48:63]
    s_add_u32 m0, s18, 57344
    s_add_u32 s3, s3, 8192
    ds_read_b64_tr_b16 v[132:133], v99 offset:32768
    ds_read_b64_tr_b16 v[134:135], v99 offset:33280
    buffer_load_dwordx4 v226, s[56:59], s3 offen offset:0 lds
    s_waitcnt lgkmcnt(12)
    v_mfma_f32_32x32x16_bf16 v[0:15], v[136:139], a[216:219], v[0:15]
    ds_read_b64_tr_b16 v[136:137], v98 offset:40960
    ds_read_b64_tr_b16 v[138:139], v98 offset:41472
    v_mfma_f32_32x32x16_bf16 v[16:31], v[140:143], a[216:219], v[16:31]
    ds_read_b64_tr_b16 v[140:141], v99 offset:40960
    ds_read_b64_tr_b16 v[142:143], v99 offset:41472
    buffer_load_dwordx4 a[216:219], v226, s[4:7], s16 offen offset:2048 sc1
    s_waitcnt vmcnt(30) lgkmcnt(12)
    v_mfma_f32_32x32x16_bf16 v[32:47], v[144:147], a[156:159], v[32:47]
    ds_read_b64_tr_b16 v[144:145], v98 offset:34816
    ds_read_b64_tr_b16 v[146:147], v98 offset:35328
    buffer_load_dwordx4 v226, s[56:59], s3 offen offset:1024 lds
    v_mfma_f32_32x32x16_bf16 v[48:63], v[148:151], a[156:159], v[48:63]
    ds_read_b64_tr_b16 v[148:149], v99 offset:34816
    ds_read_b64_tr_b16 v[150:151], v99 offset:35328
    s_waitcnt lgkmcnt(12)
    v_mfma_f32_32x32x16_bf16 v[0:15], v[152:155], a[220:223], v[0:15]
    ds_read_b64_tr_b16 v[152:153], v98 offset:43008
    ds_read_b64_tr_b16 v[154:155], v98 offset:43520
    v_mfma_f32_32x32x16_bf16 v[16:31], v[156:159], a[220:223], v[16:31]
    ds_read_b64_tr_b16 v[156:157], v99 offset:43008
    ds_read_b64_tr_b16 v[158:159], v99 offset:43520
    buffer_load_dwordx4 a[220:223], v226, s[4:7], s16 offen offset:3072 sc1
    s_waitcnt vmcnt(30) lgkmcnt(12)
    s_barrier
    v_mfma_f32_32x32x16_bf16 v[32:47], v[128:131], a[160:163], v[32:47]
    ds_read_b64_tr_b16 v[128:129], v98 offset:36864
    ds_read_b64_tr_b16 v[130:131], v98 offset:37376
    v_mfma_f32_32x32x16_bf16 v[48:63], v[132:135], a[160:163], v[48:63]
    s_add_u32 m0, s18, 65536
    s_add_u32 s3, s3, 8192
    ds_read_b64_tr_b16 v[132:133], v99 offset:36864
    ds_read_b64_tr_b16 v[134:135], v99 offset:37376
    buffer_load_dwordx4 v226, s[56:59], s3 offen offset:0 lds
    s_waitcnt lgkmcnt(12)
    v_mfma_f32_32x32x16_bf16 v[0:15], v[136:139], a[0:3], v[0:15]
    ds_read_b64_tr_b16 v[136:137], v98 offset:45056
    ds_read_b64_tr_b16 v[138:139], v98 offset:45568
    v_mfma_f32_32x32x16_bf16 v[16:31], v[140:143], a[0:3], v[16:31]
    ds_read_b64_tr_b16 v[140:141], v99 offset:45056
    ds_read_b64_tr_b16 v[142:143], v99 offset:45568
    s_waitcnt vmcnt(29) lgkmcnt(12)
    v_mfma_f32_32x32x16_bf16 v[32:47], v[144:147], a[164:167], v[32:47]
    ds_read_b64_tr_b16 v[144:145], v98 offset:38912
    ds_read_b64_tr_b16 v[146:147], v98 offset:39424
    buffer_load_dwordx4 v226, s[56:59], s3 offen offset:1024 lds
    v_mfma_f32_32x32x16_bf16 v[48:63], v[148:151], a[164:167], v[48:63]
    ds_read_b64_tr_b16 v[148:149], v99 offset:38912
    ds_read_b64_tr_b16 v[150:151], v99 offset:39424
    s_waitcnt lgkmcnt(12)
    v_mfma_f32_32x32x16_bf16 v[0:15], v[152:155], a[4:7], v[0:15]
    ds_read_b64_tr_b16 v[152:153], v98 offset:47104
    ds_read_b64_tr_b16 v[154:155], v98 offset:47616
    v_mfma_f32_32x32x16_bf16 v[16:31], v[156:159], a[4:7], v[16:31]
    ds_read_b64_tr_b16 v[156:157], v99 offset:47104
    ds_read_b64_tr_b16 v[158:159], v99 offset:47616
    s_waitcnt vmcnt(28) lgkmcnt(12)
    v_mfma_f32_32x32x16_bf16 v[32:47], v[128:131], a[168:171], v[32:47]
    ds_read_b64_tr_b16 v[128:129], v100 offset:0
    ds_read_b64_tr_b16 v[130:131], v100 offset:512
    v_mfma_f32_32x32x16_bf16 v[48:63], v[132:135], a[168:171], v[48:63]
    s_add_u32 m0, s18, 73728
    s_add_u32 s3, s3, 8192
    ds_read_b64_tr_b16 v[132:133], v101 offset:0
    ds_read_b64_tr_b16 v[134:135], v101 offset:512
    buffer_load_dwordx4 v226, s[56:59], s3 offen offset:0 lds
    s_waitcnt lgkmcnt(12)
    v_mfma_f32_32x32x16_bf16 v[0:15], v[136:139], a[8:11], v[0:15]
    ds_read_b64_tr_b16 v[136:137], v100 offset:8192
    ds_read_b64_tr_b16 v[138:139], v100 offset:8704
    v_mfma_f32_32x32x16_bf16 v[16:31], v[140:143], a[8:11], v[16:31]
    ds_read_b64_tr_b16 v[140:141], v101 offset:8192
    ds_read_b64_tr_b16 v[142:143], v101 offset:8704
    s_waitcnt vmcnt(27) lgkmcnt(12)
    v_mfma_f32_32x32x16_bf16 v[32:47], v[144:147], a[172:175], v[32:47]
    ds_read_b64_tr_b16 v[144:145], v100 offset:2048
    ds_read_b64_tr_b16 v[146:147], v100 offset:2560
    buffer_load_dwordx4 v226, s[56:59], s3 offen offset:1024 lds
    v_mfma_f32_32x32x16_bf16 v[48:63], v[148:151], a[172:175], v[48:63]
    ds_read_b64_tr_b16 v[148:149], v101 offset:2048
    ds_read_b64_tr_b16 v[150:151], v101 offset:2560
    s_waitcnt lgkmcnt(12)
    v_mfma_f32_32x32x16_bf16 v[0:15], v[152:155], a[12:15], v[0:15]
    ds_read_b64_tr_b16 v[152:153], v100 offset:10240
    ds_read_b64_tr_b16 v[154:155], v100 offset:10752
    v_mfma_f32_32x32x16_bf16 v[16:31], v[156:159], a[12:15], v[16:31]
    ds_read_b64_tr_b16 v[156:157], v101 offset:10240
    ds_read_b64_tr_b16 v[158:159], v101 offset:10752
    s_waitcnt vmcnt(26) lgkmcnt(12)
    v_mfma_f32_32x32x16_bf16 v[32:47], v[128:131], a[176:179], v[32:47]
    ds_read_b64_tr_b16 v[128:129], v100 offset:4096
    ds_read_b64_tr_b16 v[130:131], v100 offset:4608
    v_mfma_f32_32x32x16_bf16 v[48:63], v[132:135], a[176:179], v[48:63]
    ds_read_b64_tr_b16 v[132:133], v101 offset:4096
    ds_read_b64_tr_b16 v[134:135], v101 offset:4608
    s_waitcnt lgkmcnt(12)
    v_mfma_f32_32x32x16_bf16 v[0:15], v[136:139], a[16:19], v[0:15]
    ds_read_b64_tr_b16 v[136:137], v100 offset:12288
    ds_read_b64_tr_b16 v[138:139], v100 offset:12800
    v_mfma_f32_32x32x16_bf16 v[16:31], v[140:143], a[16:19], v[16:31]
    ds_read_b64_tr_b16 v[140:141], v101 offset:12288
    ds_read_b64_tr_b16 v[142:143], v101 offset:12800
    s_waitcnt vmcnt(24) lgkmcnt(12)
    v_mfma_f32_32x32x16_bf16 v[32:47], v[144:147], a[180:183], v[32:47]
    ds_read_b64_tr_b16 v[144:145], v100 offset:6144
    ds_read_b64_tr_b16 v[146:147], v100 offset:6656
    v_mfma_f32_32x32x16_bf16 v[48:63], v[148:151], a[180:183], v[48:63]
    ds_read_b64_tr_b16 v[148:149], v101 offset:6144
    ds_read_b64_tr_b16 v[150:151], v101 offset:6656
    s_waitcnt lgkmcnt(12)
    v_mfma_f32_32x32x16_bf16 v[0:15], v[152:155], a[20:23], v[0:15]
    ds_read_b64_tr_b16 v[152:153], v100 offset:14336
    ds_read_b64_tr_b16 v[154:155], v100 offset:14848
    v_mfma_f32_32x32x16_bf16 v[16:31], v[156:159], a[20:23], v[16:31]
    ds_read_b64_tr_b16 v[156:157], v101 offset:14336
    ds_read_b64_tr_b16 v[158:159], v101 offset:14848
    s_waitcnt vmcnt(22) lgkmcnt(12)
    v_mfma_f32_32x32x16_bf16 v[32:47], v[128:131], a[184:187], v[32:47]
    ds_read_b64_tr_b16 v[128:129], v100 offset:16384
    ds_read_b64_tr_b16 v[130:131], v100 offset:16896
    v_mfma_f32_32x32x16_bf16 v[48:63], v[132:135], a[184:187], v[48:63]
    ds_read_b64_tr_b16 v[132:133], v101 offset:16384
    ds_read_b64_tr_b16 v[134:135], v101 offset:16896
    s_waitcnt lgkmcnt(12)
    v_mfma_f32_32x32x16_bf16 v[0:15], v[136:139], a[24:27], v[0:15]
    ds_read_b64_tr_b16 v[136:137], v100 offset:24576
    ds_read_b64_tr_b16 v[138:139], v100 offset:25088
    v_mfma_f32_32x32x16_bf16 v[16:31], v[140:143], a[24:27], v[16:31]
    ds_read_b64_tr_b16 v[140:141], v101 offset:24576
    ds_read_b64_tr_b16 v[142:143], v101 offset:25088
    s_waitcnt vmcnt(20) lgkmcnt(12)
    v_mfma_f32_32x32x16_bf16 v[32:47], v[144:147], a[188:191], v[32:47]
    ds_read_b64_tr_b16 v[144:145], v100 offset:18432
    ds_read_b64_tr_b16 v[146:147], v100 offset:18944
    v_mfma_f32_32x32x16_bf16 v[48:63], v[148:151], a[188:191], v[48:63]
    ds_read_b64_tr_b16 v[148:149], v101 offset:18432
    ds_read_b64_tr_b16 v[150:151], v101 offset:18944
    s_waitcnt lgkmcnt(12)
    v_mfma_f32_32x32x16_bf16 v[0:15], v[152:155], a[28:31], v[0:15]
    ds_read_b64_tr_b16 v[152:153], v100 offset:26624
    ds_read_b64_tr_b16 v[154:155], v100 offset:27136
    v_mfma_f32_32x32x16_bf16 v[16:31], v[156:159], a[28:31], v[16:31]
    ds_read_b64_tr_b16 v[156:157], v101 offset:26624
    ds_read_b64_tr_b16 v[158:159], v101 offset:27136
    s_waitcnt vmcnt(18) lgkmcnt(12)
    s_barrier
    v_mfma_f32_32x32x16_bf16 v[32:47], v[128:131], a[192:195], v[32:47]
    ds_read_b64_tr_b16 v[128:129], v100 offset:20480
    ds_read_b64_tr_b16 v[130:131], v100 offset:20992
    v_mfma_f32_32x32x16_bf16 v[48:63], v[132:135], a[192:195], v[48:63]
    ds_read_b64_tr_b16 v[132:133], v101 offset:20480
    ds_read_b64_tr_b16 v[134:135], v101 offset:20992
    s_waitcnt lgkmcnt(12)
    v_mfma_f32_32x32x16_bf16 v[0:15], v[136:139], a[32:35], v[0:15]
    ds_read_b64_tr_b16 v[136:137], v100 offset:28672
    ds_read_b64_tr_b16 v[138:139], v100 offset:29184
    v_mfma_f32_32x32x16_bf16 v[16:31], v[140:143], a[32:35], v[16:31]
    ds_read_b64_tr_b16 v[140:141], v101 offset:28672
    ds_read_b64_tr_b16 v[142:143], v101 offset:29184
    s_waitcnt vmcnt(16) lgkmcnt(12)
    v_mfma_f32_32x32x16_bf16 v[32:47], v[144:147], a[196:199], v[32:47]
    ds_read_b64_tr_b16 v[144:145], v100 offset:22528
    ds_read_b64_tr_b16 v[146:147], v100 offset:23040
    v_mfma_f32_32x32x16_bf16 v[48:63], v[148:151], a[196:199], v[48:63]
    ds_read_b64_tr_b16 v[148:149], v101 offset:22528
    ds_read_b64_tr_b16 v[150:151], v101 offset:23040
    s_waitcnt lgkmcnt(12)
    v_mfma_f32_32x32x16_bf16 v[0:15], v[152:155], a[36:39], v[0:15]
    ds_read_b64_tr_b16 v[152:153], v100 offset:30720
    ds_read_b64_tr_b16 v[154:155], v100 offset:31232
    v_mfma_f32_32x32x16_bf16 v[16:31], v[156:159], a[36:39], v[16:31]
    ds_read_b64_tr_b16 v[156:157], v101 offset:30720
    ds_read_b64_tr_b16 v[158:159], v101 offset:31232
    s_waitcnt vmcnt(14) lgkmcnt(12)
    v_mfma_f32_32x32x16_bf16 v[32:47], v[128:131], a[200:203], v[32:47]
    ds_read_b64_tr_b16 v[128:129], v100 offset:32768
    ds_read_b64_tr_b16 v[130:131], v100 offset:33280
    v_mfma_f32_32x32x16_bf16 v[48:63], v[132:135], a[200:203], v[48:63]
    ds_read_b64_tr_b16 v[132:133], v101 offset:32768
    ds_read_b64_tr_b16 v[134:135], v101 offset:33280
    s_waitcnt lgkmcnt(12)
    v_mfma_f32_32x32x16_bf16 v[0:15], v[136:139], a[40:43], v[0:15]
    ds_read_b64_tr_b16 v[136:137], v100 offset:40960
    ds_read_b64_tr_b16 v[138:139], v100 offset:41472
    v_mfma_f32_32x32x16_bf16 v[16:31], v[140:143], a[40:43], v[16:31]
    ds_read_b64_tr_b16 v[140:141], v101 offset:40960
    ds_read_b64_tr_b16 v[142:143], v101 offset:41472
    s_waitcnt vmcnt(12) lgkmcnt(12)
    v_mfma_f32_32x32x16_bf16 v[32:47], v[144:147], a[204:207], v[32:47]
    ds_read_b64_tr_b16 v[144:145], v100 offset:34816
    ds_read_b64_tr_b16 v[146:147], v100 offset:35328
    v_mfma_f32_32x32x16_bf16 v[48:63], v[148:151], a[204:207], v[48:63]
    ds_read_b64_tr_b16 v[148:149], v101 offset:34816
    ds_read_b64_tr_b16 v[150:151], v101 offset:35328
    s_waitcnt lgkmcnt(12)
    v_mfma_f32_32x32x16_bf16 v[0:15], v[152:155], a[44:47], v[0:15]
    ds_read_b64_tr_b16 v[152:153], v100 offset:43008
    ds_read_b64_tr_b16 v[154:155], v100 offset:43520
    v_mfma_f32_32x32x16_bf16 v[16:31], v[156:159], a[44:47], v[16:31]
    ds_read_b64_tr_b16 v[156:157], v101 offset:43008
    ds_read_b64_tr_b16 v[158:159], v101 offset:43520
    s_waitcnt vmcnt(10) lgkmcnt(12)
    v_mfma_f32_32x32x16_bf16 v[32:47], v[128:131], a[208:211], v[32:47]
    ds_read_b64_tr_b16 v[128:129], v100 offset:36864
    ds_read_b64_tr_b16 v[130:131], v100 offset:37376
    v_mfma_f32_32x32x16_bf16 v[48:63], v[132:135], a[208:211], v[48:63]
    ds_read_b64_tr_b16 v[132:133], v101 offset:36864
    ds_read_b64_tr_b16 v[134:135], v101 offset:37376
    s_waitcnt lgkmcnt(12)
    v_mfma_f32_32x32x16_bf16 v[0:15], v[136:139], a[48:51], v[0:15]
    ds_read_b64_tr_b16 v[136:137], v100 offset:45056
    ds_read_b64_tr_b16 v[138:139], v100 offset:45568
    v_mfma_f32_32x32x16_bf16 v[16:31], v[140:143], a[48:51], v[16:31]
    ds_read_b64_tr_b16 v[140:141], v101 offset:45056
    ds_read_b64_tr_b16 v[142:143], v101 offset:45568
    s_waitcnt vmcnt(8) lgkmcnt(12)
    v_mfma_f32_32x32x16_bf16 v[32:47], v[144:147], a[212:215], v[32:47]
    ds_read_b64_tr_b16 v[144:145], v100 offset:38912
    ds_read_b64_tr_b16 v[146:147], v100 offset:39424
    s_add_u32 s40, s30, 33554432
    s_addc_u32 s41, s31, 0
    v_mfma_f32_32x32x16_bf16 v[48:63], v[148:151], a[212:215], v[48:63]
    ds_read_b64_tr_b16 v[148:149], v101 offset:38912
    ds_read_b64_tr_b16 v[150:151], v101 offset:39424
    s_mov_b32 s42, 8388608
    s_waitcnt lgkmcnt(12)
    v_mfma_f32_32x32x16_bf16 v[0:15], v[152:155], a[52:55], v[0:15]
    ds_read_b64_tr_b16 v[152:153], v100 offset:47104
    ds_read_b64_tr_b16 v[154:155], v100 offset:47616
    s_mov_b32 s43, 0x20000
    v_mfma_f32_32x32x16_bf16 v[16:31], v[156:159], a[52:55], v[16:31]
    ds_read_b64_tr_b16 v[156:157], v101 offset:47104
    ds_read_b64_tr_b16 v[158:159], v101 offset:47616
    s_lshl_b32 s46, s2, 15
    s_waitcnt vmcnt(6) lgkmcnt(12)
    v_mfma_f32_32x32x16_bf16 v[32:47], v[128:131], a[216:219], v[32:47]
    ds_read_b64_tr_b16 v[128:129], v96 offset:0
    ds_read_b64_tr_b16 v[130:131], v96 offset:512
    s_lshl_b32 s48, s21, 13
    v_mfma_f32_32x32x16_bf16 v[48:63], v[132:135], a[216:219], v[48:63]
    ds_read_b64_tr_b16 v[132:133], v97 offset:0
    ds_read_b64_tr_b16 v[134:135], v97 offset:512
    s_add_u32 s46, s46, s48
    s_waitcnt lgkmcnt(12)
    v_mfma_f32_32x32x16_bf16 v[0:15], v[136:139], a[56:59], v[0:15]
    ds_read_b64_tr_b16 v[136:137], v96 offset:2048
    ds_read_b64_tr_b16 v[138:139], v96 offset:2560
    s_xor_b32 s50, s46, 65536
    v_mfma_f32_32x32x16_bf16 v[16:31], v[140:143], a[56:59], v[16:31]
    ds_read_b64_tr_b16 v[140:141], v97 offset:2048
    ds_read_b64_tr_b16 v[142:143], v97 offset:2560
    s_waitcnt vmcnt(4) lgkmcnt(12)
    v_mfma_f32_32x32x16_bf16 v[32:47], v[144:147], a[220:223], v[32:47]
    ds_read_b64_tr_b16 v[144:145], v96 offset:4096
    ds_read_b64_tr_b16 v[146:147], v96 offset:4608
    v_mfma_f32_32x32x16_bf16 v[48:63], v[148:151], a[220:223], v[48:63]
    ds_read_b64_tr_b16 v[148:149], v97 offset:4096
    ds_read_b64_tr_b16 v[150:151], v97 offset:4608
    s_waitcnt lgkmcnt(12)
    v_mfma_f32_32x32x16_bf16 v[0:15], v[152:155], a[60:63], v[0:15]
    ds_read_b64_tr_b16 v[152:153], v96 offset:6144
    ds_read_b64_tr_b16 v[154:155], v96 offset:6656
    v_mfma_f32_32x32x16_bf16 v[16:31], v[156:159], a[60:63], v[16:31]
    ds_read_b64_tr_b16 v[156:157], v97 offset:6144
    ds_read_b64_tr_b16 v[158:159], v97 offset:6656
    s_waitcnt lgkmcnt(12)
    s_barrier
    v_mfma_f32_32x32x16_bf16 v[0:15], v[128:131], a[64:67], v[0:15]
    ds_read_b64_tr_b16 v[128:129], v96 offset:8192
    ds_read_b64_tr_b16 v[130:131], v96 offset:8704
    v_mfma_f32_32x32x16_bf16 v[16:31], v[132:135], a[64:67], v[16:31]
    ds_read_b64_tr_b16 v[132:133], v97 offset:8192
    ds_read_b64_tr_b16 v[134:135], v97 offset:8704
    s_waitcnt lgkmcnt(12)
    v_mfma_f32_32x32x16_bf16 v[0:15], v[136:139], a[68:71], v[0:15]
    ds_read_b64_tr_b16 v[136:137], v96 offset:10240
    ds_read_b64_tr_b16 v[138:139], v96 offset:10752
    v_mfma_f32_32x32x16_bf16 v[16:31], v[140:143], a[68:71], v[16:31]
    ds_read_b64_tr_b16 v[140:141], v97 offset:10240
    ds_read_b64_tr_b16 v[142:143], v97 offset:10752
    buffer_store_dwordx4 v[32:35], v226, s[40:43], s46 offen offset:0 sc1
    s_waitcnt lgkmcnt(12)
    v_mfma_f32_32x32x16_bf16 v[0:15], v[144:147], a[72:75], v[0:15]
    ds_read_b64_tr_b16 v[144:145], v96 offset:12288
    ds_read_b64_tr_b16 v[146:147], v96 offset:12800
    buffer_store_dwordx4 v[36:39], v226, s[40:43], s46 offen offset:1024 sc1
    v_mfma_f32_32x32x16_bf16 v[16:31], v[148:151], a[72:75], v[16:31]
    ds_read_b64_tr_b16 v[148:149], v97 offset:12288
    ds_read_b64_tr_b16 v[150:151], v97 offset:12800
    buffer_store_dwordx4 v[40:43], v226, s[40:43], s46 offen offset:2048 sc1
    s_waitcnt lgkmcnt(12)
    v_mfma_f32_32x32x16_bf16 v[0:15], v[152:155], a[76:79], v[0:15]
    ds_read_b64_tr_b16 v[152:153], v96 offset:14336
    ds_read_b64_tr_b16 v[154:155], v96 offset:14848
    buffer_store_dwordx4 v[44:47], v226, s[40:43], s46 offen offset:3072 sc1
    v_mfma_f32_32x32x16_bf16 v[16:31], v[156:159], a[76:79], v[16:31]
    ds_read_b64_tr_b16 v[156:157], v97 offset:14336
    ds_read_b64_tr_b16 v[158:159], v97 offset:14848
    buffer_store_dwordx4 v[48:51], v227, s[40:43], s46 offen offset:0 sc1
    s_waitcnt lgkmcnt(12)
    v_mfma_f32_32x32x16_bf16 v[0:15], v[128:131], a[80:83], v[0:15]
    ds_read_b64_tr_b16 v[128:129], v96 offset:16384
    ds_read_b64_tr_b16 v[130:131], v96 offset:16896
    buffer_store_dwordx4 v[52:55], v227, s[40:43], s46 offen offset:1024 sc1
    v_mfma_f32_32x32x16_bf16 v[16:31], v[132:135], a[80:83], v[16:31]
    ds_read_b64_tr_b16 v[132:133], v97 offset:16384
    ds_read_b64_tr_b16 v[134:135], v97 offset:16896
    buffer_store_dwordx4 v[56:59], v227, s[40:43], s46 offen offset:2048 sc1
    s_waitcnt lgkmcnt(12)
    v_mfma_f32_32x32x16_bf16 v[0:15], v[136:139], a[84:87], v[0:15]
    ds_read_b64_tr_b16 v[136:137], v96 offset:18432
    ds_read_b64_tr_b16 v[138:139], v96 offset:18944
    buffer_store_dwordx4 v[60:63], v227, s[40:43], s46 offen offset:3072 sc1
    v_mfma_f32_32x32x16_bf16 v[16:31], v[140:143], a[84:87], v[16:31]
    ds_read_b64_tr_b16 v[140:141], v97 offset:18432
    ds_read_b64_tr_b16 v[142:143], v97 offset:18944
    s_waitcnt lgkmcnt(12)
    v_mfma_f32_32x32x16_bf16 v[0:15], v[144:147], a[88:91], v[0:15]
    ds_read_b64_tr_b16 v[144:145], v96 offset:20480
    ds_read_b64_tr_b16 v[146:147], v96 offset:20992
    v_mfma_f32_32x32x16_bf16 v[16:31], v[148:151], a[88:91], v[16:31]
    ds_read_b64_tr_b16 v[148:149], v97 offset:20480
    ds_read_b64_tr_b16 v[150:151], v97 offset:20992
    s_waitcnt lgkmcnt(12)
    v_mfma_f32_32x32x16_bf16 v[0:15], v[152:155], a[92:95], v[0:15]
    ds_read_b64_tr_b16 v[152:153], v96 offset:22528
    ds_read_b64_tr_b16 v[154:155], v96 offset:23040
    s_mov_b32 s36, s32
    v_mfma_f32_32x32x16_bf16 v[16:31], v[156:159], a[92:95], v[16:31]
    ds_read_b64_tr_b16 v[156:157], v97 offset:22528
    ds_read_b64_tr_b16 v[158:159], v97 offset:23040
    s_mov_b32 s37, s33
    s_waitcnt lgkmcnt(12)
    s_barrier
    v_mfma_f32_32x32x16_bf16 v[0:15], v[128:131], a[96:99], v[0:15]
    ds_read_b64_tr_b16 v[128:129], v96 offset:24576
    ds_read_b64_tr_b16 v[130:131], v96 offset:25088
    s_mov_b32 s38, 4194304
    v_mfma_f32_32x32x16_bf16 v[16:31], v[132:135], a[96:99], v[16:31]
    ds_read_b64_tr_b16 v[132:133], v97 offset:24576
    ds_read_b64_tr_b16 v[134:135], v97 offset:25088
    s_mov_b32 s39, 0x20000
    s_waitcnt lgkmcnt(12)
    v_mfma_f32_32x32x16_bf16 v[0:15], v[136:139], a[100:103], v[0:15]
    ds_read_b64_tr_b16 v[136:137], v96 offset:26624
    ds_read_b64_tr_b16 v[138:139], v96 offset:27136
    v_and_b32 v248, 31, v235
    v_mfma_f32_32x32x16_bf16 v[16:31], v[140:143], a[100:103], v[16:31]
    ds_read_b64_tr_b16 v[140:141], v97 offset:26624
    ds_read_b64_tr_b16 v[142:143], v97 offset:27136
    v_lshlrev_b32 v248, 11, v248
    s_waitcnt lgkmcnt(12)
    v_mfma_f32_32x32x16_bf16 v[0:15], v[144:147], a[104:107], v[0:15]
    ds_read_b64_tr_b16 v[144:145], v96 offset:28672
    ds_read_b64_tr_b16 v[146:147], v96 offset:29184
    v_lshrrev_b32 v245, 5, v235
    v_mfma_f32_32x32x16_bf16 v[16:31], v[148:151], a[104:107], v[16:31]
    ds_read_b64_tr_b16 v[148:149], v97 offset:28672
    ds_read_b64_tr_b16 v[150:151], v97 offset:29184
    v_lshl_add_u32 v248, v245, 4, v248
    s_waitcnt lgkmcnt(12)
    v_mfma_f32_32x32x16_bf16 v[0:15], v[152:155], a[108:111], v[0:15]
    ds_read_b64_tr_b16 v[152:153], v96 offset:30720
    ds_read_b64_tr_b16 v[154:155], v96 offset:31232
    s_lshl_b32 s48, s53, 7
    v_mfma_f32_32x32x16_bf16 v[16:31], v[156:159], a[108:111], v[16:31]
    ds_read_b64_tr_b16 v[156:157], v97 offset:30720
    ds_read_b64_tr_b16 v[158:159], v97 offset:31232
    s_add_u32 s47, s49, s48
    s_waitcnt lgkmcnt(12)
    v_mfma_f32_32x32x16_bf16 v[0:15], v[128:131], a[112:115], v[0:15]
    ds_read_b64_tr_b16 v[128:129], v96 offset:32768
    ds_read_b64_tr_b16 v[130:131], v96 offset:33280
    v_mfma_f32_32x32x16_bf16 v[16:31], v[132:135], a[112:115], v[16:31]
    ds_read_b64_tr_b16 v[132:133], v97 offset:32768
    ds_read_b64_tr_b16 v[134:135], v97 offset:33280
    s_waitcnt lgkmcnt(12)
    v_mfma_f32_32x32x16_bf16 v[0:15], v[136:139], a[116:119], v[0:15]
    ds_read_b64_tr_b16 v[136:137], v96 offset:34816
    ds_read_b64_tr_b16 v[138:139], v96 offset:35328
    v_mfma_f32_32x32x16_bf16 v[16:31], v[140:143], a[116:119], v[16:31]
    ds_read_b64_tr_b16 v[140:141], v97 offset:34816
    ds_read_b64_tr_b16 v[142:143], v97 offset:35328
    s_waitcnt lgkmcnt(12)
    v_mfma_f32_32x32x16_bf16 v[0:15], v[144:147], a[120:123], v[0:15]
    ds_read_b64_tr_b16 v[144:145], v96 offset:36864
    ds_read_b64_tr_b16 v[146:147], v96 offset:37376
    v_mfma_f32_32x32x16_bf16 v[16:31], v[148:151], a[120:123], v[16:31]
    ds_read_b64_tr_b16 v[148:149], v97 offset:36864
    ds_read_b64_tr_b16 v[150:151], v97 offset:37376
    s_waitcnt lgkmcnt(12)
    v_mfma_f32_32x32x16_bf16 v[0:15], v[152:155], a[124:127], v[0:15]
    ds_read_b64_tr_b16 v[152:153], v96 offset:38912
    ds_read_b64_tr_b16 v[154:155], v96 offset:39424
    v_mfma_f32_32x32x16_bf16 v[16:31], v[156:159], a[124:127], v[16:31]
    ds_read_b64_tr_b16 v[156:157], v97 offset:38912
    ds_read_b64_tr_b16 v[158:159], v97 offset:39424
    s_waitcnt lgkmcnt(12)
    s_barrier
    v_mfma_f32_32x32x16_bf16 v[0:15], v[128:131], a[128:131], v[0:15]
    ds_read_b64_tr_b16 v[128:129], v96 offset:40960
    ds_read_b64_tr_b16 v[130:131], v96 offset:41472
    v_mfma_f32_32x32x16_bf16 v[16:31], v[132:135], a[128:131], v[16:31]
    ds_read_b64_tr_b16 v[132:133], v97 offset:40960
    ds_read_b64_tr_b16 v[134:135], v97 offset:41472
    s_waitcnt lgkmcnt(12)
    v_mfma_f32_32x32x16_bf16 v[0:15], v[136:139], a[132:135], v[0:15]
    ds_read_b64_tr_b16 v[136:137], v96 offset:43008
    ds_read_b64_tr_b16 v[138:139], v96 offset:43520
    v_mfma_f32_32x32x16_bf16 v[16:31], v[140:143], a[132:135], v[16:31]
    ds_read_b64_tr_b16 v[140:141], v97 offset:43008
    ds_read_b64_tr_b16 v[142:143], v97 offset:43520
    s_waitcnt lgkmcnt(12)
    v_mfma_f32_32x32x16_bf16 v[0:15], v[144:147], a[136:139], v[0:15]
    ds_read_b64_tr_b16 v[144:145], v96 offset:45056
    ds_read_b64_tr_b16 v[146:147], v96 offset:45568
    v_mfma_f32_32x32x16_bf16 v[16:31], v[148:151], a[136:139], v[16:31]
    ds_read_b64_tr_b16 v[148:149], v97 offset:45056
    ds_read_b64_tr_b16 v[150:151], v97 offset:45568
    s_waitcnt lgkmcnt(12)
    v_mfma_f32_32x32x16_bf16 v[0:15], v[152:155], a[140:143], v[0:15]
    ds_read_b64_tr_b16 v[152:153], v96 offset:47104
    ds_read_b64_tr_b16 v[154:155], v96 offset:47616
    v_mfma_f32_32x32x16_bf16 v[16:31], v[156:159], a[140:143], v[16:31]
    ds_read_b64_tr_b16 v[156:157], v97 offset:47104
    ds_read_b64_tr_b16 v[158:159], v97 offset:47616
    s_waitcnt lgkmcnt(12)
    v_mfma_f32_32x32x16_bf16 v[0:15], v[128:131], a[144:147], v[0:15]
    ds_read_b64_tr_b16 v[128:129], v96 offset:49152
    ds_read_b64_tr_b16 v[130:131], v96 offset:49664
    v_mfma_f32_32x32x16_bf16 v[16:31], v[132:135], a[144:147], v[16:31]
    ds_read_b64_tr_b16 v[132:133], v97 offset:49152
    ds_read_b64_tr_b16 v[134:135], v97 offset:49664
    s_waitcnt lgkmcnt(12)
    v_mfma_f32_32x32x16_bf16 v[0:15], v[136:139], a[148:151], v[0:15]
    ds_read_b64_tr_b16 v[136:137], v96 offset:51200
    ds_read_b64_tr_b16 v[138:139], v96 offset:51712
    v_mfma_f32_32x32x16_bf16 v[16:31], v[140:143], a[148:151], v[16:31]
    ds_read_b64_tr_b16 v[140:141], v97 offset:51200
    ds_read_b64_tr_b16 v[142:143], v97 offset:51712
    s_waitcnt lgkmcnt(12)
    v_mfma_f32_32x32x16_bf16 v[0:15], v[144:147], a[152:155], v[0:15]
    ds_read_b64_tr_b16 v[144:145], v96 offset:53248
    ds_read_b64_tr_b16 v[146:147], v96 offset:53760
    v_mfma_f32_32x32x16_bf16 v[16:31], v[148:151], a[152:155], v[16:31]
    ds_read_b64_tr_b16 v[148:149], v97 offset:53248
    ds_read_b64_tr_b16 v[150:151], v97 offset:53760
    s_waitcnt lgkmcnt(12)
    v_mfma_f32_32x32x16_bf16 v[0:15], v[152:155], a[156:159], v[0:15]
    ds_read_b64_tr_b16 v[152:153], v96 offset:55296
    ds_read_b64_tr_b16 v[154:155], v96 offset:55808
    v_mfma_f32_32x32x16_bf16 v[16:31], v[156:159], a[156:159], v[16:31]
    ds_read_b64_tr_b16 v[156:157], v97 offset:55296
    ds_read_b64_tr_b16 v[158:159], v97 offset:55808
    s_waitcnt vmcnt(10) lgkmcnt(12)
    s_barrier
    v_mfma_f32_32x32x16_bf16 v[0:15], v[128:131], a[160:163], v[0:15]
    ds_read_b64_tr_b16 v[128:129], v96 offset:57344
    ds_read_b64_tr_b16 v[130:131], v96 offset:57856
    v_mfma_f32_32x32x16_bf16 v[16:31], v[132:135], a[160:163], v[16:31]
    ds_read_b64_tr_b16 v[132:133], v97 offset:57344
    ds_read_b64_tr_b16 v[134:135], v97 offset:57856
    s_waitcnt lgkmcnt(12)
    v_mfma_f32_32x32x16_bf16 v[0:15], v[136:139], a[164:167], v[0:15]
    ds_read_b64_tr_b16 v[136:137], v96 offset:59392
    ds_read_b64_tr_b16 v[138:139], v96 offset:59904
    buffer_load_dwordx4 v[64:67], v226, s[40:43], s50 offen offset:0 sc1
    v_mfma_f32_32x32x16_bf16 v[16:31], v[140:143], a[164:167], v[16:31]
    ds_read_b64_tr_b16 v[140:141], v97 offset:59392
    ds_read_b64_tr_b16 v[142:143], v97 offset:59904
    buffer_load_dwordx4 v[68:71], v226, s[40:43], s50 offen offset:1024 sc1
    s_waitcnt lgkmcnt(12)
    v_mfma_f32_32x32x16_bf16 v[0:15], v[144:147], a[168:171], v[0:15]
    ds_read_b64_tr_b16 v[144:145], v96 offset:61440
    ds_read_b64_tr_b16 v[146:147], v96 offset:61952
    buffer_load_dwordx4 v[72:75], v226, s[40:43], s50 offen offset:2048 sc1
    v_mfma_f32_32x32x16_bf16 v[16:31], v[148:151], a[168:171], v[16:31]
    ds_read_b64_tr_b16 v[148:149], v97 offset:61440
    ds_read_b64_tr_b16 v[150:151], v97 offset:61952
    buffer_load_dwordx4 v[76:79], v226, s[40:43], s50 offen offset:3072 sc1
    s_waitcnt lgkmcnt(12)
    v_mfma_f32_32x32x16_bf16 v[0:15], v[152:155], a[172:175], v[0:15]
    ds_read_b64_tr_b16 v[152:153], v96 offset:63488
    ds_read_b64_tr_b16 v[154:155], v96 offset:64000
    buffer_load_dwordx4 v[80:83], v227, s[40:43], s50 offen offset:0 sc1
    v_mfma_f32_32x32x16_bf16 v[16:31], v[156:159], a[172:175], v[16:31]
    ds_read_b64_tr_b16 v[156:157], v97 offset:63488
    ds_read_b64_tr_b16 v[158:159], v97 offset:64000
    buffer_load_dwordx4 v[84:87], v227, s[40:43], s50 offen offset:1024 sc1
    s_waitcnt lgkmcnt(12)
    v_mfma_f32_32x32x16_bf16 v[0:15], v[128:131], a[176:179], v[0:15]
    ds_read_b64_tr_b16 v[128:129], v98 offset:0
    ds_read_b64_tr_b16 v[130:131], v98 offset:512
    buffer_load_dwordx4 v[88:91], v227, s[40:43], s50 offen offset:2048 sc1
    v_mfma_f32_32x32x16_bf16 v[16:31], v[132:135], a[176:179], v[16:31]
    ds_read_b64_tr_b16 v[132:133], v99 offset:0
    ds_read_b64_tr_b16 v[134:135], v99 offset:512
    buffer_load_dwordx4 v[92:95], v227, s[40:43], s50 offen offset:3072 sc1
    s_waitcnt lgkmcnt(12)
    v_mfma_f32_32x32x16_bf16 v[0:15], v[136:139], a[180:183], v[0:15]
    ds_read_b64_tr_b16 v[136:137], v98 offset:2048
    ds_read_b64_tr_b16 v[138:139], v98 offset:2560
    v_mfma_f32_32x32x16_bf16 v[16:31], v[140:143], a[180:183], v[16:31]
    ds_read_b64_tr_b16 v[140:141], v99 offset:2048
    ds_read_b64_tr_b16 v[142:143], v99 offset:2560
    s_waitcnt lgkmcnt(12)
    v_mfma_f32_32x32x16_bf16 v[0:15], v[144:147], a[184:187], v[0:15]
    ds_read_b64_tr_b16 v[144:145], v98 offset:4096
    ds_read_b64_tr_b16 v[146:147], v98 offset:4608
    v_mfma_f32_32x32x16_bf16 v[16:31], v[148:151], a[184:187], v[16:31]
    ds_read_b64_tr_b16 v[148:149], v99 offset:4096
    ds_read_b64_tr_b16 v[150:151], v99 offset:4608
    s_waitcnt lgkmcnt(12)
    v_mfma_f32_32x32x16_bf16 v[0:15], v[152:155], a[188:191], v[0:15]
    ds_read_b64_tr_b16 v[152:153], v98 offset:6144
    ds_read_b64_tr_b16 v[154:155], v98 offset:6656
    v_mfma_f32_32x32x16_bf16 v[16:31], v[156:159], a[188:191], v[16:31]
    ds_read_b64_tr_b16 v[156:157], v99 offset:6144
    ds_read_b64_tr_b16 v[158:159], v99 offset:6656
    s_waitcnt vmcnt(16) lgkmcnt(12)
    s_barrier
    v_mfma_f32_32x32x16_bf16 v[0:15], v[128:131], a[192:195], v[0:15]
    ds_read_b64_tr_b16 v[128:129], v98 offset:8192
    ds_read_b64_tr_b16 v[130:131], v98 offset:8704
    v_mfma_f32_32x32x16_bf16 v[16:31], v[132:135], a[192:195], v[16:31]
    ds_read_b64_tr_b16 v[132:133], v99 offset:8192
    ds_read_b64_tr_b16 v[134:135], v99 offset:8704
    s_waitcnt lgkmcnt(12)
    v_mfma_f32_32x32x16_bf16 v[0:15], v[136:139], a[196:199], v[0:15]
    ds_read_b64_tr_b16 v[136:137], v98 offset:10240
    ds_read_b64_tr_b16 v[138:139], v98 offset:10752
    v_mfma_f32_32x32x16_bf16 v[16:31], v[140:143], a[196:199], v[16:31]
    ds_read_b64_tr_b16 v[140:141], v99 offset:10240
    ds_read_b64_tr_b16 v[142:143], v99 offset:10752
    s_waitcnt lgkmcnt(12)
    v_mfma_f32_32x32x16_bf16 v[0:15], v[144:147], a[200:203], v[0:15]
    ds_read_b64_tr_b16 v[144:145], v98 offset:12288
    ds_read_b64_tr_b16 v[146:147], v98 offset:12800
    v_mfma_f32_32x32x16_bf16 v[16:31], v[148:151], a[200:203], v[16:31]
    ds_read_b64_tr_b16 v[148:149], v99 offset:12288
    ds_read_b64_tr_b16 v[150:151], v99 offset:12800
    s_waitcnt lgkmcnt(12)
    v_mfma_f32_32x32x16_bf16 v[0:15], v[152:155], a[204:207], v[0:15]
    ds_read_b64_tr_b16 v[152:153], v98 offset:14336
    ds_read_b64_tr_b16 v[154:155], v98 offset:14848
    v_mfma_f32_32x32x16_bf16 v[16:31], v[156:159], a[204:207], v[16:31]
    ds_read_b64_tr_b16 v[156:157], v99 offset:14336
    ds_read_b64_tr_b16 v[158:159], v99 offset:14848
    s_waitcnt lgkmcnt(12)
    v_mfma_f32_32x32x16_bf16 v[0:15], v[128:131], a[208:211], v[0:15]
    v_mfma_f32_32x32x16_bf16 v[16:31], v[132:135], a[208:211], v[16:31]
    s_waitcnt lgkmcnt(8)
    v_mfma_f32_32x32x16_bf16 v[0:15], v[136:139], a[212:215], v[0:15]
    v_mfma_f32_32x32x16_bf16 v[16:31], v[140:143], a[212:215], v[16:31]
    s_waitcnt vmcnt(0)
    v_max3_u32 v244, v64, v65, v66
    v_max3_u32 v244, v244, v67, v68
    v_max3_u32 v244, v244, v69, v70
    v_max3_u32 v244, v244, v71, v72
    s_waitcnt lgkmcnt(4)
    v_mfma_f32_32x32x16_bf16 v[0:15], v[144:147], a[216:219], v[0:15]
    v_max3_u32 v244, v244, v73, v74
    v_max3_u32 v244, v244, v75, v76
    v_max3_u32 v244, v244, v77, v78
    v_max3_u32 v244, v244, v79, v80
    v_mfma_f32_32x32x16_bf16 v[16:31], v[148:151], a[216:219], v[16:31]
    v_max3_u32 v244, v244, v81, v82
    v_max3_u32 v244, v244, v83, v84
    v_max3_u32 v244, v244, v85, v86
    v_max3_u32 v244, v244, v87, v88
    s_waitcnt lgkmcnt(0)
    v_mfma_f32_32x32x16_bf16 v[0:15], v[152:155], a[220:223], v[0:15]
    v_max3_u32 v244, v244, v89, v90
    v_max3_u32 v244, v244, v91, v92
    v_max3_u32 v244, v244, v93, v94
    v_max_u32 v244, v244, v95
    v_mfma_f32_32x32x16_bf16 v[16:31], v[156:159], a[220:223], v[16:31]
    v_cmp_eq_u32 vcc, -1, v244
    s_nop 1
    s_cmp_eq_u64 vcc, 0
    s_cbranch_scc0 mlp_kernel_xslow
mlp_kernel_xgo:
    s_nop 7
    v_pk_add_f32 v[0:1], v[0:1], v[64:65]
    v_cvt_pk_bf16_f32 v176, v0, v1
    v_pk_add_f32 v[2:3], v[2:3], v[66:67]
    v_cvt_pk_bf16_f32 v177, v2, v3
    v_pk_add_f32 v[4:5], v[4:5], v[68:69]
    v_cvt_pk_bf16_f32 v178, v4, v5
    v_pk_add_f32 v[6:7], v[6:7], v[70:71]
    v_cvt_pk_bf16_f32 v179, v6, v7
    s_nop 1
    v_permlane32_swap_b32 v176, v178
    v_permlane32_swap_b32 v177, v179
    buffer_store_dwordx4 v[176:179], v248, s[36:39], s47 offen offset:0
    v_pk_add_f32 v[8:9], v[8:9], v[72:73]
    v_cvt_pk_bf16_f32 v180, v8, v9
    v_pk_add_f32 v[10:11], v[10:11], v[74:75]
    v_cvt_pk_bf16_f32 v181, v10, v11
    v_pk_add_f32 v[12:13], v[12:13], v[76:77]
    v_cvt_pk_bf16_f32 v182, v12, v13
    v_pk_add_f32 v[14:15], v[14:15], v[78:79]
    v_cvt_pk_bf16_f32 v183, v14, v15
    s_nop 1
    v_permlane32_swap_b32 v180, v182
    v_permlane32_swap_b32 v181, v183
    buffer_store_dwordx4 v[180:183], v248, s[36:39], s47 offen offset:32
    v_pk_add_f32 v[16:17], v[16:17], v[80:81]
    v_cvt_pk_bf16_f32 v184, v16, v17
    v_pk_add_f32 v[18:19], v[18:19], v[82:83]
    v_cvt_pk_bf16_f32 v185, v18, v19
    v_pk_add_f32 v[20:21], v[20:21], v[84:85]
    v_cvt_pk_bf16_f32 v186, v20, v21
    v_pk_add_f32 v[22:23], v[22:23], v[86:87]
    v_cvt_pk_bf16_f32 v187, v22, v23
    s_nop 1
    v_permlane32_swap_b32 v184, v186
    v_permlane32_swap_b32 v185, v187
    buffer_store_dwordx4 v[184:187], v248, s[36:39], s47 offen offset:64
    v_pk_add_f32 v[24:25], v[24:25], v[88:89]
    v_cvt_pk_bf16_f32 v188, v24, v25
    v_pk_add_f32 v[26:27], v[26:27], v[90:91]
    v_cvt_pk_bf16_f32 v189, v26, v27
    v_pk_add_f32 v[28:29], v[28:29], v[92:93]
    v_cvt_pk_bf16_f32 v190, v28, v29
    v_pk_add_f32 v[30:31], v[30:31], v[94:95]
    v_cvt_pk_bf16_f32 v191, v30, v31
    s_nop 1
    v_permlane32_swap_b32 v188, v190
    v_permlane32_swap_b32 v189, v191
    buffer_store_dwordx4 v[188:191], v248, s[36:39], s47 offen offset:96
mlp_kernel_done:
    s_endpgm
mlp_kernel_pollB_slow:
    buffer_load_dword v248, v244, s[12:15], s47 offen sc1
    s_mov_b32 s51, 0x40000
mlp_kernel_pollB:
    s_waitcnt vmcnt(0)
    v_cmp_eq_u32 vcc, 1, v248
    s_nop 1
    s_cmp_eq_u64 vcc, -1
    s_cbranch_scc1 mlp_kernel_pollB_ok
    s_sleep 2
    buffer_load_dword v248, v244, s[12:15], s47 offen sc1
    s_sub_u32 s51, s51, 1
    s_cmp_lg_u32 s51, 0
    s_cbranch_scc1 mlp_kernel_pollB
mlp_kernel_pollB_ok:
    s_branch mlp_kernel_pollB_go
mlp_kernel_pollA_slow:
    buffer_load_dword v248, v244, s[12:15], s47 offen sc1
    s_mov_b32 s51, 0x40000
mlp_kernel_pollA:
    s_waitcnt vmcnt(0)
    v_cmp_eq_u32 vcc, 1, v248
    s_nop 1
    s_cmp_eq_u64 vcc, -1
    s_cbranch_scc1 mlp_kernel_pollA_ok
    s_sleep 2
    buffer_load_dword v248, v244, s[12:15], s47 offen sc1
    s_sub_u32 s51, s51, 1
    s_cmp_lg_u32 s51, 0
    s_cbranch_scc1 mlp_kernel_pollA
mlp_kernel_pollA_ok:
    s_branch mlp_kernel_pollA_go
mlp_kernel_xslow:
    buffer_load_dwordx4 v[64:67], v226, s[40:43], s50 offen offset:0 sc1
    buffer_load_dwordx4 v[68:71], v226, s[40:43], s50 offen offset:1024 sc1
    buffer_load_dwordx4 v[72:75], v226, s[40:43], s50 offen offset:2048 sc1
    buffer_load_dwordx4 v[76:79], v226, s[40:43], s50 offen offset:3072 sc1
    buffer_load_dwordx4 v[80:83], v227, s[40:43], s50 offen offset:0 sc1
    buffer_load_dwordx4 v[84:87], v227, s[40:43], s50 offen offset:1024 sc1
    buffer_load_dwordx4 v[88:91], v227, s[40:43], s50 offen offset:2048 sc1
    buffer_load_dwordx4 v[92:95], v227, s[40:43], s50 offen offset:3072 sc1
    s_mov_b32 s51, 0x40000
mlp_kernel_xspin:
    s_waitcnt vmcnt(0)
    v_max3_u32 v244, v64, v65, v66
    v_max3_u32 v244, v244, v67, v68
    v_max3_u32 v244, v244, v69, v70
    v_max3_u32 v244, v244, v71, v72
    v_max3_u32 v244, v244, v73, v74
    v_max3_u32 v244, v244, v75, v76
    v_max3_u32 v244, v244, v77, v78
    v_max3_u32 v244, v244, v79, v80
    v_max3_u32 v244, v244, v81, v82
    v_max3_u32 v244, v244, v83, v84
    v_max3_u32 v244, v244, v85, v86
    v_max3_u32 v244, v244, v87, v88
    v_max3_u32 v244, v244, v89, v90
    v_max3_u32 v244, v244, v91, v92
    v_max3_u32 v244, v244, v93, v94
    v_max_u32 v244, v244, v95
    v_cmp_eq_u32 vcc, -1, v244
    s_nop 1
    s_cmp_eq_u64 vcc, 0
    s_cbranch_scc1 mlp_kernel_xspin_ok
    s_sleep 2
    buffer_load_dwordx4 v[64:67], v226, s[40:43], s50 offen offset:0 sc1
    buffer_load_dwordx4 v[68:71], v226, s[40:43], s50 offen offset:1024 sc1
    buffer_load_dwordx4 v[72:75], v226, s[40:43], s50 offen offset:2048 sc1
    buffer_load_dwordx4 v[76:79], v226, s[40:43], s50 offen offset:3072 sc1
    buffer_load_dwordx4 v[80:83], v227, s[40:43], s50 offen offset:0 sc1
    buffer_load_dwordx4 v[84:87], v227, s[40:43], s50 offen offset:1024 sc1
    buffer_load_dwordx4 v[88:91], v227, s[40:43], s50 offen offset:2048 sc1
    buffer_load_dwordx4 v[92:95], v227, s[40:43], s50 offen offset:3072 sc1
    s_sub_u32 s51, s51, 1
    s_cmp_lg_u32 s51, 0
    s_cbranch_scc1 mlp_kernel_xspin
mlp_kernel_xspin_ok:
    s_branch mlp_kernel_xgo
mlp_kernel_end:
.section .rodata,"a"
.p2align 6
.amdhsa_kernel qkv_kernel
  .amdhsa_next_free_vgpr 220
  .amdhsa_next_free_sgpr 96
  .amdhsa_accum_offset 220
  .amdhsa_group_segment_fixed_size 0
  .amdhsa_kernarg_size 80
  .amdhsa_user_sgpr_count 2
  .amdhsa_user_sgpr_kernarg_segment_ptr 1
  .amdhsa_system_sgpr_workgroup_id_x 1
.end_amdhsa_kernel
.p2align 6
.amdhsa_kernel attn_kernel
  .amdhsa_next_free_vgpr 160
  .amdhsa_next_free_sgpr 96
  .amdhsa_accum_offset 160
  .amdhsa_group_segment_fixed_size 0
  .amdhsa_kernarg_size 80
  .amdhsa_user_sgpr_count 2
  .amdhsa_user_sgpr_kernarg_segment_ptr 1
  .amdhsa_system_sgpr_workgroup_id_x 1
.end_amdhsa_kernel
.p2align 6
.amdhsa_kernel mlp_kernel
  .amdhsa_next_free_vgpr 476
  .amdhsa_next_free_sgpr 96
  .amdhsa_accum_offset 252
  .amdhsa_group_segment_fixed_size 0
  .amdhsa_kernarg_size 80
  .amdhsa_user_sgpr_count 2
  .amdhsa_user_sgpr_kernarg_segment_ptr 1
  .amdhsa_system_sgpr_workgroup_id_x 1
.end_amdhsa_kernel
```
